```python
import torch

def _softmax(x, axis=-1):
    return torch.softmax(x, dim=axis)

def _gelu(x):
    return torch.nn.functional.gelu(x, approximate='tanh')

def _silu(x):
    return torch.nn.functional.silu(x)

def _sigmoid(x):
    return torch.sigmoid(x)

def _layernorm(x, axis=-1, eps=1e-05):
    m = x.mean(dim=axis, keepdim=True)
    v = x.var(dim=axis, keepdim=True, unbiased=False)
    return (x - m) / torch.sqrt(v + eps)

def _scatter_add(tgt, idx, src, axis=0):
    return tgt.clone().index_add_(axis, idx, src)

def _segment_sum(src, seg, n):
    out = torch.zeros((n,) + src.shape[1:], dtype=src.dtype)
    return out.index_add_(0, seg, src)

def _pad(x, pw):
    flat = tuple((v for pair in reversed(pw) for v in pair))
    return torch.nn.functional.pad(x, flat)
kernel_name = 'adaLN_cond__memory_aug_recurrent_mem_tr__dense_activation_mish__prompt'

def setup_inputs():

    _w = lambda a: (lambda t: t.to(torch.bfloat16) if t.is_floating_point() else t)(torch.as_tensor(a))

    def _A_setup():
        B, S, Dm = (1, 2048, 448)
        H, Dh = (16, 256)
        M, seg = (8, 32)
        seg = min(seg, S)
        S = S // seg * seg
        return {'x': _w((lambda *s: torch.randn(*s, dtype=torch.bfloat16) * 0.05)(B, S, Dm)), 'mem0': _w((lambda *s: torch.randn(*s, dtype=torch.bfloat16) * 0.8)(B, M, Dm)), 'Wq': _w((lambda *s: torch.randn(*s, dtype=torch.bfloat16) * 0.8)(Dm, H, Dh) * Dm ** (-0.5)), 'Wk': _w((lambda *s: torch.randn(*s, dtype=torch.bfloat16) * 0.8)(Dm, H, Dh) * Dm ** (-0.5)), 'Wv': _w((lambda *s: torch.randn(*s, dtype=torch.bfloat16) * 0.8)(Dm, H, Dh) * Dm ** (-0.5)), 'Wo': _w((lambda *s: torch.randn(*s, dtype=torch.bfloat16) * 0.8)(H, Dh, Dm) * (H * Dh) ** (-0.5)), 'seg_len': seg}
    _A_in = _A_setup()

    def _B_setup():
        B, S, D, F = (1, 2048, 448, 1792)
        return {'x': _w((lambda *s: torch.randn(*s, dtype=torch.bfloat16) * 0.05)(B, S, D)), 'w1': _w((lambda *s: torch.randn(*s, dtype=torch.bfloat16) * 0.8)(D, F) * D ** (-0.5)), 'b1': _w((lambda *s: torch.randn(*s, dtype=torch.bfloat16) * 0.2)(F)), 'w2': _w((lambda *s: torch.randn(*s, dtype=torch.bfloat16) * 0.2)(F, D) * F ** (-0.5))}
    _B_in = _B_setup()
    return {'A_x': _A_in['x'], 'A_mem0': _A_in['mem0'], 'A_Wq': _A_in['Wq'], 'A_Wk': _A_in['Wk'], 'A_Wv': _A_in['Wv'], 'A_Wo': _A_in['Wo'], 'A_seg_len': _A_in['seg_len'], 'B_x': _B_in['x'], 'B_w1': _B_in['w1'], 'B_b1': _B_in['b1'], 'B_w2': _B_in['w2'], 'c': _w((lambda *s: torch.randn(*s, dtype=torch.bfloat16) * 0.05)(1, 448) * 8.0), 'w_mod': _w((lambda *s: torch.randn(*s, dtype=torch.bfloat16) * 0.05)(448, 6 * 448) * 448 ** (-0.5) * 8.0)}

def reference(A_x, A_mem0, A_Wq, A_Wk, A_Wv, A_Wo, A_seg_len, B_x, B_w1, B_b1, B_w2, c, w_mod):

    def _A_ref(x, mem0, Wq, Wk, Wv, Wo, seg_len):
        B, S, Dm = x.shape
        H, Dh = (Wq.shape[1], Wq.shape[2])
        M = mem0.shape[1]
        scale = Dh ** (-0.5)
        n_seg = S // seg_len
        L = M + seg_len
        idx = torch.arange(L)
        mask = (idx[:, None] < M) | (idx[:, None] >= idx[None, :])
        mem = mem0
        outs = []
        for s in range(n_seg):
            xs = x[:, s * seg_len:(s + 1) * seg_len, :].clone()
            h = torch.concatenate([mem, xs], axis=1)
            q = torch.einsum('btd,dhe->bhte', h, Wq)
            k = torch.einsum('btd,dhe->bhte', h, Wk)
            v = torch.einsum('btd,dhe->bhte', h, Wv)
            scores = torch.einsum('bhqe,bhke->bhqk', q, k) * scale
            scores = torch.where(mask[None, None], scores, -1000000000.0)
            p = _softmax(scores, axis=-1)
            o = torch.einsum('bhqk,bhke->bhqe', p, v)
            o = torch.einsum('bhte,hed->btd', o, Wo)
            mem = o[:, :M, :].clone()
            outs.append(o[:, M:, :])
        return torch.concatenate(outs, axis=1)

    def _B_ref(x, w1, b1, w2):
        h = torch.einsum('bsd,df->bsf', x, w1) + b1
        sp = torch.log1p(torch.exp(-torch.abs(h))) + torch.where(h > 0, h, torch.zeros_like(h))
        act = h * torch.tanh(sp)
        return torch.einsum('bsf,fd->bsd', act, w2)
    x = A_x
    mod = (_silu(c) @ w_mod).reshape(c.shape[0], 6, 1, -1)
    sa, ca, ga, sb, cb, gb = (mod[:, 0].clone(), mod[:, 1].clone(), mod[:, 2].clone(), mod[:, 3].clone(), mod[:, 4].clone(), mod[:, 5].clone())
    h = _layernorm(x, axis=-1) * (1 + ca) + sa
    x = x + ga * _A_ref(h, A_mem0, A_Wq, A_Wk, A_Wv, A_Wo, A_seg_len)
    h = _layernorm(x, axis=-1) * (1 + cb) + sb
    x = x + gb * _B_ref(h, B_w1, B_b1, B_w2)
    return x
```

```asm
; @launch grid=(256,1,1) block=(256,1,1) lds=147456
.amdgcn_target "amdgcn-amd-amdhsa--gfx950"
.text
.globl adaLN_cond__memory_aug_recurrent_mem_tr__dense_activation_mish__prompt_kernel
.p2align 8
.type adaLN_cond__memory_aug_recurrent_mem_tr__dense_activation_mish__prompt_kernel,@function
adaLN_cond__memory_aug_recurrent_mem_tr__dense_activation_mish__prompt_kernel:
    s_cmp_ge_u32 s2, 256
    s_cbranch_scc1 L_exit
    s_load_dwordx4 s[4:7], s[0:1], 112
    s_getreg_b32 s95, hwreg(HW_REG_XCC_ID)
    s_and_b32 s95, s95, 7
    v_and_b32 v1, 63, v0
    v_lshrrev_b32 v2, 6, v0
    s_nop 0
    v_readfirstlane_b32 s20, v2
    s_waitcnt lgkmcnt(0)
    s_mov_b32 s8, s6
    s_mov_b32 s9, s7
    s_mov_b32 s10, 268435456
    s_mov_b32 s11, 0x20000
    s_mov_b32 s12, s4
    s_mov_b32 s13, s5
    s_mov_b32 s14, 256
    s_mov_b32 s15, 0x20000
    s_getpc_b64 s[98:99]
    s_and_b32 s98, s98, 0xffffff00
    s_lshr_b32 s3, s2, 3
    s_lshl_b32 s3, s3, 2
    s_add_u32 s3, s3, s20
    s_cmp_ge_u32 s3, 8
    s_cbranch_scc1 L_noct
    s_lshl_b32 s3, s3, 13
    v_lshlrev_b32 v4, 7, v1
    v_add_u32 v4, s3, v4
    global_load_dword v255, v4, s[98:99]
L_noct:
    s_or_b32 s3, s2, s20
    s_cmp_lg_u32 s3, 0
    s_cbranch_scc1 L_notag
    v_mov_b32 v4, 0
    s_mov_b32 s3, 46874624
    buffer_load_dwordx2 v[6:7], v4, s[8:11], s3 offen sc1
    s_waitcnt vmcnt(0)
    v_add_u32 v6, 2, v6
    v_or_b32 v6, 1, v6
    v_add_u32 v7, 0x9e3779b8, v7
    v_or_b32 v7, 1, v7
    s_mov_b64 exec, 1
    buffer_store_dwordx2 v[6:7], v4, s[12:15], 0 offen offset:128 sc1
    s_mov_b64 exec, -1
L_notag:
    s_load_dwordx8 s[40:47], s[0:1], 16
    s_load_dwordx4 s[48:51], s[0:1], 0
    s_load_dwordx4 s[52:55], s[0:1], 88
    v_lshlrev_b32 v2, 4, v1
    s_waitcnt lgkmcnt(0)
    s_and_b32 s3, s2, 7
    s_cmp_eq_u32 s3, 0
    s_cbranch_scc1 P_small
    s_sub_u32 s3, s3, 1
    s_lshl_b32 s3, s3, 5
    s_lshr_b32 s56, s2, 3
    s_add_u32 s56, s56, s3
    s_mul_i32 s26, s56, 293
    s_lshr_b32 s26, s26, 11
    s_mul_i32 s23, s26, 7
    s_sub_u32 s23, s56, s23
    s_lshr_b32 s21, s26, 4
    s_and_b32 s22, s26, 15
    s_and_b32 s24, s20, 1
    s_lshr_b32 s25, s20, 1
    s_cmp_eq_u32 s21, 0
    s_cselect_b32 s32, s40, s44
    s_cselect_b32 s33, s41, s45
    s_cselect_b32 s36, s42, s46
    s_cselect_b32 s37, s43, s47
    s_mov_b32 s34, 3670016
    s_mov_b32 s35, 0x20000
    s_mov_b32 s38, 3670016
    s_mov_b32 s39, 0x20000
    v_bfe_u32 v10, v1, 3, 3
    v_lshlrev_b32 v10, 13, v10
    v_bfe_u32 v3, v1, 4, 2
    v_and_b32 v11, 7, v1
    v_xor_b32 v3, v3, v11
    v_lshl_add_u32 v12, v3, 4, v10
    v_xor_b32 v3, 4, v3
    v_lshl_add_u32 v13, v3, 4, v10
    s_lshl_b32 s28, s23, 1
    s_add_u32 s28, s28, s24
    s_cmp_lg_u32 s21, 0
    s_cbranch_scc1 P_bwo
    v_lshrrev_b32 v3, 5, v0
    v_and_b32 v14, 31, v0
    v_xor_b32 v14, v14, v3
    v_lshlrev_b32 v14, 4, v14
    v_lshl_add_u32 v14, v3, 13, v14
    v_xor_b32 v15, 0x80, v14
    s_lshl_b32 s26, s23, 19
    s_lshl_b32 s27, s22, 9
    s_add_u32 s26, s26, s27
    s_lshl_b32 s27, s20, 10
    s_add_u32 s27, s27, 114688
    s_mov_b32 m0, s27
    s_add_u32 s27, s27, 4096
    buffer_load_dwordx4 v14, s[36:39], s26 offen lds
    s_add_u32 s26, s26, 65536
    s_mov_b32 m0, s27
    s_add_u32 s27, s27, 4096
    buffer_load_dwordx4 v15, s[36:39], s26 offen lds
    s_add_u32 s26, s26, 65536
    s_mov_b32 m0, s27
    s_add_u32 s27, s27, 4096
    buffer_load_dwordx4 v14, s[36:39], s26 offen lds
    s_add_u32 s26, s26, 65536
    s_mov_b32 m0, s27
    s_add_u32 s27, s27, 4096
    buffer_load_dwordx4 v15, s[36:39], s26 offen lds
    s_add_u32 s26, s26, 65536
    s_mov_b32 m0, s27
    s_add_u32 s27, s27, 4096
    buffer_load_dwordx4 v14, s[36:39], s26 offen lds
    s_add_u32 s26, s26, 65536
    s_mov_b32 m0, s27
    s_add_u32 s27, s27, 4096
    buffer_load_dwordx4 v15, s[36:39], s26 offen lds
    s_add_u32 s26, s26, 65536
    s_mov_b32 m0, s27
    s_add_u32 s27, s27, 4096
    buffer_load_dwordx4 v14, s[36:39], s26 offen lds
    s_add_u32 s26, s26, 65536
    s_mov_b32 m0, s27
    s_add_u32 s27, s27, 4096
    buffer_load_dwordx4 v15, s[36:39], s26 offen lds
    s_add_u32 s26, s26, 65536
    s_mul_i32 s27, s20, 14
    s_lshl_b32 s31, s23, 1
    s_add_u32 s27, s27, s31
    s_lshl_b32 s29, s27, 16
    s_lshl_b32 s26, s22, 9
    s_add_u32 s29, s29, s26
    s_add_u32 s29, s29, 0
    s_lshl_b32 s27, s27, 10
    s_add_u32 s27, s27, 0
    s_mov_b32 m0, s27
    s_add_u32 s27, s27, 1024
    buffer_load_dwordx4 v12, s[32:35], s29 offen lds
    s_add_u32 s29, s29, 65536
    s_mov_b32 m0, s27
    s_add_u32 s27, s27, 1024
    buffer_load_dwordx4 v13, s[32:35], s29 offen lds
    s_add_u32 s29, s29, 65536
    s_add_u32 s31, s31, 2
    s_cmp_eq_u32 s31, 14
    s_cselect_b32 s30, 14, 0
    s_lshl_b32 s57, s30, 16
    s_sub_u32 s29, s29, s57
    s_lshl_b32 s57, s30, 10
    s_sub_u32 s27, s27, s57
    s_mov_b32 m0, s27
    s_add_u32 s27, s27, 1024
    buffer_load_dwordx4 v12, s[32:35], s29 offen lds
    s_add_u32 s29, s29, 65536
    s_mov_b32 m0, s27
    s_add_u32 s27, s27, 1024
    buffer_load_dwordx4 v13, s[32:35], s29 offen lds
    s_add_u32 s29, s29, 65536
    s_add_u32 s31, s31, 2
    s_cmp_eq_u32 s31, 14
    s_cselect_b32 s30, 14, 0
    s_lshl_b32 s57, s30, 16
    s_sub_u32 s29, s29, s57
    s_lshl_b32 s57, s30, 10
    s_sub_u32 s27, s27, s57
    s_mov_b32 m0, s27
    s_add_u32 s27, s27, 1024
    buffer_load_dwordx4 v12, s[32:35], s29 offen lds
    s_add_u32 s29, s29, 65536
    s_mov_b32 m0, s27
    s_add_u32 s27, s27, 1024
    buffer_load_dwordx4 v13, s[32:35], s29 offen lds
    s_add_u32 s29, s29, 65536
    s_add_u32 s31, s31, 2
    s_cmp_eq_u32 s31, 14
    s_cselect_b32 s30, 14, 0
    s_lshl_b32 s57, s30, 16
    s_sub_u32 s29, s29, s57
    s_lshl_b32 s57, s30, 10
    s_sub_u32 s27, s27, s57
    s_mov_b32 m0, s27
    s_add_u32 s27, s27, 1024
    buffer_load_dwordx4 v12, s[32:35], s29 offen lds
    s_add_u32 s29, s29, 65536
    s_mov_b32 m0, s27
    s_add_u32 s27, s27, 1024
    buffer_load_dwordx4 v13, s[32:35], s29 offen lds
    s_add_u32 s29, s29, 65536
    s_add_u32 s31, s31, 2
    s_cmp_eq_u32 s31, 14
    s_cselect_b32 s30, 14, 0
    s_lshl_b32 s57, s30, 16
    s_sub_u32 s29, s29, s57
    s_lshl_b32 s57, s30, 10
    s_sub_u32 s27, s27, s57
    s_mov_b32 m0, s27
    s_add_u32 s27, s27, 1024
    buffer_load_dwordx4 v12, s[32:35], s29 offen lds
    s_add_u32 s29, s29, 65536
    s_mov_b32 m0, s27
    s_add_u32 s27, s27, 1024
    buffer_load_dwordx4 v13, s[32:35], s29 offen lds
    s_add_u32 s29, s29, 65536
    s_add_u32 s31, s31, 2
    s_cmp_eq_u32 s31, 14
    s_cselect_b32 s30, 14, 0
    s_lshl_b32 s57, s30, 16
    s_sub_u32 s29, s29, s57
    s_lshl_b32 s57, s30, 10
    s_sub_u32 s27, s27, s57
    s_mov_b32 m0, s27
    s_add_u32 s27, s27, 1024
    buffer_load_dwordx4 v12, s[32:35], s29 offen lds
    s_add_u32 s29, s29, 65536
    s_mov_b32 m0, s27
    s_add_u32 s27, s27, 1024
    buffer_load_dwordx4 v13, s[32:35], s29 offen lds
    s_add_u32 s29, s29, 65536
    s_add_u32 s31, s31, 2
    s_cmp_eq_u32 s31, 14
    s_cselect_b32 s30, 14, 0
    s_lshl_b32 s57, s30, 16
    s_sub_u32 s29, s29, s57
    s_lshl_b32 s57, s30, 10
    s_sub_u32 s27, s27, s57
    s_mov_b32 m0, s27
    s_add_u32 s27, s27, 1024
    buffer_load_dwordx4 v12, s[32:35], s29 offen lds
    s_add_u32 s29, s29, 65536
    s_mov_b32 m0, s27
    s_add_u32 s27, s27, 1024
    buffer_load_dwordx4 v13, s[32:35], s29 offen lds
    s_add_u32 s29, s29, 65536
    s_mul_i32 s27, s20, 14
    s_lshl_b32 s31, s23, 1
    s_add_u32 s27, s27, s31
    s_lshl_b32 s29, s27, 16
    s_lshl_b32 s26, s22, 9
    s_add_u32 s29, s29, s26
    s_add_u32 s29, s29, 128
    s_lshl_b32 s27, s27, 10
    s_add_u32 s27, s27, 57344
    s_mov_b32 m0, s27
    s_add_u32 s27, s27, 1024
    buffer_load_dwordx4 v12, s[32:35], s29 offen lds
    s_add_u32 s29, s29, 65536
    s_mov_b32 m0, s27
    s_add_u32 s27, s27, 1024
    buffer_load_dwordx4 v13, s[32:35], s29 offen lds
    s_add_u32 s29, s29, 65536
    s_add_u32 s31, s31, 2
    s_cmp_eq_u32 s31, 14
    s_cselect_b32 s30, 14, 0
    s_lshl_b32 s57, s30, 16
    s_sub_u32 s29, s29, s57
    s_lshl_b32 s57, s30, 10
    s_sub_u32 s27, s27, s57
    s_mov_b32 m0, s27
    s_add_u32 s27, s27, 1024
    buffer_load_dwordx4 v12, s[32:35], s29 offen lds
    s_add_u32 s29, s29, 65536
    s_mov_b32 m0, s27
    s_add_u32 s27, s27, 1024
    buffer_load_dwordx4 v13, s[32:35], s29 offen lds
    s_add_u32 s29, s29, 65536
    s_add_u32 s31, s31, 2
    s_cmp_eq_u32 s31, 14
    s_cselect_b32 s30, 14, 0
    s_lshl_b32 s57, s30, 16
    s_sub_u32 s29, s29, s57
    s_lshl_b32 s57, s30, 10
    s_sub_u32 s27, s27, s57
    s_mov_b32 m0, s27
    s_add_u32 s27, s27, 1024
    buffer_load_dwordx4 v12, s[32:35], s29 offen lds
    s_add_u32 s29, s29, 65536
    s_mov_b32 m0, s27
    s_add_u32 s27, s27, 1024
    buffer_load_dwordx4 v13, s[32:35], s29 offen lds
    s_add_u32 s29, s29, 65536
    s_add_u32 s31, s31, 2
    s_cmp_eq_u32 s31, 14
    s_cselect_b32 s30, 14, 0
    s_lshl_b32 s57, s30, 16
    s_sub_u32 s29, s29, s57
    s_lshl_b32 s57, s30, 10
    s_sub_u32 s27, s27, s57
    s_mov_b32 m0, s27
    s_add_u32 s27, s27, 1024
    buffer_load_dwordx4 v12, s[32:35], s29 offen lds
    s_add_u32 s29, s29, 65536
    s_mov_b32 m0, s27
    s_add_u32 s27, s27, 1024
    buffer_load_dwordx4 v13, s[32:35], s29 offen lds
    s_add_u32 s29, s29, 65536
    s_add_u32 s31, s31, 2
    s_cmp_eq_u32 s31, 14
    s_cselect_b32 s30, 14, 0
    s_lshl_b32 s57, s30, 16
    s_sub_u32 s29, s29, s57
    s_lshl_b32 s57, s30, 10
    s_sub_u32 s27, s27, s57
    s_mov_b32 m0, s27
    s_add_u32 s27, s27, 1024
    buffer_load_dwordx4 v12, s[32:35], s29 offen lds
    s_add_u32 s29, s29, 65536
    s_mov_b32 m0, s27
    s_add_u32 s27, s27, 1024
    buffer_load_dwordx4 v13, s[32:35], s29 offen lds
    s_add_u32 s29, s29, 65536
    s_add_u32 s31, s31, 2
    s_cmp_eq_u32 s31, 14
    s_cselect_b32 s30, 14, 0
    s_lshl_b32 s57, s30, 16
    s_sub_u32 s29, s29, s57
    s_lshl_b32 s57, s30, 10
    s_sub_u32 s27, s27, s57
    s_mov_b32 m0, s27
    s_add_u32 s27, s27, 1024
    buffer_load_dwordx4 v12, s[32:35], s29 offen lds
    s_add_u32 s29, s29, 65536
    s_mov_b32 m0, s27
    s_add_u32 s27, s27, 1024
    buffer_load_dwordx4 v13, s[32:35], s29 offen lds
    s_add_u32 s29, s29, 65536
    s_add_u32 s31, s31, 2
    s_cmp_eq_u32 s31, 14
    s_cselect_b32 s30, 14, 0
    s_lshl_b32 s57, s30, 16
    s_sub_u32 s29, s29, s57
    s_lshl_b32 s57, s30, 10
    s_sub_u32 s27, s27, s57
    s_mov_b32 m0, s27
    s_add_u32 s27, s27, 1024
    buffer_load_dwordx4 v12, s[32:35], s29 offen lds
    s_add_u32 s29, s29, 65536
    s_mov_b32 m0, s27
    s_add_u32 s27, s27, 1024
    buffer_load_dwordx4 v13, s[32:35], s29 offen lds
    s_add_u32 s29, s29, 65536
    s_lshl_b32 s26, s23, 19
    s_lshl_b32 s27, s22, 9
    s_add_u32 s26, s26, s27
    v_lshlrev_b32 v3, 13, v1
    s_cmp_ge_u32 s20, 2
    s_cbranch_scc1 P_nt_1
    s_lshl_b32 s27, s20, 7
    s_add_u32 s26, s26, s27
    buffer_load_dword v240, v3, s[32:35], s26 offen offset:256
P_nt_1:
    v_and_b32 v3, 31, v1
    v_lshlrev_b32 v15, 9, v3
    s_lshl_b32 s26, s24, 14
    s_add_u32 s26, s26, 114688
    v_add_u32 v15, s26, v15
    v_and_b32 v3, 15, v1
    v_bfe_u32 v14, v1, 5, 1
    v_xor_b32 v14, v14, v3
    s_waitcnt vmcnt(14)
    s_barrier
    v_xor_b32 v3, 0, v14
    v_lshl_add_u32 v3, v3, 4, v15
    ds_read_b128 v[64:67], v3
    ds_read_b128 v[96:99], v3 offset:256
    v_xor_b32 v3, 2, v14
    v_lshl_add_u32 v3, v3, 4, v15
    ds_read_b128 v[68:71], v3
    ds_read_b128 v[100:103], v3 offset:256
    v_xor_b32 v3, 4, v14
    v_lshl_add_u32 v3, v3, 4, v15
    ds_read_b128 v[72:75], v3
    ds_read_b128 v[104:107], v3 offset:256
    v_xor_b32 v3, 6, v14
    v_lshl_add_u32 v3, v3, 4, v15
    ds_read_b128 v[76:79], v3
    ds_read_b128 v[108:111], v3 offset:256
    v_xor_b32 v3, 8, v14
    v_lshl_add_u32 v3, v3, 4, v15
    ds_read_b128 v[80:83], v3
    ds_read_b128 v[112:115], v3 offset:256
    v_xor_b32 v3, 10, v14
    v_lshl_add_u32 v3, v3, 4, v15
    ds_read_b128 v[84:87], v3
    ds_read_b128 v[116:119], v3 offset:256
    v_xor_b32 v3, 12, v14
    v_lshl_add_u32 v3, v3, 4, v15
    ds_read_b128 v[88:91], v3
    ds_read_b128 v[120:123], v3 offset:256
    v_xor_b32 v3, 14, v14
    v_lshl_add_u32 v3, v3, 4, v15
    ds_read_b128 v[92:95], v3
    ds_read_b128 v[124:127], v3 offset:256
    s_branch P_go
P_bwo:
    v_bfe_u32 v14, v0, 0, 3
    v_lshlrev_b32 v14, 4, v14
    v_lshrrev_b32 v3, 3, v0
    v_mul_u32_u24 v3, 896, v3
    v_add_u32 v14, v14, v3
    s_mul_i32 s26, s22, 229376
    s_lshl_b32 s27, s23, 7
    s_add_u32 s26, s26, s27
    s_lshl_b32 s27, s20, 10
    s_add_u32 s27, s27, 114688
    s_mov_b32 m0, s27
    s_add_u32 s27, s27, 4096
    buffer_load_dwordx4 v14, s[36:39], s26 offen lds
    s_add_u32 s26, s26, 28672
    s_mov_b32 m0, s27
    s_add_u32 s27, s27, 4096
    buffer_load_dwordx4 v14, s[36:39], s26 offen lds
    s_add_u32 s26, s26, 28672
    s_mov_b32 m0, s27
    s_add_u32 s27, s27, 4096
    buffer_load_dwordx4 v14, s[36:39], s26 offen lds
    s_add_u32 s26, s26, 28672
    s_mov_b32 m0, s27
    s_add_u32 s27, s27, 4096
    buffer_load_dwordx4 v14, s[36:39], s26 offen lds
    s_add_u32 s26, s26, 28672
    s_mov_b32 m0, s27
    s_add_u32 s27, s27, 4096
    buffer_load_dwordx4 v14, s[36:39], s26 offen lds
    s_add_u32 s26, s26, 28672
    s_mov_b32 m0, s27
    s_add_u32 s27, s27, 4096
    buffer_load_dwordx4 v14, s[36:39], s26 offen lds
    s_add_u32 s26, s26, 28672
    s_mov_b32 m0, s27
    s_add_u32 s27, s27, 4096
    buffer_load_dwordx4 v14, s[36:39], s26 offen lds
    s_add_u32 s26, s26, 28672
    s_mov_b32 m0, s27
    s_add_u32 s27, s27, 4096
    buffer_load_dwordx4 v14, s[36:39], s26 offen lds
    s_add_u32 s26, s26, 28672
    s_mul_i32 s27, s20, 14
    s_lshl_b32 s31, s23, 1
    s_add_u32 s27, s27, s31
    s_lshl_b32 s29, s27, 16
    s_lshl_b32 s26, s22, 9
    s_add_u32 s29, s29, s26
    s_add_u32 s29, s29, 0
    s_lshl_b32 s27, s27, 10
    s_add_u32 s27, s27, 0
    s_mov_b32 m0, s27
    s_add_u32 s27, s27, 1024
    buffer_load_dwordx4 v12, s[32:35], s29 offen lds
    s_add_u32 s29, s29, 65536
    s_mov_b32 m0, s27
    s_add_u32 s27, s27, 1024
    buffer_load_dwordx4 v13, s[32:35], s29 offen lds
    s_add_u32 s29, s29, 65536
    s_add_u32 s31, s31, 2
    s_cmp_eq_u32 s31, 14
    s_cselect_b32 s30, 14, 0
    s_lshl_b32 s57, s30, 16
    s_sub_u32 s29, s29, s57
    s_lshl_b32 s57, s30, 10
    s_sub_u32 s27, s27, s57
    s_mov_b32 m0, s27
    s_add_u32 s27, s27, 1024
    buffer_load_dwordx4 v12, s[32:35], s29 offen lds
    s_add_u32 s29, s29, 65536
    s_mov_b32 m0, s27
    s_add_u32 s27, s27, 1024
    buffer_load_dwordx4 v13, s[32:35], s29 offen lds
    s_add_u32 s29, s29, 65536
    s_add_u32 s31, s31, 2
    s_cmp_eq_u32 s31, 14
    s_cselect_b32 s30, 14, 0
    s_lshl_b32 s57, s30, 16
    s_sub_u32 s29, s29, s57
    s_lshl_b32 s57, s30, 10
    s_sub_u32 s27, s27, s57
    s_mov_b32 m0, s27
    s_add_u32 s27, s27, 1024
    buffer_load_dwordx4 v12, s[32:35], s29 offen lds
    s_add_u32 s29, s29, 65536
    s_mov_b32 m0, s27
    s_add_u32 s27, s27, 1024
    buffer_load_dwordx4 v13, s[32:35], s29 offen lds
    s_add_u32 s29, s29, 65536
    s_add_u32 s31, s31, 2
    s_cmp_eq_u32 s31, 14
    s_cselect_b32 s30, 14, 0
    s_lshl_b32 s57, s30, 16
    s_sub_u32 s29, s29, s57
    s_lshl_b32 s57, s30, 10
    s_sub_u32 s27, s27, s57
    s_mov_b32 m0, s27
    s_add_u32 s27, s27, 1024
    buffer_load_dwordx4 v12, s[32:35], s29 offen lds
    s_add_u32 s29, s29, 65536
    s_mov_b32 m0, s27
    s_add_u32 s27, s27, 1024
    buffer_load_dwordx4 v13, s[32:35], s29 offen lds
    s_add_u32 s29, s29, 65536
    s_add_u32 s31, s31, 2
    s_cmp_eq_u32 s31, 14
    s_cselect_b32 s30, 14, 0
    s_lshl_b32 s57, s30, 16
    s_sub_u32 s29, s29, s57
    s_lshl_b32 s57, s30, 10
    s_sub_u32 s27, s27, s57
    s_mov_b32 m0, s27
    s_add_u32 s27, s27, 1024
    buffer_load_dwordx4 v12, s[32:35], s29 offen lds
    s_add_u32 s29, s29, 65536
    s_mov_b32 m0, s27
    s_add_u32 s27, s27, 1024
    buffer_load_dwordx4 v13, s[32:35], s29 offen lds
    s_add_u32 s29, s29, 65536
    s_add_u32 s31, s31, 2
    s_cmp_eq_u32 s31, 14
    s_cselect_b32 s30, 14, 0
    s_lshl_b32 s57, s30, 16
    s_sub_u32 s29, s29, s57
    s_lshl_b32 s57, s30, 10
    s_sub_u32 s27, s27, s57
    s_mov_b32 m0, s27
    s_add_u32 s27, s27, 1024
    buffer_load_dwordx4 v12, s[32:35], s29 offen lds
    s_add_u32 s29, s29, 65536
    s_mov_b32 m0, s27
    s_add_u32 s27, s27, 1024
    buffer_load_dwordx4 v13, s[32:35], s29 offen lds
    s_add_u32 s29, s29, 65536
    s_add_u32 s31, s31, 2
    s_cmp_eq_u32 s31, 14
    s_cselect_b32 s30, 14, 0
    s_lshl_b32 s57, s30, 16
    s_sub_u32 s29, s29, s57
    s_lshl_b32 s57, s30, 10
    s_sub_u32 s27, s27, s57
    s_mov_b32 m0, s27
    s_add_u32 s27, s27, 1024
    buffer_load_dwordx4 v12, s[32:35], s29 offen lds
    s_add_u32 s29, s29, 65536
    s_mov_b32 m0, s27
    s_add_u32 s27, s27, 1024
    buffer_load_dwordx4 v13, s[32:35], s29 offen lds
    s_add_u32 s29, s29, 65536
    s_mul_i32 s27, s20, 14
    s_lshl_b32 s31, s23, 1
    s_add_u32 s27, s27, s31
    s_lshl_b32 s29, s27, 16
    s_lshl_b32 s26, s22, 9
    s_add_u32 s29, s29, s26
    s_add_u32 s29, s29, 128
    s_lshl_b32 s27, s27, 10
    s_add_u32 s27, s27, 57344
    s_mov_b32 m0, s27
    s_add_u32 s27, s27, 1024
    buffer_load_dwordx4 v12, s[32:35], s29 offen lds
    s_add_u32 s29, s29, 65536
    s_mov_b32 m0, s27
    s_add_u32 s27, s27, 1024
    buffer_load_dwordx4 v13, s[32:35], s29 offen lds
    s_add_u32 s29, s29, 65536
    s_add_u32 s31, s31, 2
    s_cmp_eq_u32 s31, 14
    s_cselect_b32 s30, 14, 0
    s_lshl_b32 s57, s30, 16
    s_sub_u32 s29, s29, s57
    s_lshl_b32 s57, s30, 10
    s_sub_u32 s27, s27, s57
    s_mov_b32 m0, s27
    s_add_u32 s27, s27, 1024
    buffer_load_dwordx4 v12, s[32:35], s29 offen lds
    s_add_u32 s29, s29, 65536
    s_mov_b32 m0, s27
    s_add_u32 s27, s27, 1024
    buffer_load_dwordx4 v13, s[32:35], s29 offen lds
    s_add_u32 s29, s29, 65536
    s_add_u32 s31, s31, 2
    s_cmp_eq_u32 s31, 14
    s_cselect_b32 s30, 14, 0
    s_lshl_b32 s57, s30, 16
    s_sub_u32 s29, s29, s57
    s_lshl_b32 s57, s30, 10
    s_sub_u32 s27, s27, s57
    s_mov_b32 m0, s27
    s_add_u32 s27, s27, 1024
    buffer_load_dwordx4 v12, s[32:35], s29 offen lds
    s_add_u32 s29, s29, 65536
    s_mov_b32 m0, s27
    s_add_u32 s27, s27, 1024
    buffer_load_dwordx4 v13, s[32:35], s29 offen lds
    s_add_u32 s29, s29, 65536
    s_add_u32 s31, s31, 2
    s_cmp_eq_u32 s31, 14
    s_cselect_b32 s30, 14, 0
    s_lshl_b32 s57, s30, 16
    s_sub_u32 s29, s29, s57
    s_lshl_b32 s57, s30, 10
    s_sub_u32 s27, s27, s57
    s_mov_b32 m0, s27
    s_add_u32 s27, s27, 1024
    buffer_load_dwordx4 v12, s[32:35], s29 offen lds
    s_add_u32 s29, s29, 65536
    s_mov_b32 m0, s27
    s_add_u32 s27, s27, 1024
    buffer_load_dwordx4 v13, s[32:35], s29 offen lds
    s_add_u32 s29, s29, 65536
    s_add_u32 s31, s31, 2
    s_cmp_eq_u32 s31, 14
    s_cselect_b32 s30, 14, 0
    s_lshl_b32 s57, s30, 16
    s_sub_u32 s29, s29, s57
    s_lshl_b32 s57, s30, 10
    s_sub_u32 s27, s27, s57
    s_mov_b32 m0, s27
    s_add_u32 s27, s27, 1024
    buffer_load_dwordx4 v12, s[32:35], s29 offen lds
    s_add_u32 s29, s29, 65536
    s_mov_b32 m0, s27
    s_add_u32 s27, s27, 1024
    buffer_load_dwordx4 v13, s[32:35], s29 offen lds
    s_add_u32 s29, s29, 65536
    s_add_u32 s31, s31, 2
    s_cmp_eq_u32 s31, 14
    s_cselect_b32 s30, 14, 0
    s_lshl_b32 s57, s30, 16
    s_sub_u32 s29, s29, s57
    s_lshl_b32 s57, s30, 10
    s_sub_u32 s27, s27, s57
    s_mov_b32 m0, s27
    s_add_u32 s27, s27, 1024
    buffer_load_dwordx4 v12, s[32:35], s29 offen lds
    s_add_u32 s29, s29, 65536
    s_mov_b32 m0, s27
    s_add_u32 s27, s27, 1024
    buffer_load_dwordx4 v13, s[32:35], s29 offen lds
    s_add_u32 s29, s29, 65536
    s_add_u32 s31, s31, 2
    s_cmp_eq_u32 s31, 14
    s_cselect_b32 s30, 14, 0
    s_lshl_b32 s57, s30, 16
    s_sub_u32 s29, s29, s57
    s_lshl_b32 s57, s30, 10
    s_sub_u32 s27, s27, s57
    s_mov_b32 m0, s27
    s_add_u32 s27, s27, 1024
    buffer_load_dwordx4 v12, s[32:35], s29 offen lds
    s_add_u32 s29, s29, 65536
    s_mov_b32 m0, s27
    s_add_u32 s27, s27, 1024
    buffer_load_dwordx4 v13, s[32:35], s29 offen lds
    s_add_u32 s29, s29, 65536
    s_lshl_b32 s26, s23, 19
    s_lshl_b32 s27, s22, 9
    s_add_u32 s26, s26, s27
    v_lshlrev_b32 v3, 13, v1
    s_cmp_ge_u32 s20, 2
    s_cbranch_scc1 P_nt_2
    s_lshl_b32 s27, s20, 7
    s_add_u32 s26, s26, s27
    buffer_load_dword v240, v3, s[32:35], s26 offen offset:256
P_nt_2:
    v_bfe_u32 v15, v1, 5, 1
    v_lshlrev_b32 v15, 10, v15
    v_bfe_u32 v3, v1, 2, 2
    v_lshl_add_u32 v15, v3, 7, v15
    v_bfe_u32 v3, v1, 4, 1
    v_lshl_add_u32 v15, v3, 5, v15
    v_bfe_u32 v3, v1, 0, 2
    v_lshl_add_u32 v15, v3, 3, v15
    v_add_u32 v15, 0x1c000, v15
    s_lshl_b32 s26, s24, 6
    v_add_u32 v15, s26, v15
    s_waitcnt vmcnt(14)
    s_barrier
    ds_read_b64_tr_b16 v[64:65], v15 offset:0
    ds_read_b64_tr_b16 v[66:67], v15 offset:512
    ds_read_b64_tr_b16 v[68:69], v15 offset:2048
    ds_read_b64_tr_b16 v[70:71], v15 offset:2560
    ds_read_b64_tr_b16 v[72:73], v15 offset:4096
    ds_read_b64_tr_b16 v[74:75], v15 offset:4608
    ds_read_b64_tr_b16 v[76:77], v15 offset:6144
    ds_read_b64_tr_b16 v[78:79], v15 offset:6656
    ds_read_b64_tr_b16 v[80:81], v15 offset:8192
    ds_read_b64_tr_b16 v[82:83], v15 offset:8704
    ds_read_b64_tr_b16 v[84:85], v15 offset:10240
    ds_read_b64_tr_b16 v[86:87], v15 offset:10752
    ds_read_b64_tr_b16 v[88:89], v15 offset:12288
    ds_read_b64_tr_b16 v[90:91], v15 offset:12800
    ds_read_b64_tr_b16 v[92:93], v15 offset:14336
    ds_read_b64_tr_b16 v[94:95], v15 offset:14848
    ds_read_b64_tr_b16 v[96:97], v15 offset:16384
    ds_read_b64_tr_b16 v[98:99], v15 offset:16896
    ds_read_b64_tr_b16 v[100:101], v15 offset:18432
    ds_read_b64_tr_b16 v[102:103], v15 offset:18944
    ds_read_b64_tr_b16 v[104:105], v15 offset:20480
    ds_read_b64_tr_b16 v[106:107], v15 offset:20992
    ds_read_b64_tr_b16 v[108:109], v15 offset:22528
    ds_read_b64_tr_b16 v[110:111], v15 offset:23040
    ds_read_b64_tr_b16 v[112:113], v15 offset:24576
    ds_read_b64_tr_b16 v[114:115], v15 offset:25088
    ds_read_b64_tr_b16 v[116:117], v15 offset:26624
    ds_read_b64_tr_b16 v[118:119], v15 offset:27136
    ds_read_b64_tr_b16 v[120:121], v15 offset:28672
    ds_read_b64_tr_b16 v[122:123], v15 offset:29184
    ds_read_b64_tr_b16 v[124:125], v15 offset:30720
    ds_read_b64_tr_b16 v[126:127], v15 offset:31232
P_go:
    v_bfe_u32 v16, v1, 0, 2
    v_bfe_u32 v3, v1, 2, 1
    v_lshl_add_u32 v16, v3, 3, v16
    v_bfe_u32 v3, v1, 3, 1
    v_lshl_add_u32 v16, v3, 2, v16
    v_bfe_u32 v3, v1, 4, 1
    v_lshl_add_u32 v16, v3, 4, v16
    v_bfe_u32 v17, v16, 1, 3
    v_bfe_u32 v3, v1, 5, 1
    v_xor_b32 v17, v17, v3
    s_mul_i32 s26, s25, 28672
    v_lshlrev_b32 v16, 7, v16
    v_add_u32 v16, s26, v16
    v_xor_b32 v3, 0, v17
    v_lshl_add_u32 v20, v3, 4, v16
    v_xor_b32 v3, 2, v17
    v_lshl_add_u32 v21, v3, 4, v16
    v_xor_b32 v3, 4, v17
    v_lshl_add_u32 v22, v3, 4, v16
    v_xor_b32 v3, 6, v17
    v_lshl_add_u32 v23, v3, 4, v16
    v_mov_b64 v[128:129], 0
    v_mov_b64 v[130:131], 0
    v_mov_b64 v[132:133], 0
    v_mov_b64 v[134:135], 0
    v_mov_b64 v[136:137], 0
    v_mov_b64 v[138:139], 0
    v_mov_b64 v[140:141], 0
    v_mov_b64 v[142:143], 0
    v_mov_b64 v[144:145], 0
    v_mov_b64 v[146:147], 0
    v_mov_b64 v[148:149], 0
    v_mov_b64 v[150:151], 0
    v_mov_b64 v[152:153], 0
    v_mov_b64 v[154:155], 0
    v_mov_b64 v[156:157], 0
    v_mov_b64 v[158:159], 0
    v_mov_b64 v[160:161], 0
    v_mov_b64 v[162:163], 0
    v_mov_b64 v[164:165], 0
    v_mov_b64 v[166:167], 0
    v_mov_b64 v[168:169], 0
    v_mov_b64 v[170:171], 0
    v_mov_b64 v[172:173], 0
    v_mov_b64 v[174:175], 0
    v_mov_b64 v[176:177], 0
    v_mov_b64 v[178:179], 0
    v_mov_b64 v[180:181], 0
    v_mov_b64 v[182:183], 0
    v_mov_b64 v[184:185], 0
    v_mov_b64 v[186:187], 0
    v_mov_b64 v[188:189], 0
    v_mov_b64 v[190:191], 0
    v_mov_b64 v[192:193], 0
    v_mov_b64 v[194:195], 0
    v_mov_b64 v[196:197], 0
    v_mov_b64 v[198:199], 0
    v_mov_b64 v[200:201], 0
    v_mov_b64 v[202:203], 0
    v_mov_b64 v[204:205], 0
    v_mov_b64 v[206:207], 0
    v_mov_b64 v[208:209], 0
    v_mov_b64 v[210:211], 0
    v_mov_b64 v[212:213], 0
    v_mov_b64 v[214:215], 0
    v_mov_b64 v[216:217], 0
    v_mov_b64 v[218:219], 0
    v_mov_b64 v[220:221], 0
    v_mov_b64 v[222:223], 0
    v_mov_b64 v[224:225], 0
    v_mov_b64 v[226:227], 0
    v_mov_b64 v[228:229], 0
    v_mov_b64 v[230:231], 0
    v_mov_b64 v[232:233], 0
    v_mov_b64 v[234:235], 0
    v_mov_b64 v[236:237], 0
    v_mov_b64 v[238:239], 0
    s_waitcnt lgkmcnt(0)
    v_mov_b32 v60, 0
    buffer_load_dwordx2 v[56:57], v60, s[12:15], 0 offen offset:128 sc1
    ds_read_b128 v[32:35], v20 offset:0
    ds_read_b128 v[36:39], v20 offset:4096
    ds_read_b128 v[40:43], v20 offset:8192
    ds_read_b128 v[44:47], v20 offset:12288
    s_waitcnt lgkmcnt(3)
    v_mfma_f32_32x32x16_bf16 v[128:143], v[32:35], v[64:67], v[128:143]
    ds_read_b128 v[32:35], v20 offset:16384
    s_waitcnt lgkmcnt(3)
    v_mfma_f32_32x32x16_bf16 v[144:159], v[36:39], v[64:67], v[144:159]
    ds_read_b128 v[36:39], v20 offset:20480
    s_waitcnt lgkmcnt(3)
    v_mfma_f32_32x32x16_bf16 v[160:175], v[40:43], v[64:67], v[160:175]
    ds_read_b128 v[40:43], v20 offset:24576
    s_waitcnt lgkmcnt(3)
    v_mfma_f32_32x32x16_bf16 v[176:191], v[44:47], v[64:67], v[176:191]
    ds_read_b128 v[44:47], v21 offset:0
    s_waitcnt lgkmcnt(3)
    v_mfma_f32_32x32x16_bf16 v[192:207], v[32:35], v[64:67], v[192:207]
    ds_read_b128 v[32:35], v21 offset:4096
    s_waitcnt lgkmcnt(3)
    v_mfma_f32_32x32x16_bf16 v[208:223], v[36:39], v[64:67], v[208:223]
    ds_read_b128 v[36:39], v21 offset:8192
    s_waitcnt lgkmcnt(3)
    v_mfma_f32_32x32x16_bf16 v[224:239], v[40:43], v[64:67], v[224:239]
    ds_read_b128 v[40:43], v21 offset:12288
    s_waitcnt lgkmcnt(3)
    v_mfma_f32_32x32x16_bf16 v[128:143], v[44:47], v[68:71], v[128:143]
    ds_read_b128 v[44:47], v21 offset:16384
    s_waitcnt lgkmcnt(3)
    v_mfma_f32_32x32x16_bf16 v[144:159], v[32:35], v[68:71], v[144:159]
    ds_read_b128 v[32:35], v21 offset:20480
    s_waitcnt lgkmcnt(3)
    v_mfma_f32_32x32x16_bf16 v[160:175], v[36:39], v[68:71], v[160:175]
    ds_read_b128 v[36:39], v21 offset:24576
    s_waitcnt lgkmcnt(3)
    v_mfma_f32_32x32x16_bf16 v[176:191], v[40:43], v[68:71], v[176:191]
    ds_read_b128 v[40:43], v22 offset:0
    s_waitcnt lgkmcnt(3)
    v_mfma_f32_32x32x16_bf16 v[192:207], v[44:47], v[68:71], v[192:207]
    ds_read_b128 v[44:47], v22 offset:4096
    s_waitcnt lgkmcnt(3)
    v_mfma_f32_32x32x16_bf16 v[208:223], v[32:35], v[68:71], v[208:223]
    ds_read_b128 v[32:35], v22 offset:8192
    s_waitcnt lgkmcnt(3)
    v_mfma_f32_32x32x16_bf16 v[224:239], v[36:39], v[68:71], v[224:239]
    ds_read_b128 v[36:39], v22 offset:12288
    s_waitcnt lgkmcnt(3)
    v_mfma_f32_32x32x16_bf16 v[128:143], v[40:43], v[72:75], v[128:143]
    ds_read_b128 v[40:43], v22 offset:16384
    s_waitcnt lgkmcnt(3)
    v_mfma_f32_32x32x16_bf16 v[144:159], v[44:47], v[72:75], v[144:159]
    ds_read_b128 v[44:47], v22 offset:20480
    s_waitcnt lgkmcnt(3)
    v_mfma_f32_32x32x16_bf16 v[160:175], v[32:35], v[72:75], v[160:175]
    ds_read_b128 v[32:35], v22 offset:24576
    s_waitcnt lgkmcnt(3)
    v_mfma_f32_32x32x16_bf16 v[176:191], v[36:39], v[72:75], v[176:191]
    ds_read_b128 v[36:39], v23 offset:0
    s_waitcnt lgkmcnt(3)
    v_mfma_f32_32x32x16_bf16 v[192:207], v[40:43], v[72:75], v[192:207]
    ds_read_b128 v[40:43], v23 offset:4096
    s_waitcnt lgkmcnt(3)
    v_mfma_f32_32x32x16_bf16 v[208:223], v[44:47], v[72:75], v[208:223]
    ds_read_b128 v[44:47], v23 offset:8192
    s_waitcnt lgkmcnt(3)
    v_mfma_f32_32x32x16_bf16 v[224:239], v[32:35], v[72:75], v[224:239]
    ds_read_b128 v[32:35], v23 offset:12288
    s_waitcnt lgkmcnt(3)
    v_mfma_f32_32x32x16_bf16 v[128:143], v[36:39], v[76:79], v[128:143]
    ds_read_b128 v[36:39], v23 offset:16384
    s_waitcnt lgkmcnt(3)
    v_mfma_f32_32x32x16_bf16 v[144:159], v[40:43], v[76:79], v[144:159]
    ds_read_b128 v[40:43], v23 offset:20480
    s_waitcnt lgkmcnt(3)
    v_mfma_f32_32x32x16_bf16 v[160:175], v[44:47], v[76:79], v[160:175]
    ds_read_b128 v[44:47], v23 offset:24576
    s_waitcnt lgkmcnt(3)
    v_mfma_f32_32x32x16_bf16 v[176:191], v[32:35], v[76:79], v[176:191]
    s_waitcnt lgkmcnt(2)
    v_mfma_f32_32x32x16_bf16 v[192:207], v[36:39], v[76:79], v[192:207]
    s_waitcnt lgkmcnt(1)
    v_mfma_f32_32x32x16_bf16 v[208:223], v[40:43], v[76:79], v[208:223]
    s_waitcnt lgkmcnt(0)
    v_mfma_f32_32x32x16_bf16 v[224:239], v[44:47], v[76:79], v[224:239]
    v_add_u32 v20, 57344, v20
    v_add_u32 v21, 57344, v21
    v_add_u32 v22, 57344, v22
    v_add_u32 v23, 57344, v23
    s_mov_b32 s47, 400000
    s_branch L_tag_g_c
L_tag_g:
    buffer_load_dwordx2 v[56:57], v60, s[12:15], 0 offen offset:128 sc1
L_tag_g_c:
    s_waitcnt vmcnt(0)
    v_min_u32 v59, v56, v57
    v_cmp_eq_u32 vcc, 0, v59
    s_cbranch_vccz L_tag_g_ok
    s_sub_u32 s47, s47, 1
    s_cbranch_scc0 L_tag_g
    s_branch L_fail
L_tag_g_ok:
    v_readfirstlane_b32 s96, v56
    v_readfirstlane_b32 s97, v57
    v_mov_b32 v58, s95
    s_barrier
    s_mul_i32 s27, s20, 14
    s_lshl_b32 s31, s23, 1
    s_add_u32 s27, s27, s31
    s_lshl_b32 s29, s27, 16
    s_lshl_b32 s26, s22, 9
    s_add_u32 s29, s29, s26
    s_add_u32 s29, s29, 256
    s_lshl_b32 s27, s27, 10
    s_add_u32 s27, s27, 0
    s_mov_b32 m0, s27
    s_add_u32 s27, s27, 1024
    buffer_load_dwordx4 v12, s[32:35], s29 offen lds
    s_add_u32 s29, s29, 65536
    s_mov_b32 m0, s27
    s_add_u32 s27, s27, 1024
    buffer_load_dwordx4 v13, s[32:35], s29 offen lds
    s_add_u32 s29, s29, 65536
    s_add_u32 s31, s31, 2
    s_cmp_eq_u32 s31, 14
    s_cselect_b32 s30, 14, 0
    s_lshl_b32 s57, s30, 16
    s_sub_u32 s29, s29, s57
    s_lshl_b32 s57, s30, 10
    s_sub_u32 s27, s27, s57
    s_mov_b32 m0, s27
    s_add_u32 s27, s27, 1024
    buffer_load_dwordx4 v12, s[32:35], s29 offen lds
    s_add_u32 s29, s29, 65536
    s_mov_b32 m0, s27
    s_add_u32 s27, s27, 1024
    buffer_load_dwordx4 v13, s[32:35], s29 offen lds
    s_add_u32 s29, s29, 65536
    s_add_u32 s31, s31, 2
    s_cmp_eq_u32 s31, 14
    s_cselect_b32 s30, 14, 0
    s_lshl_b32 s57, s30, 16
    s_sub_u32 s29, s29, s57
    s_lshl_b32 s57, s30, 10
    s_sub_u32 s27, s27, s57
    s_mov_b32 m0, s27
    s_add_u32 s27, s27, 1024
    buffer_load_dwordx4 v12, s[32:35], s29 offen lds
    s_add_u32 s29, s29, 65536
    s_mov_b32 m0, s27
    s_add_u32 s27, s27, 1024
    buffer_load_dwordx4 v13, s[32:35], s29 offen lds
    s_add_u32 s29, s29, 65536
    s_add_u32 s31, s31, 2
    s_cmp_eq_u32 s31, 14
    s_cselect_b32 s30, 14, 0
    s_lshl_b32 s57, s30, 16
    s_sub_u32 s29, s29, s57
    s_lshl_b32 s57, s30, 10
    s_sub_u32 s27, s27, s57
    s_mov_b32 m0, s27
    s_add_u32 s27, s27, 1024
    buffer_load_dwordx4 v12, s[32:35], s29 offen lds
    s_add_u32 s29, s29, 65536
    s_mov_b32 m0, s27
    s_add_u32 s27, s27, 1024
    buffer_load_dwordx4 v13, s[32:35], s29 offen lds
    s_add_u32 s29, s29, 65536
    s_add_u32 s31, s31, 2
    s_cmp_eq_u32 s31, 14
    s_cselect_b32 s30, 14, 0
    s_lshl_b32 s57, s30, 16
    s_sub_u32 s29, s29, s57
    s_lshl_b32 s57, s30, 10
    s_sub_u32 s27, s27, s57
    s_mov_b32 m0, s27
    s_add_u32 s27, s27, 1024
    buffer_load_dwordx4 v12, s[32:35], s29 offen lds
    s_add_u32 s29, s29, 65536
    s_mov_b32 m0, s27
    s_add_u32 s27, s27, 1024
    buffer_load_dwordx4 v13, s[32:35], s29 offen lds
    s_add_u32 s29, s29, 65536
    s_add_u32 s31, s31, 2
    s_cmp_eq_u32 s31, 14
    s_cselect_b32 s30, 14, 0
    s_lshl_b32 s57, s30, 16
    s_sub_u32 s29, s29, s57
    s_lshl_b32 s57, s30, 10
    s_sub_u32 s27, s27, s57
    s_mov_b32 m0, s27
    s_add_u32 s27, s27, 1024
    buffer_load_dwordx4 v12, s[32:35], s29 offen lds
    s_add_u32 s29, s29, 65536
    s_mov_b32 m0, s27
    s_add_u32 s27, s27, 1024
    buffer_load_dwordx4 v13, s[32:35], s29 offen lds
    s_add_u32 s29, s29, 65536
    s_add_u32 s31, s31, 2
    s_cmp_eq_u32 s31, 14
    s_cselect_b32 s30, 14, 0
    s_lshl_b32 s57, s30, 16
    s_sub_u32 s29, s29, s57
    s_lshl_b32 s57, s30, 10
    s_sub_u32 s27, s27, s57
    s_mov_b32 m0, s27
    s_add_u32 s27, s27, 1024
    buffer_load_dwordx4 v12, s[32:35], s29 offen lds
    s_add_u32 s29, s29, 65536
    s_mov_b32 m0, s27
    s_add_u32 s27, s27, 1024
    buffer_load_dwordx4 v13, s[32:35], s29 offen lds
    s_add_u32 s29, s29, 65536
    s_mov_b32 s60, s48
    s_mov_b32 s61, s49
    s_mov_b32 s62, 1835008
    s_mov_b32 s63, 0x20000
    v_lshrrev_b32 v3, 3, v0
    v_and_b32 v8, 7, v0
    v_mul_u32_u24 v9, 896, v3
    v_lshl_add_u32 v9, v8, 5, v9
    v_add_u32 v3, 768, v9
    v_cmp_gt_u32 vcc, 4, v8
    v_mov_b32 v8, 0x40000000
    s_sub_u32 s58, s56, 160
    v_cndmask_b32 v8, v8, v3, vcc
    s_mul_i32 s59, s58, 28672
    s_cmp_lt_u32 s56, 160
    s_cselect_b32 s59, 0x40000000, s59
    buffer_load_dwordx4 a[0:3], v9, s[60:63], s59 offen offset:0
    buffer_load_dwordx4 a[4:7], v9, s[60:63], s59 offen offset:16
    buffer_load_dwordx4 a[8:11], v9, s[60:63], s59 offen offset:256
    buffer_load_dwordx4 a[12:15], v9, s[60:63], s59 offen offset:272
    buffer_load_dwordx4 a[16:19], v9, s[60:63], s59 offen offset:512
    buffer_load_dwordx4 a[20:23], v9, s[60:63], s59 offen offset:528
    buffer_load_dwordx4 a[24:27], v8, s[60:63], s59 offen offset:0
    buffer_load_dwordx4 a[28:31], v8, s[60:63], s59 offen offset:16
    s_lshl_b32 s3, s2, 7
    s_add_u32 s3, s3, 46874624
    s_cmp_eq_u32 s20, 0
    s_cselect_b32 s3, s3, 0x40000000
    s_mov_b64 exec, 0xff
    buffer_store_dwordx4 v[56:59], v2, s[8:11], s3 offen sc1
    s_mov_b64 exec, -1
    s_waitcnt vmcnt(23)
    s_barrier
    ds_read_b128 v[32:35], v20 offset:0
    ds_read_b128 v[36:39], v20 offset:4096
    ds_read_b128 v[40:43], v20 offset:8192
    ds_read_b128 v[44:47], v20 offset:12288
    s_waitcnt lgkmcnt(3)
    v_mfma_f32_32x32x16_bf16 v[128:143], v[32:35], v[80:83], v[128:143]
    ds_read_b128 v[32:35], v20 offset:16384
    s_waitcnt lgkmcnt(3)
    v_mfma_f32_32x32x16_bf16 v[144:159], v[36:39], v[80:83], v[144:159]
    ds_read_b128 v[36:39], v20 offset:20480
    s_waitcnt lgkmcnt(3)
    v_mfma_f32_32x32x16_bf16 v[160:175], v[40:43], v[80:83], v[160:175]
    ds_read_b128 v[40:43], v20 offset:24576
    s_waitcnt lgkmcnt(3)
    v_mfma_f32_32x32x16_bf16 v[176:191], v[44:47], v[80:83], v[176:191]
    ds_read_b128 v[44:47], v21 offset:0
    s_waitcnt lgkmcnt(3)
    v_mfma_f32_32x32x16_bf16 v[192:207], v[32:35], v[80:83], v[192:207]
    ds_read_b128 v[32:35], v21 offset:4096
    s_waitcnt lgkmcnt(3)
    v_mfma_f32_32x32x16_bf16 v[208:223], v[36:39], v[80:83], v[208:223]
    ds_read_b128 v[36:39], v21 offset:8192
    s_waitcnt lgkmcnt(3)
    v_mfma_f32_32x32x16_bf16 v[224:239], v[40:43], v[80:83], v[224:239]
    ds_read_b128 v[40:43], v21 offset:12288
    s_waitcnt lgkmcnt(3)
    v_mfma_f32_32x32x16_bf16 v[128:143], v[44:47], v[84:87], v[128:143]
    ds_read_b128 v[44:47], v21 offset:16384
    s_waitcnt lgkmcnt(3)
    v_mfma_f32_32x32x16_bf16 v[144:159], v[32:35], v[84:87], v[144:159]
    ds_read_b128 v[32:35], v21 offset:20480
    s_waitcnt lgkmcnt(3)
    v_mfma_f32_32x32x16_bf16 v[160:175], v[36:39], v[84:87], v[160:175]
    ds_read_b128 v[36:39], v21 offset:24576
    s_waitcnt lgkmcnt(3)
    v_mfma_f32_32x32x16_bf16 v[176:191], v[40:43], v[84:87], v[176:191]
    ds_read_b128 v[40:43], v22 offset:0
    s_waitcnt lgkmcnt(3)
    v_mfma_f32_32x32x16_bf16 v[192:207], v[44:47], v[84:87], v[192:207]
    ds_read_b128 v[44:47], v22 offset:4096
    s_waitcnt lgkmcnt(3)
    v_mfma_f32_32x32x16_bf16 v[208:223], v[32:35], v[84:87], v[208:223]
    ds_read_b128 v[32:35], v22 offset:8192
    s_waitcnt lgkmcnt(3)
    v_mfma_f32_32x32x16_bf16 v[224:239], v[36:39], v[84:87], v[224:239]
    ds_read_b128 v[36:39], v22 offset:12288
    s_waitcnt lgkmcnt(3)
    v_mfma_f32_32x32x16_bf16 v[128:143], v[40:43], v[88:91], v[128:143]
    ds_read_b128 v[40:43], v22 offset:16384
    s_waitcnt lgkmcnt(3)
    v_mfma_f32_32x32x16_bf16 v[144:159], v[44:47], v[88:91], v[144:159]
    ds_read_b128 v[44:47], v22 offset:20480
    s_waitcnt lgkmcnt(3)
    v_mfma_f32_32x32x16_bf16 v[160:175], v[32:35], v[88:91], v[160:175]
    ds_read_b128 v[32:35], v22 offset:24576
    s_waitcnt lgkmcnt(3)
    v_mfma_f32_32x32x16_bf16 v[176:191], v[36:39], v[88:91], v[176:191]
    ds_read_b128 v[36:39], v23 offset:0
    s_waitcnt lgkmcnt(3)
    v_mfma_f32_32x32x16_bf16 v[192:207], v[40:43], v[88:91], v[192:207]
    ds_read_b128 v[40:43], v23 offset:4096
    s_waitcnt lgkmcnt(3)
    v_mfma_f32_32x32x16_bf16 v[208:223], v[44:47], v[88:91], v[208:223]
    ds_read_b128 v[44:47], v23 offset:8192
    s_waitcnt lgkmcnt(3)
    v_mfma_f32_32x32x16_bf16 v[224:239], v[32:35], v[88:91], v[224:239]
    ds_read_b128 v[32:35], v23 offset:12288
    s_waitcnt lgkmcnt(3)
    v_mfma_f32_32x32x16_bf16 v[128:143], v[36:39], v[92:95], v[128:143]
    ds_read_b128 v[36:39], v23 offset:16384
    s_waitcnt lgkmcnt(3)
    v_mfma_f32_32x32x16_bf16 v[144:159], v[40:43], v[92:95], v[144:159]
    ds_read_b128 v[40:43], v23 offset:20480
    s_waitcnt lgkmcnt(3)
    v_mfma_f32_32x32x16_bf16 v[160:175], v[44:47], v[92:95], v[160:175]
    ds_read_b128 v[44:47], v23 offset:24576
    s_waitcnt lgkmcnt(3)
    v_mfma_f32_32x32x16_bf16 v[176:191], v[32:35], v[92:95], v[176:191]
    s_waitcnt lgkmcnt(2)
    v_mfma_f32_32x32x16_bf16 v[192:207], v[36:39], v[92:95], v[192:207]
    s_waitcnt lgkmcnt(1)
    v_mfma_f32_32x32x16_bf16 v[208:223], v[40:43], v[92:95], v[208:223]
    s_waitcnt lgkmcnt(0)
    v_mfma_f32_32x32x16_bf16 v[224:239], v[44:47], v[92:95], v[224:239]
    v_subrev_u32 v20, 57344, v20
    v_subrev_u32 v21, 57344, v21
    v_subrev_u32 v22, 57344, v22
    v_subrev_u32 v23, 57344, v23
    s_barrier
    s_mul_i32 s27, s20, 14
    s_lshl_b32 s31, s23, 1
    s_add_u32 s27, s27, s31
    s_lshl_b32 s29, s27, 16
    s_lshl_b32 s26, s22, 9
    s_add_u32 s29, s29, s26
    s_add_u32 s29, s29, 384
    s_lshl_b32 s27, s27, 10
    s_add_u32 s27, s27, 57344
    s_mov_b32 m0, s27
    s_add_u32 s27, s27, 1024
    buffer_load_dwordx4 v12, s[32:35], s29 offen lds
    s_add_u32 s29, s29, 65536
    s_mov_b32 m0, s27
    s_add_u32 s27, s27, 1024
    buffer_load_dwordx4 v13, s[32:35], s29 offen lds
    s_add_u32 s29, s29, 65536
    s_add_u32 s31, s31, 2
    s_cmp_eq_u32 s31, 14
    s_cselect_b32 s30, 14, 0
    s_lshl_b32 s57, s30, 16
    s_sub_u32 s29, s29, s57
    s_lshl_b32 s57, s30, 10
    s_sub_u32 s27, s27, s57
    s_mov_b32 m0, s27
    s_add_u32 s27, s27, 1024
    buffer_load_dwordx4 v12, s[32:35], s29 offen lds
    s_add_u32 s29, s29, 65536
    s_mov_b32 m0, s27
    s_add_u32 s27, s27, 1024
    buffer_load_dwordx4 v13, s[32:35], s29 offen lds
    s_add_u32 s29, s29, 65536
    s_add_u32 s31, s31, 2
    s_cmp_eq_u32 s31, 14
    s_cselect_b32 s30, 14, 0
    s_lshl_b32 s57, s30, 16
    s_sub_u32 s29, s29, s57
    s_lshl_b32 s57, s30, 10
    s_sub_u32 s27, s27, s57
    s_mov_b32 m0, s27
    s_add_u32 s27, s27, 1024
    buffer_load_dwordx4 v12, s[32:35], s29 offen lds
    s_add_u32 s29, s29, 65536
    s_mov_b32 m0, s27
    s_add_u32 s27, s27, 1024
    buffer_load_dwordx4 v13, s[32:35], s29 offen lds
    s_add_u32 s29, s29, 65536
    s_add_u32 s31, s31, 2
    s_cmp_eq_u32 s31, 14
    s_cselect_b32 s30, 14, 0
    s_lshl_b32 s57, s30, 16
    s_sub_u32 s29, s29, s57
    s_lshl_b32 s57, s30, 10
    s_sub_u32 s27, s27, s57
    s_mov_b32 m0, s27
    s_add_u32 s27, s27, 1024
    buffer_load_dwordx4 v12, s[32:35], s29 offen lds
    s_add_u32 s29, s29, 65536
    s_mov_b32 m0, s27
    s_add_u32 s27, s27, 1024
    buffer_load_dwordx4 v13, s[32:35], s29 offen lds
    s_add_u32 s29, s29, 65536
    s_add_u32 s31, s31, 2
    s_cmp_eq_u32 s31, 14
    s_cselect_b32 s30, 14, 0
    s_lshl_b32 s57, s30, 16
    s_sub_u32 s29, s29, s57
    s_lshl_b32 s57, s30, 10
    s_sub_u32 s27, s27, s57
    s_mov_b32 m0, s27
    s_add_u32 s27, s27, 1024
    buffer_load_dwordx4 v12, s[32:35], s29 offen lds
    s_add_u32 s29, s29, 65536
    s_mov_b32 m0, s27
    s_add_u32 s27, s27, 1024
    buffer_load_dwordx4 v13, s[32:35], s29 offen lds
    s_add_u32 s29, s29, 65536
    s_add_u32 s31, s31, 2
    s_cmp_eq_u32 s31, 14
    s_cselect_b32 s30, 14, 0
    s_lshl_b32 s57, s30, 16
    s_sub_u32 s29, s29, s57
    s_lshl_b32 s57, s30, 10
    s_sub_u32 s27, s27, s57
    s_mov_b32 m0, s27
    s_add_u32 s27, s27, 1024
    buffer_load_dwordx4 v12, s[32:35], s29 offen lds
    s_add_u32 s29, s29, 65536
    s_mov_b32 m0, s27
    s_add_u32 s27, s27, 1024
    buffer_load_dwordx4 v13, s[32:35], s29 offen lds
    s_add_u32 s29, s29, 65536
    s_add_u32 s31, s31, 2
    s_cmp_eq_u32 s31, 14
    s_cselect_b32 s30, 14, 0
    s_lshl_b32 s57, s30, 16
    s_sub_u32 s29, s29, s57
    s_lshl_b32 s57, s30, 10
    s_sub_u32 s27, s27, s57
    s_mov_b32 m0, s27
    s_add_u32 s27, s27, 1024
    buffer_load_dwordx4 v12, s[32:35], s29 offen lds
    s_add_u32 s29, s29, 65536
    s_mov_b32 m0, s27
    s_add_u32 s27, s27, 1024
    buffer_load_dwordx4 v13, s[32:35], s29 offen lds
    s_add_u32 s29, s29, 65536
    v_mov_b32 v4, -1
    v_mov_b32 v5, -1
    v_mov_b32 v6, -1
    v_mov_b32 v7, -1
    v_lshlrev_b32 v3, 4, v0
    s_mul_i32 s26, s56, 11264
    s_add_u32 s26, s26, 44310528
    v_add_u32 v8, 8192, v3
    v_mov_b32 v9, 0x40000000
    v_cmp_gt_u32 vcc, 192, v0
    s_add_u32 s27, s26, 4096
    s_nop 0
    v_cndmask_b32 v8, v9, v8, vcc
    buffer_store_dwordx4 v[4:7], v3, s[8:11], s26 offen sc1
    buffer_store_dwordx4 v[4:7], v3, s[8:11], s27 offen sc1
    buffer_store_dwordx4 v[4:7], v8, s[8:11], s26 offen sc1
    s_waitcnt vmcnt(17)
    s_barrier
    ds_read_b128 v[32:35], v20 offset:0
    ds_read_b128 v[36:39], v20 offset:4096
    ds_read_b128 v[40:43], v20 offset:8192
    ds_read_b128 v[44:47], v20 offset:12288
    s_waitcnt lgkmcnt(3)
    v_mfma_f32_32x32x16_bf16 v[128:143], v[32:35], v[96:99], v[128:143]
    ds_read_b128 v[32:35], v20 offset:16384
    s_waitcnt lgkmcnt(3)
    v_mfma_f32_32x32x16_bf16 v[144:159], v[36:39], v[96:99], v[144:159]
    ds_read_b128 v[36:39], v20 offset:20480
    s_waitcnt lgkmcnt(3)
    v_mfma_f32_32x32x16_bf16 v[160:175], v[40:43], v[96:99], v[160:175]
    ds_read_b128 v[40:43], v20 offset:24576
    s_waitcnt lgkmcnt(3)
    v_mfma_f32_32x32x16_bf16 v[176:191], v[44:47], v[96:99], v[176:191]
    ds_read_b128 v[44:47], v21 offset:0
    s_waitcnt lgkmcnt(3)
    v_mfma_f32_32x32x16_bf16 v[192:207], v[32:35], v[96:99], v[192:207]
    ds_read_b128 v[32:35], v21 offset:4096
    s_waitcnt lgkmcnt(3)
    v_mfma_f32_32x32x16_bf16 v[208:223], v[36:39], v[96:99], v[208:223]
    ds_read_b128 v[36:39], v21 offset:8192
    s_waitcnt lgkmcnt(3)
    v_mfma_f32_32x32x16_bf16 v[224:239], v[40:43], v[96:99], v[224:239]
    ds_read_b128 v[40:43], v21 offset:12288
    s_waitcnt lgkmcnt(3)
    v_mfma_f32_32x32x16_bf16 v[128:143], v[44:47], v[100:103], v[128:143]
    ds_read_b128 v[44:47], v21 offset:16384
    s_waitcnt lgkmcnt(3)
    v_mfma_f32_32x32x16_bf16 v[144:159], v[32:35], v[100:103], v[144:159]
    ds_read_b128 v[32:35], v21 offset:20480
    s_waitcnt lgkmcnt(3)
    v_mfma_f32_32x32x16_bf16 v[160:175], v[36:39], v[100:103], v[160:175]
    ds_read_b128 v[36:39], v21 offset:24576
    s_waitcnt lgkmcnt(3)
    v_mfma_f32_32x32x16_bf16 v[176:191], v[40:43], v[100:103], v[176:191]
    ds_read_b128 v[40:43], v22 offset:0
    s_waitcnt lgkmcnt(3)
    v_mfma_f32_32x32x16_bf16 v[192:207], v[44:47], v[100:103], v[192:207]
    ds_read_b128 v[44:47], v22 offset:4096
    s_waitcnt lgkmcnt(3)
    v_mfma_f32_32x32x16_bf16 v[208:223], v[32:35], v[100:103], v[208:223]
    ds_read_b128 v[32:35], v22 offset:8192
    s_waitcnt lgkmcnt(3)
    v_mfma_f32_32x32x16_bf16 v[224:239], v[36:39], v[100:103], v[224:239]
    ds_read_b128 v[36:39], v22 offset:12288
    s_waitcnt lgkmcnt(3)
    v_mfma_f32_32x32x16_bf16 v[128:143], v[40:43], v[104:107], v[128:143]
    ds_read_b128 v[40:43], v22 offset:16384
    s_waitcnt lgkmcnt(3)
    v_mfma_f32_32x32x16_bf16 v[144:159], v[44:47], v[104:107], v[144:159]
    ds_read_b128 v[44:47], v22 offset:20480
    s_waitcnt lgkmcnt(3)
    v_mfma_f32_32x32x16_bf16 v[160:175], v[32:35], v[104:107], v[160:175]
    ds_read_b128 v[32:35], v22 offset:24576
    s_waitcnt lgkmcnt(3)
    v_mfma_f32_32x32x16_bf16 v[176:191], v[36:39], v[104:107], v[176:191]
    ds_read_b128 v[36:39], v23 offset:0
    s_waitcnt lgkmcnt(3)
    v_mfma_f32_32x32x16_bf16 v[192:207], v[40:43], v[104:107], v[192:207]
    ds_read_b128 v[40:43], v23 offset:4096
    s_waitcnt lgkmcnt(3)
    v_mfma_f32_32x32x16_bf16 v[208:223], v[44:47], v[104:107], v[208:223]
    ds_read_b128 v[44:47], v23 offset:8192
    s_waitcnt lgkmcnt(3)
    v_mfma_f32_32x32x16_bf16 v[224:239], v[32:35], v[104:107], v[224:239]
    ds_read_b128 v[32:35], v23 offset:12288
    s_waitcnt lgkmcnt(3)
    v_mfma_f32_32x32x16_bf16 v[128:143], v[36:39], v[108:111], v[128:143]
    ds_read_b128 v[36:39], v23 offset:16384
    s_waitcnt lgkmcnt(3)
    v_mfma_f32_32x32x16_bf16 v[144:159], v[40:43], v[108:111], v[144:159]
    ds_read_b128 v[40:43], v23 offset:20480
    s_waitcnt lgkmcnt(3)
    v_mfma_f32_32x32x16_bf16 v[160:175], v[44:47], v[108:111], v[160:175]
    ds_read_b128 v[44:47], v23 offset:24576
    s_waitcnt lgkmcnt(3)
    v_mfma_f32_32x32x16_bf16 v[176:191], v[32:35], v[108:111], v[176:191]
    s_waitcnt lgkmcnt(2)
    v_mfma_f32_32x32x16_bf16 v[192:207], v[36:39], v[108:111], v[192:207]
    s_waitcnt lgkmcnt(1)
    v_mfma_f32_32x32x16_bf16 v[208:223], v[40:43], v[108:111], v[208:223]
    s_waitcnt lgkmcnt(0)
    v_mfma_f32_32x32x16_bf16 v[224:239], v[44:47], v[108:111], v[224:239]
    v_add_u32 v20, 57344, v20
    v_add_u32 v21, 57344, v21
    v_add_u32 v22, 57344, v22
    v_add_u32 v23, 57344, v23
    s_waitcnt vmcnt(3)
    s_barrier
    ds_read_b128 v[32:35], v20 offset:0
    ds_read_b128 v[36:39], v20 offset:4096
    ds_read_b128 v[40:43], v20 offset:8192
    ds_read_b128 v[44:47], v20 offset:12288
    s_waitcnt lgkmcnt(3)
    v_mfma_f32_32x32x16_bf16 v[128:143], v[32:35], v[112:115], v[128:143]
    ds_read_b128 v[32:35], v20 offset:16384
    s_waitcnt lgkmcnt(3)
    v_mfma_f32_32x32x16_bf16 v[144:159], v[36:39], v[112:115], v[144:159]
    ds_read_b128 v[36:39], v20 offset:20480
    s_waitcnt lgkmcnt(3)
    v_mfma_f32_32x32x16_bf16 v[160:175], v[40:43], v[112:115], v[160:175]
    ds_read_b128 v[40:43], v20 offset:24576
    s_waitcnt lgkmcnt(3)
    v_mfma_f32_32x32x16_bf16 v[176:191], v[44:47], v[112:115], v[176:191]
    ds_read_b128 v[44:47], v21 offset:0
    s_waitcnt lgkmcnt(3)
    v_mfma_f32_32x32x16_bf16 v[192:207], v[32:35], v[112:115], v[192:207]
    ds_read_b128 v[32:35], v21 offset:4096
    s_waitcnt lgkmcnt(3)
    v_mfma_f32_32x32x16_bf16 v[208:223], v[36:39], v[112:115], v[208:223]
    ds_read_b128 v[36:39], v21 offset:8192
    s_waitcnt lgkmcnt(3)
    v_mfma_f32_32x32x16_bf16 v[224:239], v[40:43], v[112:115], v[224:239]
    ds_read_b128 v[40:43], v21 offset:12288
    s_waitcnt lgkmcnt(3)
    v_mfma_f32_32x32x16_bf16 v[128:143], v[44:47], v[116:119], v[128:143]
    ds_read_b128 v[44:47], v21 offset:16384
    s_waitcnt lgkmcnt(3)
    v_mfma_f32_32x32x16_bf16 v[144:159], v[32:35], v[116:119], v[144:159]
    ds_read_b128 v[32:35], v21 offset:20480
    s_waitcnt lgkmcnt(3)
    v_mfma_f32_32x32x16_bf16 v[160:175], v[36:39], v[116:119], v[160:175]
    ds_read_b128 v[36:39], v21 offset:24576
    s_waitcnt lgkmcnt(3)
    v_mfma_f32_32x32x16_bf16 v[176:191], v[40:43], v[116:119], v[176:191]
    ds_read_b128 v[40:43], v22 offset:0
    s_waitcnt lgkmcnt(3)
    v_mfma_f32_32x32x16_bf16 v[192:207], v[44:47], v[116:119], v[192:207]
    ds_read_b128 v[44:47], v22 offset:4096
    s_waitcnt lgkmcnt(3)
    v_mfma_f32_32x32x16_bf16 v[208:223], v[32:35], v[116:119], v[208:223]
    ds_read_b128 v[32:35], v22 offset:8192
    s_waitcnt lgkmcnt(3)
    v_mfma_f32_32x32x16_bf16 v[224:239], v[36:39], v[116:119], v[224:239]
    ds_read_b128 v[36:39], v22 offset:12288
    s_waitcnt lgkmcnt(3)
    v_mfma_f32_32x32x16_bf16 v[128:143], v[40:43], v[120:123], v[128:143]
    ds_read_b128 v[40:43], v22 offset:16384
    s_waitcnt lgkmcnt(3)
    v_mfma_f32_32x32x16_bf16 v[144:159], v[44:47], v[120:123], v[144:159]
    ds_read_b128 v[44:47], v22 offset:20480
    s_waitcnt lgkmcnt(3)
    v_mfma_f32_32x32x16_bf16 v[160:175], v[32:35], v[120:123], v[160:175]
    ds_read_b128 v[32:35], v22 offset:24576
    s_waitcnt lgkmcnt(3)
    v_mfma_f32_32x32x16_bf16 v[176:191], v[36:39], v[120:123], v[176:191]
    ds_read_b128 v[36:39], v23 offset:0
    s_waitcnt lgkmcnt(3)
    v_mfma_f32_32x32x16_bf16 v[192:207], v[40:43], v[120:123], v[192:207]
    ds_read_b128 v[40:43], v23 offset:4096
    s_waitcnt lgkmcnt(3)
    v_mfma_f32_32x32x16_bf16 v[208:223], v[44:47], v[120:123], v[208:223]
    ds_read_b128 v[44:47], v23 offset:8192
    s_waitcnt lgkmcnt(3)
    v_mfma_f32_32x32x16_bf16 v[224:239], v[32:35], v[120:123], v[224:239]
    ds_read_b128 v[32:35], v23 offset:12288
    s_waitcnt lgkmcnt(3)
    v_mfma_f32_32x32x16_bf16 v[128:143], v[36:39], v[124:127], v[128:143]
    ds_read_b128 v[36:39], v23 offset:16384
    s_waitcnt lgkmcnt(3)
    v_mfma_f32_32x32x16_bf16 v[144:159], v[40:43], v[124:127], v[144:159]
    ds_read_b128 v[40:43], v23 offset:20480
    s_waitcnt lgkmcnt(3)
    v_mfma_f32_32x32x16_bf16 v[160:175], v[44:47], v[124:127], v[160:175]
    ds_read_b128 v[44:47], v23 offset:24576
    s_waitcnt lgkmcnt(3)
    v_mfma_f32_32x32x16_bf16 v[176:191], v[32:35], v[124:127], v[176:191]
    s_waitcnt lgkmcnt(2)
    v_mfma_f32_32x32x16_bf16 v[192:207], v[36:39], v[124:127], v[192:207]
    s_waitcnt lgkmcnt(1)
    v_mfma_f32_32x32x16_bf16 v[208:223], v[40:43], v[124:127], v[208:223]
    s_waitcnt lgkmcnt(0)
    v_mfma_f32_32x32x16_bf16 v[224:239], v[44:47], v[124:127], v[224:239]
    v_lshlrev_b32 v60, 7, v1
    s_mov_b32 s3, 46874624
    buffer_load_dwordx3 v[40:42], v60, s[8:11], s3 offen sc1
    s_mov_b32 s3, 46882816
    buffer_load_dwordx3 v[44:46], v60, s[8:11], s3 offen sc1
    s_mov_b32 s3, 46891008
    buffer_load_dwordx3 v[48:50], v60, s[8:11], s3 offen sc1
    s_mov_b32 s3, 46899200
    buffer_load_dwordx3 v[52:54], v60, s[8:11], s3 offen sc1
    s_cmp_lg_u32 s21, 0
    s_cbranch_scc1 P_e1
    s_mul_i32 s26, s22, 196
    s_mul_i32 s27, s28, 14
    s_add_u32 s26, s26, s27
    s_lshl_b32 s26, s26, 11
    s_mov_b32 s27, 14336
    s_mov_b32 s30, 0x3db8aa3b
    s_branch P_e2
P_e1:
    s_lshl_b32 s26, s28, 2
    s_lshr_b32 s27, s22, 3
    s_lshl_b32 s27, s27, 1
    s_add_u32 s26, s26, s27
    s_mul_i32 s26, s26, 56
    s_and_b32 s27, s22, 7
    s_mul_i32 s27, s27, 7
    s_add_u32 s26, s26, s27
    s_lshl_b32 s26, s26, 11
    s_add_u32 s26, s26, 6422528
    s_mov_b32 s27, 114688
    s_mov_b32 s30, 1.0
P_e2:
    s_mul_i32 s31, s25, 7168
    s_add_u32 s26, s26, s31
    v_bfe_u32 v16, v1, 5, 1
    v_lshlrev_b32 v16, 8, v16
    v_bfe_u32 v3, v1, 0, 4
    v_lshl_add_u32 v16, v3, 4, v16
    v_bfe_u32 v3, v1, 4, 1
    v_mul_lo_u32 v3, v3, s27
    v_add_u32 v16, v16, v3
    s_nop 7
    v_mul_f32 v128, s30, v128
    v_mul_f32 v129, s30, v129
    v_mul_f32 v130, s30, v130
    v_mul_f32 v131, s30, v131
    v_mul_f32 v132, s30, v132
    v_mul_f32 v133, s30, v133
    v_mul_f32 v134, s30, v134
    v_mul_f32 v135, s30, v135
    v_cvt_pk_bf16_f32 v128, v128, v129
    v_cvt_pk_bf16_f32 v129, v130, v131
    v_cvt_pk_bf16_f32 v130, v132, v133
    v_cvt_pk_bf16_f32 v131, v134, v135
    buffer_store_dwordx4 v[128:131], v16, s[8:11], s26 offen offset:0 sc1
    v_mul_f32 v136, s30, v136
    v_mul_f32 v137, s30, v137
    v_mul_f32 v138, s30, v138
    v_mul_f32 v139, s30, v139
    v_mul_f32 v140, s30, v140
    v_mul_f32 v141, s30, v141
    v_mul_f32 v142, s30, v142
    v_mul_f32 v143, s30, v143
    v_cvt_pk_bf16_f32 v136, v136, v137
    v_cvt_pk_bf16_f32 v137, v138, v139
    v_cvt_pk_bf16_f32 v138, v140, v141
    v_cvt_pk_bf16_f32 v139, v142, v143
    buffer_store_dwordx4 v[136:139], v16, s[8:11], s26 offen offset:512 sc1
    v_mul_f32 v144, s30, v144
    v_mul_f32 v145, s30, v145
    v_mul_f32 v146, s30, v146
    v_mul_f32 v147, s30, v147
    v_mul_f32 v148, s30, v148
    v_mul_f32 v149, s30, v149
    v_mul_f32 v150, s30, v150
    v_mul_f32 v151, s30, v151
    v_cvt_pk_bf16_f32 v144, v144, v145
    v_cvt_pk_bf16_f32 v145, v146, v147
    v_cvt_pk_bf16_f32 v146, v148, v149
    v_cvt_pk_bf16_f32 v147, v150, v151
    buffer_store_dwordx4 v[144:147], v16, s[8:11], s26 offen offset:1024 sc1
    v_mul_f32 v152, s30, v152
    v_mul_f32 v153, s30, v153
    v_mul_f32 v154, s30, v154
    v_mul_f32 v155, s30, v155
    v_mul_f32 v156, s30, v156
    v_mul_f32 v157, s30, v157
    v_mul_f32 v158, s30, v158
    v_mul_f32 v159, s30, v159
    v_cvt_pk_bf16_f32 v152, v152, v153
    v_cvt_pk_bf16_f32 v153, v154, v155
    v_cvt_pk_bf16_f32 v154, v156, v157
    v_cvt_pk_bf16_f32 v155, v158, v159
    buffer_store_dwordx4 v[152:155], v16, s[8:11], s26 offen offset:1536 sc1
    v_mul_f32 v160, s30, v160
    v_mul_f32 v161, s30, v161
    v_mul_f32 v162, s30, v162
    v_mul_f32 v163, s30, v163
    v_mul_f32 v164, s30, v164
    v_mul_f32 v165, s30, v165
    v_mul_f32 v166, s30, v166
    v_mul_f32 v167, s30, v167
    v_cvt_pk_bf16_f32 v160, v160, v161
    v_cvt_pk_bf16_f32 v161, v162, v163
    v_cvt_pk_bf16_f32 v162, v164, v165
    v_cvt_pk_bf16_f32 v163, v166, v167
    buffer_store_dwordx4 v[160:163], v16, s[8:11], s26 offen offset:2048 sc1
    v_mul_f32 v168, s30, v168
    v_mul_f32 v169, s30, v169
    v_mul_f32 v170, s30, v170
    v_mul_f32 v171, s30, v171
    v_mul_f32 v172, s30, v172
    v_mul_f32 v173, s30, v173
    v_mul_f32 v174, s30, v174
    v_mul_f32 v175, s30, v175
    v_cvt_pk_bf16_f32 v168, v168, v169
    v_cvt_pk_bf16_f32 v169, v170, v171
    v_cvt_pk_bf16_f32 v170, v172, v173
    v_cvt_pk_bf16_f32 v171, v174, v175
    buffer_store_dwordx4 v[168:171], v16, s[8:11], s26 offen offset:2560 sc1
    v_mul_f32 v176, s30, v176
    v_mul_f32 v177, s30, v177
    v_mul_f32 v178, s30, v178
    v_mul_f32 v179, s30, v179
    v_mul_f32 v180, s30, v180
    v_mul_f32 v181, s30, v181
    v_mul_f32 v182, s30, v182
    v_mul_f32 v183, s30, v183
    v_cvt_pk_bf16_f32 v176, v176, v177
    v_cvt_pk_bf16_f32 v177, v178, v179
    v_cvt_pk_bf16_f32 v178, v180, v181
    v_cvt_pk_bf16_f32 v179, v182, v183
    buffer_store_dwordx4 v[176:179], v16, s[8:11], s26 offen offset:3072 sc1
    v_mul_f32 v184, s30, v184
    v_mul_f32 v185, s30, v185
    v_mul_f32 v186, s30, v186
    v_mul_f32 v187, s30, v187
    v_mul_f32 v188, s30, v188
    v_mul_f32 v189, s30, v189
    v_mul_f32 v190, s30, v190
    v_mul_f32 v191, s30, v191
    v_cvt_pk_bf16_f32 v184, v184, v185
    v_cvt_pk_bf16_f32 v185, v186, v187
    v_cvt_pk_bf16_f32 v186, v188, v189
    v_cvt_pk_bf16_f32 v187, v190, v191
    buffer_store_dwordx4 v[184:187], v16, s[8:11], s26 offen offset:3584 sc1
    s_add_u32 s26, s26, 4096
    v_mul_f32 v192, s30, v192
    v_mul_f32 v193, s30, v193
    v_mul_f32 v194, s30, v194
    v_mul_f32 v195, s30, v195
    v_mul_f32 v196, s30, v196
    v_mul_f32 v197, s30, v197
    v_mul_f32 v198, s30, v198
    v_mul_f32 v199, s30, v199
    v_cvt_pk_bf16_f32 v192, v192, v193
    v_cvt_pk_bf16_f32 v193, v194, v195
    v_cvt_pk_bf16_f32 v194, v196, v197
    v_cvt_pk_bf16_f32 v195, v198, v199
    buffer_store_dwordx4 v[192:195], v16, s[8:11], s26 offen offset:0 sc1
    v_mul_f32 v200, s30, v200
    v_mul_f32 v201, s30, v201
    v_mul_f32 v202, s30, v202
    v_mul_f32 v203, s30, v203
    v_mul_f32 v204, s30, v204
    v_mul_f32 v205, s30, v205
    v_mul_f32 v206, s30, v206
    v_mul_f32 v207, s30, v207
    v_cvt_pk_bf16_f32 v200, v200, v201
    v_cvt_pk_bf16_f32 v201, v202, v203
    v_cvt_pk_bf16_f32 v202, v204, v205
    v_cvt_pk_bf16_f32 v203, v206, v207
    buffer_store_dwordx4 v[200:203], v16, s[8:11], s26 offen offset:512 sc1
    v_mul_f32 v208, s30, v208
    v_mul_f32 v209, s30, v209
    v_mul_f32 v210, s30, v210
    v_mul_f32 v211, s30, v211
    v_mul_f32 v212, s30, v212
    v_mul_f32 v213, s30, v213
    v_mul_f32 v214, s30, v214
    v_mul_f32 v215, s30, v215
    v_cvt_pk_bf16_f32 v208, v208, v209
    v_cvt_pk_bf16_f32 v209, v210, v211
    v_cvt_pk_bf16_f32 v210, v212, v213
    v_cvt_pk_bf16_f32 v211, v214, v215
    buffer_store_dwordx4 v[208:211], v16, s[8:11], s26 offen offset:1024 sc1
    v_mul_f32 v216, s30, v216
    v_mul_f32 v217, s30, v217
    v_mul_f32 v218, s30, v218
    v_mul_f32 v219, s30, v219
    v_mul_f32 v220, s30, v220
    v_mul_f32 v221, s30, v221
    v_mul_f32 v222, s30, v222
    v_mul_f32 v223, s30, v223
    v_cvt_pk_bf16_f32 v216, v216, v217
    v_cvt_pk_bf16_f32 v217, v218, v219
    v_cvt_pk_bf16_f32 v218, v220, v221
    v_cvt_pk_bf16_f32 v219, v222, v223
    buffer_store_dwordx4 v[216:219], v16, s[8:11], s26 offen offset:1536 sc1
    v_mul_f32 v224, s30, v224
    v_mul_f32 v225, s30, v225
    v_mul_f32 v226, s30, v226
    v_mul_f32 v227, s30, v227
    v_mul_f32 v228, s30, v228
    v_mul_f32 v229, s30, v229
    v_mul_f32 v230, s30, v230
    v_mul_f32 v231, s30, v231
    v_cvt_pk_bf16_f32 v224, v224, v225
    v_cvt_pk_bf16_f32 v225, v226, v227
    v_cvt_pk_bf16_f32 v226, v228, v229
    v_cvt_pk_bf16_f32 v227, v230, v231
    buffer_store_dwordx4 v[224:227], v16, s[8:11], s26 offen offset:2048 sc1
    v_mul_f32 v232, s30, v232
    v_mul_f32 v233, s30, v233
    v_mul_f32 v234, s30, v234
    v_mul_f32 v235, s30, v235
    v_mul_f32 v236, s30, v236
    v_mul_f32 v237, s30, v237
    v_mul_f32 v238, s30, v238
    v_mul_f32 v239, s30, v239
    v_cvt_pk_bf16_f32 v232, v232, v233
    v_cvt_pk_bf16_f32 v233, v234, v235
    v_cvt_pk_bf16_f32 v234, v236, v237
    v_cvt_pk_bf16_f32 v235, v238, v239
    buffer_store_dwordx4 v[232:235], v16, s[8:11], s26 offen offset:2560 sc1
    s_lshl_b32 s26, s56, 7
    s_add_u32 s26, s26, 46833664
    s_waitcnt vmcnt(0)
    s_barrier
    s_cmp_lg_u32 s20, 0
    s_cbranch_scc1 P_f_3
    s_mov_b64 exec, 0xff
    v_mov_b32 v56, s96
    v_mov_b32 v57, s97
    v_mov_b32 v58, s96
    v_mov_b32 v59, s97
    buffer_store_dwordx4 v[56:59], v2, s[8:11], s26 offen sc1
    s_mov_b64 exec, -1
P_f_3:
    s_mov_b32 s47, 400000
    s_branch L_tk_g_c
L_tk_g:
    s_mov_b32 s3, 46874624
    buffer_load_dwordx3 v[40:42], v60, s[8:11], s3 offen sc1
    s_mov_b32 s3, 46882816
    buffer_load_dwordx3 v[44:46], v60, s[8:11], s3 offen sc1
    s_mov_b32 s3, 46891008
    buffer_load_dwordx3 v[48:50], v60, s[8:11], s3 offen sc1
    s_mov_b32 s3, 46899200
    buffer_load_dwordx3 v[52:54], v60, s[8:11], s3 offen sc1
L_tk_g_c:
    v_mov_b32 v59, 0
    s_waitcnt vmcnt(0)
    v_xor_b32 v40, s96, v40
    v_xor_b32 v41, s97, v41
    v_or3_b32 v59, v59, v40, v41
    v_xor_b32 v44, s96, v44
    v_xor_b32 v45, s97, v45
    v_or3_b32 v59, v59, v44, v45
    v_xor_b32 v48, s96, v48
    v_xor_b32 v49, s97, v49
    v_or3_b32 v59, v59, v48, v49
    v_xor_b32 v52, s96, v52
    v_xor_b32 v53, s97, v53
    v_or3_b32 v59, v59, v52, v53
    v_cmp_ne_u32 vcc, 0, v59
    s_cbranch_vccz L_tk_g_ok
    s_sub_u32 s47, s47, 1
    s_cbranch_scc0 L_tk_g
    s_branch L_fail
L_tk_g_ok:
    s_mov_b32 s46, 0
    s_mov_b32 s89, 0x100
    v_add_u32 v56, 192, v1
    v_cmp_eq_u32 s[80:81], s95, v54
    v_cmp_gt_u32 vcc, s2, v56
    s_ff1_i32_b64 s3, s[80:81]
    s_add_u32 s90, s3, 192
    s_cmp_lg_u32 s3, -1
    s_cselect_b32 s89, s90, s89
    s_and_b64 s[80:81], s[80:81], vcc
    s_bcnt1_i32_b64 s3, s[80:81]
    s_add_u32 s46, s46, s3
    v_add_u32 v56, 128, v1
    v_cmp_eq_u32 s[80:81], s95, v50
    v_cmp_gt_u32 vcc, s2, v56
    s_ff1_i32_b64 s3, s[80:81]
    s_add_u32 s90, s3, 128
    s_cmp_lg_u32 s3, -1
    s_cselect_b32 s89, s90, s89
    s_and_b64 s[80:81], s[80:81], vcc
    s_bcnt1_i32_b64 s3, s[80:81]
    s_add_u32 s46, s46, s3
    v_add_u32 v56, 64, v1
    v_cmp_eq_u32 s[80:81], s95, v46
    v_cmp_gt_u32 vcc, s2, v56
    s_ff1_i32_b64 s3, s[80:81]
    s_add_u32 s90, s3, 64
    s_cmp_lg_u32 s3, -1
    s_cselect_b32 s89, s90, s89
    s_and_b64 s[80:81], s[80:81], vcc
    s_bcnt1_i32_b64 s3, s[80:81]
    s_add_u32 s46, s46, s3
    v_add_u32 v56, 0, v1
    v_cmp_eq_u32 s[80:81], s95, v42
    v_cmp_gt_u32 vcc, s2, v56
    s_ff1_i32_b64 s3, s[80:81]
    s_add_u32 s90, s3, 0
    s_cmp_lg_u32 s3, -1
    s_cselect_b32 s89, s90, s89
    s_and_b64 s[80:81], s[80:81], vcc
    s_bcnt1_i32_b64 s3, s[80:81]
    s_add_u32 s46, s46, s3
    s_mov_b32 s94, 0
    s_mov_b32 s91, 0
    v_add_u32 v56, 0, v1
    v_cmp_gt_u32 s[64:65], s89, v56
    v_add_u32 v56, 64, v1
    v_cmp_gt_u32 s[66:67], s89, v56
    v_add_u32 v56, 128, v1
    v_cmp_gt_u32 s[68:69], s89, v56
    v_add_u32 v56, 192, v1
    v_cmp_gt_u32 s[70:71], s89, v56
    v_cmp_eq_u32 s[80:81], 0, v42
    v_cmp_eq_u32 s[82:83], 0, v46
    v_cmp_eq_u32 s[84:85], 0, v50
    v_cmp_eq_u32 s[86:87], 0, v54
    s_mov_b32 s90, 0
    s_mov_b64 s[72:73], 0
    s_bcnt1_i32_b64 s3, s[80:81]
    s_add_u32 s90, s90, s3
    s_and_b64 s[74:75], s[80:81], s[64:65]
    s_or_b64 s[72:73], s[72:73], s[74:75]
    s_bcnt1_i32_b64 s3, s[82:83]
    s_add_u32 s90, s90, s3
    s_and_b64 s[74:75], s[82:83], s[66:67]
    s_or_b64 s[72:73], s[72:73], s[74:75]
    s_bcnt1_i32_b64 s3, s[84:85]
    s_add_u32 s90, s90, s3
    s_and_b64 s[74:75], s[84:85], s[68:69]
    s_or_b64 s[72:73], s[72:73], s[74:75]
    s_bcnt1_i32_b64 s3, s[86:87]
    s_add_u32 s90, s90, s3
    s_and_b64 s[74:75], s[86:87], s[70:71]
    s_or_b64 s[72:73], s[72:73], s[74:75]
    s_cselect_b32 s3, s90, 0
    s_add_u32 s91, s91, s3
    s_cmp_lg_u32 s90, 32
    s_cselect_b32 s94, 1, s94
    v_cmp_eq_u32 s[80:81], 1, v42
    v_cmp_eq_u32 s[82:83], 1, v46
    v_cmp_eq_u32 s[84:85], 1, v50
    v_cmp_eq_u32 s[86:87], 1, v54
    s_mov_b32 s90, 0
    s_mov_b64 s[72:73], 0
    s_bcnt1_i32_b64 s3, s[80:81]
    s_add_u32 s90, s90, s3
    s_and_b64 s[74:75], s[80:81], s[64:65]
    s_or_b64 s[72:73], s[72:73], s[74:75]
    s_bcnt1_i32_b64 s3, s[82:83]
    s_add_u32 s90, s90, s3
    s_and_b64 s[74:75], s[82:83], s[66:67]
    s_or_b64 s[72:73], s[72:73], s[74:75]
    s_bcnt1_i32_b64 s3, s[84:85]
    s_add_u32 s90, s90, s3
    s_and_b64 s[74:75], s[84:85], s[68:69]
    s_or_b64 s[72:73], s[72:73], s[74:75]
    s_bcnt1_i32_b64 s3, s[86:87]
    s_add_u32 s90, s90, s3
    s_and_b64 s[74:75], s[86:87], s[70:71]
    s_or_b64 s[72:73], s[72:73], s[74:75]
    s_cselect_b32 s3, s90, 0
    s_add_u32 s91, s91, s3
    s_cmp_lg_u32 s90, 32
    s_cselect_b32 s94, 1, s94
    v_cmp_eq_u32 s[80:81], 2, v42
    v_cmp_eq_u32 s[82:83], 2, v46
    v_cmp_eq_u32 s[84:85], 2, v50
    v_cmp_eq_u32 s[86:87], 2, v54
    s_mov_b32 s90, 0
    s_mov_b64 s[72:73], 0
    s_bcnt1_i32_b64 s3, s[80:81]
    s_add_u32 s90, s90, s3
    s_and_b64 s[74:75], s[80:81], s[64:65]
    s_or_b64 s[72:73], s[72:73], s[74:75]
    s_bcnt1_i32_b64 s3, s[82:83]
    s_add_u32 s90, s90, s3
    s_and_b64 s[74:75], s[82:83], s[66:67]
    s_or_b64 s[72:73], s[72:73], s[74:75]
    s_bcnt1_i32_b64 s3, s[84:85]
    s_add_u32 s90, s90, s3
    s_and_b64 s[74:75], s[84:85], s[68:69]
    s_or_b64 s[72:73], s[72:73], s[74:75]
    s_bcnt1_i32_b64 s3, s[86:87]
    s_add_u32 s90, s90, s3
    s_and_b64 s[74:75], s[86:87], s[70:71]
    s_or_b64 s[72:73], s[72:73], s[74:75]
    s_cselect_b32 s3, s90, 0
    s_add_u32 s91, s91, s3
    s_cmp_lg_u32 s90, 32
    s_cselect_b32 s94, 1, s94
    v_cmp_eq_u32 s[80:81], 3, v42
    v_cmp_eq_u32 s[82:83], 3, v46
    v_cmp_eq_u32 s[84:85], 3, v50
    v_cmp_eq_u32 s[86:87], 3, v54
    s_mov_b32 s90, 0
    s_mov_b64 s[72:73], 0
    s_bcnt1_i32_b64 s3, s[80:81]
    s_add_u32 s90, s90, s3
    s_and_b64 s[74:75], s[80:81], s[64:65]
    s_or_b64 s[72:73], s[72:73], s[74:75]
    s_bcnt1_i32_b64 s3, s[82:83]
    s_add_u32 s90, s90, s3
    s_and_b64 s[74:75], s[82:83], s[66:67]
    s_or_b64 s[72:73], s[72:73], s[74:75]
    s_bcnt1_i32_b64 s3, s[84:85]
    s_add_u32 s90, s90, s3
    s_and_b64 s[74:75], s[84:85], s[68:69]
    s_or_b64 s[72:73], s[72:73], s[74:75]
    s_bcnt1_i32_b64 s3, s[86:87]
    s_add_u32 s90, s90, s3
    s_and_b64 s[74:75], s[86:87], s[70:71]
    s_or_b64 s[72:73], s[72:73], s[74:75]
    s_cselect_b32 s3, s90, 0
    s_add_u32 s91, s91, s3
    s_cmp_lg_u32 s90, 32
    s_cselect_b32 s94, 1, s94
    v_cmp_eq_u32 s[80:81], 4, v42
    v_cmp_eq_u32 s[82:83], 4, v46
    v_cmp_eq_u32 s[84:85], 4, v50
    v_cmp_eq_u32 s[86:87], 4, v54
    s_mov_b32 s90, 0
    s_mov_b64 s[72:73], 0
    s_bcnt1_i32_b64 s3, s[80:81]
    s_add_u32 s90, s90, s3
    s_and_b64 s[74:75], s[80:81], s[64:65]
    s_or_b64 s[72:73], s[72:73], s[74:75]
    s_bcnt1_i32_b64 s3, s[82:83]
    s_add_u32 s90, s90, s3
    s_and_b64 s[74:75], s[82:83], s[66:67]
    s_or_b64 s[72:73], s[72:73], s[74:75]
    s_bcnt1_i32_b64 s3, s[84:85]
    s_add_u32 s90, s90, s3
    s_and_b64 s[74:75], s[84:85], s[68:69]
    s_or_b64 s[72:73], s[72:73], s[74:75]
    s_bcnt1_i32_b64 s3, s[86:87]
    s_add_u32 s90, s90, s3
    s_and_b64 s[74:75], s[86:87], s[70:71]
    s_or_b64 s[72:73], s[72:73], s[74:75]
    s_cselect_b32 s3, s90, 0
    s_add_u32 s91, s91, s3
    s_cmp_lg_u32 s90, 32
    s_cselect_b32 s94, 1, s94
    v_cmp_eq_u32 s[80:81], 5, v42
    v_cmp_eq_u32 s[82:83], 5, v46
    v_cmp_eq_u32 s[84:85], 5, v50
    v_cmp_eq_u32 s[86:87], 5, v54
    s_mov_b32 s90, 0
    s_mov_b64 s[72:73], 0
    s_bcnt1_i32_b64 s3, s[80:81]
    s_add_u32 s90, s90, s3
    s_and_b64 s[74:75], s[80:81], s[64:65]
    s_or_b64 s[72:73], s[72:73], s[74:75]
    s_bcnt1_i32_b64 s3, s[82:83]
    s_add_u32 s90, s90, s3
    s_and_b64 s[74:75], s[82:83], s[66:67]
    s_or_b64 s[72:73], s[72:73], s[74:75]
    s_bcnt1_i32_b64 s3, s[84:85]
    s_add_u32 s90, s90, s3
    s_and_b64 s[74:75], s[84:85], s[68:69]
    s_or_b64 s[72:73], s[72:73], s[74:75]
    s_bcnt1_i32_b64 s3, s[86:87]
    s_add_u32 s90, s90, s3
    s_and_b64 s[74:75], s[86:87], s[70:71]
    s_or_b64 s[72:73], s[72:73], s[74:75]
    s_cselect_b32 s3, s90, 0
    s_add_u32 s91, s91, s3
    s_cmp_lg_u32 s90, 32
    s_cselect_b32 s94, 1, s94
    v_cmp_eq_u32 s[80:81], 6, v42
    v_cmp_eq_u32 s[82:83], 6, v46
    v_cmp_eq_u32 s[84:85], 6, v50
    v_cmp_eq_u32 s[86:87], 6, v54
    s_mov_b32 s90, 0
    s_mov_b64 s[72:73], 0
    s_bcnt1_i32_b64 s3, s[80:81]
    s_add_u32 s90, s90, s3
    s_and_b64 s[74:75], s[80:81], s[64:65]
    s_or_b64 s[72:73], s[72:73], s[74:75]
    s_bcnt1_i32_b64 s3, s[82:83]
    s_add_u32 s90, s90, s3
    s_and_b64 s[74:75], s[82:83], s[66:67]
    s_or_b64 s[72:73], s[72:73], s[74:75]
    s_bcnt1_i32_b64 s3, s[84:85]
    s_add_u32 s90, s90, s3
    s_and_b64 s[74:75], s[84:85], s[68:69]
    s_or_b64 s[72:73], s[72:73], s[74:75]
    s_bcnt1_i32_b64 s3, s[86:87]
    s_add_u32 s90, s90, s3
    s_and_b64 s[74:75], s[86:87], s[70:71]
    s_or_b64 s[72:73], s[72:73], s[74:75]
    s_cselect_b32 s3, s90, 0
    s_add_u32 s91, s91, s3
    s_cmp_lg_u32 s90, 32
    s_cselect_b32 s94, 1, s94
    v_cmp_eq_u32 s[80:81], 7, v42
    v_cmp_eq_u32 s[82:83], 7, v46
    v_cmp_eq_u32 s[84:85], 7, v50
    v_cmp_eq_u32 s[86:87], 7, v54
    s_mov_b32 s90, 0
    s_mov_b64 s[72:73], 0
    s_bcnt1_i32_b64 s3, s[80:81]
    s_add_u32 s90, s90, s3
    s_and_b64 s[74:75], s[80:81], s[64:65]
    s_or_b64 s[72:73], s[72:73], s[74:75]
    s_bcnt1_i32_b64 s3, s[82:83]
    s_add_u32 s90, s90, s3
    s_and_b64 s[74:75], s[82:83], s[66:67]
    s_or_b64 s[72:73], s[72:73], s[74:75]
    s_bcnt1_i32_b64 s3, s[84:85]
    s_add_u32 s90, s90, s3
    s_and_b64 s[74:75], s[84:85], s[68:69]
    s_or_b64 s[72:73], s[72:73], s[74:75]
    s_bcnt1_i32_b64 s3, s[86:87]
    s_add_u32 s90, s90, s3
    s_and_b64 s[74:75], s[86:87], s[70:71]
    s_or_b64 s[72:73], s[72:73], s[74:75]
    s_cselect_b32 s3, s90, 0
    s_add_u32 s91, s91, s3
    s_cmp_lg_u32 s90, 32
    s_cselect_b32 s94, 1, s94
    s_add_u32 s93, s91, s46
    s_cmp_lt_u32 s56, 160
    s_cbranch_scc1 P_done
    s_mov_b32 s46, 224
    v_min_u32 v60, 31, v1
    v_mul_u32_u24 v60, 128, v60
    s_lshl_b32 s3, s46, 7
    s_add_u32 s3, s3, 46833664
    s_mov_b32 s47, 200000
P_nm:
    buffer_load_dwordx2 v[62:63], v60, s[8:11], s3 offen sc1
    s_waitcnt vmcnt(0)
    v_xor_b32 v62, s96, v62
    v_xor_b32 v63, s97, v63
    v_or_b32 v62, v62, v63
    v_cmp_ne_u32 vcc, 0, v62
    s_cbranch_vccz P_nm_ok
    s_sub_u32 s47, s47, 1
    s_cbranch_scc0 P_nm
    s_branch L_fail
P_nm_ok:
    v_lshlrev_b32 v14, 4, v0
    s_mov_b32 s24, 85558272
    buffer_load_dwordx4 v[24:27], v14, s[8:11], s24 offen sc1
    v_lshrrev_b32 v10, 3, v0
    v_and_b32 v11, 7, v0
    v_mov_b32 v3, 0
    v_mov_b32 v4, 1.0
    v_cmp_gt_u32 vcc, 4, v11
    s_nop 1
    v_cndmask_b32 v9, v3, v4, vcc
    v_accvgpr_read_b32 v129, a0
    v_lshlrev_b32 v128, 16, v129
    v_and_b32 v129, 0xffff0000, v129
    v_accvgpr_read_b32 v131, a1
    v_lshlrev_b32 v130, 16, v131
    v_and_b32 v131, 0xffff0000, v131
    v_pk_add_f32 v[22:23], v[128:129], v[130:131]
    v_accvgpr_read_b32 v133, a2
    v_lshlrev_b32 v132, 16, v133
    v_and_b32 v133, 0xffff0000, v133
    v_pk_add_f32 v[22:23], v[22:23], v[132:133]
    v_accvgpr_read_b32 v135, a3
    v_lshlrev_b32 v134, 16, v135
    v_and_b32 v135, 0xffff0000, v135
    v_pk_add_f32 v[22:23], v[22:23], v[134:135]
    v_accvgpr_read_b32 v137, a4
    v_lshlrev_b32 v136, 16, v137
    v_and_b32 v137, 0xffff0000, v137
    v_pk_add_f32 v[22:23], v[22:23], v[136:137]
    v_accvgpr_read_b32 v139, a5
    v_lshlrev_b32 v138, 16, v139
    v_and_b32 v139, 0xffff0000, v139
    v_pk_add_f32 v[22:23], v[22:23], v[138:139]
    v_accvgpr_read_b32 v141, a6
    v_lshlrev_b32 v140, 16, v141
    v_and_b32 v141, 0xffff0000, v141
    v_pk_add_f32 v[22:23], v[22:23], v[140:141]
    v_accvgpr_read_b32 v143, a7
    v_lshlrev_b32 v142, 16, v143
    v_and_b32 v143, 0xffff0000, v143
    v_pk_add_f32 v[22:23], v[22:23], v[142:143]
    v_accvgpr_read_b32 v145, a8
    v_lshlrev_b32 v144, 16, v145
    v_and_b32 v145, 0xffff0000, v145
    v_pk_add_f32 v[22:23], v[22:23], v[144:145]
    v_accvgpr_read_b32 v147, a9
    v_lshlrev_b32 v146, 16, v147
    v_and_b32 v147, 0xffff0000, v147
    v_pk_add_f32 v[22:23], v[22:23], v[146:147]
    v_accvgpr_read_b32 v149, a10
    v_lshlrev_b32 v148, 16, v149
    v_and_b32 v149, 0xffff0000, v149
    v_pk_add_f32 v[22:23], v[22:23], v[148:149]
    v_accvgpr_read_b32 v151, a11
    v_lshlrev_b32 v150, 16, v151
    v_and_b32 v151, 0xffff0000, v151
    v_pk_add_f32 v[22:23], v[22:23], v[150:151]
    v_accvgpr_read_b32 v153, a12
    v_lshlrev_b32 v152, 16, v153
    v_and_b32 v153, 0xffff0000, v153
    v_pk_add_f32 v[22:23], v[22:23], v[152:153]
    v_accvgpr_read_b32 v155, a13
    v_lshlrev_b32 v154, 16, v155
    v_and_b32 v155, 0xffff0000, v155
    v_pk_add_f32 v[22:23], v[22:23], v[154:155]
    v_accvgpr_read_b32 v157, a14
    v_lshlrev_b32 v156, 16, v157
    v_and_b32 v157, 0xffff0000, v157
    v_pk_add_f32 v[22:23], v[22:23], v[156:157]
    v_accvgpr_read_b32 v159, a15
    v_lshlrev_b32 v158, 16, v159
    v_and_b32 v159, 0xffff0000, v159
    v_pk_add_f32 v[22:23], v[22:23], v[158:159]
    v_accvgpr_read_b32 v161, a16
    v_lshlrev_b32 v160, 16, v161
    v_and_b32 v161, 0xffff0000, v161
    v_pk_add_f32 v[22:23], v[22:23], v[160:161]
    v_accvgpr_read_b32 v163, a17
    v_lshlrev_b32 v162, 16, v163
    v_and_b32 v163, 0xffff0000, v163
    v_pk_add_f32 v[22:23], v[22:23], v[162:163]
    v_accvgpr_read_b32 v165, a18
    v_lshlrev_b32 v164, 16, v165
    v_and_b32 v165, 0xffff0000, v165
    v_pk_add_f32 v[22:23], v[22:23], v[164:165]
    v_accvgpr_read_b32 v167, a19
    v_lshlrev_b32 v166, 16, v167
    v_and_b32 v167, 0xffff0000, v167
    v_pk_add_f32 v[22:23], v[22:23], v[166:167]
    v_accvgpr_read_b32 v169, a20
    v_lshlrev_b32 v168, 16, v169
    v_and_b32 v169, 0xffff0000, v169
    v_pk_add_f32 v[22:23], v[22:23], v[168:169]
    v_accvgpr_read_b32 v171, a21
    v_lshlrev_b32 v170, 16, v171
    v_and_b32 v171, 0xffff0000, v171
    v_pk_add_f32 v[22:23], v[22:23], v[170:171]
    v_accvgpr_read_b32 v173, a22
    v_lshlrev_b32 v172, 16, v173
    v_and_b32 v173, 0xffff0000, v173
    v_pk_add_f32 v[22:23], v[22:23], v[172:173]
    v_accvgpr_read_b32 v175, a23
    v_lshlrev_b32 v174, 16, v175
    v_and_b32 v175, 0xffff0000, v175
    v_pk_add_f32 v[22:23], v[22:23], v[174:175]
    v_accvgpr_read_b32 v177, a24
    v_lshlrev_b32 v176, 16, v177
    v_and_b32 v177, 0xffff0000, v177
    v_pk_add_f32 v[22:23], v[22:23], v[176:177]
    v_accvgpr_read_b32 v179, a25
    v_lshlrev_b32 v178, 16, v179
    v_and_b32 v179, 0xffff0000, v179
    v_pk_add_f32 v[22:23], v[22:23], v[178:179]
    v_accvgpr_read_b32 v181, a26
    v_lshlrev_b32 v180, 16, v181
    v_and_b32 v181, 0xffff0000, v181
    v_pk_add_f32 v[22:23], v[22:23], v[180:181]
    v_accvgpr_read_b32 v183, a27
    v_lshlrev_b32 v182, 16, v183
    v_and_b32 v183, 0xffff0000, v183
    v_pk_add_f32 v[22:23], v[22:23], v[182:183]
    v_accvgpr_read_b32 v185, a28
    v_lshlrev_b32 v184, 16, v185
    v_and_b32 v185, 0xffff0000, v185
    v_pk_add_f32 v[22:23], v[22:23], v[184:185]
    v_accvgpr_read_b32 v187, a29
    v_lshlrev_b32 v186, 16, v187
    v_and_b32 v187, 0xffff0000, v187
    v_pk_add_f32 v[22:23], v[22:23], v[186:187]
    v_accvgpr_read_b32 v189, a30
    v_lshlrev_b32 v188, 16, v189
    v_and_b32 v189, 0xffff0000, v189
    v_pk_add_f32 v[22:23], v[22:23], v[188:189]
    v_accvgpr_read_b32 v191, a31
    v_lshlrev_b32 v190, 16, v191
    v_and_b32 v191, 0xffff0000, v191
    v_pk_add_f32 v[22:23], v[22:23], v[190:191]
    v_mov_b32 v28, 0
    v_cmp_lt_u32 vcc, 111, v0
    v_add_f32 v22, v22, v23
    s_nop 0
    v_cndmask_b32 v28, v28, 1.0, vcc
    s_waitcnt vmcnt(0)
    v_add_f32 v24, v24, v28
    v_add_f32 v25, v25, v28
    v_add_f32 v26, v26, v28
    v_add_f32 v27, v27, v28
    ds_write_b128 v14, v[24:27]
    v_lshlrev_b32 v14, 6, v11
    s_nop 1
    v_add_f32_dpp v22, v22, v22 quad_perm:[1,0,3,2] row_mask:0xf bank_mask:0xf
    s_nop 1
    v_add_f32_dpp v22, v22, v22 quad_perm:[2,3,0,1] row_mask:0xf bank_mask:0xf
    s_nop 1
    v_add_f32_dpp v22, v22, v22 row_half_mirror row_mask:0xf bank_mask:0xf
    v_mul_f32 v22, 0xbb124925, v22
    v_mov_b64 v[24:25], 0
    v_mov_b64 v[26:27], 0
    s_waitcnt lgkmcnt(0)
    s_barrier
    ds_read_b128 v[64:67], v14 offset:0
    ds_read_b128 v[192:195], v14 offset:1792
    ds_read_b128 v[68:71], v14 offset:16
    ds_read_b128 v[196:199], v14 offset:1808
    ds_read_b128 v[72:75], v14 offset:32
    ds_read_b128 v[200:203], v14 offset:1824
    ds_read_b128 v[76:79], v14 offset:48
    ds_read_b128 v[204:207], v14 offset:1840
    ds_read_b128 v[80:83], v14 offset:512
    ds_read_b128 v[208:211], v14 offset:2304
    ds_read_b128 v[84:87], v14 offset:528
    ds_read_b128 v[212:215], v14 offset:2320
    ds_read_b128 v[88:91], v14 offset:544
    ds_read_b128 v[216:219], v14 offset:2336
    ds_read_b128 v[92:95], v14 offset:560
    ds_read_b128 v[220:223], v14 offset:2352
    ds_read_b128 v[96:99], v14 offset:1024
    ds_read_b128 v[224:227], v14 offset:2816
    ds_read_b128 v[100:103], v14 offset:1040
    ds_read_b128 v[228:231], v14 offset:2832
    ds_read_b128 v[104:107], v14 offset:1056
    ds_read_b128 v[232:235], v14 offset:2848
    ds_read_b128 v[108:111], v14 offset:1072
    ds_read_b128 v[236:239], v14 offset:2864
    ds_read_b128 v[112:115], v14 offset:1536
    ds_read_b128 v[240:243], v14 offset:3328
    ds_read_b128 v[116:119], v14 offset:1552
    ds_read_b128 v[244:247], v14 offset:3344
    ds_read_b128 v[120:123], v14 offset:1568
    ds_read_b128 v[248:251], v14 offset:3360
    ds_read_b128 v[124:127], v14 offset:1584
    ds_read_b128 v[252:255], v14 offset:3376
    v_pk_add_f32 v[128:129], v[128:129], v[22:23] op_sel_hi:[1,0]
    v_pk_add_f32 v[130:131], v[130:131], v[22:23] op_sel_hi:[1,0]
    v_pk_add_f32 v[132:133], v[132:133], v[22:23] op_sel_hi:[1,0]
    v_pk_add_f32 v[134:135], v[134:135], v[22:23] op_sel_hi:[1,0]
    v_pk_add_f32 v[136:137], v[136:137], v[22:23] op_sel_hi:[1,0]
    v_pk_add_f32 v[138:139], v[138:139], v[22:23] op_sel_hi:[1,0]
    v_pk_add_f32 v[140:141], v[140:141], v[22:23] op_sel_hi:[1,0]
    v_pk_add_f32 v[142:143], v[142:143], v[22:23] op_sel_hi:[1,0]
    v_pk_add_f32 v[144:145], v[144:145], v[22:23] op_sel_hi:[1,0]
    v_pk_add_f32 v[146:147], v[146:147], v[22:23] op_sel_hi:[1,0]
    v_pk_add_f32 v[148:149], v[148:149], v[22:23] op_sel_hi:[1,0]
    v_pk_add_f32 v[150:151], v[150:151], v[22:23] op_sel_hi:[1,0]
    v_pk_add_f32 v[152:153], v[152:153], v[22:23] op_sel_hi:[1,0]
    v_pk_add_f32 v[154:155], v[154:155], v[22:23] op_sel_hi:[1,0]
    v_pk_add_f32 v[156:157], v[156:157], v[22:23] op_sel_hi:[1,0]
    v_pk_add_f32 v[158:159], v[158:159], v[22:23] op_sel_hi:[1,0]
    v_pk_add_f32 v[160:161], v[160:161], v[22:23] op_sel_hi:[1,0]
    v_pk_add_f32 v[162:163], v[162:163], v[22:23] op_sel_hi:[1,0]
    v_pk_add_f32 v[164:165], v[164:165], v[22:23] op_sel_hi:[1,0]
    v_pk_add_f32 v[166:167], v[166:167], v[22:23] op_sel_hi:[1,0]
    v_pk_add_f32 v[168:169], v[168:169], v[22:23] op_sel_hi:[1,0]
    v_pk_add_f32 v[170:171], v[170:171], v[22:23] op_sel_hi:[1,0]
    v_pk_add_f32 v[172:173], v[172:173], v[22:23] op_sel_hi:[1,0]
    v_pk_add_f32 v[174:175], v[174:175], v[22:23] op_sel_hi:[1,0]
    v_pk_add_f32 v[176:177], v[176:177], v[22:23] op_sel_hi:[1,0]
    v_pk_add_f32 v[178:179], v[178:179], v[22:23] op_sel_hi:[1,0]
    v_pk_add_f32 v[180:181], v[180:181], v[22:23] op_sel_hi:[1,0]
    v_pk_add_f32 v[182:183], v[182:183], v[22:23] op_sel_hi:[1,0]
    v_pk_add_f32 v[184:185], v[184:185], v[22:23] op_sel_hi:[1,0]
    v_pk_add_f32 v[186:187], v[186:187], v[22:23] op_sel_hi:[1,0]
    v_pk_add_f32 v[188:189], v[188:189], v[22:23] op_sel_hi:[1,0]
    v_pk_add_f32 v[190:191], v[190:191], v[22:23] op_sel_hi:[1,0]
    v_pk_fma_f32 v[24:25], v[128:129], v[128:129], v[24:25]
    v_pk_fma_f32 v[24:25], v[130:131], v[130:131], v[24:25]
    v_pk_fma_f32 v[24:25], v[132:133], v[132:133], v[24:25]
    v_pk_fma_f32 v[24:25], v[134:135], v[134:135], v[24:25]
    v_pk_fma_f32 v[24:25], v[136:137], v[136:137], v[24:25]
    v_pk_fma_f32 v[24:25], v[138:139], v[138:139], v[24:25]
    v_pk_fma_f32 v[24:25], v[140:141], v[140:141], v[24:25]
    v_pk_fma_f32 v[24:25], v[142:143], v[142:143], v[24:25]
    v_pk_fma_f32 v[24:25], v[144:145], v[144:145], v[24:25]
    v_pk_fma_f32 v[24:25], v[146:147], v[146:147], v[24:25]
    v_pk_fma_f32 v[24:25], v[148:149], v[148:149], v[24:25]
    v_pk_fma_f32 v[24:25], v[150:151], v[150:151], v[24:25]
    v_pk_fma_f32 v[24:25], v[152:153], v[152:153], v[24:25]
    v_pk_fma_f32 v[24:25], v[154:155], v[154:155], v[24:25]
    v_pk_fma_f32 v[24:25], v[156:157], v[156:157], v[24:25]
    v_pk_fma_f32 v[24:25], v[158:159], v[158:159], v[24:25]
    v_pk_fma_f32 v[24:25], v[160:161], v[160:161], v[24:25]
    v_pk_fma_f32 v[24:25], v[162:163], v[162:163], v[24:25]
    v_pk_fma_f32 v[24:25], v[164:165], v[164:165], v[24:25]
    v_pk_fma_f32 v[24:25], v[166:167], v[166:167], v[24:25]
    v_pk_fma_f32 v[24:25], v[168:169], v[168:169], v[24:25]
    v_pk_fma_f32 v[24:25], v[170:171], v[170:171], v[24:25]
    v_pk_fma_f32 v[24:25], v[172:173], v[172:173], v[24:25]
    v_pk_fma_f32 v[24:25], v[174:175], v[174:175], v[24:25]
    v_pk_fma_f32 v[26:27], v[176:177], v[176:177], v[26:27]
    v_pk_fma_f32 v[26:27], v[178:179], v[178:179], v[26:27]
    v_pk_fma_f32 v[26:27], v[180:181], v[180:181], v[26:27]
    v_pk_fma_f32 v[26:27], v[182:183], v[182:183], v[26:27]
    v_pk_fma_f32 v[26:27], v[184:185], v[184:185], v[26:27]
    v_pk_fma_f32 v[26:27], v[186:187], v[186:187], v[26:27]
    v_pk_fma_f32 v[26:27], v[188:189], v[188:189], v[26:27]
    v_pk_fma_f32 v[26:27], v[190:191], v[190:191], v[26:27]
    v_add_f32 v22, v24, v25
    v_add_f32 v23, v26, v27
    v_fmac_f32 v22, v23, v9
    s_nop 1
    v_add_f32_dpp v22, v22, v22 quad_perm:[1,0,3,2] row_mask:0xf bank_mask:0xf
    s_nop 1
    v_add_f32_dpp v22, v22, v22 quad_perm:[2,3,0,1] row_mask:0xf bank_mask:0xf
    s_nop 1
    v_add_f32_dpp v22, v22, v22 row_half_mirror row_mask:0xf bank_mask:0xf
    v_mov_b32 v23, 0x3727c5ac
    v_fmac_f32 v23, 0x3b124925, v22
    v_rsq_f32 v22, v23
    v_lshlrev_b32 v15, 4, v10
    v_lshl_add_u32 v15, v11, 10, v15
    v_add_u32 v3, 0, v11
    v_mul_u32_u24 v4, 37, v3
    v_lshrrev_b32 v4, 8, v4
    v_mul_u32_u24 v5, 7, v4
    v_sub_u32 v5, v3, v5
    v_lshlrev_b32 v16, 13, v4
    v_lshl_add_u32 v16, v5, 9, v16
    v_bfe_u32 v3, v10, 4, 1
    v_lshl_add_u32 v16, v3, 12, v16
    v_and_b32 v3, 15, v10
    v_lshl_add_u32 v16, v3, 4, v16
    v_add_u32 v3, 8, v11
    v_mul_u32_u24 v4, 37, v3
    v_lshrrev_b32 v4, 8, v4
    v_mul_u32_u24 v5, 7, v4
    v_sub_u32 v5, v3, v5
    v_lshlrev_b32 v17, 13, v4
    v_lshl_add_u32 v17, v5, 9, v17
    v_bfe_u32 v3, v10, 4, 1
    v_lshl_add_u32 v17, v3, 12, v17
    v_and_b32 v3, 15, v10
    v_lshl_add_u32 v17, v3, 4, v17
    v_add_u32 v3, 16, v11
    v_mul_u32_u24 v4, 37, v3
    v_lshrrev_b32 v4, 8, v4
    v_mul_u32_u24 v5, 7, v4
    v_sub_u32 v5, v3, v5
    v_lshlrev_b32 v18, 13, v4
    v_lshl_add_u32 v18, v5, 9, v18
    v_bfe_u32 v3, v10, 4, 1
    v_lshl_add_u32 v18, v3, 12, v18
    v_and_b32 v3, 15, v10
    v_lshl_add_u32 v18, v3, 4, v18
    v_add_u32 v3, 24, v11
    v_mul_u32_u24 v4, 37, v3
    v_lshrrev_b32 v4, 8, v4
    v_mul_u32_u24 v5, 7, v4
    v_sub_u32 v5, v3, v5
    v_lshlrev_b32 v19, 13, v4
    v_lshl_add_u32 v19, v5, 9, v19
    v_bfe_u32 v3, v10, 4, 1
    v_lshl_add_u32 v19, v3, 12, v19
    v_and_b32 v3, 15, v10
    v_lshl_add_u32 v19, v3, 4, v19
    v_mov_b32 v3, 0x40000000
    v_cmp_gt_u32 vcc, 4, v11
    v_add_u32 v20, 24576, v15
    s_nop 0
    v_cndmask_b32 v19, v3, v19, vcc
    v_cndmask_b32 v20, v3, v20, vcc
    v_bfe_u32 v21, v0, 6, 2
    v_lshlrev_b32 v21, 13, v21
    v_bfe_u32 v3, v0, 5, 1
    v_lshl_add_u32 v21, v3, 12, v21
    v_bfe_u32 v3, v0, 0, 5
    v_lshl_add_u32 v21, v3, 4, v21
    v_add_u32 v21, 0xe00, v21
    v_mov_b64 v[4:5], 0
    v_mov_b64 v[6:7], 0
    s_mul_i32 s26, s58, 28672
    s_add_u32 s26, s26, 54363136
    s_lshl_b32 s27, s58, 15
    s_add_u32 s27, s27, 12845056
    buffer_store_dwordx4 v[4:7], v21, s[8:11], s27 offen sc1
    s_waitcnt lgkmcnt(0)
    v_pk_mul_f32 v[128:129], v[128:129], v[22:23] op_sel_hi:[1,0]
    v_pk_fma_f32 v[128:129], v[128:129], v[192:193], v[64:65]
    v_pk_mul_f32 v[130:131], v[130:131], v[22:23] op_sel_hi:[1,0]
    v_pk_fma_f32 v[130:131], v[130:131], v[194:195], v[66:67]
    v_pk_mul_f32 v[132:133], v[132:133], v[22:23] op_sel_hi:[1,0]
    v_pk_fma_f32 v[132:133], v[132:133], v[196:197], v[68:69]
    v_pk_mul_f32 v[134:135], v[134:135], v[22:23] op_sel_hi:[1,0]
    v_pk_fma_f32 v[134:135], v[134:135], v[198:199], v[70:71]
    v_pk_mul_f32 v[136:137], v[136:137], v[22:23] op_sel_hi:[1,0]
    v_pk_fma_f32 v[136:137], v[136:137], v[200:201], v[72:73]
    v_pk_mul_f32 v[138:139], v[138:139], v[22:23] op_sel_hi:[1,0]
    v_pk_fma_f32 v[138:139], v[138:139], v[202:203], v[74:75]
    v_pk_mul_f32 v[140:141], v[140:141], v[22:23] op_sel_hi:[1,0]
    v_pk_fma_f32 v[140:141], v[140:141], v[204:205], v[76:77]
    v_pk_mul_f32 v[142:143], v[142:143], v[22:23] op_sel_hi:[1,0]
    v_pk_fma_f32 v[142:143], v[142:143], v[206:207], v[78:79]
    v_cvt_pk_bf16_f32 v24, v128, v129
    v_cvt_pk_bf16_f32 v25, v130, v131
    v_cvt_pk_bf16_f32 v26, v132, v133
    v_cvt_pk_bf16_f32 v27, v134, v135
    v_cvt_pk_bf16_f32 v28, v136, v137
    v_cvt_pk_bf16_f32 v29, v138, v139
    v_cvt_pk_bf16_f32 v30, v140, v141
    v_cvt_pk_bf16_f32 v31, v142, v143
    v_mov_b32 v32, v24
    v_mov_b32 v36, v25
    v_mov_b32 v33, v26
    v_mov_b32 v37, v27
    v_mov_b32 v34, v28
    v_mov_b32 v38, v29
    v_mov_b32 v35, v30
    v_mov_b32 v39, v31
    s_add_u32 s28, s26, 0
    buffer_store_dwordx4 v[24:27], v15, s[8:11], s28 offen sc1
    buffer_store_dwordx4 v[28:31], v15, s[8:11], s28 offen offset:512 sc1
    buffer_store_dwordx4 v[32:35], v16, s[8:11], s27 offen sc1
    buffer_store_dwordx4 v[36:39], v16, s[8:11], s27 offen offset:256 sc1
    v_pk_mul_f32 v[144:145], v[144:145], v[22:23] op_sel_hi:[1,0]
    v_pk_fma_f32 v[144:145], v[144:145], v[208:209], v[80:81]
    v_pk_mul_f32 v[146:147], v[146:147], v[22:23] op_sel_hi:[1,0]
    v_pk_fma_f32 v[146:147], v[146:147], v[210:211], v[82:83]
    v_pk_mul_f32 v[148:149], v[148:149], v[22:23] op_sel_hi:[1,0]
    v_pk_fma_f32 v[148:149], v[148:149], v[212:213], v[84:85]
    v_pk_mul_f32 v[150:151], v[150:151], v[22:23] op_sel_hi:[1,0]
    v_pk_fma_f32 v[150:151], v[150:151], v[214:215], v[86:87]
    v_pk_mul_f32 v[152:153], v[152:153], v[22:23] op_sel_hi:[1,0]
    v_pk_fma_f32 v[152:153], v[152:153], v[216:217], v[88:89]
    v_pk_mul_f32 v[154:155], v[154:155], v[22:23] op_sel_hi:[1,0]
    v_pk_fma_f32 v[154:155], v[154:155], v[218:219], v[90:91]
    v_pk_mul_f32 v[156:157], v[156:157], v[22:23] op_sel_hi:[1,0]
    v_pk_fma_f32 v[156:157], v[156:157], v[220:221], v[92:93]
    v_pk_mul_f32 v[158:159], v[158:159], v[22:23] op_sel_hi:[1,0]
    v_pk_fma_f32 v[158:159], v[158:159], v[222:223], v[94:95]
    v_cvt_pk_bf16_f32 v40, v144, v145
    v_cvt_pk_bf16_f32 v41, v146, v147
    v_cvt_pk_bf16_f32 v42, v148, v149
    v_cvt_pk_bf16_f32 v43, v150, v151
    v_cvt_pk_bf16_f32 v44, v152, v153
    v_cvt_pk_bf16_f32 v45, v154, v155
    v_cvt_pk_bf16_f32 v46, v156, v157
    v_cvt_pk_bf16_f32 v47, v158, v159
    v_mov_b32 v48, v40
    v_mov_b32 v52, v41
    v_mov_b32 v49, v42
    v_mov_b32 v53, v43
    v_mov_b32 v50, v44
    v_mov_b32 v54, v45
    v_mov_b32 v51, v46
    v_mov_b32 v55, v47
    s_add_u32 s28, s26, 8192
    buffer_store_dwordx4 v[40:43], v15, s[8:11], s28 offen sc1
    buffer_store_dwordx4 v[44:47], v15, s[8:11], s28 offen offset:512 sc1
    buffer_store_dwordx4 v[48:51], v17, s[8:11], s27 offen sc1
    buffer_store_dwordx4 v[52:55], v17, s[8:11], s27 offen offset:256 sc1
    v_pk_mul_f32 v[160:161], v[160:161], v[22:23] op_sel_hi:[1,0]
    v_pk_fma_f32 v[160:161], v[160:161], v[224:225], v[96:97]
    v_pk_mul_f32 v[162:163], v[162:163], v[22:23] op_sel_hi:[1,0]
    v_pk_fma_f32 v[162:163], v[162:163], v[226:227], v[98:99]
    v_pk_mul_f32 v[164:165], v[164:165], v[22:23] op_sel_hi:[1,0]
    v_pk_fma_f32 v[164:165], v[164:165], v[228:229], v[100:101]
    v_pk_mul_f32 v[166:167], v[166:167], v[22:23] op_sel_hi:[1,0]
    v_pk_fma_f32 v[166:167], v[166:167], v[230:231], v[102:103]
    v_pk_mul_f32 v[168:169], v[168:169], v[22:23] op_sel_hi:[1,0]
    v_pk_fma_f32 v[168:169], v[168:169], v[232:233], v[104:105]
    v_pk_mul_f32 v[170:171], v[170:171], v[22:23] op_sel_hi:[1,0]
    v_pk_fma_f32 v[170:171], v[170:171], v[234:235], v[106:107]
    v_pk_mul_f32 v[172:173], v[172:173], v[22:23] op_sel_hi:[1,0]
    v_pk_fma_f32 v[172:173], v[172:173], v[236:237], v[108:109]
    v_pk_mul_f32 v[174:175], v[174:175], v[22:23] op_sel_hi:[1,0]
    v_pk_fma_f32 v[174:175], v[174:175], v[238:239], v[110:111]
    v_cvt_pk_bf16_f32 v24, v160, v161
    v_cvt_pk_bf16_f32 v25, v162, v163
    v_cvt_pk_bf16_f32 v26, v164, v165
    v_cvt_pk_bf16_f32 v27, v166, v167
    v_cvt_pk_bf16_f32 v28, v168, v169
    v_cvt_pk_bf16_f32 v29, v170, v171
    v_cvt_pk_bf16_f32 v30, v172, v173
    v_cvt_pk_bf16_f32 v31, v174, v175
    v_mov_b32 v32, v24
    v_mov_b32 v36, v25
    v_mov_b32 v33, v26
    v_mov_b32 v37, v27
    v_mov_b32 v34, v28
    v_mov_b32 v38, v29
    v_mov_b32 v35, v30
    v_mov_b32 v39, v31
    s_add_u32 s28, s26, 16384
    buffer_store_dwordx4 v[24:27], v15, s[8:11], s28 offen sc1
    buffer_store_dwordx4 v[28:31], v15, s[8:11], s28 offen offset:512 sc1
    buffer_store_dwordx4 v[32:35], v18, s[8:11], s27 offen sc1
    buffer_store_dwordx4 v[36:39], v18, s[8:11], s27 offen offset:256 sc1
    v_pk_mul_f32 v[176:177], v[176:177], v[22:23] op_sel_hi:[1,0]
    v_pk_fma_f32 v[176:177], v[176:177], v[240:241], v[112:113]
    v_pk_mul_f32 v[178:179], v[178:179], v[22:23] op_sel_hi:[1,0]
    v_pk_fma_f32 v[178:179], v[178:179], v[242:243], v[114:115]
    v_pk_mul_f32 v[180:181], v[180:181], v[22:23] op_sel_hi:[1,0]
    v_pk_fma_f32 v[180:181], v[180:181], v[244:245], v[116:117]
    v_pk_mul_f32 v[182:183], v[182:183], v[22:23] op_sel_hi:[1,0]
    v_pk_fma_f32 v[182:183], v[182:183], v[246:247], v[118:119]
    v_pk_mul_f32 v[184:185], v[184:185], v[22:23] op_sel_hi:[1,0]
    v_pk_fma_f32 v[184:185], v[184:185], v[248:249], v[120:121]
    v_pk_mul_f32 v[186:187], v[186:187], v[22:23] op_sel_hi:[1,0]
    v_pk_fma_f32 v[186:187], v[186:187], v[250:251], v[122:123]
    v_pk_mul_f32 v[188:189], v[188:189], v[22:23] op_sel_hi:[1,0]
    v_pk_fma_f32 v[188:189], v[188:189], v[252:253], v[124:125]
    v_pk_mul_f32 v[190:191], v[190:191], v[22:23] op_sel_hi:[1,0]
    v_pk_fma_f32 v[190:191], v[190:191], v[254:255], v[126:127]
    v_cvt_pk_bf16_f32 v40, v176, v177
    v_cvt_pk_bf16_f32 v41, v178, v179
    v_cvt_pk_bf16_f32 v42, v180, v181
    v_cvt_pk_bf16_f32 v43, v182, v183
    v_cvt_pk_bf16_f32 v44, v184, v185
    v_cvt_pk_bf16_f32 v45, v186, v187
    v_cvt_pk_bf16_f32 v46, v188, v189
    v_cvt_pk_bf16_f32 v47, v190, v191
    v_mov_b32 v48, v40
    v_mov_b32 v52, v41
    v_mov_b32 v49, v42
    v_mov_b32 v53, v43
    v_mov_b32 v50, v44
    v_mov_b32 v54, v45
    v_mov_b32 v51, v46
    v_mov_b32 v55, v47
    buffer_store_dwordx4 v[40:43], v20, s[8:11], s26 offen sc1
    buffer_store_dwordx4 v[44:47], v20, s[8:11], s26 offen offset:512 sc1
    buffer_store_dwordx4 v[48:51], v19, s[8:11], s27 offen sc1
    buffer_store_dwordx4 v[52:55], v19, s[8:11], s27 offen offset:256 sc1
    s_lshl_b32 s24, s58, 7
    s_add_u32 s24, s24, 46866432
    s_waitcnt vmcnt(0)
    s_barrier
    s_cmp_lg_u32 s20, 0
    s_cbranch_scc1 P_f_4
    s_mov_b64 exec, 0xff
    v_mov_b32 v56, s96
    v_mov_b32 v57, s97
    v_mov_b32 v58, s96
    v_mov_b32 v59, s97
    buffer_store_dwordx4 v[56:59], v2, s[8:11], s24 offen sc1
    s_mov_b64 exec, -1
P_f_4:
    s_branch P_done
P_small:
    s_lshr_b32 s21, s2, 3
    s_mov_b32 s32, s48
    s_mov_b32 s33, s49
    s_mov_b32 s34, 1835008
    s_mov_b32 s35, 0x20000
    s_mov_b32 s36, s52
    s_mov_b32 s37, s53
    s_mov_b32 s38, 896
    s_mov_b32 s39, 0x20000
    s_mov_b32 s56, s54
    s_mov_b32 s57, s55
    s_mov_b32 s58, 2408448
    s_mov_b32 s59, 0x20000
    v_lshlrev_b32 v14, 2, v0
    buffer_load_dword v15, v14, s[36:39], 0 offen
    v_lshrrev_b32 v16, 2, v0
    v_mul_u32_u24 v17, 5376, v16
    v_and_b32 v3, 3, v0
    v_lshl_add_u32 v17, v3, 4, v17
    s_lshl_b32 s24, s21, 6
    s_cmp_ge_u32 s21, 28
    s_cselect_b32 s24, 0x40000000, s24
    buffer_load_dwordx4 v[128:131], v17, s[56:59], s24 offen
    s_add_u32 s24, s24, 344064
    buffer_load_dwordx4 v[132:135], v17, s[56:59], s24 offen
    s_add_u32 s24, s24, 344064
    buffer_load_dwordx4 v[136:139], v17, s[56:59], s24 offen
    s_add_u32 s24, s24, 344064
    buffer_load_dwordx4 v[140:143], v17, s[56:59], s24 offen
    s_add_u32 s24, s24, 344064
    buffer_load_dwordx4 v[144:147], v17, s[56:59], s24 offen
    s_add_u32 s24, s24, 344064
    buffer_load_dwordx4 v[148:151], v17, s[56:59], s24 offen
    s_add_u32 s24, s24, 344064
    buffer_load_dwordx4 v[152:155], v17, s[56:59], s24 offen
    s_add_u32 s24, s24, 344064
    v_lshrrev_b32 v10, 3, v0
    v_and_b32 v11, 7, v0
    v_mul_u32_u24 v17, 5376, v10
    v_lshl_add_u32 v17, v11, 4, v17
    s_lshl_b32 s24, s21, 7
    s_add_u32 s24, s24, 1792
    s_cmp_ge_u32 s21, 28
    s_cselect_b32 s24, 0x40000000, s24
    buffer_load_dwordx4 v[160:163], v17, s[56:59], s24 offen
    s_add_u32 s24, s24, 172032
    buffer_load_dwordx4 v[164:167], v17, s[56:59], s24 offen
    s_add_u32 s24, s24, 172032
    buffer_load_dwordx4 v[168:171], v17, s[56:59], s24 offen
    s_add_u32 s24, s24, 172032
    buffer_load_dwordx4 v[172:175], v17, s[56:59], s24 offen
    s_add_u32 s24, s24, 172032
    buffer_load_dwordx4 v[176:179], v17, s[56:59], s24 offen
    s_add_u32 s24, s24, 172032
    buffer_load_dwordx4 v[180:183], v17, s[56:59], s24 offen
    s_add_u32 s24, s24, 172032
    buffer_load_dwordx4 v[184:187], v17, s[56:59], s24 offen
    s_add_u32 s24, s24, 172032
    buffer_load_dwordx4 v[188:191], v17, s[56:59], s24 offen
    s_add_u32 s24, s24, 172032
    buffer_load_dwordx4 v[192:195], v17, s[56:59], s24 offen
    s_add_u32 s24, s24, 172032
    buffer_load_dwordx4 v[196:199], v17, s[56:59], s24 offen
    s_add_u32 s24, s24, 172032
    buffer_load_dwordx4 v[200:203], v17, s[56:59], s24 offen
    s_add_u32 s24, s24, 172032
    buffer_load_dwordx4 v[204:207], v17, s[56:59], s24 offen
    s_add_u32 s24, s24, 172032
    buffer_load_dwordx4 v[208:211], v17, s[56:59], s24 offen
    s_add_u32 s24, s24, 172032
    buffer_load_dwordx4 v[212:215], v17, s[56:59], s24 offen
    s_add_u32 s24, s24, 172032
    s_waitcnt vmcnt(21)
    v_lshlrev_b32 v18, 16, v15
    v_and_b32 v19, 0xffff0000, v15
    v_mul_f32 v3, 0xbfb8aa3b, v18
    v_exp_f32 v3, v3
    s_nop 0
    v_add_f32 v3, 1.0, v3
    v_rcp_f32 v3, v3
    s_nop 0
    v_mul_f32 v18, v18, v3
    v_mul_f32 v3, 0xbfb8aa3b, v19
    v_exp_f32 v3, v3
    s_nop 0
    v_add_f32 v3, 1.0, v3
    v_rcp_f32 v3, v3
    s_nop 0
    v_mul_f32 v19, v19, v3
    v_lshlrev_b32 v14, 3, v0
    ds_write_b64 v14, v[18:19]
    s_waitcnt lgkmcnt(0)
    s_barrier
    v_lshlrev_b32 v14, 2, v16
    ds_read_b32 v32, v14 offset:0
    ds_read_b32 v33, v14 offset:256
    ds_read_b32 v34, v14 offset:512
    ds_read_b32 v35, v14 offset:768
    ds_read_b32 v36, v14 offset:1024
    ds_read_b32 v37, v14 offset:1280
    ds_read_b32 v38, v14 offset:1536
    v_mov_b64 v[20:21], 0
    v_mov_b64 v[22:23], 0
    v_mov_b64 v[24:25], 0
    v_mov_b64 v[26:27], 0
    s_waitcnt lgkmcnt(0)
    s_waitcnt vmcnt(20)
    v_lshlrev_b32 v3, 16, v128
    v_and_b32 v4, 0xffff0000, v128
    v_fmac_f32 v20, v3, v32
    v_fmac_f32 v21, v4, v32
    v_lshlrev_b32 v3, 16, v129
    v_and_b32 v4, 0xffff0000, v129
    v_fmac_f32 v22, v3, v32
    v_fmac_f32 v23, v4, v32
    v_lshlrev_b32 v3, 16, v130
    v_and_b32 v4, 0xffff0000, v130
    v_fmac_f32 v24, v3, v32
    v_fmac_f32 v25, v4, v32
    v_lshlrev_b32 v3, 16, v131
    v_and_b32 v4, 0xffff0000, v131
    v_fmac_f32 v26, v3, v32
    v_fmac_f32 v27, v4, v32
    s_waitcnt vmcnt(19)
    v_lshlrev_b32 v3, 16, v132
    v_and_b32 v4, 0xffff0000, v132
    v_fmac_f32 v20, v3, v33
    v_fmac_f32 v21, v4, v33
    v_lshlrev_b32 v3, 16, v133
    v_and_b32 v4, 0xffff0000, v133
    v_fmac_f32 v22, v3, v33
    v_fmac_f32 v23, v4, v33
    v_lshlrev_b32 v3, 16, v134
    v_and_b32 v4, 0xffff0000, v134
    v_fmac_f32 v24, v3, v33
    v_fmac_f32 v25, v4, v33
    v_lshlrev_b32 v3, 16, v135
    v_and_b32 v4, 0xffff0000, v135
    v_fmac_f32 v26, v3, v33
    v_fmac_f32 v27, v4, v33
    s_waitcnt vmcnt(18)
    v_lshlrev_b32 v3, 16, v136
    v_and_b32 v4, 0xffff0000, v136
    v_fmac_f32 v20, v3, v34
    v_fmac_f32 v21, v4, v34
    v_lshlrev_b32 v3, 16, v137
    v_and_b32 v4, 0xffff0000, v137
    v_fmac_f32 v22, v3, v34
    v_fmac_f32 v23, v4, v34
    v_lshlrev_b32 v3, 16, v138
    v_and_b32 v4, 0xffff0000, v138
    v_fmac_f32 v24, v3, v34
    v_fmac_f32 v25, v4, v34
    v_lshlrev_b32 v3, 16, v139
    v_and_b32 v4, 0xffff0000, v139
    v_fmac_f32 v26, v3, v34
    v_fmac_f32 v27, v4, v34
    s_waitcnt vmcnt(17)
    v_lshlrev_b32 v3, 16, v140
    v_and_b32 v4, 0xffff0000, v140
    v_fmac_f32 v20, v3, v35
    v_fmac_f32 v21, v4, v35
    v_lshlrev_b32 v3, 16, v141
    v_and_b32 v4, 0xffff0000, v141
    v_fmac_f32 v22, v3, v35
    v_fmac_f32 v23, v4, v35
    v_lshlrev_b32 v3, 16, v142
    v_and_b32 v4, 0xffff0000, v142
    v_fmac_f32 v24, v3, v35
    v_fmac_f32 v25, v4, v35
    v_lshlrev_b32 v3, 16, v143
    v_and_b32 v4, 0xffff0000, v143
    v_fmac_f32 v26, v3, v35
    v_fmac_f32 v27, v4, v35
    s_waitcnt vmcnt(16)
    v_lshlrev_b32 v3, 16, v144
    v_and_b32 v4, 0xffff0000, v144
    v_fmac_f32 v20, v3, v36
    v_fmac_f32 v21, v4, v36
    v_lshlrev_b32 v3, 16, v145
    v_and_b32 v4, 0xffff0000, v145
    v_fmac_f32 v22, v3, v36
    v_fmac_f32 v23, v4, v36
    v_lshlrev_b32 v3, 16, v146
    v_and_b32 v4, 0xffff0000, v146
    v_fmac_f32 v24, v3, v36
    v_fmac_f32 v25, v4, v36
    v_lshlrev_b32 v3, 16, v147
    v_and_b32 v4, 0xffff0000, v147
    v_fmac_f32 v26, v3, v36
    v_fmac_f32 v27, v4, v36
    s_waitcnt vmcnt(15)
    v_lshlrev_b32 v3, 16, v148
    v_and_b32 v4, 0xffff0000, v148
    v_fmac_f32 v20, v3, v37
    v_fmac_f32 v21, v4, v37
    v_lshlrev_b32 v3, 16, v149
    v_and_b32 v4, 0xffff0000, v149
    v_fmac_f32 v22, v3, v37
    v_fmac_f32 v23, v4, v37
    v_lshlrev_b32 v3, 16, v150
    v_and_b32 v4, 0xffff0000, v150
    v_fmac_f32 v24, v3, v37
    v_fmac_f32 v25, v4, v37
    v_lshlrev_b32 v3, 16, v151
    v_and_b32 v4, 0xffff0000, v151
    v_fmac_f32 v26, v3, v37
    v_fmac_f32 v27, v4, v37
    s_waitcnt vmcnt(14)
    v_lshlrev_b32 v3, 16, v152
    v_and_b32 v4, 0xffff0000, v152
    v_fmac_f32 v20, v3, v38
    v_fmac_f32 v21, v4, v38
    v_lshlrev_b32 v3, 16, v153
    v_and_b32 v4, 0xffff0000, v153
    v_fmac_f32 v22, v3, v38
    v_fmac_f32 v23, v4, v38
    v_lshlrev_b32 v3, 16, v154
    v_and_b32 v4, 0xffff0000, v154
    v_fmac_f32 v24, v3, v38
    v_fmac_f32 v25, v4, v38
    v_lshlrev_b32 v3, 16, v155
    v_and_b32 v4, 0xffff0000, v155
    v_fmac_f32 v26, v3, v38
    v_fmac_f32 v27, v4, v38
    v_lshlrev_b32 v14, 5, v0
    ds_write_b128 v14, v[20:23] offset:4096
    ds_write_b128 v14, v[24:27] offset:4112
    s_waitcnt lgkmcnt(0)
    s_barrier
    v_and_b32 v14, 7, v0
    v_lshrrev_b32 v3, 3, v0
    v_lshlrev_b32 v14, 10, v14
    v_lshl_add_u32 v14, v3, 2, v14
    ds_read_b32 v32, v14 offset:4096
    ds_read_b32 v33, v14 offset:4224
    ds_read_b32 v34, v14 offset:4352
    ds_read_b32 v35, v14 offset:4480
    ds_read_b32 v36, v14 offset:4608
    ds_read_b32 v37, v14 offset:4736
    ds_read_b32 v38, v14 offset:4864
    ds_read_b32 v39, v14 offset:4992
    s_waitcnt lgkmcnt(0)
    v_add_f32 v32, v32, v33
    v_add_f32 v32, v32, v34
    v_add_f32 v32, v32, v35
    v_add_f32 v32, v32, v36
    v_add_f32 v32, v32, v37
    v_add_f32 v32, v32, v38
    v_add_f32 v32, v32, v39
    s_nop 1
    v_add_f32_dpp v32, v32, v32 quad_perm:[1,0,3,2] row_mask:0xf bank_mask:0xf
    s_nop 1
    v_add_f32_dpp v32, v32, v32 quad_perm:[2,3,0,1] row_mask:0xf bank_mask:0xf
    s_nop 1
    v_add_f32_dpp v32, v32, v32 row_half_mirror row_mask:0xf bank_mask:0xf
    v_lshlrev_b32 v14, 2, v3
    s_mul_i32 s24, s21, 128
    s_add_u32 s24, s24, 85558272
    s_cmp_ge_u32 s21, 28
    s_cselect_b32 s24, 0x40000000, s24
    buffer_store_dword v32, v14, s[8:11], s24 offen sc1
    s_waitcnt vmcnt(1)
    s_barrier
    v_lshlrev_b32 v14, 2, v10
    ds_read_b32 v32, v14 offset:0
    ds_read_b32 v33, v14 offset:128
    ds_read_b32 v34, v14 offset:256
    ds_read_b32 v35, v14 offset:384
    ds_read_b32 v36, v14 offset:512
    ds_read_b32 v37, v14 offset:640
    ds_read_b32 v38, v14 offset:768
    ds_read_b32 v39, v14 offset:896
    ds_read_b32 v40, v14 offset:1024
    ds_read_b32 v41, v14 offset:1152
    ds_read_b32 v42, v14 offset:1280
    ds_read_b32 v43, v14 offset:1408
    ds_read_b32 v44, v14 offset:1536
    ds_read_b32 v45, v14 offset:1664
    v_mov_b64 v[20:21], 0
    v_mov_b64 v[22:23], 0
    v_mov_b64 v[24:25], 0
    v_mov_b64 v[26:27], 0
    s_waitcnt lgkmcnt(0)
    v_lshlrev_b32 v3, 16, v160
    v_and_b32 v4, 0xffff0000, v160
    v_fmac_f32 v20, v3, v32
    v_fmac_f32 v21, v4, v32
    v_lshlrev_b32 v3, 16, v161
    v_and_b32 v4, 0xffff0000, v161
    v_fmac_f32 v22, v3, v32
    v_fmac_f32 v23, v4, v32
    v_lshlrev_b32 v3, 16, v162
    v_and_b32 v4, 0xffff0000, v162
    v_fmac_f32 v24, v3, v32
    v_fmac_f32 v25, v4, v32
    v_lshlrev_b32 v3, 16, v163
    v_and_b32 v4, 0xffff0000, v163
    v_fmac_f32 v26, v3, v32
    v_fmac_f32 v27, v4, v32
    v_lshlrev_b32 v3, 16, v164
    v_and_b32 v4, 0xffff0000, v164
    v_fmac_f32 v20, v3, v33
    v_fmac_f32 v21, v4, v33
    v_lshlrev_b32 v3, 16, v165
    v_and_b32 v4, 0xffff0000, v165
    v_fmac_f32 v22, v3, v33
    v_fmac_f32 v23, v4, v33
    v_lshlrev_b32 v3, 16, v166
    v_and_b32 v4, 0xffff0000, v166
    v_fmac_f32 v24, v3, v33
    v_fmac_f32 v25, v4, v33
    v_lshlrev_b32 v3, 16, v167
    v_and_b32 v4, 0xffff0000, v167
    v_fmac_f32 v26, v3, v33
    v_fmac_f32 v27, v4, v33
    v_lshlrev_b32 v3, 16, v168
    v_and_b32 v4, 0xffff0000, v168
    v_fmac_f32 v20, v3, v34
    v_fmac_f32 v21, v4, v34
    v_lshlrev_b32 v3, 16, v169
    v_and_b32 v4, 0xffff0000, v169
    v_fmac_f32 v22, v3, v34
    v_fmac_f32 v23, v4, v34
    v_lshlrev_b32 v3, 16, v170
    v_and_b32 v4, 0xffff0000, v170
    v_fmac_f32 v24, v3, v34
    v_fmac_f32 v25, v4, v34
    v_lshlrev_b32 v3, 16, v171
    v_and_b32 v4, 0xffff0000, v171
    v_fmac_f32 v26, v3, v34
    v_fmac_f32 v27, v4, v34
    v_lshlrev_b32 v3, 16, v172
    v_and_b32 v4, 0xffff0000, v172
    v_fmac_f32 v20, v3, v35
    v_fmac_f32 v21, v4, v35
    v_lshlrev_b32 v3, 16, v173
    v_and_b32 v4, 0xffff0000, v173
    v_fmac_f32 v22, v3, v35
    v_fmac_f32 v23, v4, v35
    v_lshlrev_b32 v3, 16, v174
    v_and_b32 v4, 0xffff0000, v174
    v_fmac_f32 v24, v3, v35
    v_fmac_f32 v25, v4, v35
    v_lshlrev_b32 v3, 16, v175
    v_and_b32 v4, 0xffff0000, v175
    v_fmac_f32 v26, v3, v35
    v_fmac_f32 v27, v4, v35
    v_lshlrev_b32 v3, 16, v176
    v_and_b32 v4, 0xffff0000, v176
    v_fmac_f32 v20, v3, v36
    v_fmac_f32 v21, v4, v36
    v_lshlrev_b32 v3, 16, v177
    v_and_b32 v4, 0xffff0000, v177
    v_fmac_f32 v22, v3, v36
    v_fmac_f32 v23, v4, v36
    v_lshlrev_b32 v3, 16, v178
    v_and_b32 v4, 0xffff0000, v178
    v_fmac_f32 v24, v3, v36
    v_fmac_f32 v25, v4, v36
    v_lshlrev_b32 v3, 16, v179
    v_and_b32 v4, 0xffff0000, v179
    v_fmac_f32 v26, v3, v36
    v_fmac_f32 v27, v4, v36
    v_lshlrev_b32 v3, 16, v180
    v_and_b32 v4, 0xffff0000, v180
    v_fmac_f32 v20, v3, v37
    v_fmac_f32 v21, v4, v37
    v_lshlrev_b32 v3, 16, v181
    v_and_b32 v4, 0xffff0000, v181
    v_fmac_f32 v22, v3, v37
    v_fmac_f32 v23, v4, v37
    v_lshlrev_b32 v3, 16, v182
    v_and_b32 v4, 0xffff0000, v182
    v_fmac_f32 v24, v3, v37
    v_fmac_f32 v25, v4, v37
    v_lshlrev_b32 v3, 16, v183
    v_and_b32 v4, 0xffff0000, v183
    v_fmac_f32 v26, v3, v37
    v_fmac_f32 v27, v4, v37
    v_lshlrev_b32 v3, 16, v184
    v_and_b32 v4, 0xffff0000, v184
    v_fmac_f32 v20, v3, v38
    v_fmac_f32 v21, v4, v38
    v_lshlrev_b32 v3, 16, v185
    v_and_b32 v4, 0xffff0000, v185
    v_fmac_f32 v22, v3, v38
    v_fmac_f32 v23, v4, v38
    v_lshlrev_b32 v3, 16, v186
    v_and_b32 v4, 0xffff0000, v186
    v_fmac_f32 v24, v3, v38
    v_fmac_f32 v25, v4, v38
    v_lshlrev_b32 v3, 16, v187
    v_and_b32 v4, 0xffff0000, v187
    v_fmac_f32 v26, v3, v38
    v_fmac_f32 v27, v4, v38
    v_lshlrev_b32 v3, 16, v188
    v_and_b32 v4, 0xffff0000, v188
    v_fmac_f32 v20, v3, v39
    v_fmac_f32 v21, v4, v39
    v_lshlrev_b32 v3, 16, v189
    v_and_b32 v4, 0xffff0000, v189
    v_fmac_f32 v22, v3, v39
    v_fmac_f32 v23, v4, v39
    v_lshlrev_b32 v3, 16, v190
    v_and_b32 v4, 0xffff0000, v190
    v_fmac_f32 v24, v3, v39
    v_fmac_f32 v25, v4, v39
    v_lshlrev_b32 v3, 16, v191
    v_and_b32 v4, 0xffff0000, v191
    v_fmac_f32 v26, v3, v39
    v_fmac_f32 v27, v4, v39
    v_lshlrev_b32 v3, 16, v192
    v_and_b32 v4, 0xffff0000, v192
    v_fmac_f32 v20, v3, v40
    v_fmac_f32 v21, v4, v40
    v_lshlrev_b32 v3, 16, v193
    v_and_b32 v4, 0xffff0000, v193
    v_fmac_f32 v22, v3, v40
    v_fmac_f32 v23, v4, v40
    v_lshlrev_b32 v3, 16, v194
    v_and_b32 v4, 0xffff0000, v194
    v_fmac_f32 v24, v3, v40
    v_fmac_f32 v25, v4, v40
    v_lshlrev_b32 v3, 16, v195
    v_and_b32 v4, 0xffff0000, v195
    v_fmac_f32 v26, v3, v40
    v_fmac_f32 v27, v4, v40
    v_lshlrev_b32 v3, 16, v196
    v_and_b32 v4, 0xffff0000, v196
    v_fmac_f32 v20, v3, v41
    v_fmac_f32 v21, v4, v41
    v_lshlrev_b32 v3, 16, v197
    v_and_b32 v4, 0xffff0000, v197
    v_fmac_f32 v22, v3, v41
    v_fmac_f32 v23, v4, v41
    v_lshlrev_b32 v3, 16, v198
    v_and_b32 v4, 0xffff0000, v198
    v_fmac_f32 v24, v3, v41
    v_fmac_f32 v25, v4, v41
    v_lshlrev_b32 v3, 16, v199
    v_and_b32 v4, 0xffff0000, v199
    v_fmac_f32 v26, v3, v41
    v_fmac_f32 v27, v4, v41
    v_lshlrev_b32 v3, 16, v200
    v_and_b32 v4, 0xffff0000, v200
    v_fmac_f32 v20, v3, v42
    v_fmac_f32 v21, v4, v42
    v_lshlrev_b32 v3, 16, v201
    v_and_b32 v4, 0xffff0000, v201
    v_fmac_f32 v22, v3, v42
    v_fmac_f32 v23, v4, v42
    v_lshlrev_b32 v3, 16, v202
    v_and_b32 v4, 0xffff0000, v202
    v_fmac_f32 v24, v3, v42
    v_fmac_f32 v25, v4, v42
    v_lshlrev_b32 v3, 16, v203
    v_and_b32 v4, 0xffff0000, v203
    v_fmac_f32 v26, v3, v42
    v_fmac_f32 v27, v4, v42
    v_lshlrev_b32 v3, 16, v204
    v_and_b32 v4, 0xffff0000, v204
    v_fmac_f32 v20, v3, v43
    v_fmac_f32 v21, v4, v43
    v_lshlrev_b32 v3, 16, v205
    v_and_b32 v4, 0xffff0000, v205
    v_fmac_f32 v22, v3, v43
    v_fmac_f32 v23, v4, v43
    v_lshlrev_b32 v3, 16, v206
    v_and_b32 v4, 0xffff0000, v206
    v_fmac_f32 v24, v3, v43
    v_fmac_f32 v25, v4, v43
    v_lshlrev_b32 v3, 16, v207
    v_and_b32 v4, 0xffff0000, v207
    v_fmac_f32 v26, v3, v43
    v_fmac_f32 v27, v4, v43
    v_lshlrev_b32 v3, 16, v208
    v_and_b32 v4, 0xffff0000, v208
    v_fmac_f32 v20, v3, v44
    v_fmac_f32 v21, v4, v44
    v_lshlrev_b32 v3, 16, v209
    v_and_b32 v4, 0xffff0000, v209
    v_fmac_f32 v22, v3, v44
    v_fmac_f32 v23, v4, v44
    v_lshlrev_b32 v3, 16, v210
    v_and_b32 v4, 0xffff0000, v210
    v_fmac_f32 v24, v3, v44
    v_fmac_f32 v25, v4, v44
    v_lshlrev_b32 v3, 16, v211
    v_and_b32 v4, 0xffff0000, v211
    v_fmac_f32 v26, v3, v44
    v_fmac_f32 v27, v4, v44
    v_lshlrev_b32 v3, 16, v212
    v_and_b32 v4, 0xffff0000, v212
    v_fmac_f32 v20, v3, v45
    v_fmac_f32 v21, v4, v45
    v_lshlrev_b32 v3, 16, v213
    v_and_b32 v4, 0xffff0000, v213
    v_fmac_f32 v22, v3, v45
    v_fmac_f32 v23, v4, v45
    v_lshlrev_b32 v3, 16, v214
    v_and_b32 v4, 0xffff0000, v214
    v_fmac_f32 v24, v3, v45
    v_fmac_f32 v25, v4, v45
    v_lshlrev_b32 v3, 16, v215
    v_and_b32 v4, 0xffff0000, v215
    v_fmac_f32 v26, v3, v45
    v_fmac_f32 v27, v4, v45
    v_lshlrev_b32 v14, 5, v0
    ds_write_b128 v14, v[20:23] offset:4096
    ds_write_b128 v14, v[24:27] offset:4112
    s_waitcnt lgkmcnt(0)
    s_barrier
    v_and_b32 v14, 3, v0
    v_lshrrev_b32 v3, 2, v0
    v_lshlrev_b32 v14, 11, v14
    v_lshl_add_u32 v14, v3, 2, v14
    ds_read_b32 v32, v14 offset:4096
    ds_read_b32 v33, v14 offset:4352
    ds_read_b32 v34, v14 offset:4608
    ds_read_b32 v35, v14 offset:4864
    ds_read_b32 v36, v14 offset:5120
    ds_read_b32 v37, v14 offset:5376
    ds_read_b32 v38, v14 offset:5632
    ds_read_b32 v39, v14 offset:5888
    s_waitcnt lgkmcnt(0)
    v_add_f32 v32, v32, v33
    v_add_f32 v32, v32, v34
    v_add_f32 v32, v32, v35
    v_add_f32 v32, v32, v36
    v_add_f32 v32, v32, v37
    v_add_f32 v32, v32, v38
    v_add_f32 v32, v32, v39
    s_nop 1
    v_add_f32_dpp v32, v32, v32 quad_perm:[1,0,3,2] row_mask:0xf bank_mask:0xf
    s_nop 1
    v_add_f32_dpp v32, v32, v32 quad_perm:[2,3,0,1] row_mask:0xf bank_mask:0xf
    v_lshlrev_b32 v14, 2, v3
    s_mul_i32 s24, s21, 256
    s_add_u32 s24, s24, 85561856
    s_cmp_ge_u32 s21, 28
    s_cselect_b32 s24, 0x40000000, s24
    buffer_store_dword v32, v14, s[8:11], s24 offen sc1
    s_cmp_lg_u32 s21, 31
    s_cbranch_scc1 P_nomem
    s_mov_b32 s24, s50
    s_mov_b32 s25, s51
    s_mov_b32 s26, 7168
    s_mov_b32 s27, 0x20000
    v_and_b32 v14, 7, v0
    v_mul_u32_u24 v15, 896, v14
    v_lshrrev_b32 v16, 3, v0
    v_lshl_add_u32 v15, v16, 5, v15
    v_mov_b32 v3, 0x40000000
    v_cmp_gt_u32 vcc, 224, v0
    s_nop 1
    v_cndmask_b32 v15, v3, v15, vcc
    buffer_load_dwordx4 v[20:23], v15, s[24:27], 0 offen
    buffer_load_dwordx4 v[24:27], v15, s[24:27], 0 offen offset:16
    v_bfe_u32 v17, v0, 3, 5
    v_lshlrev_b32 v17, 8, v17
    v_bfe_u32 v4, v0, 1, 2
    v_lshl_add_u32 v17, v4, 6, v17
    v_bfe_u32 v4, v0, 0, 1
    v_lshl_add_u32 v17, v4, 4, v17
    v_cndmask_b32 v17, v3, v17, vcc
    s_mov_b32 s28, 44302336
    s_waitcnt vmcnt(0)
    v_min_u32 v20, -2, v20
    v_min_u32 v21, -2, v21
    v_min_u32 v22, -2, v22
    v_min_u32 v23, -2, v23
    v_min_u32 v24, -2, v24
    v_min_u32 v25, -2, v25
    v_min_u32 v26, -2, v26
    v_min_u32 v27, -2, v27
    v_mov_b32 v28, v20
    v_mov_b32 v29, v22
    v_mov_b32 v30, v24
    v_mov_b32 v31, v26
    v_mov_b32 v32, v21
    v_mov_b32 v33, v23
    v_mov_b32 v34, v25
    v_mov_b32 v35, v27
    buffer_store_dwordx4 v[28:31], v17, s[8:11], s28 offen sc1
    buffer_store_dwordx4 v[32:35], v17, s[8:11], s28 offen offset:32 sc1
    v_and_b32 v14, 31, v0
    v_cmp_gt_u32 vcc, 28, v14
    s_nop 1
    v_cndmask_b32 v15, -1, 0, vcc
    v_lshlrev_b32 v14, 2, v0
    s_mov_b32 s28, 44309504
    buffer_store_dword v15, v14, s[8:11], s28 offen sc1
P_nomem:
    v_mov_b32 v60, 0
    buffer_load_dwordx2 v[56:57], v60, s[12:15], 0 offen offset:128 sc1
    s_mov_b32 s47, 400000
    s_branch L_tag_s_c
L_tag_s:
    buffer_load_dwordx2 v[56:57], v60, s[12:15], 0 offen offset:128 sc1
L_tag_s_c:
    s_waitcnt vmcnt(0)
    v_min_u32 v59, v56, v57
    v_cmp_eq_u32 vcc, 0, v59
    s_cbranch_vccz L_tag_s_ok
    s_sub_u32 s47, s47, 1
    s_cbranch_scc0 L_tag_s
    s_branch L_fail
L_tag_s_ok:
    v_readfirstlane_b32 s96, v56
    v_readfirstlane_b32 s97, v57
    v_mov_b32 v58, s95
    s_lshl_b32 s3, s2, 7
    s_add_u32 s3, s3, 46874624
    s_cmp_eq_u32 s20, 0
    s_cselect_b32 s3, s3, 0x40000000
    s_mov_b64 exec, 0xff
    buffer_store_dwordx4 v[56:59], v2, s[8:11], s3 offen sc1
    s_mov_b64 exec, -1
    s_lshl_b32 s24, s21, 7
    s_add_u32 s24, s24, 46862336
    s_waitcnt vmcnt(0)
    s_barrier
    s_cmp_lg_u32 s20, 0
    s_cbranch_scc1 P_f_5
    s_mov_b64 exec, 0xff
    v_mov_b32 v56, s96
    v_mov_b32 v57, s97
    v_mov_b32 v58, s96
    v_mov_b32 v59, s97
    buffer_store_dwordx4 v[56:59], v2, s[8:11], s24 offen sc1
    s_mov_b64 exec, -1
P_f_5:
    v_lshlrev_b32 v60, 7, v1
    s_mov_b32 s3, 46874624
    buffer_load_dwordx3 v[40:42], v60, s[8:11], s3 offen sc1
    s_mov_b32 s3, 46882816
    buffer_load_dwordx3 v[44:46], v60, s[8:11], s3 offen sc1
    s_mov_b32 s3, 46891008
    buffer_load_dwordx3 v[48:50], v60, s[8:11], s3 offen sc1
    s_mov_b32 s3, 46899200
    buffer_load_dwordx3 v[52:54], v60, s[8:11], s3 offen sc1
    s_mov_b32 s47, 400000
    s_branch L_tk_s_c
L_tk_s:
    s_mov_b32 s3, 46874624
    buffer_load_dwordx3 v[40:42], v60, s[8:11], s3 offen sc1
    s_mov_b32 s3, 46882816
    buffer_load_dwordx3 v[44:46], v60, s[8:11], s3 offen sc1
    s_mov_b32 s3, 46891008
    buffer_load_dwordx3 v[48:50], v60, s[8:11], s3 offen sc1
    s_mov_b32 s3, 46899200
    buffer_load_dwordx3 v[52:54], v60, s[8:11], s3 offen sc1
L_tk_s_c:
    v_mov_b32 v59, 0
    s_waitcnt vmcnt(0)
    v_xor_b32 v40, s96, v40
    v_xor_b32 v41, s97, v41
    v_or3_b32 v59, v59, v40, v41
    v_xor_b32 v44, s96, v44
    v_xor_b32 v45, s97, v45
    v_or3_b32 v59, v59, v44, v45
    v_xor_b32 v48, s96, v48
    v_xor_b32 v49, s97, v49
    v_or3_b32 v59, v59, v48, v49
    v_xor_b32 v52, s96, v52
    v_xor_b32 v53, s97, v53
    v_or3_b32 v59, v59, v52, v53
    v_cmp_ne_u32 vcc, 0, v59
    s_cbranch_vccz L_tk_s_ok
    s_sub_u32 s47, s47, 1
    s_cbranch_scc0 L_tk_s
    s_branch L_fail
L_tk_s_ok:
    s_mov_b32 s46, 0
    s_mov_b32 s89, 0x100
    v_add_u32 v56, 192, v1
    v_cmp_eq_u32 s[80:81], s95, v54
    v_cmp_gt_u32 vcc, s2, v56
    s_ff1_i32_b64 s3, s[80:81]
    s_add_u32 s90, s3, 192
    s_cmp_lg_u32 s3, -1
    s_cselect_b32 s89, s90, s89
    s_and_b64 s[80:81], s[80:81], vcc
    s_bcnt1_i32_b64 s3, s[80:81]
    s_add_u32 s46, s46, s3
    v_add_u32 v56, 128, v1
    v_cmp_eq_u32 s[80:81], s95, v50
    v_cmp_gt_u32 vcc, s2, v56
    s_ff1_i32_b64 s3, s[80:81]
    s_add_u32 s90, s3, 128
    s_cmp_lg_u32 s3, -1
    s_cselect_b32 s89, s90, s89
    s_and_b64 s[80:81], s[80:81], vcc
    s_bcnt1_i32_b64 s3, s[80:81]
    s_add_u32 s46, s46, s3
    v_add_u32 v56, 64, v1
    v_cmp_eq_u32 s[80:81], s95, v46
    v_cmp_gt_u32 vcc, s2, v56
    s_ff1_i32_b64 s3, s[80:81]
    s_add_u32 s90, s3, 64
    s_cmp_lg_u32 s3, -1
    s_cselect_b32 s89, s90, s89
    s_and_b64 s[80:81], s[80:81], vcc
    s_bcnt1_i32_b64 s3, s[80:81]
    s_add_u32 s46, s46, s3
    v_add_u32 v56, 0, v1
    v_cmp_eq_u32 s[80:81], s95, v42
    v_cmp_gt_u32 vcc, s2, v56
    s_ff1_i32_b64 s3, s[80:81]
    s_add_u32 s90, s3, 0
    s_cmp_lg_u32 s3, -1
    s_cselect_b32 s89, s90, s89
    s_and_b64 s[80:81], s[80:81], vcc
    s_bcnt1_i32_b64 s3, s[80:81]
    s_add_u32 s46, s46, s3
    s_mov_b32 s94, 0
    s_mov_b32 s91, 0
    v_add_u32 v56, 0, v1
    v_cmp_gt_u32 s[64:65], s89, v56
    v_add_u32 v56, 64, v1
    v_cmp_gt_u32 s[66:67], s89, v56
    v_add_u32 v56, 128, v1
    v_cmp_gt_u32 s[68:69], s89, v56
    v_add_u32 v56, 192, v1
    v_cmp_gt_u32 s[70:71], s89, v56
    v_cmp_eq_u32 s[80:81], 0, v42
    v_cmp_eq_u32 s[82:83], 0, v46
    v_cmp_eq_u32 s[84:85], 0, v50
    v_cmp_eq_u32 s[86:87], 0, v54
    s_mov_b32 s90, 0
    s_mov_b64 s[72:73], 0
    s_bcnt1_i32_b64 s3, s[80:81]
    s_add_u32 s90, s90, s3
    s_and_b64 s[74:75], s[80:81], s[64:65]
    s_or_b64 s[72:73], s[72:73], s[74:75]
    s_bcnt1_i32_b64 s3, s[82:83]
    s_add_u32 s90, s90, s3
    s_and_b64 s[74:75], s[82:83], s[66:67]
    s_or_b64 s[72:73], s[72:73], s[74:75]
    s_bcnt1_i32_b64 s3, s[84:85]
    s_add_u32 s90, s90, s3
    s_and_b64 s[74:75], s[84:85], s[68:69]
    s_or_b64 s[72:73], s[72:73], s[74:75]
    s_bcnt1_i32_b64 s3, s[86:87]
    s_add_u32 s90, s90, s3
    s_and_b64 s[74:75], s[86:87], s[70:71]
    s_or_b64 s[72:73], s[72:73], s[74:75]
    s_cselect_b32 s3, s90, 0
    s_add_u32 s91, s91, s3
    s_cmp_lg_u32 s90, 32
    s_cselect_b32 s94, 1, s94
    v_cmp_eq_u32 s[80:81], 1, v42
    v_cmp_eq_u32 s[82:83], 1, v46
    v_cmp_eq_u32 s[84:85], 1, v50
    v_cmp_eq_u32 s[86:87], 1, v54
    s_mov_b32 s90, 0
    s_mov_b64 s[72:73], 0
    s_bcnt1_i32_b64 s3, s[80:81]
    s_add_u32 s90, s90, s3
    s_and_b64 s[74:75], s[80:81], s[64:65]
    s_or_b64 s[72:73], s[72:73], s[74:75]
    s_bcnt1_i32_b64 s3, s[82:83]
    s_add_u32 s90, s90, s3
    s_and_b64 s[74:75], s[82:83], s[66:67]
    s_or_b64 s[72:73], s[72:73], s[74:75]
    s_bcnt1_i32_b64 s3, s[84:85]
    s_add_u32 s90, s90, s3
    s_and_b64 s[74:75], s[84:85], s[68:69]
    s_or_b64 s[72:73], s[72:73], s[74:75]
    s_bcnt1_i32_b64 s3, s[86:87]
    s_add_u32 s90, s90, s3
    s_and_b64 s[74:75], s[86:87], s[70:71]
    s_or_b64 s[72:73], s[72:73], s[74:75]
    s_cselect_b32 s3, s90, 0
    s_add_u32 s91, s91, s3
    s_cmp_lg_u32 s90, 32
    s_cselect_b32 s94, 1, s94
    v_cmp_eq_u32 s[80:81], 2, v42
    v_cmp_eq_u32 s[82:83], 2, v46
    v_cmp_eq_u32 s[84:85], 2, v50
    v_cmp_eq_u32 s[86:87], 2, v54
    s_mov_b32 s90, 0
    s_mov_b64 s[72:73], 0
    s_bcnt1_i32_b64 s3, s[80:81]
    s_add_u32 s90, s90, s3
    s_and_b64 s[74:75], s[80:81], s[64:65]
    s_or_b64 s[72:73], s[72:73], s[74:75]
    s_bcnt1_i32_b64 s3, s[82:83]
    s_add_u32 s90, s90, s3
    s_and_b64 s[74:75], s[82:83], s[66:67]
    s_or_b64 s[72:73], s[72:73], s[74:75]
    s_bcnt1_i32_b64 s3, s[84:85]
    s_add_u32 s90, s90, s3
    s_and_b64 s[74:75], s[84:85], s[68:69]
    s_or_b64 s[72:73], s[72:73], s[74:75]
    s_bcnt1_i32_b64 s3, s[86:87]
    s_add_u32 s90, s90, s3
    s_and_b64 s[74:75], s[86:87], s[70:71]
    s_or_b64 s[72:73], s[72:73], s[74:75]
    s_cselect_b32 s3, s90, 0
    s_add_u32 s91, s91, s3
    s_cmp_lg_u32 s90, 32
    s_cselect_b32 s94, 1, s94
    v_cmp_eq_u32 s[80:81], 3, v42
    v_cmp_eq_u32 s[82:83], 3, v46
    v_cmp_eq_u32 s[84:85], 3, v50
    v_cmp_eq_u32 s[86:87], 3, v54
    s_mov_b32 s90, 0
    s_mov_b64 s[72:73], 0
    s_bcnt1_i32_b64 s3, s[80:81]
    s_add_u32 s90, s90, s3
    s_and_b64 s[74:75], s[80:81], s[64:65]
    s_or_b64 s[72:73], s[72:73], s[74:75]
    s_bcnt1_i32_b64 s3, s[82:83]
    s_add_u32 s90, s90, s3
    s_and_b64 s[74:75], s[82:83], s[66:67]
    s_or_b64 s[72:73], s[72:73], s[74:75]
    s_bcnt1_i32_b64 s3, s[84:85]
    s_add_u32 s90, s90, s3
    s_and_b64 s[74:75], s[84:85], s[68:69]
    s_or_b64 s[72:73], s[72:73], s[74:75]
    s_bcnt1_i32_b64 s3, s[86:87]
    s_add_u32 s90, s90, s3
    s_and_b64 s[74:75], s[86:87], s[70:71]
    s_or_b64 s[72:73], s[72:73], s[74:75]
    s_cselect_b32 s3, s90, 0
    s_add_u32 s91, s91, s3
    s_cmp_lg_u32 s90, 32
    s_cselect_b32 s94, 1, s94
    v_cmp_eq_u32 s[80:81], 4, v42
    v_cmp_eq_u32 s[82:83], 4, v46
    v_cmp_eq_u32 s[84:85], 4, v50
    v_cmp_eq_u32 s[86:87], 4, v54
    s_mov_b32 s90, 0
    s_mov_b64 s[72:73], 0
    s_bcnt1_i32_b64 s3, s[80:81]
    s_add_u32 s90, s90, s3
    s_and_b64 s[74:75], s[80:81], s[64:65]
    s_or_b64 s[72:73], s[72:73], s[74:75]
    s_bcnt1_i32_b64 s3, s[82:83]
    s_add_u32 s90, s90, s3
    s_and_b64 s[74:75], s[82:83], s[66:67]
    s_or_b64 s[72:73], s[72:73], s[74:75]
    s_bcnt1_i32_b64 s3, s[84:85]
    s_add_u32 s90, s90, s3
    s_and_b64 s[74:75], s[84:85], s[68:69]
    s_or_b64 s[72:73], s[72:73], s[74:75]
    s_bcnt1_i32_b64 s3, s[86:87]
    s_add_u32 s90, s90, s3
    s_and_b64 s[74:75], s[86:87], s[70:71]
    s_or_b64 s[72:73], s[72:73], s[74:75]
    s_cselect_b32 s3, s90, 0
    s_add_u32 s91, s91, s3
    s_cmp_lg_u32 s90, 32
    s_cselect_b32 s94, 1, s94
    v_cmp_eq_u32 s[80:81], 5, v42
    v_cmp_eq_u32 s[82:83], 5, v46
    v_cmp_eq_u32 s[84:85], 5, v50
    v_cmp_eq_u32 s[86:87], 5, v54
    s_mov_b32 s90, 0
    s_mov_b64 s[72:73], 0
    s_bcnt1_i32_b64 s3, s[80:81]
    s_add_u32 s90, s90, s3
    s_and_b64 s[74:75], s[80:81], s[64:65]
    s_or_b64 s[72:73], s[72:73], s[74:75]
    s_bcnt1_i32_b64 s3, s[82:83]
    s_add_u32 s90, s90, s3
    s_and_b64 s[74:75], s[82:83], s[66:67]
    s_or_b64 s[72:73], s[72:73], s[74:75]
    s_bcnt1_i32_b64 s3, s[84:85]
    s_add_u32 s90, s90, s3
    s_and_b64 s[74:75], s[84:85], s[68:69]
    s_or_b64 s[72:73], s[72:73], s[74:75]
    s_bcnt1_i32_b64 s3, s[86:87]
    s_add_u32 s90, s90, s3
    s_and_b64 s[74:75], s[86:87], s[70:71]
    s_or_b64 s[72:73], s[72:73], s[74:75]
    s_cselect_b32 s3, s90, 0
    s_add_u32 s91, s91, s3
    s_cmp_lg_u32 s90, 32
    s_cselect_b32 s94, 1, s94
    v_cmp_eq_u32 s[80:81], 6, v42
    v_cmp_eq_u32 s[82:83], 6, v46
    v_cmp_eq_u32 s[84:85], 6, v50
    v_cmp_eq_u32 s[86:87], 6, v54
    s_mov_b32 s90, 0
    s_mov_b64 s[72:73], 0
    s_bcnt1_i32_b64 s3, s[80:81]
    s_add_u32 s90, s90, s3
    s_and_b64 s[74:75], s[80:81], s[64:65]
    s_or_b64 s[72:73], s[72:73], s[74:75]
    s_bcnt1_i32_b64 s3, s[82:83]
    s_add_u32 s90, s90, s3
    s_and_b64 s[74:75], s[82:83], s[66:67]
    s_or_b64 s[72:73], s[72:73], s[74:75]
    s_bcnt1_i32_b64 s3, s[84:85]
    s_add_u32 s90, s90, s3
    s_and_b64 s[74:75], s[84:85], s[68:69]
    s_or_b64 s[72:73], s[72:73], s[74:75]
    s_bcnt1_i32_b64 s3, s[86:87]
    s_add_u32 s90, s90, s3
    s_and_b64 s[74:75], s[86:87], s[70:71]
    s_or_b64 s[72:73], s[72:73], s[74:75]
    s_cselect_b32 s3, s90, 0
    s_add_u32 s91, s91, s3
    s_cmp_lg_u32 s90, 32
    s_cselect_b32 s94, 1, s94
    v_cmp_eq_u32 s[80:81], 7, v42
    v_cmp_eq_u32 s[82:83], 7, v46
    v_cmp_eq_u32 s[84:85], 7, v50
    v_cmp_eq_u32 s[86:87], 7, v54
    s_mov_b32 s90, 0
    s_mov_b64 s[72:73], 0
    s_bcnt1_i32_b64 s3, s[80:81]
    s_add_u32 s90, s90, s3
    s_and_b64 s[74:75], s[80:81], s[64:65]
    s_or_b64 s[72:73], s[72:73], s[74:75]
    s_bcnt1_i32_b64 s3, s[82:83]
    s_add_u32 s90, s90, s3
    s_and_b64 s[74:75], s[82:83], s[66:67]
    s_or_b64 s[72:73], s[72:73], s[74:75]
    s_bcnt1_i32_b64 s3, s[84:85]
    s_add_u32 s90, s90, s3
    s_and_b64 s[74:75], s[84:85], s[68:69]
    s_or_b64 s[72:73], s[72:73], s[74:75]
    s_bcnt1_i32_b64 s3, s[86:87]
    s_add_u32 s90, s90, s3
    s_and_b64 s[74:75], s[86:87], s[70:71]
    s_or_b64 s[72:73], s[72:73], s[74:75]
    s_cselect_b32 s3, s90, 0
    s_add_u32 s91, s91, s3
    s_cmp_lg_u32 s90, 32
    s_cselect_b32 s94, 1, s94
    s_add_u32 s93, s91, s46
P_done:
    s_mov_b32 s23, s93
    s_cmp_lg_u32 s94, 0
    s_cbranch_scc1 L_any
    s_cmp_ge_u32 s23, 32
    s_cbranch_scc1 L_help
    s_mov_b32 s21, s23
    s_cmp_ge_u32 s21, 30
    s_cbranch_scc1 L_pref
    s_cmp_ge_u32 s21, 16
    s_cbranch_scc1 L_value
    v_lshlrev_b32 v92, 4, v1
    v_lshlrev_b32 v119, 7, v1
    s_mul_i32 s32, s21, 7
    v_min_u32 v60, 6, v1
    v_mul_u32_u24 v60, 128, v60
    s_lshl_b32 s3, s32, 7
    s_add_u32 s3, s3, 46833664
    s_mov_b32 s47, 200000
L_sc_nw:
    buffer_load_dwordx2 v[62:63], v60, s[8:11], s3 offen sc1
    s_waitcnt vmcnt(0)
    v_xor_b32 v62, s96, v62
    v_xor_b32 v63, s97, v63
    v_or_b32 v62, v62, v63
    v_cmp_ne_u32 vcc, 0, v62
    s_cbranch_vccz L_sc_nw_ok
    s_sub_u32 s47, s47, 1
    s_cbranch_scc0 L_sc_nw
    s_branch L_fail
L_sc_nw_ok:
    s_lshl_b32 s32, s21, 2
    s_add_u32 s32, s32, s20
    s_mul_i32 s32, s32, 100352
    s_mul_i32 s33, s20, 7
    s_lshr_b32 s33, s33, 2
    s_lshl_b32 s37, s33, 11
    s_add_u32 s37, s37, s32
    buffer_load_dwordx4 a[0:3], v92, s[8:11], s37 offen offset:0
    buffer_load_dwordx4 a[4:7], v92, s[8:11], s37 offen offset:1024
    s_add_u32 s37, s37, 14336
    buffer_load_dwordx4 a[56:59], v92, s[8:11], s37 offen offset:0
    buffer_load_dwordx4 a[60:63], v92, s[8:11], s37 offen offset:1024
    s_add_u32 s37, s37, 14336
    buffer_load_dwordx4 a[112:115], v92, s[8:11], s37 offen offset:0
    buffer_load_dwordx4 a[116:119], v92, s[8:11], s37 offen offset:1024
    s_add_u32 s37, s37, 14336
    buffer_load_dwordx4 a[168:171], v92, s[8:11], s37 offen offset:0
    buffer_load_dwordx4 a[172:175], v92, s[8:11], s37 offen offset:1024
    s_add_u32 s37, s37, 14336
    buffer_load_dwordx4 a[224:227], v92, s[8:11], s37 offen offset:0
    buffer_load_dwordx4 a[228:231], v92, s[8:11], s37 offen offset:1024
    s_add_u32 s37, s37, 14336
    buffer_load_dwordx4 v[144:147], v92, s[8:11], s37 offen offset:0
    buffer_load_dwordx4 v[148:151], v92, s[8:11], s37 offen offset:1024
    s_add_u32 s37, s37, 14336
    buffer_load_dwordx4 v[200:203], v92, s[8:11], s37 offen offset:0
    buffer_load_dwordx4 v[204:207], v92, s[8:11], s37 offen offset:1024
    s_lshl_b32 s64, s33, 10
    s_add_u32 s64, s64, 44302336
    s_add_u32 s33, s33, 1
    s_cmp_eq_u32 s33, 7
    s_cselect_b32 s33, 0, s33
    s_lshl_b32 s37, s33, 11
    s_add_u32 s37, s37, s32
    buffer_load_dwordx4 a[8:11], v92, s[8:11], s37 offen offset:0
    buffer_load_dwordx4 a[12:15], v92, s[8:11], s37 offen offset:1024
    s_add_u32 s37, s37, 14336
    buffer_load_dwordx4 a[64:67], v92, s[8:11], s37 offen offset:0
    buffer_load_dwordx4 a[68:71], v92, s[8:11], s37 offen offset:1024
    s_add_u32 s37, s37, 14336
    buffer_load_dwordx4 a[120:123], v92, s[8:11], s37 offen offset:0
    buffer_load_dwordx4 a[124:127], v92, s[8:11], s37 offen offset:1024
    s_add_u32 s37, s37, 14336
    buffer_load_dwordx4 a[176:179], v92, s[8:11], s37 offen offset:0
    buffer_load_dwordx4 a[180:183], v92, s[8:11], s37 offen offset:1024
    s_add_u32 s37, s37, 14336
    buffer_load_dwordx4 a[232:235], v92, s[8:11], s37 offen offset:0
    buffer_load_dwordx4 a[236:239], v92, s[8:11], s37 offen offset:1024
    s_add_u32 s37, s37, 14336
    buffer_load_dwordx4 v[152:155], v92, s[8:11], s37 offen offset:0
    buffer_load_dwordx4 v[156:159], v92, s[8:11], s37 offen offset:1024
    s_add_u32 s37, s37, 14336
    buffer_load_dwordx4 v[208:211], v92, s[8:11], s37 offen offset:0
    buffer_load_dwordx4 v[212:215], v92, s[8:11], s37 offen offset:1024
    s_lshl_b32 s65, s33, 10
    s_add_u32 s65, s65, 44302336
    s_add_u32 s33, s33, 1
    s_cmp_eq_u32 s33, 7
    s_cselect_b32 s33, 0, s33
    s_lshl_b32 s37, s33, 11
    s_add_u32 s37, s37, s32
    buffer_load_dwordx4 a[16:19], v92, s[8:11], s37 offen offset:0
    buffer_load_dwordx4 a[20:23], v92, s[8:11], s37 offen offset:1024
    s_add_u32 s37, s37, 14336
    buffer_load_dwordx4 a[72:75], v92, s[8:11], s37 offen offset:0
    buffer_load_dwordx4 a[76:79], v92, s[8:11], s37 offen offset:1024
    s_add_u32 s37, s37, 14336
    buffer_load_dwordx4 a[128:131], v92, s[8:11], s37 offen offset:0
    buffer_load_dwordx4 a[132:135], v92, s[8:11], s37 offen offset:1024
    s_add_u32 s37, s37, 14336
    buffer_load_dwordx4 a[184:187], v92, s[8:11], s37 offen offset:0
    buffer_load_dwordx4 a[188:191], v92, s[8:11], s37 offen offset:1024
    s_add_u32 s37, s37, 14336
    buffer_load_dwordx4 a[240:243], v92, s[8:11], s37 offen offset:0
    buffer_load_dwordx4 a[244:247], v92, s[8:11], s37 offen offset:1024
    s_add_u32 s37, s37, 14336
    buffer_load_dwordx4 v[160:163], v92, s[8:11], s37 offen offset:0
    buffer_load_dwordx4 v[164:167], v92, s[8:11], s37 offen offset:1024
    s_add_u32 s37, s37, 14336
    buffer_load_dwordx4 v[216:219], v92, s[8:11], s37 offen offset:0
    buffer_load_dwordx4 v[220:223], v92, s[8:11], s37 offen offset:1024
    s_lshl_b32 s66, s33, 10
    s_add_u32 s66, s66, 44302336
    s_add_u32 s33, s33, 1
    s_cmp_eq_u32 s33, 7
    s_cselect_b32 s33, 0, s33
    s_lshl_b32 s37, s33, 11
    s_add_u32 s37, s37, s32
    buffer_load_dwordx4 a[24:27], v92, s[8:11], s37 offen offset:0
    buffer_load_dwordx4 a[28:31], v92, s[8:11], s37 offen offset:1024
    s_add_u32 s37, s37, 14336
    buffer_load_dwordx4 a[80:83], v92, s[8:11], s37 offen offset:0
    buffer_load_dwordx4 a[84:87], v92, s[8:11], s37 offen offset:1024
    s_add_u32 s37, s37, 14336
    buffer_load_dwordx4 a[136:139], v92, s[8:11], s37 offen offset:0
    buffer_load_dwordx4 a[140:143], v92, s[8:11], s37 offen offset:1024
    s_add_u32 s37, s37, 14336
    buffer_load_dwordx4 a[192:195], v92, s[8:11], s37 offen offset:0
    buffer_load_dwordx4 a[196:199], v92, s[8:11], s37 offen offset:1024
    s_add_u32 s37, s37, 14336
    buffer_load_dwordx4 a[248:251], v92, s[8:11], s37 offen offset:0
    buffer_load_dwordx4 a[252:255], v92, s[8:11], s37 offen offset:1024
    s_add_u32 s37, s37, 14336
    buffer_load_dwordx4 v[168:171], v92, s[8:11], s37 offen offset:0
    buffer_load_dwordx4 v[172:175], v92, s[8:11], s37 offen offset:1024
    s_add_u32 s37, s37, 14336
    buffer_load_dwordx4 v[224:227], v92, s[8:11], s37 offen offset:0
    buffer_load_dwordx4 v[228:231], v92, s[8:11], s37 offen offset:1024
    s_lshl_b32 s67, s33, 10
    s_add_u32 s67, s67, 44302336
    s_add_u32 s33, s33, 1
    s_cmp_eq_u32 s33, 7
    s_cselect_b32 s33, 0, s33
    s_lshl_b32 s37, s33, 11
    s_add_u32 s37, s37, s32
    buffer_load_dwordx4 a[32:35], v92, s[8:11], s37 offen offset:0
    buffer_load_dwordx4 a[36:39], v92, s[8:11], s37 offen offset:1024
    s_add_u32 s37, s37, 14336
    buffer_load_dwordx4 a[88:91], v92, s[8:11], s37 offen offset:0
    buffer_load_dwordx4 a[92:95], v92, s[8:11], s37 offen offset:1024
    s_add_u32 s37, s37, 14336
    buffer_load_dwordx4 a[144:147], v92, s[8:11], s37 offen offset:0
    buffer_load_dwordx4 a[148:151], v92, s[8:11], s37 offen offset:1024
    s_add_u32 s37, s37, 14336
    buffer_load_dwordx4 a[200:203], v92, s[8:11], s37 offen offset:0
    buffer_load_dwordx4 a[204:207], v92, s[8:11], s37 offen offset:1024
    s_add_u32 s37, s37, 14336
    buffer_load_dwordx4 v[120:123], v92, s[8:11], s37 offen offset:0
    buffer_load_dwordx4 v[124:127], v92, s[8:11], s37 offen offset:1024
    s_add_u32 s37, s37, 14336
    buffer_load_dwordx4 v[176:179], v92, s[8:11], s37 offen offset:0
    buffer_load_dwordx4 v[180:183], v92, s[8:11], s37 offen offset:1024
    s_add_u32 s37, s37, 14336
    buffer_load_dwordx4 v[232:235], v92, s[8:11], s37 offen offset:0
    buffer_load_dwordx4 v[236:239], v92, s[8:11], s37 offen offset:1024
    s_lshl_b32 s68, s33, 10
    s_add_u32 s68, s68, 44302336
    s_add_u32 s33, s33, 1
    s_cmp_eq_u32 s33, 7
    s_cselect_b32 s33, 0, s33
    s_lshl_b32 s37, s33, 11
    s_add_u32 s37, s37, s32
    buffer_load_dwordx4 a[40:43], v92, s[8:11], s37 offen offset:0
    buffer_load_dwordx4 a[44:47], v92, s[8:11], s37 offen offset:1024
    s_add_u32 s37, s37, 14336
    buffer_load_dwordx4 a[96:99], v92, s[8:11], s37 offen offset:0
    buffer_load_dwordx4 a[100:103], v92, s[8:11], s37 offen offset:1024
    s_add_u32 s37, s37, 14336
    buffer_load_dwordx4 a[152:155], v92, s[8:11], s37 offen offset:0
    buffer_load_dwordx4 a[156:159], v92, s[8:11], s37 offen offset:1024
    s_add_u32 s37, s37, 14336
    buffer_load_dwordx4 a[208:211], v92, s[8:11], s37 offen offset:0
    buffer_load_dwordx4 a[212:215], v92, s[8:11], s37 offen offset:1024
    s_add_u32 s37, s37, 14336
    buffer_load_dwordx4 v[128:131], v92, s[8:11], s37 offen offset:0
    buffer_load_dwordx4 v[132:135], v92, s[8:11], s37 offen offset:1024
    s_add_u32 s37, s37, 14336
    buffer_load_dwordx4 v[184:187], v92, s[8:11], s37 offen offset:0
    buffer_load_dwordx4 v[188:191], v92, s[8:11], s37 offen offset:1024
    s_add_u32 s37, s37, 14336
    buffer_load_dwordx4 v[240:243], v92, s[8:11], s37 offen offset:0
    buffer_load_dwordx4 v[244:247], v92, s[8:11], s37 offen offset:1024
    s_lshl_b32 s69, s33, 10
    s_add_u32 s69, s69, 44302336
    s_add_u32 s33, s33, 1
    s_cmp_eq_u32 s33, 7
    s_cselect_b32 s33, 0, s33
    s_lshl_b32 s37, s33, 11
    s_add_u32 s37, s37, s32
    buffer_load_dwordx4 a[48:51], v92, s[8:11], s37 offen offset:0
    buffer_load_dwordx4 a[52:55], v92, s[8:11], s37 offen offset:1024
    s_add_u32 s37, s37, 14336
    buffer_load_dwordx4 a[104:107], v92, s[8:11], s37 offen offset:0
    buffer_load_dwordx4 a[108:111], v92, s[8:11], s37 offen offset:1024
    s_add_u32 s37, s37, 14336
    buffer_load_dwordx4 a[160:163], v92, s[8:11], s37 offen offset:0
    buffer_load_dwordx4 a[164:167], v92, s[8:11], s37 offen offset:1024
    s_add_u32 s37, s37, 14336
    buffer_load_dwordx4 a[216:219], v92, s[8:11], s37 offen offset:0
    buffer_load_dwordx4 a[220:223], v92, s[8:11], s37 offen offset:1024
    s_add_u32 s37, s37, 14336
    buffer_load_dwordx4 v[136:139], v92, s[8:11], s37 offen offset:0
    buffer_load_dwordx4 v[140:143], v92, s[8:11], s37 offen offset:1024
    s_add_u32 s37, s37, 14336
    buffer_load_dwordx4 v[192:195], v92, s[8:11], s37 offen offset:0
    buffer_load_dwordx4 v[196:199], v92, s[8:11], s37 offen offset:1024
    s_add_u32 s37, s37, 14336
    buffer_load_dwordx4 v[248:251], v92, s[8:11], s37 offen offset:0
    buffer_load_dwordx4 v[252:255], v92, s[8:11], s37 offen offset:1024
    s_lshl_b32 s70, s33, 10
    s_add_u32 s70, s70, 44302336
    s_add_u32 s33, s33, 1
    s_cmp_eq_u32 s33, 7
    s_cselect_b32 s33, 0, s33
    s_mov_b32 s46, 0
    v_min_u32 v60, 63, v1
    v_mul_u32_u24 v60, 128, v60
    s_lshl_b32 s3, s46, 7
    s_add_u32 s3, s3, 46833664
    s_mov_b32 s47, 200000
L_sc_na0:
    buffer_load_dwordx2 v[62:63], v60, s[8:11], s3 offen sc1
    s_waitcnt vmcnt(0)
    v_xor_b32 v62, s96, v62
    v_xor_b32 v63, s97, v63
    v_or_b32 v62, v62, v63
    v_cmp_ne_u32 vcc, 0, v62
    s_cbranch_vccz L_sc_na0_ok
    s_sub_u32 s47, s47, 1
    s_cbranch_scc0 L_sc_na0
    s_branch L_fail
L_sc_na0_ok:
    s_mov_b32 s46, 64
    v_min_u32 v60, 63, v1
    v_mul_u32_u24 v60, 128, v60
    s_lshl_b32 s3, s46, 7
    s_add_u32 s3, s3, 46833664
    s_mov_b32 s47, 200000
L_sc_na1:
    buffer_load_dwordx2 v[62:63], v60, s[8:11], s3 offen sc1
    s_waitcnt vmcnt(0)
    v_xor_b32 v62, s96, v62
    v_xor_b32 v63, s97, v63
    v_or_b32 v62, v62, v63
    v_cmp_ne_u32 vcc, 0, v62
    s_cbranch_vccz L_sc_na1_ok
    s_sub_u32 s47, s47, 1
    s_cbranch_scc0 L_sc_na1
    s_branch L_fail
L_sc_na1_ok:
    s_mov_b32 s46, 128
    v_min_u32 v60, 63, v1
    v_mul_u32_u24 v60, 128, v60
    s_lshl_b32 s3, s46, 7
    s_add_u32 s3, s3, 46833664
    s_mov_b32 s47, 200000
L_sc_na2:
    buffer_load_dwordx2 v[62:63], v60, s[8:11], s3 offen sc1
    s_waitcnt vmcnt(0)
    v_xor_b32 v62, s96, v62
    v_xor_b32 v63, s97, v63
    v_or_b32 v62, v62, v63
    v_cmp_ne_u32 vcc, 0, v62
    s_cbranch_vccz L_sc_na2_ok
    s_sub_u32 s47, s47, 1
    s_cbranch_scc0 L_sc_na2
    s_branch L_fail
L_sc_na2_ok:
    s_mov_b32 s46, 192
    v_min_u32 v60, 63, v1
    v_mul_u32_u24 v60, 128, v60
    s_lshl_b32 s3, s46, 7
    s_add_u32 s3, s3, 46833664
    s_mov_b32 s47, 200000
L_sc_na3:
    buffer_load_dwordx2 v[62:63], v60, s[8:11], s3 offen sc1
    s_waitcnt vmcnt(0)
    v_xor_b32 v62, s96, v62
    v_xor_b32 v63, s97, v63
    v_or_b32 v62, v62, v63
    v_cmp_ne_u32 vcc, 0, v62
    s_cbranch_vccz L_sc_na3_ok
    s_sub_u32 s47, s47, 1
    s_cbranch_scc0 L_sc_na3
    s_branch L_fail
L_sc_na3_ok:
    s_mov_b32 s46, 256
    v_min_u32 v60, 63, v1
    v_mul_u32_u24 v60, 128, v60
    s_lshl_b32 s3, s46, 7
    s_add_u32 s3, s3, 46833664
    s_mov_b32 s47, 200000
L_sc_na4:
    buffer_load_dwordx2 v[62:63], v60, s[8:11], s3 offen sc1
    s_waitcnt vmcnt(0)
    v_xor_b32 v62, s96, v62
    v_xor_b32 v63, s97, v63
    v_or_b32 v62, v62, v63
    v_cmp_ne_u32 vcc, 0, v62
    s_cbranch_vccz L_sc_na4_ok
    s_sub_u32 s47, s47, 1
    s_cbranch_scc0 L_sc_na4
    s_branch L_fail
L_sc_na4_ok:
    v_mov_b32 v116, 0x4444
    v_mov_b32 v117, 0xeeee
    v_and_b32 v103, 2, v1
    v_cmp_ne_u32 vcc, 0, v103
    s_nop 1
    v_cndmask_b32 v93, v116, v117, vcc
    v_bfe_u32 v100, v1, 1, 1
    v_lshlrev_b32 v100, 7, v100
    v_bfe_u32 v103, v1, 3, 1
    v_lshl_add_u32 v100, v103, 6, v100
    v_bfe_u32 v103, v1, 0, 1
    v_lshl_add_u32 v100, v103, 5, v100
    v_bfe_u32 v103, v1, 2, 1
    v_lshl_add_u32 v100, v103, 2, v100
    v_bfe_u32 v103, v1, 4, 2
    v_lshl_add_u32 v100, v103, 3, v100
    s_lshl_b32 s32, s20, 11
    v_add_u32 v100, s32, v100
    v_bfe_u32 v96, v1, 4, 2
    v_lshlrev_b32 v96, 8, v96
    v_bfe_u32 v103, v1, 0, 4
    v_lshl_add_u32 v96, v103, 3, v96
    v_add_u32 v96, s32, v96
    v_lshlrev_b32 v103, 2, v1
    v_add_u32 v103, s32, v103
    v_mov_b32 v116, 0
    ds_write_b32 v103, v116 offset:1792
    v_bfe_u32 v98, v1, 1, 2
    v_lshlrev_b32 v98, 6, v98
    v_bfe_u32 v103, v1, 4, 1
    v_lshl_add_u32 v98, v103, 5, v98
    v_bfe_u32 v103, v1, 0, 1
    v_lshl_add_u32 v98, v103, 4, v98
    s_mul_i32 s33, s20, 7
    s_and_b32 s33, s33, 3
    s_lshl_b32 s33, s33, 8
    s_lshl_b32 s32, s20, 12
    s_add_u32 s33, s33, s32
    v_add_u32 v98, s33, v98
    v_add_u32 v118, s32, v92
    v_bfe_u32 v103, v1, 5, 1
    v_lshl_add_u32 v97, v103, 8, v98
    s_mul_i32 s33, s20, 1792
    s_add_u32 s33, s33, 8192
    v_bfe_u32 v103, v1, 4, 2
    v_mul_u32_u24 v117, 448, v103
    v_bfe_u32 v99, v1, 0, 4
    v_lshlrev_b32 v99, 2, v99
    v_add3_u32 v99, v99, v117, s33
    v_and_b32 v103, 31, v1
    v_cmp_gt_u32 vcc, 20, v103
    s_nop 1
    v_cndmask_b32 v101, 24, v103, vcc
    v_bfe_u32 v103, v1, 5, 1
    v_mul_u32_u24 v103, 224, v103
    v_lshl_add_u32 v101, v101, 3, v103
    s_mul_i32 s33, s20, 448
    s_add_u32 s33, s33, 8192
    v_add_u32 v101, s33, v101
    v_mov_b32 v116, 0xf149f2ca
    v_mov_b32 v117, 0xf149f2ca
    v_and_b32 v103, 31, v1
    v_mul_u32_u24 v103, 224, v103
    ds_write_b64 v103, v[116:117] offset:8384
    v_bfe_u32 v102, v1, 3, 1
    v_lshlrev_b32 v102, 8, v102
    v_bfe_u32 v103, v1, 0, 1
    v_lshl_add_u32 v102, v103, 5, v102
    v_bfe_u32 v103, v1, 5, 1
    v_lshl_add_u32 v102, v103, 4, v102
    v_bfe_u32 v103, v1, 2, 1
    v_lshl_add_u32 v102, v103, 2, v102
    v_bfe_u32 v103, v1, 1, 1
    v_lshl_add_u32 v102, v103, 3, v102
    s_lshr_b32 s32, s21, 1
    s_lshl_b32 s32, s32, 10
    s_and_b32 s33, s21, 1
    s_lshl_b32 s33, s33, 9
    s_add_u32 s32, s32, s33
    v_add_u32 v102, s32, v102
    v_bfe_u32 v116, v1, 1, 1
    v_lshlrev_b32 v116, 8, v116
    v_bfe_u32 v103, v1, 5, 1
    v_lshl_add_u32 v116, v103, 4, v116
    v_bfe_u32 v103, v1, 0, 1
    v_lshl_add_u32 v116, v103, 3, v116
    v_add_u32 v116, 0x2000, v116
    s_lshr_b32 s32, s21, 3
    s_lshl_b32 s32, s32, 10
    s_bfe_u32 s33, s21, 0x10002
    s_lshl_b32 s33, s33, 9
    s_add_u32 s32, s32, s33
    s_bfe_u32 s33, s21, 0x10000
    s_lshl_b32 s33, s33, 5
    s_add_u32 s32, s32, s33
    s_bfe_u32 s33, s21, 0x10001
    s_lshl_b32 s33, s33, 2
    s_add_u32 s32, s32, s33
    v_add_u32 v116, s32, v116
    v_and_b32 v103, 31, v1
    v_cmp_gt_u32 vcc, 16, v103
    s_nop 1
    v_cndmask_b32 v102, v116, v102, vcc
    s_lshl_b32 s32, s20, 6
    v_add_u32 v102, s32, v102
    v_cmp_gt_u32 vcc, 20, v103
    v_mov_b32 v116, 0x40000000
    s_nop 0
    v_cndmask_b32 v102, v116, v102, vcc
    s_mov_b32 s24, 44302336
    s_mov_b32 s25, 44306432
    s_mov_b32 s26, 44826624
    s_lshl_b32 s29, s20, 13
    s_add_u32 s29, s29, 12845056
    s_mul_i32 s39, s21, 0
    s_add_u32 s39, s39, s20
    s_lshl_b32 s39, s39, 13
    s_add_u32 s39, s39, 16318464
    s_cmp_lt_u32 s20, 0
    s_cbranch_scc1 L_sc_tch
    v_mov_b32 v119, 0x40000000
L_sc_tch:
    v_min_u32 v103, 28, v1
    v_lshlrev_b32 v103, 2, v103
    s_and_b32 s32, s21, 3
    s_lshl_b32 s32, s32, 7
    v_add_u32 v2, s32, v103
    v_mov_b32 v2, v103
    s_lshl_b32 s32, s21, 2
    s_add_u32 s32, s32, 10240
    s_cmp_eq_u32 s20, 0
    s_cselect_b32 s32, s32, 0x40000000
    v_lshlrev_b32 v116, 7, v1
    v_add_u32 v116, s32, v116
    v_mov_b32 v103, 0x40000000
    v_cmp_gt_u32 vcc, 1, v1
    s_nop 1
    v_cndmask_b32 v3, v103, v116, vcc
    s_mov_b32 s30, 0
    s_mov_b32 s37, 0x21800000
    s_mov_b32 s38, 0x3c000000
    v_mov_b64 v[32:33], 0
    v_mov_b64 v[34:35], 0
    v_mov_b64 v[36:37], 0
    v_mov_b64 v[38:39], 0
    v_mov_b64 v[40:41], 0
    v_mov_b64 v[42:43], 0
    v_mov_b64 v[44:45], 0
    v_mov_b64 v[46:47], 0
    v_mov_b64 v[48:49], 0
    v_mov_b64 v[50:51], 0
    v_mov_b64 v[52:53], 0
    v_mov_b64 v[54:55], 0
    v_mov_b64 v[56:57], 0
    v_mov_b64 v[58:59], 0
    v_mov_b64 v[104:105], 0
    v_mov_b64 v[106:107], 0
    v_mov_b64 v[108:109], 0
    v_mov_b64 v[110:111], 0
    v_mov_b64 v[112:113], 0
    v_mov_b64 v[114:115], 0
    v_mov_b64 v[94:95], 0
    s_add_u32 s40, s29, 4096
    s_add_u32 s41, s29, 32768
    s_add_u32 s42, s40, 32768
    buffer_load_dwordx4 v[60:63], v92, s[8:11], s29 offen offset:0
    buffer_load_dwordx4 v[64:67], v92, s[8:11], s29 offen offset:1024
    buffer_load_dwordx4 v[76:79], v92, s[8:11], s40 offen offset:0
    buffer_load_dwordx4 v[80:83], v92, s[8:11], s40 offen offset:1024
    s_waitcnt lgkmcnt(0)
L_sc_step:
    s_barrier
    buffer_load_dwordx4 v[68:71], v92, s[8:11], s29 offen offset:2048
    buffer_load_dwordx4 v[72:75], v92, s[8:11], s29 offen offset:3072
    buffer_load_dwordx4 v[84:87], v92, s[8:11], s40 offen offset:2048
    buffer_load_dwordx4 v[88:91], v92, s[8:11], s40 offen offset:3072
    s_cmp_lg_u32 s20, 0
    s_cbranch_scc1 L_sc_go
    s_sleep 2
    v_mov_b32 v0, -1
    s_mov_b32 s31, 200000
L_sc_probe:
    buffer_load_dword v0, v2, s[8:11], s25 offen offset:3072 sc1
    s_waitcnt vmcnt(2)
    v_cmp_eq_u32 vcc, -1, v0
    s_sub_u32 s31, s31, 1
    s_cbranch_scc1 L_fail
    s_cbranch_vccnz L_sc_probe
L_sc_go:
    s_barrier
    buffer_load_dwordx4 v[4:7], v92, s[8:11], s64 offen sc1
    s_nop 15
    buffer_load_dwordx4 v[8:11], v92, s[8:11], s65 offen sc1
    s_nop 15
    buffer_load_dwordx4 v[12:15], v92, s[8:11], s66 offen sc1
    s_nop 15
    buffer_load_dwordx4 v[16:19], v92, s[8:11], s67 offen sc1
    s_waitcnt vmcnt(3)
    .p2align 3
    v_smfmac_f32_16x16x64_bf16 v[32:35], v[4:7], a[0:7], v93
    buffer_load_dwordx4 v[20:23], v92, s[8:11], s68 offen sc1
    v_smfmac_f32_16x16x64_bf16 v[36:39], v[4:7], a[56:63], v93
    v_smfmac_f32_16x16x64_bf16 v[40:43], v[4:7], a[112:119], v93
    ds_write_b128 v118, v[4:7] offset:16384
    v_smfmac_f32_16x16x64_bf16 v[44:47], v[4:7], a[168:175], v93
    v_smfmac_f32_16x16x64_bf16 v[48:51], v[4:7], a[224:231], v93
    buffer_load_dwordx4 v[24:27], v92, s[8:11], s69 offen sc1
    v_smfmac_f32_16x16x64_bf16 v[52:55], v[4:7], v[144:151], v93
    v_smfmac_f32_16x16x64_bf16 v[56:59], v[4:7], v[200:207], v93
    s_waitcnt vmcnt(4)
    s_mov_b32 s44, 0
    v_smfmac_f32_16x16x64_bf16 v[32:35], v[8:11], a[8:15], v93
    v_smfmac_f32_16x16x64_bf16 v[36:39], v[8:11], a[64:71], v93
    buffer_load_dwordx4 v[28:31], v92, s[8:11], s70 offen sc1
    v_smfmac_f32_16x16x64_bf16 v[40:43], v[8:11], a[120:127], v93
    ds_write_b128 v118, v[8:11] offset:17408
    v_smfmac_f32_16x16x64_bf16 v[44:47], v[8:11], a[176:183], v93
    v_smfmac_f32_16x16x64_bf16 v[48:51], v[8:11], a[232:239], v93
    v_smfmac_f32_16x16x64_bf16 v[52:55], v[8:11], v[152:159], v93
    v_smfmac_f32_16x16x64_bf16 v[56:59], v[8:11], v[208:215], v93
    s_waitcnt vmcnt(4)
    s_mov_b32 s44, 0
    v_smfmac_f32_16x16x64_bf16 v[32:35], v[12:15], a[16:23], v93
    v_smfmac_f32_16x16x64_bf16 v[36:39], v[12:15], a[72:79], v93
    ds_write_b128 v118, v[12:15] offset:18432
    v_smfmac_f32_16x16x64_bf16 v[40:43], v[12:15], a[128:135], v93
    v_smfmac_f32_16x16x64_bf16 v[44:47], v[12:15], a[184:191], v93
    v_smfmac_f32_16x16x64_bf16 v[48:51], v[12:15], a[240:247], v93
    v_smfmac_f32_16x16x64_bf16 v[52:55], v[12:15], v[160:167], v93
    v_smfmac_f32_16x16x64_bf16 v[56:59], v[12:15], v[216:223], v93
    s_waitcnt vmcnt(3)
    s_mov_b32 s44, 0
    v_smfmac_f32_16x16x64_bf16 v[32:35], v[16:19], a[24:31], v93
    ds_read_b128 v[4:7], v97 offset:16384
    v_smfmac_f32_16x16x64_bf16 v[36:39], v[16:19], a[80:87], v93
    v_smfmac_f32_16x16x64_bf16 v[40:43], v[16:19], a[136:143], v93
    ds_read_b128 v[8:11], v97 offset:16896
    v_smfmac_f32_16x16x64_bf16 v[44:47], v[16:19], a[192:199], v93
    v_smfmac_f32_16x16x64_bf16 v[48:51], v[16:19], a[248:255], v93
    ds_read_b128 v[12:15], v97 offset:17408
    v_smfmac_f32_16x16x64_bf16 v[52:55], v[16:19], v[168:175], v93
    v_smfmac_f32_16x16x64_bf16 v[56:59], v[16:19], v[224:231], v93
    s_waitcnt vmcnt(0)
    s_mov_b32 s44, 0
    v_smfmac_f32_16x16x64_bf16 v[32:35], v[20:23], a[32:39], v93
    v_smfmac_f32_16x16x64_bf16 v[32:35], v[24:27], a[40:47], v93
    v_smfmac_f32_16x16x64_bf16 v[32:35], v[28:31], a[48:55], v93
    ds_read_b128 v[16:19], v98 offset:17920
    v_smfmac_f32_16x16x64_bf16 v[36:39], v[20:23], a[88:95], v93
    v_smfmac_f32_16x16x64_bf16 v[36:39], v[24:27], a[96:103], v93
    v_smfmac_f32_16x16x64_bf16 v[36:39], v[28:31], a[104:111], v93
    v_add_f32_e64 v32, v32, v34
    v_smfmac_f32_16x16x64_bf16 v[40:43], v[20:23], a[144:151], v93
    v_add_f32_e64 v33, v33, v35
    v_smfmac_f32_16x16x64_bf16 v[40:43], v[24:27], a[152:159], v93
    v_cvt_pk_bf16_f32 v32, v32, v33
    v_smfmac_f32_16x16x64_bf16 v[40:43], v[28:31], a[160:167], v93
    ds_write_b32 v100, v32 offset:0
    v_add_f32_e64 v36, v36, v38
    v_smfmac_f32_16x16x64_bf16 v[44:47], v[20:23], a[200:207], v93
    v_add_f32_e64 v37, v37, v39
    v_smfmac_f32_16x16x64_bf16 v[44:47], v[24:27], a[208:215], v93
    v_cvt_pk_bf16_f32 v36, v36, v37
    v_smfmac_f32_16x16x64_bf16 v[44:47], v[28:31], a[216:223], v93
    ds_write_b32 v100, v36 offset:256
    v_add_f32_e64 v40, v40, v42
    v_smfmac_f32_16x16x64_bf16 v[48:51], v[20:23], v[120:127], v93
    v_add_f32_e64 v41, v41, v43
    v_smfmac_f32_16x16x64_bf16 v[48:51], v[24:27], v[128:135], v93
    v_cvt_pk_bf16_f32 v40, v40, v41
    v_smfmac_f32_16x16x64_bf16 v[48:51], v[28:31], v[136:143], v93
    ds_write_b32 v100, v40 offset:512
    v_add_f32_e64 v44, v44, v46
    v_smfmac_f32_16x16x64_bf16 v[52:55], v[20:23], v[176:183], v93
    v_add_f32_e64 v45, v45, v47
    v_smfmac_f32_16x16x64_bf16 v[52:55], v[24:27], v[184:191], v93
    v_cvt_pk_bf16_f32 v44, v44, v45
    v_smfmac_f32_16x16x64_bf16 v[52:55], v[28:31], v[192:199], v93
    ds_write_b32 v100, v44 offset:768
    ds_read_b64_tr_b16 v[32:33], v96 offset:0
    ds_read_b64_tr_b16 v[34:35], v96 offset:128
    v_add_f32_e64 v48, v48, v50
    v_smfmac_f32_16x16x64_bf16 v[56:59], v[20:23], v[232:239], v93
    v_add_f32_e64 v49, v49, v51
    v_smfmac_f32_16x16x64_bf16 v[56:59], v[24:27], v[240:247], v93
    v_cvt_pk_bf16_f32 v48, v48, v49
    v_smfmac_f32_16x16x64_bf16 v[56:59], v[28:31], v[248:255], v93
    ds_write_b32 v100, v48 offset:1024
    s_waitcnt vmcnt(0) lgkmcnt(1)
    v_add_f32 v52, v52, v54
    v_smfmac_f32_16x16x64_bf16 v[104:107], v[32:35], v[60:67], v93
    v_add_f32_e64 v53, v53, v55
    v_smfmac_f32_16x16x64_bf16 v[108:111], v[32:35], v[76:83], v93
    buffer_load_dwordx4 v[60:63], v92, s[8:11], s41 offen offset:0
    v_cvt_pk_bf16_f32 v52, v52, v53
    v_smfmac_f32_16x16x64_bf16 v[112:115], v[32:35], v[4:11], v93
    ds_write_b32 v100, v52 offset:1280
    v_add_f32 v56, v56, v58
    v_add_f32 v57, v57, v59
    v_cvt_pk_bf16_f32 v56, v56, v57
    ds_write_b32 v100, v56 offset:1536
    ds_read_b64_tr_b16 v[36:37], v96 offset:1024
    ds_read_b64_tr_b16 v[38:39], v96 offset:1152
    buffer_load_dwordx4 v[64:67], v92, s[8:11], s41 offen offset:1024
    v_mfma_f32_16x16x16_bf16 v[40:43], v[94:95], v[94:95], 0
    v_mfma_f32_16x16x16_bf16 v[44:47], v[94:95], v[94:95], 0
    v_mfma_f32_16x16x16_bf16 v[48:51], v[94:95], v[94:95], 0
    s_waitcnt lgkmcnt(0)
    v_smfmac_f32_16x16x64_bf16 v[104:107], v[36:39], v[68:75], v93
    v_smfmac_f32_16x16x64_bf16 v[108:111], v[36:39], v[84:91], v93
    v_smfmac_f32_16x16x64_bf16 v[112:115], v[36:39], v[12:19], v93
    s_nop 3
    v_add_f32 v104, v104, v106
    v_add_f32 v105, v105, v107
    v_add_f32 v108, v108, v110
    v_add_f32 v109, v109, v111
    v_add_f32 v112, v112, v114
    v_add_f32 v113, v113, v115
    ds_write2_b32 v99, v104, v105 offset0:0 offset1:56
    ds_write2_b32 v99, v108, v109 offset0:16 offset1:72
    ds_write2_b32 v99, v112, v113 offset0:32 offset1:88
    v_cmp_u_f32 vcc, v104, v105
    buffer_load_dwordx4 v[76:79], v92, s[8:11], s42 offen offset:0
    v_mfma_f32_16x16x16_bf16 v[32:35], v[94:95], v[94:95], 0
    v_mfma_f32_16x16x16_bf16 v[36:39], v[94:95], v[94:95], 0
    v_mfma_f32_16x16x16_bf16 v[52:55], v[94:95], v[94:95], 0
    v_mfma_f32_16x16x16_bf16 v[56:59], v[94:95], v[94:95], 0
    s_waitcnt lgkmcnt(0)
    s_cbranch_vccnz L_sc_redo
    s_barrier
    ds_read_b64 v[20:21], v101 offset:0
    ds_read_b64 v[22:23], v101 offset:1792
    ds_read_b64 v[24:25], v101 offset:3584
    ds_read_b64 v[26:27], v101 offset:5376
    buffer_load_dwordx4 v[80:83], v92, s[8:11], s42 offen offset:1024
    v_mfma_f32_16x16x16_bf16 v[104:107], v[94:95], v[94:95], 0
    v_mfma_f32_16x16x16_bf16 v[108:111], v[94:95], v[94:95], 0
    v_mfma_f32_16x16x16_bf16 v[112:115], v[94:95], v[94:95], 0
    s_waitcnt lgkmcnt(2)
    v_add_f32 v20, v20, v22
    v_add_f32 v21, v21, v23
    s_waitcnt lgkmcnt(0)
    v_add_f32 v24, v24, v26
    v_add_f32 v25, v25, v27
    v_add_f32 v20, v20, v24
    v_add_f32 v21, v21, v25
    v_exp_f32 v22, v20
    v_exp_f32 v23, v21
    s_nop 0
    v_add_f32 v24, v22, v23
    s_nop 1
    v_add_f32_dpp v24, v24, v24 row_ror:8 row_mask:0xf bank_mask:0xf
    buffer_store_dword v93, v3, s[8:11], s26 offen
    s_nop 0
    v_add_f32_dpp v24, v24, v24 row_ror:4 row_mask:0xf bank_mask:0xf
    s_nop 1
    v_add_f32_dpp v24, v24, v24 row_ror:2 row_mask:0xf bank_mask:0xf
    s_nop 1
    v_add_f32_dpp v24, v24, v24 row_ror:1 row_mask:0xf bank_mask:0xf
    v_mov_b32 v25, v24
    s_nop 1
    v_permlane16_swap_b32 v24, v25
    v_add_f32 v24, v24, v25
    v_subrev_u32 v25, s37, v24
    v_cmp_le_u32 vcc, s38, v25
    v_rcp_f32 v24, v24
    s_nop 0
    v_mul_f32 v22, v22, v24
    v_mul_f32 v23, v23, v24
    v_cvt_pk_bf16_f32 v22, v22, v23
    v_min_u32 v22, -2, v22
    s_cbranch_vccnz L_sc_max
    buffer_store_dword v22, v102, s[8:11], s26 offen
    s_branch L_sc_next
L_sc_max:
    v_max_f32 v24, v20, v21
    s_nop 1
    v_max_f32_dpp v24, v24, v24 row_ror:8 row_mask:0xf bank_mask:0xf
    s_nop 1
    v_max_f32_dpp v24, v24, v24 row_ror:4 row_mask:0xf bank_mask:0xf
    s_nop 1
    v_max_f32_dpp v24, v24, v24 row_ror:2 row_mask:0xf bank_mask:0xf
    s_nop 1
    v_max_f32_dpp v24, v24, v24 row_ror:1 row_mask:0xf bank_mask:0xf
    v_mov_b32 v25, v24
    s_nop 1
    v_permlane16_swap_b32 v24, v25
    v_max_f32 v24, v24, v25
    v_sub_f32 v20, v20, v24
    v_sub_f32 v21, v21, v24
    v_exp_f32 v22, v20
    v_exp_f32 v23, v21
    s_nop 0
    v_add_f32 v24, v22, v23
    s_nop 1
    v_add_f32_dpp v24, v24, v24 row_ror:8 row_mask:0xf bank_mask:0xf
    s_nop 1
    v_add_f32_dpp v24, v24, v24 row_ror:4 row_mask:0xf bank_mask:0xf
    s_nop 1
    v_add_f32_dpp v24, v24, v24 row_ror:2 row_mask:0xf bank_mask:0xf
    s_nop 1
    v_add_f32_dpp v24, v24, v24 row_ror:1 row_mask:0xf bank_mask:0xf
    v_mov_b32 v25, v24
    s_nop 1
    v_permlane16_swap_b32 v24, v25
    v_add_f32 v24, v24, v25
    v_rcp_f32 v24, v24
    s_nop 0
    v_mul_f32 v22, v22, v24
    v_mul_f32 v23, v23, v24
    v_cvt_pk_bf16_f32 v22, v22, v23
    v_min_u32 v22, -2, v22
    buffer_store_dword v22, v102, s[8:11], s26 offen
L_sc_next:
    s_add_u32 s24, s24, 8192
    s_add_u32 s25, s25, 8192
    s_add_u32 s26, s26, 11264
    s_add_u32 s39, s39, 458752
    s_add_u32 s29, s29, 32768
    s_add_u32 s40, s40, 32768
    s_add_u32 s41, s41, 32768
    s_add_u32 s42, s42, 32768
    s_add_u32 s30, s30, 1
    s_add_u32 s64, s64, 8192
    s_add_u32 s65, s65, 8192
    s_add_u32 s66, s66, 8192
    s_add_u32 s67, s67, 8192
    s_add_u32 s68, s68, 8192
    s_add_u32 s69, s69, 8192
    s_add_u32 s70, s70, 8192
    s_cmp_lt_u32 s30, 63
    s_cbranch_scc1 L_sc_step
    s_branch L_done
L_sc_redo:
    s_mov_b32 s31, 0
    buffer_load_dwordx4 v[60:63], v92, s[8:11], s29 offen offset:0
    buffer_load_dwordx4 v[64:67], v92, s[8:11], s29 offen offset:1024
    buffer_load_dwordx4 v[76:79], v92, s[8:11], s40 offen offset:0
L_sc_redo_l:
    buffer_load_dwordx4 v[4:7], v92, s[8:11], s64 offen sc1
    buffer_load_dwordx4 v[8:11], v92, s[8:11], s65 offen sc1
    buffer_load_dwordx4 v[12:15], v92, s[8:11], s66 offen sc1
    buffer_load_dwordx4 v[16:19], v92, s[8:11], s67 offen sc1
    buffer_load_dwordx4 v[20:23], v92, s[8:11], s68 offen sc1
    buffer_load_dwordx4 v[24:27], v92, s[8:11], s69 offen sc1
    buffer_load_dwordx4 v[28:31], v92, s[8:11], s70 offen sc1
    s_waitcnt vmcnt(0)
    v_max3_u32 v103, v4, v5, v6
    v_max3_u32 v103, v103, v7, v8
    v_max3_u32 v103, v103, v9, v10
    v_max3_u32 v103, v103, v11, v12
    v_max3_u32 v103, v103, v13, v14
    v_max3_u32 v103, v103, v15, v16
    v_max3_u32 v103, v103, v17, v18
    v_max3_u32 v103, v103, v19, v20
    v_max3_u32 v103, v103, v21, v22
    v_max3_u32 v103, v103, v23, v24
    v_max3_u32 v103, v103, v25, v26
    v_max3_u32 v103, v103, v27, v28
    v_max3_u32 v103, v103, v29, v30
    v_max_u32 v103, v103, v31
    v_cmp_eq_u32 vcc, -1, v103
    s_cbranch_vccz L_sc_redo_go
    s_add_u32 s31, s31, 1
    s_cmp_lt_u32 s31, 200000
    s_cbranch_scc1 L_sc_redo_l
    s_branch L_fail
L_sc_redo_go:
    v_mfma_f32_16x16x16_bf16 v[104:107], v[94:95], v[94:95], 0
    v_mfma_f32_16x16x16_bf16 v[108:111], v[94:95], v[94:95], 0
    v_mfma_f32_16x16x16_bf16 v[112:115], v[94:95], v[94:95], 0
    v_mfma_f32_16x16x16_bf16 v[32:35], v[94:95], v[94:95], 0
    v_mfma_f32_16x16x16_bf16 v[36:39], v[94:95], v[94:95], 0
    v_mfma_f32_16x16x16_bf16 v[40:43], v[94:95], v[94:95], 0
    v_mfma_f32_16x16x16_bf16 v[44:47], v[94:95], v[94:95], 0
    v_mfma_f32_16x16x16_bf16 v[48:51], v[94:95], v[94:95], 0
    v_mfma_f32_16x16x16_bf16 v[52:55], v[94:95], v[94:95], 0
    v_mfma_f32_16x16x16_bf16 v[56:59], v[94:95], v[94:95], 0
    ds_write_b128 v118, v[4:7] offset:16384
    ds_write_b128 v118, v[8:11] offset:17408
    ds_write_b128 v118, v[12:15] offset:18432
    v_smfmac_f32_16x16x64_bf16 v[32:35], v[4:7], a[0:7], v93
    v_smfmac_f32_16x16x64_bf16 v[36:39], v[4:7], a[56:63], v93
    v_smfmac_f32_16x16x64_bf16 v[40:43], v[4:7], a[112:119], v93
    v_smfmac_f32_16x16x64_bf16 v[44:47], v[4:7], a[168:175], v93
    v_smfmac_f32_16x16x64_bf16 v[48:51], v[4:7], a[224:231], v93
    v_smfmac_f32_16x16x64_bf16 v[52:55], v[4:7], v[144:151], v93
    v_smfmac_f32_16x16x64_bf16 v[56:59], v[4:7], v[200:207], v93
    v_smfmac_f32_16x16x64_bf16 v[32:35], v[8:11], a[8:15], v93
    v_smfmac_f32_16x16x64_bf16 v[36:39], v[8:11], a[64:71], v93
    v_smfmac_f32_16x16x64_bf16 v[40:43], v[8:11], a[120:127], v93
    v_smfmac_f32_16x16x64_bf16 v[44:47], v[8:11], a[176:183], v93
    v_smfmac_f32_16x16x64_bf16 v[48:51], v[8:11], a[232:239], v93
    v_smfmac_f32_16x16x64_bf16 v[52:55], v[8:11], v[152:159], v93
    v_smfmac_f32_16x16x64_bf16 v[56:59], v[8:11], v[208:215], v93
    v_smfmac_f32_16x16x64_bf16 v[32:35], v[12:15], a[16:23], v93
    v_smfmac_f32_16x16x64_bf16 v[36:39], v[12:15], a[72:79], v93
    v_smfmac_f32_16x16x64_bf16 v[40:43], v[12:15], a[128:135], v93
    v_smfmac_f32_16x16x64_bf16 v[44:47], v[12:15], a[184:191], v93
    v_smfmac_f32_16x16x64_bf16 v[48:51], v[12:15], a[240:247], v93
    v_smfmac_f32_16x16x64_bf16 v[52:55], v[12:15], v[160:167], v93
    v_smfmac_f32_16x16x64_bf16 v[56:59], v[12:15], v[216:223], v93
    v_smfmac_f32_16x16x64_bf16 v[32:35], v[16:19], a[24:31], v93
    v_smfmac_f32_16x16x64_bf16 v[36:39], v[16:19], a[80:87], v93
    v_smfmac_f32_16x16x64_bf16 v[40:43], v[16:19], a[136:143], v93
    v_smfmac_f32_16x16x64_bf16 v[44:47], v[16:19], a[192:199], v93
    v_smfmac_f32_16x16x64_bf16 v[48:51], v[16:19], a[248:255], v93
    v_smfmac_f32_16x16x64_bf16 v[52:55], v[16:19], v[168:175], v93
    v_smfmac_f32_16x16x64_bf16 v[56:59], v[16:19], v[224:231], v93
    ds_read_b128 v[4:7], v97 offset:16384
    ds_read_b128 v[8:11], v97 offset:16896
    ds_read_b128 v[12:15], v97 offset:17408
    v_smfmac_f32_16x16x64_bf16 v[32:35], v[20:23], a[32:39], v93
    v_smfmac_f32_16x16x64_bf16 v[32:35], v[24:27], a[40:47], v93
    v_smfmac_f32_16x16x64_bf16 v[32:35], v[28:31], a[48:55], v93
    ds_read_b128 v[16:19], v98 offset:17920
    v_smfmac_f32_16x16x64_bf16 v[36:39], v[20:23], a[88:95], v93
    v_smfmac_f32_16x16x64_bf16 v[36:39], v[24:27], a[96:103], v93
    v_smfmac_f32_16x16x64_bf16 v[36:39], v[28:31], a[104:111], v93
    v_add_f32_e64 v32, v32, v34
    v_smfmac_f32_16x16x64_bf16 v[40:43], v[20:23], a[144:151], v93
    v_add_f32_e64 v33, v33, v35
    v_smfmac_f32_16x16x64_bf16 v[40:43], v[24:27], a[152:159], v93
    v_cvt_pk_bf16_f32 v32, v32, v33
    v_smfmac_f32_16x16x64_bf16 v[40:43], v[28:31], a[160:167], v93
    ds_write_b32 v100, v32 offset:0
    v_add_f32_e64 v36, v36, v38
    v_smfmac_f32_16x16x64_bf16 v[44:47], v[20:23], a[200:207], v93
    v_add_f32_e64 v37, v37, v39
    v_smfmac_f32_16x16x64_bf16 v[44:47], v[24:27], a[208:215], v93
    v_cvt_pk_bf16_f32 v36, v36, v37
    v_smfmac_f32_16x16x64_bf16 v[44:47], v[28:31], a[216:223], v93
    ds_write_b32 v100, v36 offset:256
    v_add_f32_e64 v40, v40, v42
    v_smfmac_f32_16x16x64_bf16 v[48:51], v[20:23], v[120:127], v93
    v_add_f32_e64 v41, v41, v43
    v_smfmac_f32_16x16x64_bf16 v[48:51], v[24:27], v[128:135], v93
    v_cvt_pk_bf16_f32 v40, v40, v41
    v_smfmac_f32_16x16x64_bf16 v[48:51], v[28:31], v[136:143], v93
    ds_write_b32 v100, v40 offset:512
    v_add_f32_e64 v44, v44, v46
    v_smfmac_f32_16x16x64_bf16 v[52:55], v[20:23], v[176:183], v93
    v_add_f32_e64 v45, v45, v47
    v_smfmac_f32_16x16x64_bf16 v[52:55], v[24:27], v[184:191], v93
    v_cvt_pk_bf16_f32 v44, v44, v45
    v_smfmac_f32_16x16x64_bf16 v[52:55], v[28:31], v[192:199], v93
    ds_write_b32 v100, v44 offset:768
    ds_read_b64_tr_b16 v[32:33], v96 offset:0
    ds_read_b64_tr_b16 v[34:35], v96 offset:128
    v_add_f32_e64 v48, v48, v50
    v_smfmac_f32_16x16x64_bf16 v[56:59], v[20:23], v[232:239], v93
    v_add_f32_e64 v49, v49, v51
    v_smfmac_f32_16x16x64_bf16 v[56:59], v[24:27], v[240:247], v93
    v_cvt_pk_bf16_f32 v48, v48, v49
    v_smfmac_f32_16x16x64_bf16 v[56:59], v[28:31], v[248:255], v93
    ds_write_b32 v100, v48 offset:1024
    s_waitcnt vmcnt(0) lgkmcnt(1)
    v_add_f32 v52, v52, v54
    v_smfmac_f32_16x16x64_bf16 v[104:107], v[32:35], v[60:67], v93
    v_add_f32_e64 v53, v53, v55
    v_smfmac_f32_16x16x64_bf16 v[108:111], v[32:35], v[76:83], v93
    buffer_load_dwordx4 v[60:63], v92, s[8:11], s41 offen offset:0
    v_cvt_pk_bf16_f32 v52, v52, v53
    v_smfmac_f32_16x16x64_bf16 v[112:115], v[32:35], v[4:11], v93
    ds_write_b32 v100, v52 offset:1280
    v_add_f32 v56, v56, v58
    v_add_f32 v57, v57, v59
    v_cvt_pk_bf16_f32 v56, v56, v57
    ds_write_b32 v100, v56 offset:1536
    ds_read_b64_tr_b16 v[36:37], v96 offset:1024
    ds_read_b64_tr_b16 v[38:39], v96 offset:1152
    buffer_load_dwordx4 v[64:67], v92, s[8:11], s41 offen offset:1024
    v_mfma_f32_16x16x16_bf16 v[40:43], v[94:95], v[94:95], 0
    v_mfma_f32_16x16x16_bf16 v[44:47], v[94:95], v[94:95], 0
    v_mfma_f32_16x16x16_bf16 v[48:51], v[94:95], v[94:95], 0
    s_waitcnt lgkmcnt(0)
    v_smfmac_f32_16x16x64_bf16 v[104:107], v[36:39], v[68:75], v93
    v_smfmac_f32_16x16x64_bf16 v[108:111], v[36:39], v[84:91], v93
    v_smfmac_f32_16x16x64_bf16 v[112:115], v[36:39], v[12:19], v93
    s_nop 3
    v_add_f32 v104, v104, v106
    v_add_f32 v105, v105, v107
    v_add_f32 v108, v108, v110
    v_add_f32 v109, v109, v111
    v_add_f32 v112, v112, v114
    v_add_f32 v113, v113, v115
    ds_write2_b32 v99, v104, v105 offset0:0 offset1:56
    ds_write2_b32 v99, v108, v109 offset0:16 offset1:72
    ds_write2_b32 v99, v112, v113 offset0:32 offset1:88
    buffer_load_dwordx4 v[76:79], v92, s[8:11], s42 offen offset:0
    v_mfma_f32_16x16x16_bf16 v[32:35], v[94:95], v[94:95], 0
    v_mfma_f32_16x16x16_bf16 v[36:39], v[94:95], v[94:95], 0
    v_mfma_f32_16x16x16_bf16 v[52:55], v[94:95], v[94:95], 0
    v_mfma_f32_16x16x16_bf16 v[56:59], v[94:95], v[94:95], 0
    s_waitcnt lgkmcnt(0)
    s_barrier
    ds_read_b64 v[20:21], v101 offset:0
    ds_read_b64 v[22:23], v101 offset:1792
    ds_read_b64 v[24:25], v101 offset:3584
    ds_read_b64 v[26:27], v101 offset:5376
    buffer_load_dwordx4 v[80:83], v92, s[8:11], s42 offen offset:1024
    v_mfma_f32_16x16x16_bf16 v[104:107], v[94:95], v[94:95], 0
    v_mfma_f32_16x16x16_bf16 v[108:111], v[94:95], v[94:95], 0
    v_mfma_f32_16x16x16_bf16 v[112:115], v[94:95], v[94:95], 0
    s_waitcnt lgkmcnt(2)
    v_add_f32 v20, v20, v22
    v_add_f32 v21, v21, v23
    s_waitcnt lgkmcnt(0)
    v_add_f32 v24, v24, v26
    v_add_f32 v25, v25, v27
    v_add_f32 v20, v20, v24
    v_add_f32 v21, v21, v25
    v_exp_f32 v22, v20
    v_exp_f32 v23, v21
    s_nop 0
    v_add_f32 v24, v22, v23
    s_nop 1
    v_add_f32_dpp v24, v24, v24 row_ror:8 row_mask:0xf bank_mask:0xf
    buffer_store_dword v93, v3, s[8:11], s26 offen
    s_nop 0
    v_add_f32_dpp v24, v24, v24 row_ror:4 row_mask:0xf bank_mask:0xf
    s_nop 1
    v_add_f32_dpp v24, v24, v24 row_ror:2 row_mask:0xf bank_mask:0xf
    s_nop 1
    v_add_f32_dpp v24, v24, v24 row_ror:1 row_mask:0xf bank_mask:0xf
    v_mov_b32 v25, v24
    s_nop 1
    v_permlane16_swap_b32 v24, v25
    v_add_f32 v24, v24, v25
    v_subrev_u32 v25, s37, v24
    v_cmp_le_u32 vcc, s38, v25
    v_rcp_f32 v24, v24
    s_nop 0
    v_mul_f32 v22, v22, v24
    v_mul_f32 v23, v23, v24
    v_cvt_pk_bf16_f32 v22, v22, v23
    v_min_u32 v22, -2, v22
    s_cbranch_vccnz L_sc_max
    buffer_store_dword v22, v102, s[8:11], s26 offen
    s_branch L_sc_next
L_value:
    s_sub_u32 s21, s21, 16
    v_lshlrev_b32 v2, 4, v1
    v_mov_b32 v5, 0x4444
    v_mov_b32 v6, 0xeeee
    v_and_b32 v4, 2, v1
    v_cmp_ne_u32 vcc, 0, v4
    s_nop 1
    v_cndmask_b32 v3, v5, v6, vcc
    s_lshr_b32 s32, s21, 1
    s_add_u32 s32, s32, 112
    v_min_u32 v60, 15, v1
    v_mul_u32_u24 v60, 896, v60
    s_lshl_b32 s3, s32, 7
    s_add_u32 s3, s3, 46833664
    s_mov_b32 s47, 200000
L_va_nw:
    buffer_load_dwordx2 v[62:63], v60, s[8:11], s3 offen sc1
    s_waitcnt vmcnt(0)
    v_xor_b32 v62, s96, v62
    v_xor_b32 v63, s97, v63
    v_or_b32 v62, v62, v63
    v_cmp_ne_u32 vcc, 0, v62
    s_cbranch_vccz L_va_nw_ok
    s_sub_u32 s47, s47, 1
    s_cbranch_scc0 L_va_nw
    s_branch L_fail
L_va_nw_ok:
    s_lshl_b32 s32, s21, 2
    s_add_u32 s32, s32, s20
    s_mul_i32 s32, s32, 114688
    s_add_u32 s32, s32, 6422528
    s_and_b32 s38, s20, 1
    s_lshl_b32 s33, s38, 12
    s_add_u32 s33, s33, 8192
    v_add_u32 v7, s33, v2
    s_mov_b32 s24, 44302336
    s_mov_b32 s25, 44306432
    s_mov_b32 s30, 0
    s_cmp_ge_u32 s20, 2
    s_cbranch_scc1 L_vb
    buffer_load_dwordx4 a[0:3], v2, s[8:11], s32 offen offset:0
    buffer_load_dwordx4 a[4:7], v2, s[8:11], s32 offen offset:1024
    buffer_load_dwordx4 a[8:11], v2, s[8:11], s32 offen offset:2048
    buffer_load_dwordx4 a[12:15], v2, s[8:11], s32 offen offset:3072
    s_add_u32 s32, s32, 4096
    buffer_load_dwordx4 a[16:19], v2, s[8:11], s32 offen offset:0
    buffer_load_dwordx4 a[20:23], v2, s[8:11], s32 offen offset:1024
    buffer_load_dwordx4 a[24:27], v2, s[8:11], s32 offen offset:2048
    buffer_load_dwordx4 a[28:31], v2, s[8:11], s32 offen offset:3072
    s_add_u32 s32, s32, 4096
    buffer_load_dwordx4 a[32:35], v2, s[8:11], s32 offen offset:0
    buffer_load_dwordx4 a[36:39], v2, s[8:11], s32 offen offset:1024
    buffer_load_dwordx4 a[40:43], v2, s[8:11], s32 offen offset:2048
    buffer_load_dwordx4 a[44:47], v2, s[8:11], s32 offen offset:3072
    s_add_u32 s32, s32, 4096
    buffer_load_dwordx4 a[48:51], v2, s[8:11], s32 offen offset:0
    buffer_load_dwordx4 a[52:55], v2, s[8:11], s32 offen offset:1024
    buffer_load_dwordx4 a[56:59], v2, s[8:11], s32 offen offset:2048
    buffer_load_dwordx4 a[60:63], v2, s[8:11], s32 offen offset:3072
    s_add_u32 s32, s32, 4096
    buffer_load_dwordx4 a[64:67], v2, s[8:11], s32 offen offset:0
    buffer_load_dwordx4 a[68:71], v2, s[8:11], s32 offen offset:1024
    buffer_load_dwordx4 a[72:75], v2, s[8:11], s32 offen offset:2048
    buffer_load_dwordx4 a[76:79], v2, s[8:11], s32 offen offset:3072
    s_add_u32 s32, s32, 4096
    buffer_load_dwordx4 a[80:83], v2, s[8:11], s32 offen offset:0
    buffer_load_dwordx4 a[84:87], v2, s[8:11], s32 offen offset:1024
    buffer_load_dwordx4 a[88:91], v2, s[8:11], s32 offen offset:2048
    buffer_load_dwordx4 a[92:95], v2, s[8:11], s32 offen offset:3072
    s_add_u32 s32, s32, 4096
    buffer_load_dwordx4 a[96:99], v2, s[8:11], s32 offen offset:0
    buffer_load_dwordx4 a[100:103], v2, s[8:11], s32 offen offset:1024
    buffer_load_dwordx4 a[104:107], v2, s[8:11], s32 offen offset:2048
    buffer_load_dwordx4 a[108:111], v2, s[8:11], s32 offen offset:3072
    s_add_u32 s32, s32, 4096
    buffer_load_dwordx4 a[112:115], v2, s[8:11], s32 offen offset:0
    buffer_load_dwordx4 a[116:119], v2, s[8:11], s32 offen offset:1024
    buffer_load_dwordx4 a[120:123], v2, s[8:11], s32 offen offset:2048
    buffer_load_dwordx4 a[124:127], v2, s[8:11], s32 offen offset:3072
    s_add_u32 s32, s32, 4096
    buffer_load_dwordx4 a[128:131], v2, s[8:11], s32 offen offset:0
    buffer_load_dwordx4 a[132:135], v2, s[8:11], s32 offen offset:1024
    buffer_load_dwordx4 a[136:139], v2, s[8:11], s32 offen offset:2048
    buffer_load_dwordx4 a[140:143], v2, s[8:11], s32 offen offset:3072
    s_add_u32 s32, s32, 4096
    buffer_load_dwordx4 a[144:147], v2, s[8:11], s32 offen offset:0
    buffer_load_dwordx4 a[148:151], v2, s[8:11], s32 offen offset:1024
    buffer_load_dwordx4 a[152:155], v2, s[8:11], s32 offen offset:2048
    buffer_load_dwordx4 a[156:159], v2, s[8:11], s32 offen offset:3072
    s_add_u32 s32, s32, 4096
    buffer_load_dwordx4 a[160:163], v2, s[8:11], s32 offen offset:0
    buffer_load_dwordx4 a[164:167], v2, s[8:11], s32 offen offset:1024
    buffer_load_dwordx4 a[168:171], v2, s[8:11], s32 offen offset:2048
    buffer_load_dwordx4 a[172:175], v2, s[8:11], s32 offen offset:3072
    s_add_u32 s32, s32, 4096
    buffer_load_dwordx4 a[176:179], v2, s[8:11], s32 offen offset:0
    buffer_load_dwordx4 a[180:183], v2, s[8:11], s32 offen offset:1024
    buffer_load_dwordx4 a[184:187], v2, s[8:11], s32 offen offset:2048
    buffer_load_dwordx4 a[188:191], v2, s[8:11], s32 offen offset:3072
    s_add_u32 s32, s32, 4096
    buffer_load_dwordx4 a[192:195], v2, s[8:11], s32 offen offset:0
    buffer_load_dwordx4 a[196:199], v2, s[8:11], s32 offen offset:1024
    buffer_load_dwordx4 a[200:203], v2, s[8:11], s32 offen offset:2048
    buffer_load_dwordx4 a[204:207], v2, s[8:11], s32 offen offset:3072
    s_add_u32 s32, s32, 4096
    buffer_load_dwordx4 a[208:211], v2, s[8:11], s32 offen offset:0
    buffer_load_dwordx4 a[212:215], v2, s[8:11], s32 offen offset:1024
    buffer_load_dwordx4 a[216:219], v2, s[8:11], s32 offen offset:2048
    buffer_load_dwordx4 a[220:223], v2, s[8:11], s32 offen offset:3072
    s_add_u32 s32, s32, 4096
    buffer_load_dwordx4 a[224:227], v2, s[8:11], s32 offen offset:0
    buffer_load_dwordx4 a[228:231], v2, s[8:11], s32 offen offset:1024
    buffer_load_dwordx4 a[232:235], v2, s[8:11], s32 offen offset:2048
    buffer_load_dwordx4 a[236:239], v2, s[8:11], s32 offen offset:3072
    s_add_u32 s32, s32, 4096
    buffer_load_dwordx4 a[240:243], v2, s[8:11], s32 offen offset:0
    buffer_load_dwordx4 a[244:247], v2, s[8:11], s32 offen offset:1024
    buffer_load_dwordx4 a[248:251], v2, s[8:11], s32 offen offset:2048
    buffer_load_dwordx4 a[252:255], v2, s[8:11], s32 offen offset:3072
    s_add_u32 s32, s32, 4096
    buffer_load_dwordx4 v[176:179], v2, s[8:11], s32 offen offset:0
    buffer_load_dwordx4 v[180:183], v2, s[8:11], s32 offen offset:1024
    buffer_load_dwordx4 v[184:187], v2, s[8:11], s32 offen offset:2048
    buffer_load_dwordx4 v[188:191], v2, s[8:11], s32 offen offset:3072
    s_add_u32 s32, s32, 4096
    buffer_load_dwordx4 v[192:195], v2, s[8:11], s32 offen offset:0
    buffer_load_dwordx4 v[196:199], v2, s[8:11], s32 offen offset:1024
    buffer_load_dwordx4 v[200:203], v2, s[8:11], s32 offen offset:2048
    buffer_load_dwordx4 v[204:207], v2, s[8:11], s32 offen offset:3072
    s_add_u32 s32, s32, 4096
    buffer_load_dwordx4 v[208:211], v2, s[8:11], s32 offen offset:0
    buffer_load_dwordx4 v[212:215], v2, s[8:11], s32 offen offset:1024
    buffer_load_dwordx4 v[216:219], v2, s[8:11], s32 offen offset:2048
    buffer_load_dwordx4 v[220:223], v2, s[8:11], s32 offen offset:3072
    s_add_u32 s32, s32, 4096
    buffer_load_dwordx4 v[224:227], v2, s[8:11], s32 offen offset:0
    buffer_load_dwordx4 v[228:231], v2, s[8:11], s32 offen offset:1024
    buffer_load_dwordx4 v[232:235], v2, s[8:11], s32 offen offset:2048
    buffer_load_dwordx4 v[236:239], v2, s[8:11], s32 offen offset:3072
    s_add_u32 s32, s32, 4096
    buffer_load_dwordx4 v[240:243], v2, s[8:11], s32 offen offset:0
    buffer_load_dwordx4 v[244:247], v2, s[8:11], s32 offen offset:1024
    buffer_load_dwordx4 v[248:251], v2, s[8:11], s32 offen offset:2048
    buffer_load_dwordx4 v[252:255], v2, s[8:11], s32 offen offset:3072
    s_add_u32 s32, s32, 4096
    s_mov_b32 s46, 0
    v_min_u32 v60, 63, v1
    v_mul_u32_u24 v60, 128, v60
    s_lshl_b32 s3, s46, 7
    s_add_u32 s3, s3, 46833664
    s_mov_b32 s47, 200000
L_va_na0:
    buffer_load_dwordx2 v[62:63], v60, s[8:11], s3 offen sc1
    s_waitcnt vmcnt(0)
    v_xor_b32 v62, s96, v62
    v_xor_b32 v63, s97, v63
    v_or_b32 v62, v62, v63
    v_cmp_ne_u32 vcc, 0, v62
    s_cbranch_vccz L_va_na0_ok
    s_sub_u32 s47, s47, 1
    s_cbranch_scc0 L_va_na0
    s_branch L_fail
L_va_na0_ok:
    s_mov_b32 s46, 64
    v_min_u32 v60, 63, v1
    v_mul_u32_u24 v60, 128, v60
    s_lshl_b32 s3, s46, 7
    s_add_u32 s3, s3, 46833664
    s_mov_b32 s47, 200000
L_va_na1:
    buffer_load_dwordx2 v[62:63], v60, s[8:11], s3 offen sc1
    s_waitcnt vmcnt(0)
    v_xor_b32 v62, s96, v62
    v_xor_b32 v63, s97, v63
    v_or_b32 v62, v62, v63
    v_cmp_ne_u32 vcc, 0, v62
    s_cbranch_vccz L_va_na1_ok
    s_sub_u32 s47, s47, 1
    s_cbranch_scc0 L_va_na1
    s_branch L_fail
L_va_na1_ok:
    s_mov_b32 s46, 128
    v_min_u32 v60, 63, v1
    v_mul_u32_u24 v60, 128, v60
    s_lshl_b32 s3, s46, 7
    s_add_u32 s3, s3, 46833664
    s_mov_b32 s47, 200000
L_va_na2:
    buffer_load_dwordx2 v[62:63], v60, s[8:11], s3 offen sc1
    s_waitcnt vmcnt(0)
    v_xor_b32 v62, s96, v62
    v_xor_b32 v63, s97, v63
    v_or_b32 v62, v62, v63
    v_cmp_ne_u32 vcc, 0, v62
    s_cbranch_vccz L_va_na2_ok
    s_sub_u32 s47, s47, 1
    s_cbranch_scc0 L_va_na2
    s_branch L_fail
L_va_na2_ok:
    s_mov_b32 s46, 192
    v_min_u32 v60, 63, v1
    v_mul_u32_u24 v60, 128, v60
    s_lshl_b32 s3, s46, 7
    s_add_u32 s3, s3, 46833664
    s_mov_b32 s47, 200000
L_va_na3:
    buffer_load_dwordx2 v[62:63], v60, s[8:11], s3 offen sc1
    s_waitcnt vmcnt(0)
    v_xor_b32 v62, s96, v62
    v_xor_b32 v63, s97, v63
    v_or_b32 v62, v62, v63
    v_cmp_ne_u32 vcc, 0, v62
    s_cbranch_vccz L_va_na3_ok
    s_sub_u32 s47, s47, 1
    s_cbranch_scc0 L_va_na3
    s_branch L_fail
L_va_na3_ok:
    s_mov_b32 s46, 256
    v_min_u32 v60, 63, v1
    v_mul_u32_u24 v60, 128, v60
    s_lshl_b32 s3, s46, 7
    s_add_u32 s3, s3, 46833664
    s_mov_b32 s47, 200000
L_va_na4:
    buffer_load_dwordx2 v[62:63], v60, s[8:11], s3 offen sc1
    s_waitcnt vmcnt(0)
    v_xor_b32 v62, s96, v62
    v_xor_b32 v63, s97, v63
    v_or_b32 v62, v62, v63
    v_cmp_ne_u32 vcc, 0, v62
    s_cbranch_vccz L_va_na4_ok
    s_sub_u32 s47, s47, 1
    s_cbranch_scc0 L_va_na4
    s_branch L_fail
L_va_na4_ok:
    s_mul_i32 s33, s20, 28672
    v_add_u32 v166, s33, v2
    buffer_load_dwordx4 v[8:11], v2, s[8:11], s32 offen offset:0
    buffer_load_dwordx4 v[12:15], v2, s[8:11], s32 offen offset:1024
    buffer_load_dwordx4 v[16:19], v2, s[8:11], s32 offen offset:2048
    buffer_load_dwordx4 v[20:23], v2, s[8:11], s32 offen offset:3072
    s_add_u32 s32, s32, 4096
    buffer_load_dwordx4 v[24:27], v2, s[8:11], s32 offen offset:0
    buffer_load_dwordx4 v[28:31], v2, s[8:11], s32 offen offset:1024
    buffer_load_dwordx4 v[32:35], v2, s[8:11], s32 offen offset:2048
    buffer_load_dwordx4 v[36:39], v2, s[8:11], s32 offen offset:3072
    s_add_u32 s32, s32, 4096
    buffer_load_dwordx4 v[40:43], v2, s[8:11], s32 offen offset:0
    buffer_load_dwordx4 v[44:47], v2, s[8:11], s32 offen offset:1024
    buffer_load_dwordx4 v[48:51], v2, s[8:11], s32 offen offset:2048
    buffer_load_dwordx4 v[52:55], v2, s[8:11], s32 offen offset:3072
    s_add_u32 s32, s32, 4096
    buffer_load_dwordx4 v[56:59], v2, s[8:11], s32 offen offset:0
    buffer_load_dwordx4 v[60:63], v2, s[8:11], s32 offen offset:1024
    s_add_u32 s32, s32, 2048
    s_waitcnt vmcnt(0)
    ds_write_b128 v166, v[8:11] offset:24576
    ds_write_b128 v166, v[12:15] offset:25600
    ds_write_b128 v166, v[16:19] offset:26624
    ds_write_b128 v166, v[20:23] offset:27648
    ds_write_b128 v166, v[24:27] offset:28672
    ds_write_b128 v166, v[28:31] offset:29696
    ds_write_b128 v166, v[32:35] offset:30720
    ds_write_b128 v166, v[36:39] offset:31744
    ds_write_b128 v166, v[40:43] offset:32768
    ds_write_b128 v166, v[44:47] offset:33792
    ds_write_b128 v166, v[48:51] offset:34816
    ds_write_b128 v166, v[52:55] offset:35840
    ds_write_b128 v166, v[56:59] offset:36864
    ds_write_b128 v166, v[60:63] offset:37888
    s_waitcnt lgkmcnt(0)
    buffer_load_dwordx4 v[8:11], v2, s[8:11], s32 offen offset:0
    buffer_load_dwordx4 v[12:15], v2, s[8:11], s32 offen offset:1024
    buffer_load_dwordx4 v[16:19], v2, s[8:11], s32 offen offset:2048
    buffer_load_dwordx4 v[20:23], v2, s[8:11], s32 offen offset:3072
    s_add_u32 s32, s32, 4096
    buffer_load_dwordx4 v[24:27], v2, s[8:11], s32 offen offset:0
    buffer_load_dwordx4 v[28:31], v2, s[8:11], s32 offen offset:1024
    buffer_load_dwordx4 v[32:35], v2, s[8:11], s32 offen offset:2048
    buffer_load_dwordx4 v[36:39], v2, s[8:11], s32 offen offset:3072
    s_add_u32 s32, s32, 4096
    buffer_load_dwordx4 v[40:43], v2, s[8:11], s32 offen offset:0
    buffer_load_dwordx4 v[44:47], v2, s[8:11], s32 offen offset:1024
    buffer_load_dwordx4 v[48:51], v2, s[8:11], s32 offen offset:2048
    buffer_load_dwordx4 v[52:55], v2, s[8:11], s32 offen offset:3072
    s_add_u32 s32, s32, 4096
    buffer_load_dwordx4 v[56:59], v2, s[8:11], s32 offen offset:0
    buffer_load_dwordx4 v[60:63], v2, s[8:11], s32 offen offset:1024
    s_add_u32 s32, s32, 2048
    s_waitcnt vmcnt(0)
    ds_write_b128 v166, v[8:11] offset:38912
    ds_write_b128 v166, v[12:15] offset:39936
    ds_write_b128 v166, v[16:19] offset:40960
    ds_write_b128 v166, v[20:23] offset:41984
    ds_write_b128 v166, v[24:27] offset:43008
    ds_write_b128 v166, v[28:31] offset:44032
    ds_write_b128 v166, v[32:35] offset:45056
    ds_write_b128 v166, v[36:39] offset:46080
    ds_write_b128 v166, v[40:43] offset:47104
    ds_write_b128 v166, v[44:47] offset:48128
    ds_write_b128 v166, v[48:51] offset:49152
    ds_write_b128 v166, v[52:55] offset:50176
    ds_write_b128 v166, v[56:59] offset:51200
    ds_write_b128 v166, v[60:63] offset:52224
    s_waitcnt lgkmcnt(0)
    v_bfe_u32 v164, v1, 4, 2
    v_lshlrev_b32 v164, 6, v164
    v_bfe_u32 v4, v1, 1, 1
    v_lshl_add_u32 v164, v4, 5, v164
    v_bfe_u32 v4, v1, 0, 1
    v_lshl_add_u32 v164, v4, 4, v164
    v_bfe_u32 v4, v1, 2, 2
    v_lshl_add_u32 v164, v4, 2, v164
    s_lshl_b32 s33, s21, 1
    s_add_u32 s33, s33, s20
    s_lshl_b32 s33, s33, 8
    v_add_u32 v164, s33, v164
    v_mov_b32 v5, 0x5040100
    v_mov_b32 v167, 0x3020706
    v_and_b32 v4, 1, v1
    v_cmp_ne_u32 vcc, 0, v4
    s_nop 1
    v_cndmask_b32 v165, v5, v167, vcc
    s_lshl_b32 s29, s21, 15
    s_lshl_b32 s33, s20, 14
    s_add_u32 s29, s29, s33
    s_add_u32 s29, s29, 14942208
    s_mov_b32 s28, 44834816
    s_lshl_b32 s33, s20, 2
    s_add_u32 s33, s33, s21
    s_add_u32 s32, s33, 0
    s_and_b32 s32, s32, 7
    s_lshl_b32 s64, s32, 10
    s_add_u32 s64, s64, 44826624
    s_lshl_b32 s72, s32, 11
    s_add_u32 s72, s72, s29
    s_add_u32 s32, s33, 1
    s_and_b32 s32, s32, 7
    s_lshl_b32 s65, s32, 10
    s_add_u32 s65, s65, 44826624
    s_lshl_b32 s73, s32, 11
    s_add_u32 s73, s73, s29
    s_add_u32 s32, s33, 2
    s_and_b32 s32, s32, 7
    s_lshl_b32 s66, s32, 10
    s_add_u32 s66, s66, 44826624
    s_lshl_b32 s74, s32, 11
    s_add_u32 s74, s74, s29
    s_add_u32 s32, s33, 3
    s_and_b32 s32, s32, 7
    s_lshl_b32 s67, s32, 10
    s_add_u32 s67, s67, 44826624
    s_lshl_b32 s75, s32, 11
    s_add_u32 s75, s75, s29
    s_add_u32 s32, s33, 4
    s_and_b32 s32, s32, 7
    s_lshl_b32 s68, s32, 10
    s_add_u32 s68, s68, 44826624
    s_lshl_b32 s76, s32, 11
    s_add_u32 s76, s76, s29
    s_add_u32 s32, s33, 5
    s_and_b32 s32, s32, 7
    s_lshl_b32 s69, s32, 10
    s_add_u32 s69, s69, 44826624
    s_lshl_b32 s77, s32, 11
    s_add_u32 s77, s77, s29
    s_add_u32 s32, s33, 6
    s_and_b32 s32, s32, 7
    s_lshl_b32 s70, s32, 10
    s_add_u32 s70, s70, 44826624
    s_lshl_b32 s78, s32, 11
    s_add_u32 s78, s78, s29
    s_add_u32 s32, s33, 7
    s_and_b32 s32, s32, 7
    s_lshl_b32 s71, s32, 10
    s_add_u32 s71, s71, 44826624
    s_lshl_b32 s79, s32, 11
    s_add_u32 s79, s79, s29
    s_lshl_b32 s33, s21, 1
    s_add_u32 s33, s33, s20
    v_and_b32 v4, 15, v1
    v_lshlrev_b32 v4, 2, v4
    s_and_b32 s32, s33, 3
    s_lshl_b32 s32, s32, 7
    v_add_u32 v168, s32, v4
    v_mov_b32 v168, v4
    s_lshl_b32 s32, s33, 2
    s_add_u32 s32, s32, 7168
    v_lshlrev_b32 v5, 7, v1
    v_add_u32 v5, s32, v5
    v_mov_b32 v4, 0x40000000
    v_cmp_gt_u32 vcc, 1, v1
    s_nop 1
    v_cndmask_b32 v169, v4, v5, vcc
    s_mov_b32 s36, 44310528
    s_lshl_b32 s34, s33, 12
    s_add_u32 s34, s34, 46908416
    s_lshl_b32 s39, s33, 7
    s_add_u32 s39, s39, 46078976
    v_mov_b32 v128, 0
    v_mov_b32 v129, 0
    v_mov_b32 v130, 0
    v_mov_b32 v131, 0
    v_mov_b32 v132, 0
    v_mov_b32 v133, 0
    v_mov_b32 v134, 0
    v_mov_b32 v135, 0
    v_mov_b32 v136, 0
    v_mov_b32 v137, 0
    v_mov_b32 v138, 0
    v_mov_b32 v139, 0
    v_mov_b32 v140, 0
    v_mov_b32 v141, 0
    v_mov_b32 v142, 0
    v_mov_b32 v143, 0
    v_mov_b32 v171, 0
    ds_write_b64 v171, v[128:129] offset:16384
    s_waitcnt lgkmcnt(0)
L_va_step:
    s_barrier
    s_sleep 2
    buffer_load_dwordx4 v[8:11], v2, s[8:11], s72 offen offset:0
    buffer_load_dwordx4 v[12:15], v2, s[8:11], s72 offen offset:1024
    buffer_load_dwordx4 v[16:19], v2, s[8:11], s73 offen offset:0
    buffer_load_dwordx4 v[20:23], v2, s[8:11], s73 offen offset:1024
    buffer_load_dwordx4 v[24:27], v2, s[8:11], s74 offen offset:0
    buffer_load_dwordx4 v[28:31], v2, s[8:11], s74 offen offset:1024
    buffer_load_dwordx4 v[32:35], v2, s[8:11], s75 offen offset:0
    buffer_load_dwordx4 v[36:39], v2, s[8:11], s75 offen offset:1024
    buffer_load_dwordx4 v[40:43], v2, s[8:11], s76 offen offset:0
    buffer_load_dwordx4 v[44:47], v2, s[8:11], s76 offen offset:1024
    buffer_load_dwordx4 v[48:51], v2, s[8:11], s77 offen offset:0
    buffer_load_dwordx4 v[52:55], v2, s[8:11], s77 offen offset:1024
    buffer_load_dwordx4 v[56:59], v2, s[8:11], s78 offen offset:0
    buffer_load_dwordx4 v[60:63], v2, s[8:11], s78 offen offset:1024
    buffer_load_dwordx4 v[64:67], v2, s[8:11], s79 offen offset:0
    buffer_load_dwordx4 v[68:71], v2, s[8:11], s79 offen offset:1024
    s_mov_b32 s31, 200000
L_va_sb:
    ds_read_b64 v[4:5], v171 offset:16384
    s_waitcnt lgkmcnt(0)
    v_min_u32 v4, v4, v5
    v_cmp_ge_u32 vcc, s30, v4
    s_sub_u32 s31, s31, 1
    s_cbranch_scc1 L_fail
    s_cbranch_vccnz L_va_sb
L_va_rd:
    ds_read_b128 v[88:91], v2 offset:0
    ds_read_b128 v[92:95], v2 offset:1024
    ds_read_b128 v[96:99], v2 offset:2048
    ds_read_b128 v[100:103], v2 offset:3072
    ds_read_b128 v[104:107], v2 offset:4096
    ds_read_b128 v[108:111], v2 offset:5120
    ds_read_b128 v[112:115], v2 offset:6144
    s_waitcnt lgkmcnt(6)
    .p2align 3
    v_smfmac_f32_16x16x64_bf16 v[128:131], v[88:91], a[0:7], v3
    s_waitcnt lgkmcnt(5)
    s_mov_b32 s44, 0
    v_smfmac_f32_16x16x64_bf16 v[128:131], v[92:95], a[8:15], v3
    s_waitcnt lgkmcnt(4)
    s_mov_b32 s44, 0
    v_smfmac_f32_16x16x64_bf16 v[128:131], v[96:99], a[16:23], v3
    s_waitcnt lgkmcnt(3)
    s_mov_b32 s44, 0
    v_smfmac_f32_16x16x64_bf16 v[128:131], v[100:103], a[24:31], v3
    s_waitcnt lgkmcnt(2)
    s_mov_b32 s44, 0
    v_smfmac_f32_16x16x64_bf16 v[128:131], v[104:107], a[32:39], v3
    s_waitcnt lgkmcnt(1)
    s_mov_b32 s44, 0
    v_smfmac_f32_16x16x64_bf16 v[128:131], v[108:111], a[40:47], v3
    s_waitcnt lgkmcnt(0)
    s_mov_b32 s44, 0
    v_smfmac_f32_16x16x64_bf16 v[128:131], v[112:115], a[48:55], v3
    ds_read_b128 v[148:151], v166 offset:24576
    ds_read_b128 v[152:155], v166 offset:25600
    v_smfmac_f32_16x16x64_bf16 v[132:135], v[88:91], a[56:63], v3
    v_smfmac_f32_16x16x64_bf16 v[132:135], v[92:95], a[64:71], v3
    v_smfmac_f32_16x16x64_bf16 v[132:135], v[96:99], a[72:79], v3
    v_add_f32_e64 v128, v128, v130
    v_smfmac_f32_16x16x64_bf16 v[132:135], v[100:103], a[80:87], v3
    s_waitcnt lgkmcnt(0)
    v_add_f32 v129, v129, v131
    v_smfmac_f32_16x16x64_bf16 v[136:139], v[88:91], v[148:155], v3
    ds_read_b128 v[148:151], v166 offset:26624
    ds_read_b128 v[152:155], v166 offset:27648
    v_cmp_u_f32_e64 vcc, v128, v129
    v_smfmac_f32_16x16x64_bf16 v[132:135], v[104:107], a[88:95], v3
    v_cvt_pk_bf16_f32 v72, v128, v129
    v_smfmac_f32_16x16x64_bf16 v[132:135], v[108:111], a[96:103], v3
    v_mov_b64_e64 v[130:131], 0
    v_smfmac_f32_16x16x64_bf16 v[132:135], v[112:115], a[104:111], v3
    s_cbranch_vccnz L_va_nan
    v_mov_b64 v[128:129], 0
    v_smfmac_f32_16x16x64_bf16 v[140:143], v[88:91], a[112:119], v3
    v_smfmac_f32_16x16x64_bf16 v[140:143], v[92:95], a[120:127], v3
    s_waitcnt lgkmcnt(0)
    s_mov_b32 s44, 0
    v_smfmac_f32_16x16x64_bf16 v[136:139], v[92:95], v[148:155], v3
    ds_read_b128 v[148:151], v166 offset:28672
    ds_read_b128 v[152:155], v166 offset:29696
    v_add_f32_e64 v132, v132, v134
    v_smfmac_f32_16x16x64_bf16 v[140:143], v[96:99], a[128:135], v3
    v_add_f32_e64 v133, v133, v135
    v_smfmac_f32_16x16x64_bf16 v[140:143], v[100:103], a[136:143], v3
    v_cvt_pk_bf16_f32 v73, v132, v133
    v_smfmac_f32_16x16x64_bf16 v[140:143], v[104:107], a[144:151], v3
    v_mov_b64_e64 v[134:135], 0
    v_smfmac_f32_16x16x64_bf16 v[140:143], v[108:111], a[152:159], v3
    v_mov_b64_e64 v[132:133], 0
    v_smfmac_f32_16x16x64_bf16 v[140:143], v[112:115], a[160:167], v3
    s_waitcnt lgkmcnt(0)
    s_mov_b32 s44, 0
    v_smfmac_f32_16x16x64_bf16 v[136:139], v[96:99], v[148:155], v3
    ds_read_b128 v[148:151], v166 offset:30720
    ds_read_b128 v[152:155], v166 offset:31744
    v_smfmac_f32_16x16x64_bf16 v[128:131], v[88:91], a[168:175], v3
    v_smfmac_f32_16x16x64_bf16 v[128:131], v[92:95], a[176:183], v3
    v_add_f32_e64 v140, v140, v142
    v_smfmac_f32_16x16x64_bf16 v[128:131], v[96:99], a[184:191], v3
    v_add_f32_e64 v141, v141, v143
    v_smfmac_f32_16x16x64_bf16 v[128:131], v[100:103], a[192:199], v3
    v_cvt_pk_bf16_f32 v74, v140, v141
    v_smfmac_f32_16x16x64_bf16 v[128:131], v[104:107], a[200:207], v3
    s_waitcnt lgkmcnt(0)
    v_mov_b64 v[142:143], 0
    v_smfmac_f32_16x16x64_bf16 v[136:139], v[100:103], v[148:155], v3
    ds_read_b128 v[148:151], v166 offset:32768
    ds_read_b128 v[152:155], v166 offset:33792
    v_mov_b64_e64 v[140:141], 0
    v_smfmac_f32_16x16x64_bf16 v[128:131], v[108:111], a[208:215], v3
    v_mov_b32_e64 v170, -1
    v_smfmac_f32_16x16x64_bf16 v[128:131], v[112:115], a[216:223], v3
    v_smfmac_f32_16x16x64_bf16 v[132:135], v[88:91], a[224:231], v3
    v_smfmac_f32_16x16x64_bf16 v[132:135], v[92:95], a[232:239], v3
    v_smfmac_f32_16x16x64_bf16 v[132:135], v[96:99], a[240:247], v3
    s_waitcnt lgkmcnt(0)
    v_add_f32 v128, v128, v130
    v_smfmac_f32_16x16x64_bf16 v[136:139], v[104:107], v[148:155], v3
    ds_read_b128 v[148:151], v166 offset:34816
    ds_read_b128 v[152:155], v166 offset:35840
    v_add_f32_e64 v129, v129, v131
    v_smfmac_f32_16x16x64_bf16 v[132:135], v[100:103], a[248:255], v3
    v_cvt_pk_bf16_f32 v75, v128, v129
    v_smfmac_f32_16x16x64_bf16 v[132:135], v[104:107], v[176:183], v3
    v_mov_b64_e64 v[130:131], 0
    v_smfmac_f32_16x16x64_bf16 v[132:135], v[108:111], v[184:191], v3
    buffer_load_dword v170, v168, s[8:11], s28 offen offset:2048 sc1
    v_mov_b64_e64 v[128:129], 0
    v_smfmac_f32_16x16x64_bf16 v[132:135], v[112:115], v[192:199], v3
    v_smfmac_f32_16x16x64_bf16 v[140:143], v[88:91], v[200:207], v3
    s_waitcnt lgkmcnt(0)
    s_mov_b32 s44, 0
    v_smfmac_f32_16x16x64_bf16 v[136:139], v[108:111], v[148:155], v3
    ds_read_b128 v[148:151], v166 offset:36864
    ds_read_b128 v[152:155], v166 offset:37888
    v_smfmac_f32_16x16x64_bf16 v[140:143], v[92:95], v[208:215], v3
    buffer_load_dword v170, v168, s[8:11], s28 offen offset:2048 sc1
    v_add_f32_e64 v132, v132, v134
    v_smfmac_f32_16x16x64_bf16 v[140:143], v[96:99], v[216:223], v3
    v_add_f32_e64 v133, v133, v135
    v_smfmac_f32_16x16x64_bf16 v[140:143], v[100:103], v[224:231], v3
    v_cvt_pk_bf16_f32 v76, v132, v133
    v_smfmac_f32_16x16x64_bf16 v[140:143], v[104:107], v[232:239], v3
    v_mov_b64_e64 v[134:135], 0
    v_smfmac_f32_16x16x64_bf16 v[140:143], v[108:111], v[240:247], v3
    s_waitcnt lgkmcnt(0)
    buffer_load_dword v170, v168, s[8:11], s28 offen offset:2048 sc1
    v_mov_b64 v[132:133], 0
    v_smfmac_f32_16x16x64_bf16 v[136:139], v[112:115], v[148:155], v3
    v_smfmac_f32_16x16x64_bf16 v[140:143], v[112:115], v[248:255], v3
L_va_y:
    s_cmp_ge_u32 s30, 63
    s_cbranch_scc1 L_va_last
    s_cmp_lg_u32 s20, 0
    s_cbranch_scc1 L_va_go
    s_mov_b32 s31, 200000
L_va_probe:
    buffer_load_dword v170, v168, s[8:11], s28 offen offset:2048 sc1
    s_waitcnt vmcnt(2)
    v_cmp_eq_u32 vcc, -1, v170
    s_sub_u32 s31, s31, 1
    s_cbranch_scc1 L_fail
    s_cbranch_vccnz L_va_probe
L_va_go:
    s_barrier
    buffer_load_dwordx4 v[88:91], v2, s[8:11], s64 offen offset:0 sc1
    buffer_load_dwordx4 v[92:95], v2, s[8:11], s65 offen offset:0 sc1
    buffer_load_dwordx4 v[96:99], v2, s[8:11], s66 offen offset:0 sc1
    buffer_load_dwordx4 v[100:103], v2, s[8:11], s67 offen offset:0 sc1
    buffer_load_dwordx4 v[104:107], v2, s[8:11], s68 offen offset:0 sc1
    buffer_load_dwordx4 v[108:111], v2, s[8:11], s69 offen offset:0 sc1
    buffer_load_dwordx4 v[112:115], v2, s[8:11], s70 offen offset:0 sc1
    buffer_load_dwordx4 v[116:119], v2, s[8:11], s71 offen offset:0 sc1
    buffer_load_dwordx4 v[120:123], v2, s[8:11], s28 offen offset:0 sc1
    buffer_load_dwordx4 v[124:127], v2, s[8:11], s28 offen offset:1024 sc1
    v_mov_b64 v[144:145], 0
    v_mov_b64 v[146:147], 0
    ds_read_b32 v79, v7 offset:1036
    ds_read_b128 v[80:83], v7 offset:2048
    ds_read_b128 v[84:87], v7 offset:3072
    v_add_f32 v136, v136, v138
    v_add_f32 v137, v137, v139
    v_cvt_pk_bf16_f32 v78, v136, v137
    v_mov_b64 v[138:139], 0
    v_mov_b64 v[136:137], 0
    v_add_f32 v140, v140, v142
    v_add_f32 v141, v141, v143
    v_cvt_pk_bf16_f32 v77, v140, v141
    v_mov_b64 v[142:143], 0
    v_mov_b64 v[140:141], 0
    s_waitcnt vmcnt(9)
    v_smfmac_f32_16x16x64_bf16 v[144:147], v[88:91], v[8:15], v3
    s_waitcnt vmcnt(8)
    v_smfmac_f32_16x16x64_bf16 v[144:147], v[92:95], v[16:23], v3
    s_waitcnt vmcnt(7)
    v_smfmac_f32_16x16x64_bf16 v[144:147], v[96:99], v[24:31], v3
    s_waitcnt vmcnt(6)
    v_smfmac_f32_16x16x64_bf16 v[144:147], v[100:103], v[32:39], v3
    buffer_store_dword v3, v169, s[8:11], s36 offen
    s_waitcnt vmcnt(6)
    v_smfmac_f32_16x16x64_bf16 v[144:147], v[104:107], v[40:47], v3
    s_waitcnt vmcnt(5)
    v_smfmac_f32_16x16x64_bf16 v[144:147], v[108:111], v[48:55], v3
    s_waitcnt vmcnt(4)
    v_smfmac_f32_16x16x64_bf16 v[144:147], v[112:115], v[56:63], v3
    s_waitcnt vmcnt(3)
    v_smfmac_f32_16x16x64_bf16 v[144:147], v[116:119], v[64:71], v3
    s_waitcnt vmcnt(2) lgkmcnt(0)
    v_smfmac_f32_16x16x64_bf16 v[144:147], v[120:123], v[72:79], v3
    s_waitcnt vmcnt(1)
    v_smfmac_f32_16x16x64_bf16 v[144:147], v[124:127], v[80:87], v3
    s_nop 7
    v_add_f32 v144, v144, v146
    v_add_f32 v145, v145, v147
    v_cmp_u_f32 vcc, v144, v145
    v_cvt_pk_bf16_f32 v144, v144, v145
    s_nop 1
    v_mov_b32_dpp v145, v144 quad_perm:[1,0,3,2] row_mask:0xf bank_mask:0xf
    v_perm_b32 v144, v145, v144, v165
    v_min_u32 v144, -2, v144
    s_cbranch_vccnz L_va_redo
L_va_pub:
    buffer_store_dword v144, v164, s[8:11], s36 offen
    s_cmp_lg_u32 s30, 62
    s_cbranch_scc1 L_va_nx
    s_add_u32 s32, s36, 1245184
    buffer_store_dword v144, v164, s[8:11], s32 offen sc1
L_va_nx:
    s_add_u32 s24, s24, 8192
    s_add_u32 s25, s25, 8192
    s_add_u32 s36, s36, 8192
    s_add_u32 s28, s28, 11264
    s_add_u32 s34, s34, 114688
    s_add_u32 s39, s39, 11264
    s_add_u32 s30, s30, 1
    s_add_u32 s64, s64, 11264
    s_add_u32 s65, s65, 11264
    s_add_u32 s66, s66, 11264
    s_add_u32 s67, s67, 11264
    s_add_u32 s68, s68, 11264
    s_add_u32 s69, s69, 11264
    s_add_u32 s70, s70, 11264
    s_add_u32 s71, s71, 11264
    s_add_u32 s72, s72, 458752
    s_add_u32 s73, s73, 458752
    s_add_u32 s74, s74, 458752
    s_add_u32 s75, s75, 458752
    s_add_u32 s76, s76, 458752
    s_add_u32 s77, s77, 458752
    s_add_u32 s78, s78, 458752
    s_add_u32 s79, s79, 458752
    s_branch L_va_step
L_va_last:
    s_nop 7
    v_add_f32 v136, v136, v138
    v_add_f32 v137, v137, v139
    v_cvt_pk_bf16_f32 v78, v136, v137
    v_mov_b64 v[138:139], 0
    v_mov_b64 v[136:137], 0
    v_add_f32 v140, v140, v142
    v_add_f32 v141, v141, v143
    v_cvt_pk_bf16_f32 v77, v140, v141
    v_mov_b64 v[142:143], 0
    v_mov_b64 v[140:141], 0
    s_waitcnt lgkmcnt(0)
    s_barrier
    ds_read_b32 v79, v7 offset:1036
    ds_read_b128 v[80:83], v7 offset:2048
    ds_read_b128 v[84:87], v7 offset:3072
    s_add_u32 s34, s34, 114688
    s_add_u32 s39, s39, 11264
    s_waitcnt vmcnt(0) lgkmcnt(0)
    buffer_store_dwordx4 v[72:75], v2, s[8:11], s34 offen offset:0 sc1
    buffer_store_dwordx4 v[76:79], v2, s[8:11], s34 offen offset:1024 sc1
    buffer_store_dwordx4 v[80:83], v2, s[8:11], s34 offen offset:2048 sc1
    buffer_store_dwordx4 v[84:87], v2, s[8:11], s34 offen offset:3072 sc1
    s_add_u32 s39, s39, 11264
    s_waitcnt vmcnt(0)
    s_mov_b64 exec, 0xff
    buffer_store_dwordx4 v[128:131], v2, s[8:11], s39 offen sc1
    s_mov_b64 exec, -1
    s_branch L_done
L_va_redo:
    s_mov_b32 s31, 0
L_va_redo_l:
    buffer_load_dwordx4 v[88:91], v2, s[8:11], s64 offen offset:0 sc1
    buffer_load_dwordx4 v[92:95], v2, s[8:11], s65 offen offset:0 sc1
    buffer_load_dwordx4 v[96:99], v2, s[8:11], s66 offen offset:0 sc1
    buffer_load_dwordx4 v[100:103], v2, s[8:11], s67 offen offset:0 sc1
    buffer_load_dwordx4 v[104:107], v2, s[8:11], s68 offen offset:0 sc1
    buffer_load_dwordx4 v[108:111], v2, s[8:11], s69 offen offset:0 sc1
    buffer_load_dwordx4 v[112:115], v2, s[8:11], s70 offen offset:0 sc1
    buffer_load_dwordx4 v[116:119], v2, s[8:11], s71 offen offset:0 sc1
    buffer_load_dwordx4 v[120:123], v2, s[8:11], s28 offen offset:0 sc1
    buffer_load_dwordx4 v[124:127], v2, s[8:11], s28 offen offset:1024 sc1
    s_waitcnt vmcnt(0)
    v_max3_u32 v4, v88, v89, v90
    v_max3_u32 v4, v4, v91, v92
    v_max3_u32 v4, v4, v93, v94
    v_max3_u32 v4, v4, v95, v96
    v_max3_u32 v4, v4, v97, v98
    v_max3_u32 v4, v4, v99, v100
    v_max3_u32 v4, v4, v101, v102
    v_max3_u32 v4, v4, v103, v104
    v_max3_u32 v4, v4, v105, v106
    v_max3_u32 v4, v4, v107, v108
    v_max3_u32 v4, v4, v109, v110
    v_max3_u32 v4, v4, v111, v112
    v_max3_u32 v4, v4, v113, v114
    v_max3_u32 v4, v4, v115, v116
    v_max3_u32 v4, v4, v117, v118
    v_max3_u32 v4, v4, v119, v120
    v_max3_u32 v4, v4, v121, v122
    v_max3_u32 v4, v4, v123, v124
    v_max3_u32 v4, v4, v125, v126
    v_max_u32 v4, v4, v127
    v_cmp_eq_u32 vcc, -1, v4
    s_cbranch_vccz L_va_redo_go
    s_add_u32 s31, s31, 1
    s_cmp_lt_u32 s31, 200000
    s_cbranch_scc1 L_va_redo_l
    s_branch L_fail
L_va_redo_go:
    v_mov_b64 v[144:145], 0
    v_mov_b64 v[146:147], 0
    v_mov_b64 v[156:157], 0
    v_mov_b64 v[158:159], 0
    s_nop 1
    v_smfmac_f32_16x16x64_bf16 v[144:147], v[88:91], v[8:15], v3
    v_smfmac_f32_16x16x64_bf16 v[144:147], v[92:95], v[16:23], v3
    v_smfmac_f32_16x16x64_bf16 v[144:147], v[96:99], v[24:31], v3
    v_smfmac_f32_16x16x64_bf16 v[144:147], v[100:103], v[32:39], v3
    v_smfmac_f32_16x16x64_bf16 v[144:147], v[104:107], v[40:47], v3
    v_smfmac_f32_16x16x64_bf16 v[144:147], v[108:111], v[48:55], v3
    v_smfmac_f32_16x16x64_bf16 v[144:147], v[112:115], v[56:63], v3
    v_smfmac_f32_16x16x64_bf16 v[144:147], v[116:119], v[64:71], v3
    v_smfmac_f32_16x16x64_bf16 v[144:147], v[120:123], v[72:79], v3
    v_smfmac_f32_16x16x64_bf16 v[144:147], v[124:127], v[80:87], v3
    s_nop 7
    v_add_f32 v144, v144, v146
    v_add_f32 v145, v145, v147
    v_cvt_pk_bf16_f32 v144, v144, v145
    s_nop 1
    v_mov_b32_dpp v145, v144 quad_perm:[1,0,3,2] row_mask:0xf bank_mask:0xf
    v_perm_b32 v144, v145, v144, v165
    v_min_u32 v144, -2, v144
    s_branch L_va_pub
L_va_nan:
    s_mov_b32 s31, 0
    s_waitcnt lgkmcnt(0)
L_va_nan_l:
    buffer_load_dwordx4 v[88:91], v2, s[8:11], s24 offen offset:0 sc1
    buffer_load_dwordx4 v[92:95], v2, s[8:11], s24 offen offset:1024 sc1
    buffer_load_dwordx4 v[96:99], v2, s[8:11], s24 offen offset:2048 sc1
    buffer_load_dwordx4 v[100:103], v2, s[8:11], s24 offen offset:3072 sc1
    buffer_load_dwordx4 v[104:107], v2, s[8:11], s25 offen offset:0 sc1
    buffer_load_dwordx4 v[108:111], v2, s[8:11], s25 offen offset:1024 sc1
    buffer_load_dwordx4 v[112:115], v2, s[8:11], s25 offen offset:2048 sc1
    s_waitcnt vmcnt(0)
    v_max3_u32 v4, v88, v89, v90
    v_max3_u32 v4, v4, v91, v92
    v_max3_u32 v4, v4, v93, v94
    v_max3_u32 v4, v4, v95, v96
    v_max3_u32 v4, v4, v97, v98
    v_max3_u32 v4, v4, v99, v100
    v_max3_u32 v4, v4, v101, v102
    v_max3_u32 v4, v4, v103, v104
    v_max3_u32 v4, v4, v105, v106
    v_max3_u32 v4, v4, v107, v108
    v_max3_u32 v4, v4, v109, v110
    v_max3_u32 v4, v4, v111, v112
    v_max3_u32 v4, v4, v113, v114
    v_max_u32 v4, v4, v115
    v_cmp_eq_u32 vcc, -1, v4
    s_cbranch_vccz L_va_nan_go
    s_add_u32 s31, s31, 1
    s_cmp_lt_u32 s31, 200000
    s_cbranch_scc1 L_va_nan_l
    s_branch L_fail
L_va_nan_go:
    v_mov_b64 v[128:129], 0
    v_mov_b64 v[130:131], 0
    v_mov_b64 v[132:133], 0
    v_mov_b64 v[134:135], 0
    v_mov_b64 v[136:137], 0
    v_mov_b64 v[138:139], 0
    v_mov_b64 v[140:141], 0
    v_mov_b64 v[142:143], 0
    s_nop 1
    v_smfmac_f32_16x16x64_bf16 v[128:131], v[88:91], a[0:7], v3
    v_smfmac_f32_16x16x64_bf16 v[128:131], v[92:95], a[8:15], v3
    v_smfmac_f32_16x16x64_bf16 v[128:131], v[96:99], a[16:23], v3
    v_smfmac_f32_16x16x64_bf16 v[128:131], v[100:103], a[24:31], v3
    v_smfmac_f32_16x16x64_bf16 v[128:131], v[104:107], a[32:39], v3
    v_smfmac_f32_16x16x64_bf16 v[128:131], v[108:111], a[40:47], v3
    v_smfmac_f32_16x16x64_bf16 v[128:131], v[112:115], a[48:55], v3
    ds_read_b128 v[148:151], v166 offset:24576
    ds_read_b128 v[152:155], v166 offset:25600
    v_smfmac_f32_16x16x64_bf16 v[132:135], v[88:91], a[56:63], v3
    v_smfmac_f32_16x16x64_bf16 v[132:135], v[92:95], a[64:71], v3
    v_smfmac_f32_16x16x64_bf16 v[132:135], v[96:99], a[72:79], v3
    v_add_f32_e64 v128, v128, v130
    v_smfmac_f32_16x16x64_bf16 v[132:135], v[100:103], a[80:87], v3
    s_waitcnt lgkmcnt(0)
    v_add_f32 v129, v129, v131
    v_smfmac_f32_16x16x64_bf16 v[136:139], v[88:91], v[148:155], v3
    ds_read_b128 v[148:151], v166 offset:26624
    ds_read_b128 v[152:155], v166 offset:27648
    v_cvt_pk_bf16_f32 v72, v128, v129
    v_smfmac_f32_16x16x64_bf16 v[132:135], v[104:107], a[88:95], v3
    v_mov_b64_e64 v[130:131], 0
    v_smfmac_f32_16x16x64_bf16 v[132:135], v[108:111], a[96:103], v3
    v_mov_b64_e64 v[128:129], 0
    v_smfmac_f32_16x16x64_bf16 v[132:135], v[112:115], a[104:111], v3
    v_smfmac_f32_16x16x64_bf16 v[140:143], v[88:91], a[112:119], v3
    v_smfmac_f32_16x16x64_bf16 v[140:143], v[92:95], a[120:127], v3
    s_waitcnt lgkmcnt(0)
    s_mov_b32 s44, 0
    v_smfmac_f32_16x16x64_bf16 v[136:139], v[92:95], v[148:155], v3
    ds_read_b128 v[148:151], v166 offset:28672
    ds_read_b128 v[152:155], v166 offset:29696
    v_add_f32_e64 v132, v132, v134
    v_smfmac_f32_16x16x64_bf16 v[140:143], v[96:99], a[128:135], v3
    v_add_f32_e64 v133, v133, v135
    v_smfmac_f32_16x16x64_bf16 v[140:143], v[100:103], a[136:143], v3
    v_cvt_pk_bf16_f32 v73, v132, v133
    v_smfmac_f32_16x16x64_bf16 v[140:143], v[104:107], a[144:151], v3
    v_mov_b64_e64 v[134:135], 0
    v_smfmac_f32_16x16x64_bf16 v[140:143], v[108:111], a[152:159], v3
    v_mov_b64_e64 v[132:133], 0
    v_smfmac_f32_16x16x64_bf16 v[140:143], v[112:115], a[160:167], v3
    s_waitcnt lgkmcnt(0)
    s_mov_b32 s44, 0
    v_smfmac_f32_16x16x64_bf16 v[136:139], v[96:99], v[148:155], v3
    ds_read_b128 v[148:151], v166 offset:30720
    ds_read_b128 v[152:155], v166 offset:31744
    v_smfmac_f32_16x16x64_bf16 v[128:131], v[88:91], a[168:175], v3
    v_smfmac_f32_16x16x64_bf16 v[128:131], v[92:95], a[176:183], v3
    v_add_f32_e64 v140, v140, v142
    v_smfmac_f32_16x16x64_bf16 v[128:131], v[96:99], a[184:191], v3
    v_add_f32_e64 v141, v141, v143
    v_smfmac_f32_16x16x64_bf16 v[128:131], v[100:103], a[192:199], v3
    v_cvt_pk_bf16_f32 v74, v140, v141
    v_smfmac_f32_16x16x64_bf16 v[128:131], v[104:107], a[200:207], v3
    s_waitcnt lgkmcnt(0)
    v_mov_b64 v[142:143], 0
    v_smfmac_f32_16x16x64_bf16 v[136:139], v[100:103], v[148:155], v3
    ds_read_b128 v[148:151], v166 offset:32768
    ds_read_b128 v[152:155], v166 offset:33792
    v_mov_b64_e64 v[140:141], 0
    v_smfmac_f32_16x16x64_bf16 v[128:131], v[108:111], a[208:215], v3
    v_mov_b32_e64 v170, -1
    v_smfmac_f32_16x16x64_bf16 v[128:131], v[112:115], a[216:223], v3
    v_smfmac_f32_16x16x64_bf16 v[132:135], v[88:91], a[224:231], v3
    v_smfmac_f32_16x16x64_bf16 v[132:135], v[92:95], a[232:239], v3
    v_smfmac_f32_16x16x64_bf16 v[132:135], v[96:99], a[240:247], v3
    s_waitcnt lgkmcnt(0)
    v_add_f32 v128, v128, v130
    v_smfmac_f32_16x16x64_bf16 v[136:139], v[104:107], v[148:155], v3
    ds_read_b128 v[148:151], v166 offset:34816
    ds_read_b128 v[152:155], v166 offset:35840
    v_add_f32_e64 v129, v129, v131
    v_smfmac_f32_16x16x64_bf16 v[132:135], v[100:103], a[248:255], v3
    v_cvt_pk_bf16_f32 v75, v128, v129
    v_smfmac_f32_16x16x64_bf16 v[132:135], v[104:107], v[176:183], v3
    v_mov_b64_e64 v[130:131], 0
    v_smfmac_f32_16x16x64_bf16 v[132:135], v[108:111], v[184:191], v3
    buffer_load_dword v170, v168, s[8:11], s28 offen offset:2048 sc1
    v_mov_b64_e64 v[128:129], 0
    v_smfmac_f32_16x16x64_bf16 v[132:135], v[112:115], v[192:199], v3
    v_smfmac_f32_16x16x64_bf16 v[140:143], v[88:91], v[200:207], v3
    s_waitcnt lgkmcnt(0)
    s_mov_b32 s44, 0
    v_smfmac_f32_16x16x64_bf16 v[136:139], v[108:111], v[148:155], v3
    ds_read_b128 v[148:151], v166 offset:36864
    ds_read_b128 v[152:155], v166 offset:37888
    v_smfmac_f32_16x16x64_bf16 v[140:143], v[92:95], v[208:215], v3
    buffer_load_dword v170, v168, s[8:11], s28 offen offset:2048 sc1
    v_add_f32_e64 v132, v132, v134
    v_smfmac_f32_16x16x64_bf16 v[140:143], v[96:99], v[216:223], v3
    v_add_f32_e64 v133, v133, v135
    v_smfmac_f32_16x16x64_bf16 v[140:143], v[100:103], v[224:231], v3
    v_cvt_pk_bf16_f32 v76, v132, v133
    v_smfmac_f32_16x16x64_bf16 v[140:143], v[104:107], v[232:239], v3
    v_mov_b64_e64 v[134:135], 0
    v_smfmac_f32_16x16x64_bf16 v[140:143], v[108:111], v[240:247], v3
    s_waitcnt lgkmcnt(0)
    buffer_load_dword v170, v168, s[8:11], s28 offen offset:2048 sc1
    v_mov_b64 v[132:133], 0
    v_smfmac_f32_16x16x64_bf16 v[136:139], v[112:115], v[148:155], v3
    v_smfmac_f32_16x16x64_bf16 v[140:143], v[112:115], v[248:255], v3
    s_branch L_va_y
L_vb:
    buffer_load_dwordx4 a[0:3], v2, s[8:11], s32 offen offset:0
    buffer_load_dwordx4 a[4:7], v2, s[8:11], s32 offen offset:1024
    buffer_load_dwordx4 a[8:11], v2, s[8:11], s32 offen offset:2048
    buffer_load_dwordx4 a[12:15], v2, s[8:11], s32 offen offset:3072
    s_add_u32 s32, s32, 4096
    buffer_load_dwordx4 a[16:19], v2, s[8:11], s32 offen offset:0
    buffer_load_dwordx4 a[20:23], v2, s[8:11], s32 offen offset:1024
    buffer_load_dwordx4 a[24:27], v2, s[8:11], s32 offen offset:2048
    buffer_load_dwordx4 a[28:31], v2, s[8:11], s32 offen offset:3072
    s_add_u32 s32, s32, 4096
    buffer_load_dwordx4 a[32:35], v2, s[8:11], s32 offen offset:0
    buffer_load_dwordx4 a[36:39], v2, s[8:11], s32 offen offset:1024
    buffer_load_dwordx4 a[40:43], v2, s[8:11], s32 offen offset:2048
    buffer_load_dwordx4 a[44:47], v2, s[8:11], s32 offen offset:3072
    s_add_u32 s32, s32, 4096
    buffer_load_dwordx4 a[48:51], v2, s[8:11], s32 offen offset:0
    buffer_load_dwordx4 a[52:55], v2, s[8:11], s32 offen offset:1024
    buffer_load_dwordx4 a[56:59], v2, s[8:11], s32 offen offset:2048
    buffer_load_dwordx4 a[60:63], v2, s[8:11], s32 offen offset:3072
    s_add_u32 s32, s32, 4096
    buffer_load_dwordx4 a[64:67], v2, s[8:11], s32 offen offset:0
    buffer_load_dwordx4 a[68:71], v2, s[8:11], s32 offen offset:1024
    buffer_load_dwordx4 a[72:75], v2, s[8:11], s32 offen offset:2048
    buffer_load_dwordx4 a[76:79], v2, s[8:11], s32 offen offset:3072
    s_add_u32 s32, s32, 4096
    buffer_load_dwordx4 a[80:83], v2, s[8:11], s32 offen offset:0
    buffer_load_dwordx4 a[84:87], v2, s[8:11], s32 offen offset:1024
    buffer_load_dwordx4 a[88:91], v2, s[8:11], s32 offen offset:2048
    buffer_load_dwordx4 a[92:95], v2, s[8:11], s32 offen offset:3072
    s_add_u32 s32, s32, 4096
    buffer_load_dwordx4 a[96:99], v2, s[8:11], s32 offen offset:0
    buffer_load_dwordx4 a[100:103], v2, s[8:11], s32 offen offset:1024
    buffer_load_dwordx4 a[104:107], v2, s[8:11], s32 offen offset:2048
    buffer_load_dwordx4 a[108:111], v2, s[8:11], s32 offen offset:3072
    s_add_u32 s32, s32, 4096
    buffer_load_dwordx4 a[112:115], v2, s[8:11], s32 offen offset:0
    buffer_load_dwordx4 a[116:119], v2, s[8:11], s32 offen offset:1024
    buffer_load_dwordx4 a[120:123], v2, s[8:11], s32 offen offset:2048
    buffer_load_dwordx4 a[124:127], v2, s[8:11], s32 offen offset:3072
    s_add_u32 s32, s32, 4096
    buffer_load_dwordx4 a[128:131], v2, s[8:11], s32 offen offset:0
    buffer_load_dwordx4 a[132:135], v2, s[8:11], s32 offen offset:1024
    buffer_load_dwordx4 a[136:139], v2, s[8:11], s32 offen offset:2048
    buffer_load_dwordx4 a[140:143], v2, s[8:11], s32 offen offset:3072
    s_add_u32 s32, s32, 4096
    buffer_load_dwordx4 a[144:147], v2, s[8:11], s32 offen offset:0
    buffer_load_dwordx4 a[148:151], v2, s[8:11], s32 offen offset:1024
    buffer_load_dwordx4 a[152:155], v2, s[8:11], s32 offen offset:2048
    buffer_load_dwordx4 a[156:159], v2, s[8:11], s32 offen offset:3072
    s_add_u32 s32, s32, 4096
    buffer_load_dwordx4 a[160:163], v2, s[8:11], s32 offen offset:0
    buffer_load_dwordx4 a[164:167], v2, s[8:11], s32 offen offset:1024
    buffer_load_dwordx4 a[168:171], v2, s[8:11], s32 offen offset:2048
    buffer_load_dwordx4 a[172:175], v2, s[8:11], s32 offen offset:3072
    s_add_u32 s32, s32, 4096
    buffer_load_dwordx4 a[176:179], v2, s[8:11], s32 offen offset:0
    buffer_load_dwordx4 a[180:183], v2, s[8:11], s32 offen offset:1024
    buffer_load_dwordx4 a[184:187], v2, s[8:11], s32 offen offset:2048
    buffer_load_dwordx4 a[188:191], v2, s[8:11], s32 offen offset:3072
    s_add_u32 s32, s32, 4096
    buffer_load_dwordx4 a[192:195], v2, s[8:11], s32 offen offset:0
    buffer_load_dwordx4 a[196:199], v2, s[8:11], s32 offen offset:1024
    buffer_load_dwordx4 a[200:203], v2, s[8:11], s32 offen offset:2048
    buffer_load_dwordx4 a[204:207], v2, s[8:11], s32 offen offset:3072
    s_add_u32 s32, s32, 4096
    buffer_load_dwordx4 a[208:211], v2, s[8:11], s32 offen offset:0
    buffer_load_dwordx4 a[212:215], v2, s[8:11], s32 offen offset:1024
    buffer_load_dwordx4 a[216:219], v2, s[8:11], s32 offen offset:2048
    buffer_load_dwordx4 a[220:223], v2, s[8:11], s32 offen offset:3072
    s_add_u32 s32, s32, 4096
    buffer_load_dwordx4 a[224:227], v2, s[8:11], s32 offen offset:0
    buffer_load_dwordx4 a[228:231], v2, s[8:11], s32 offen offset:1024
    buffer_load_dwordx4 a[232:235], v2, s[8:11], s32 offen offset:2048
    buffer_load_dwordx4 a[236:239], v2, s[8:11], s32 offen offset:3072
    s_add_u32 s32, s32, 4096
    buffer_load_dwordx4 a[240:243], v2, s[8:11], s32 offen offset:0
    buffer_load_dwordx4 a[244:247], v2, s[8:11], s32 offen offset:1024
    buffer_load_dwordx4 a[248:251], v2, s[8:11], s32 offen offset:2048
    buffer_load_dwordx4 a[252:255], v2, s[8:11], s32 offen offset:3072
    s_add_u32 s32, s32, 4096
    buffer_load_dwordx4 v[64:67], v2, s[8:11], s32 offen offset:0
    buffer_load_dwordx4 v[68:71], v2, s[8:11], s32 offen offset:1024
    buffer_load_dwordx4 v[72:75], v2, s[8:11], s32 offen offset:2048
    buffer_load_dwordx4 v[76:79], v2, s[8:11], s32 offen offset:3072
    s_add_u32 s32, s32, 4096
    buffer_load_dwordx4 v[80:83], v2, s[8:11], s32 offen offset:0
    buffer_load_dwordx4 v[84:87], v2, s[8:11], s32 offen offset:1024
    buffer_load_dwordx4 v[88:91], v2, s[8:11], s32 offen offset:2048
    buffer_load_dwordx4 v[92:95], v2, s[8:11], s32 offen offset:3072
    s_add_u32 s32, s32, 4096
    buffer_load_dwordx4 v[96:99], v2, s[8:11], s32 offen offset:0
    buffer_load_dwordx4 v[100:103], v2, s[8:11], s32 offen offset:1024
    buffer_load_dwordx4 v[104:107], v2, s[8:11], s32 offen offset:2048
    buffer_load_dwordx4 v[108:111], v2, s[8:11], s32 offen offset:3072
    s_add_u32 s32, s32, 4096
    buffer_load_dwordx4 v[112:115], v2, s[8:11], s32 offen offset:0
    buffer_load_dwordx4 v[116:119], v2, s[8:11], s32 offen offset:1024
    buffer_load_dwordx4 v[120:123], v2, s[8:11], s32 offen offset:2048
    buffer_load_dwordx4 v[124:127], v2, s[8:11], s32 offen offset:3072
    s_add_u32 s32, s32, 4096
    buffer_load_dwordx4 v[128:131], v2, s[8:11], s32 offen offset:0
    buffer_load_dwordx4 v[132:135], v2, s[8:11], s32 offen offset:1024
    buffer_load_dwordx4 v[136:139], v2, s[8:11], s32 offen offset:2048
    buffer_load_dwordx4 v[140:143], v2, s[8:11], s32 offen offset:3072
    s_add_u32 s32, s32, 4096
    buffer_load_dwordx4 v[144:147], v2, s[8:11], s32 offen offset:0
    buffer_load_dwordx4 v[148:151], v2, s[8:11], s32 offen offset:1024
    buffer_load_dwordx4 v[152:155], v2, s[8:11], s32 offen offset:2048
    buffer_load_dwordx4 v[156:159], v2, s[8:11], s32 offen offset:3072
    s_add_u32 s32, s32, 4096
    buffer_load_dwordx4 v[160:163], v2, s[8:11], s32 offen offset:0
    buffer_load_dwordx4 v[164:167], v2, s[8:11], s32 offen offset:1024
    buffer_load_dwordx4 v[168:171], v2, s[8:11], s32 offen offset:2048
    buffer_load_dwordx4 v[172:175], v2, s[8:11], s32 offen offset:3072
    s_add_u32 s32, s32, 4096
    buffer_load_dwordx4 v[176:179], v2, s[8:11], s32 offen offset:0
    buffer_load_dwordx4 v[180:183], v2, s[8:11], s32 offen offset:1024
    buffer_load_dwordx4 v[184:187], v2, s[8:11], s32 offen offset:2048
    buffer_load_dwordx4 v[188:191], v2, s[8:11], s32 offen offset:3072
    s_add_u32 s32, s32, 4096
    buffer_load_dwordx4 v[192:195], v2, s[8:11], s32 offen offset:0
    buffer_load_dwordx4 v[196:199], v2, s[8:11], s32 offen offset:1024
    buffer_load_dwordx4 v[200:203], v2, s[8:11], s32 offen offset:2048
    buffer_load_dwordx4 v[204:207], v2, s[8:11], s32 offen offset:3072
    s_add_u32 s32, s32, 4096
    buffer_load_dwordx4 v[208:211], v2, s[8:11], s32 offen offset:0
    buffer_load_dwordx4 v[212:215], v2, s[8:11], s32 offen offset:1024
    buffer_load_dwordx4 v[216:219], v2, s[8:11], s32 offen offset:2048
    buffer_load_dwordx4 v[220:223], v2, s[8:11], s32 offen offset:3072
    s_add_u32 s32, s32, 4096
    buffer_load_dwordx4 v[224:227], v2, s[8:11], s32 offen offset:0
    buffer_load_dwordx4 v[228:231], v2, s[8:11], s32 offen offset:1024
    buffer_load_dwordx4 v[232:235], v2, s[8:11], s32 offen offset:2048
    buffer_load_dwordx4 v[236:239], v2, s[8:11], s32 offen offset:3072
    s_add_u32 s32, s32, 4096
    buffer_load_dwordx4 v[240:243], v2, s[8:11], s32 offen offset:0
    buffer_load_dwordx4 v[244:247], v2, s[8:11], s32 offen offset:1024
    buffer_load_dwordx4 v[248:251], v2, s[8:11], s32 offen offset:2048
    buffer_load_dwordx4 v[252:255], v2, s[8:11], s32 offen offset:3072
    s_add_u32 s32, s32, 4096
    s_mov_b32 s46, 0
    v_min_u32 v60, 63, v1
    v_mul_u32_u24 v60, 128, v60
    s_lshl_b32 s3, s46, 7
    s_add_u32 s3, s3, 46833664
    s_mov_b32 s47, 200000
L_vb_na0:
    buffer_load_dwordx2 v[62:63], v60, s[8:11], s3 offen sc1
    s_waitcnt vmcnt(0)
    v_xor_b32 v62, s96, v62
    v_xor_b32 v63, s97, v63
    v_or_b32 v62, v62, v63
    v_cmp_ne_u32 vcc, 0, v62
    s_cbranch_vccz L_vb_na0_ok
    s_sub_u32 s47, s47, 1
    s_cbranch_scc0 L_vb_na0
    s_branch L_fail
L_vb_na0_ok:
    s_mov_b32 s46, 64
    v_min_u32 v60, 63, v1
    v_mul_u32_u24 v60, 128, v60
    s_lshl_b32 s3, s46, 7
    s_add_u32 s3, s3, 46833664
    s_mov_b32 s47, 200000
L_vb_na1:
    buffer_load_dwordx2 v[62:63], v60, s[8:11], s3 offen sc1
    s_waitcnt vmcnt(0)
    v_xor_b32 v62, s96, v62
    v_xor_b32 v63, s97, v63
    v_or_b32 v62, v62, v63
    v_cmp_ne_u32 vcc, 0, v62
    s_cbranch_vccz L_vb_na1_ok
    s_sub_u32 s47, s47, 1
    s_cbranch_scc0 L_vb_na1
    s_branch L_fail
L_vb_na1_ok:
    s_mov_b32 s46, 128
    v_min_u32 v60, 63, v1
    v_mul_u32_u24 v60, 128, v60
    s_lshl_b32 s3, s46, 7
    s_add_u32 s3, s3, 46833664
    s_mov_b32 s47, 200000
L_vb_na2:
    buffer_load_dwordx2 v[62:63], v60, s[8:11], s3 offen sc1
    s_waitcnt vmcnt(0)
    v_xor_b32 v62, s96, v62
    v_xor_b32 v63, s97, v63
    v_or_b32 v62, v62, v63
    v_cmp_ne_u32 vcc, 0, v62
    s_cbranch_vccz L_vb_na2_ok
    s_sub_u32 s47, s47, 1
    s_cbranch_scc0 L_vb_na2
    s_branch L_fail
L_vb_na2_ok:
    s_mov_b32 s46, 192
    v_min_u32 v60, 63, v1
    v_mul_u32_u24 v60, 128, v60
    s_lshl_b32 s3, s46, 7
    s_add_u32 s3, s3, 46833664
    s_mov_b32 s47, 200000
L_vb_na3:
    buffer_load_dwordx2 v[62:63], v60, s[8:11], s3 offen sc1
    s_waitcnt vmcnt(0)
    v_xor_b32 v62, s96, v62
    v_xor_b32 v63, s97, v63
    v_or_b32 v62, v62, v63
    v_cmp_ne_u32 vcc, 0, v62
    s_cbranch_vccz L_vb_na3_ok
    s_sub_u32 s47, s47, 1
    s_cbranch_scc0 L_vb_na3
    s_branch L_fail
L_vb_na3_ok:
    s_mov_b32 s46, 256
    v_min_u32 v60, 63, v1
    v_mul_u32_u24 v60, 128, v60
    s_lshl_b32 s3, s46, 7
    s_add_u32 s3, s3, 46833664
    s_mov_b32 s47, 200000
L_vb_na4:
    buffer_load_dwordx2 v[62:63], v60, s[8:11], s3 offen sc1
    s_waitcnt vmcnt(0)
    v_xor_b32 v62, s96, v62
    v_xor_b32 v63, s97, v63
    v_or_b32 v62, v62, v63
    v_cmp_ne_u32 vcc, 0, v62
    s_cbranch_vccz L_vb_na4_ok
    s_sub_u32 s47, s47, 1
    s_cbranch_scc0 L_vb_na4
    s_branch L_fail
L_vb_na4_ok:
    s_lshl_b32 s32, s21, 1
    s_add_u32 s32, s32, s20
    s_and_b32 s32, s32, 3
    s_add_u32 s32, s32, 4
    s_lshl_b32 s32, s32, 7
    v_min_u32 v4, 28, v1
    v_lshlrev_b32 v4, 2, v4
    v_add_u32 v6, s32, v4
    v_mov_b32 v6, v4
    s_mul_i32 s33, s38, 28672
    v_add_u32 v1, s33, v2
    s_lshl_b32 s34, s21, 13
    s_lshl_b32 s33, s38, 12
    s_add_u32 s34, s34, s33
    s_add_u32 s34, s34, 47023104
    v_mov_b32 v36, 0
    v_mov_b32 v37, 0
    v_mov_b32 v38, 0
    v_mov_b32 v39, 0
    v_mov_b32 v40, 0
    v_mov_b32 v41, 0
    v_mov_b32 v42, 0
    v_mov_b32 v43, 0
    v_mov_b32 v44, 0
    v_mov_b32 v45, 0
    v_mov_b32 v46, 0
    v_mov_b32 v47, 0
    v_mov_b32 v48, 0
    v_mov_b32 v49, 0
    v_mov_b32 v50, 0
    v_mov_b32 v51, 0
    v_mov_b32 v52, 0
    v_mov_b32 v53, 0
    v_mov_b32 v54, 0
    v_mov_b32 v55, 0
    s_lshl_b32 s35, s21, 10
    s_add_u32 s35, s35, 45547520
    v_mov_b32 v0, 0
    s_cmp_eq_u32 s20, 3
    s_cbranch_scc1 L_vb3_step
L_vb2_step:
    s_sleep 9
    v_mov_b32 v5, -1
    s_mov_b32 s31, 200000
L_vb2_probe:
    buffer_load_dword v5, v6, s[8:11], s25 offen offset:3072 sc1
    s_waitcnt vmcnt(2)
    v_cmp_eq_u32 vcc, -1, v5
    s_sub_u32 s31, s31, 1
    s_cbranch_scc1 L_fail
    s_cbranch_vccnz L_vb2_probe
    s_add_u32 s32, s30, 1
    v_mov_b32 v4, s32
    s_barrier
    buffer_load_dwordx4 v[8:11], v2, s[8:11], s24 offen offset:0 sc1
    buffer_load_dwordx4 v[12:15], v2, s[8:11], s24 offen offset:1024 sc1
    buffer_load_dwordx4 v[16:19], v2, s[8:11], s24 offen offset:2048 sc1
    buffer_load_dwordx4 v[20:23], v2, s[8:11], s24 offen offset:3072 sc1
    buffer_load_dwordx4 v[24:27], v2, s[8:11], s25 offen offset:0 sc1
    buffer_load_dwordx4 v[28:31], v2, s[8:11], s25 offen offset:1024 sc1
    buffer_load_dwordx4 v[32:35], v2, s[8:11], s25 offen offset:2048 sc1
    s_waitcnt vmcnt(6)
    .p2align 3
    v_smfmac_f32_16x16x64_bf16 v[36:39], v[8:11], a[0:7], v3
    ds_write_b128 v2, v[8:11] offset:0
    v_smfmac_f32_16x16x64_bf16 v[40:43], v[8:11], a[56:63], v3
    s_waitcnt vmcnt(5)
    s_mov_b32 s44, 0
    v_smfmac_f32_16x16x64_bf16 v[36:39], v[12:15], a[8:15], v3
    ds_write_b128 v2, v[12:15] offset:1024
    v_smfmac_f32_16x16x64_bf16 v[40:43], v[12:15], a[64:71], v3
    s_waitcnt vmcnt(4)
    s_mov_b32 s44, 0
    v_smfmac_f32_16x16x64_bf16 v[36:39], v[16:19], a[16:23], v3
    ds_write_b128 v2, v[16:19] offset:2048
    v_smfmac_f32_16x16x64_bf16 v[40:43], v[16:19], a[72:79], v3
    s_waitcnt vmcnt(3)
    s_mov_b32 s44, 0
    v_smfmac_f32_16x16x64_bf16 v[36:39], v[20:23], a[24:31], v3
    ds_write_b128 v2, v[20:23] offset:3072
    v_smfmac_f32_16x16x64_bf16 v[40:43], v[20:23], a[80:87], v3
    s_waitcnt vmcnt(2)
    ds_write_b32 v0, v4 offset:16384
    s_mov_b32 s44, 0
    v_smfmac_f32_16x16x64_bf16 v[36:39], v[24:27], a[32:39], v3
    v_smfmac_f32_16x16x64_bf16 v[40:43], v[24:27], a[88:95], v3
    s_waitcnt vmcnt(1)
    s_mov_b32 s44, 0
    v_smfmac_f32_16x16x64_bf16 v[36:39], v[28:31], a[40:47], v3
    v_smfmac_f32_16x16x64_bf16 v[40:43], v[28:31], a[96:103], v3
    s_waitcnt vmcnt(0)
    s_mov_b32 s44, 0
    v_smfmac_f32_16x16x64_bf16 v[36:39], v[32:35], a[48:55], v3
    ds_read_b128 v[56:59], v1 offset:38912
    ds_read_b128 v[60:63], v1 offset:39936
    v_smfmac_f32_16x16x64_bf16 v[40:43], v[32:35], a[104:111], v3
    v_smfmac_f32_16x16x64_bf16 v[44:47], v[8:11], a[112:119], v3
    v_smfmac_f32_16x16x64_bf16 v[44:47], v[12:15], a[120:127], v3
    v_add_f32_e64 v36, v36, v38
    v_smfmac_f32_16x16x64_bf16 v[44:47], v[16:19], a[128:135], v3
    v_add_f32_e64 v37, v37, v39
    v_smfmac_f32_16x16x64_bf16 v[44:47], v[20:23], a[136:143], v3
    s_waitcnt lgkmcnt(0)
    v_cmp_u_f32 vcc, v36, v37
    v_smfmac_f32_16x16x64_bf16 v[48:51], v[8:11], v[56:63], v3
    ds_read_b128 v[56:59], v1 offset:40960
    ds_read_b128 v[60:63], v1 offset:41984
    v_cvt_pk_bf16_f32 v4, v36, v37
    v_smfmac_f32_16x16x64_bf16 v[44:47], v[24:27], a[144:151], v3
    ds_write_b32 v7, v4 offset:2048
    v_mov_b64_e64 v[38:39], 0
    v_smfmac_f32_16x16x64_bf16 v[44:47], v[28:31], a[152:159], v3
    s_cbranch_vccnz L_vb2_nan
    v_mov_b64 v[36:37], 0
    v_smfmac_f32_16x16x64_bf16 v[44:47], v[32:35], a[160:167], v3
    v_add_f32_e64 v40, v40, v42
    v_smfmac_f32_16x16x64_bf16 v[52:55], v[8:11], a[168:175], v3
    v_add_f32_e64 v41, v41, v43
    v_smfmac_f32_16x16x64_bf16 v[52:55], v[12:15], a[176:183], v3
    v_cvt_pk_bf16_f32 v5, v40, v41
    v_smfmac_f32_16x16x64_bf16 v[52:55], v[16:19], a[184:191], v3
    s_waitcnt lgkmcnt(0)
    ds_write_b32 v7, v5 offset:2052
    v_mov_b64 v[42:43], 0
    v_smfmac_f32_16x16x64_bf16 v[48:51], v[12:15], v[56:63], v3
    ds_read_b128 v[56:59], v1 offset:43008
    ds_read_b128 v[60:63], v1 offset:44032
    v_mov_b64_e64 v[40:41], 0
    v_smfmac_f32_16x16x64_bf16 v[52:55], v[20:23], a[192:199], v3
    v_add_f32_e64 v44, v44, v46
    v_smfmac_f32_16x16x64_bf16 v[52:55], v[24:27], a[200:207], v3
    v_add_f32_e64 v45, v45, v47
    v_smfmac_f32_16x16x64_bf16 v[52:55], v[28:31], a[208:215], v3
    v_cvt_pk_bf16_f32 v4, v44, v45
    v_smfmac_f32_16x16x64_bf16 v[52:55], v[32:35], a[216:223], v3
    ds_write_b32 v7, v4 offset:2056
    v_mov_b64_e64 v[46:47], 0
    v_smfmac_f32_16x16x64_bf16 v[36:39], v[8:11], a[224:231], v3
    v_mov_b64_e64 v[44:45], 0
    v_smfmac_f32_16x16x64_bf16 v[36:39], v[12:15], a[232:239], v3
    s_waitcnt lgkmcnt(0)
    s_mov_b32 s44, 0
    v_smfmac_f32_16x16x64_bf16 v[48:51], v[16:19], v[56:63], v3
    ds_read_b128 v[56:59], v1 offset:45056
    ds_read_b128 v[60:63], v1 offset:46080
    v_add_f32_e64 v52, v52, v54
    v_smfmac_f32_16x16x64_bf16 v[36:39], v[16:19], a[240:247], v3
    v_add_f32_e64 v53, v53, v55
    v_smfmac_f32_16x16x64_bf16 v[36:39], v[20:23], a[248:255], v3
    v_cvt_pk_bf16_f32 v5, v52, v53
    v_smfmac_f32_16x16x64_bf16 v[36:39], v[24:27], v[64:71], v3
    ds_write_b32 v7, v5 offset:2060
    v_mov_b64_e64 v[54:55], 0
    v_smfmac_f32_16x16x64_bf16 v[36:39], v[28:31], v[72:79], v3
    v_mov_b64_e64 v[52:53], 0
    v_smfmac_f32_16x16x64_bf16 v[36:39], v[32:35], v[80:87], v3
    v_smfmac_f32_16x16x64_bf16 v[40:43], v[8:11], v[88:95], v3
    s_waitcnt lgkmcnt(0)
    s_mov_b32 s44, 0
    v_smfmac_f32_16x16x64_bf16 v[48:51], v[20:23], v[56:63], v3
    ds_read_b128 v[56:59], v1 offset:47104
    ds_read_b128 v[60:63], v1 offset:48128
    v_smfmac_f32_16x16x64_bf16 v[40:43], v[12:15], v[96:103], v3
    v_add_f32_e64 v36, v36, v38
    v_smfmac_f32_16x16x64_bf16 v[40:43], v[16:19], v[104:111], v3
    v_add_f32_e64 v37, v37, v39
    v_smfmac_f32_16x16x64_bf16 v[40:43], v[20:23], v[112:119], v3
    v_cvt_pk_bf16_f32 v4, v36, v37
    v_smfmac_f32_16x16x64_bf16 v[40:43], v[24:27], v[120:127], v3
    ds_write_b32 v7, v4 offset:3072
    v_mov_b64_e64 v[38:39], 0
    v_smfmac_f32_16x16x64_bf16 v[40:43], v[28:31], v[128:135], v3
    v_mov_b64_e64 v[36:37], 0
    v_smfmac_f32_16x16x64_bf16 v[40:43], v[32:35], v[136:143], v3
    s_waitcnt lgkmcnt(0)
    s_mov_b32 s44, 0
    v_smfmac_f32_16x16x64_bf16 v[48:51], v[24:27], v[56:63], v3
    ds_read_b128 v[56:59], v1 offset:49152
    ds_read_b128 v[60:63], v1 offset:50176
    v_smfmac_f32_16x16x64_bf16 v[44:47], v[8:11], v[144:151], v3
    v_smfmac_f32_16x16x64_bf16 v[44:47], v[12:15], v[152:159], v3
    v_add_f32_e64 v40, v40, v42
    v_smfmac_f32_16x16x64_bf16 v[44:47], v[16:19], v[160:167], v3
    v_add_f32_e64 v41, v41, v43
    v_smfmac_f32_16x16x64_bf16 v[44:47], v[20:23], v[168:175], v3
    v_cvt_pk_bf16_f32 v5, v40, v41
    v_smfmac_f32_16x16x64_bf16 v[44:47], v[24:27], v[176:183], v3
    ds_write_b32 v7, v5 offset:3076
    v_mov_b64_e64 v[42:43], 0
    v_smfmac_f32_16x16x64_bf16 v[44:47], v[28:31], v[184:191], v3
    s_waitcnt lgkmcnt(0)
    v_mov_b64 v[40:41], 0
    v_smfmac_f32_16x16x64_bf16 v[48:51], v[28:31], v[56:63], v3
    ds_read_b128 v[56:59], v1 offset:51200
    ds_read_b128 v[60:63], v1 offset:52224
    v_smfmac_f32_16x16x64_bf16 v[44:47], v[32:35], v[192:199], v3
    v_smfmac_f32_16x16x64_bf16 v[52:55], v[8:11], v[200:207], v3
    v_smfmac_f32_16x16x64_bf16 v[52:55], v[12:15], v[208:215], v3
    v_smfmac_f32_16x16x64_bf16 v[52:55], v[16:19], v[216:223], v3
    v_add_f32_e64 v44, v44, v46
    v_smfmac_f32_16x16x64_bf16 v[52:55], v[20:23], v[224:231], v3
    v_add_f32_e64 v45, v45, v47
    v_smfmac_f32_16x16x64_bf16 v[52:55], v[24:27], v[232:239], v3
    s_waitcnt lgkmcnt(0)
    s_mov_b32 s44, 0
    v_cvt_pk_bf16_f32 v4, v44, v45
    v_smfmac_f32_16x16x64_bf16 v[48:51], v[32:35], v[56:63], v3
    ds_write_b32 v7, v4 offset:3080
    v_mov_b64_e64 v[46:47], 0
    v_smfmac_f32_16x16x64_bf16 v[52:55], v[28:31], v[240:247], v3
    v_mov_b64_e64 v[44:45], 0
    v_smfmac_f32_16x16x64_bf16 v[52:55], v[32:35], v[248:255], v3
L_vb2_y:
    s_nop 7
    v_add_f32 v48, v48, v50
    v_add_f32 v49, v49, v51
    v_cvt_pk_bf16_f32 v5, v48, v49
    ds_write_b32 v7, v5 offset:1036
    v_mov_b64 v[50:51], 0
    v_mov_b64 v[48:49], 0
    v_add_f32 v52, v52, v54
    v_add_f32 v53, v53, v55
    v_cvt_pk_bf16_f32 v5, v52, v53
    ds_write_b32 v7, v5 offset:3084
    v_mov_b64 v[54:55], 0
    v_mov_b64 v[52:53], 0
    s_waitcnt lgkmcnt(0)
    s_barrier
    s_add_u32 s24, s24, 8192
    s_add_u32 s25, s25, 8192
    s_add_u32 s30, s30, 1
    s_cmp_le_u32 s30, 63
    s_cbranch_scc1 L_vb2_step
    s_branch L_done
L_vb2_nan:
    s_mov_b32 s31, 0
    s_waitcnt lgkmcnt(0)
L_vb2_nan_l:
    buffer_load_dwordx4 v[8:11], v2, s[8:11], s24 offen offset:0 sc1
    buffer_load_dwordx4 v[12:15], v2, s[8:11], s24 offen offset:1024 sc1
    buffer_load_dwordx4 v[16:19], v2, s[8:11], s24 offen offset:2048 sc1
    buffer_load_dwordx4 v[20:23], v2, s[8:11], s24 offen offset:3072 sc1
    buffer_load_dwordx4 v[24:27], v2, s[8:11], s25 offen offset:0 sc1
    buffer_load_dwordx4 v[28:31], v2, s[8:11], s25 offen offset:1024 sc1
    buffer_load_dwordx4 v[32:35], v2, s[8:11], s25 offen offset:2048 sc1
    s_waitcnt vmcnt(0)
    v_max3_u32 v4, v8, v9, v10
    v_max3_u32 v4, v4, v11, v12
    v_max3_u32 v4, v4, v13, v14
    v_max3_u32 v4, v4, v15, v16
    v_max3_u32 v4, v4, v17, v18
    v_max3_u32 v4, v4, v19, v20
    v_max3_u32 v4, v4, v21, v22
    v_max3_u32 v4, v4, v23, v24
    v_max3_u32 v4, v4, v25, v26
    v_max3_u32 v4, v4, v27, v28
    v_max3_u32 v4, v4, v29, v30
    v_max3_u32 v4, v4, v31, v32
    v_max3_u32 v4, v4, v33, v34
    v_max_u32 v4, v4, v35
    v_cmp_eq_u32 vcc, -1, v4
    s_cbranch_vccz L_vb2_nan_go
    s_add_u32 s31, s31, 1
    s_cmp_lt_u32 s31, 200000
    s_cbranch_scc1 L_vb2_nan_l
    s_branch L_fail
L_vb2_nan_go:
    v_mov_b64 v[36:37], 0
    v_mov_b64 v[38:39], 0
    v_mov_b64 v[40:41], 0
    v_mov_b64 v[42:43], 0
    v_mov_b64 v[44:45], 0
    v_mov_b64 v[46:47], 0
    v_mov_b64 v[48:49], 0
    v_mov_b64 v[50:51], 0
    v_mov_b64 v[52:53], 0
    v_mov_b64 v[54:55], 0
    s_nop 1
    v_smfmac_f32_16x16x64_bf16 v[36:39], v[8:11], a[0:7], v3
    v_smfmac_f32_16x16x64_bf16 v[40:43], v[8:11], a[56:63], v3
    v_smfmac_f32_16x16x64_bf16 v[36:39], v[12:15], a[8:15], v3
    v_smfmac_f32_16x16x64_bf16 v[40:43], v[12:15], a[64:71], v3
    v_smfmac_f32_16x16x64_bf16 v[36:39], v[16:19], a[16:23], v3
    v_smfmac_f32_16x16x64_bf16 v[40:43], v[16:19], a[72:79], v3
    v_smfmac_f32_16x16x64_bf16 v[36:39], v[20:23], a[24:31], v3
    v_smfmac_f32_16x16x64_bf16 v[40:43], v[20:23], a[80:87], v3
    v_smfmac_f32_16x16x64_bf16 v[36:39], v[24:27], a[32:39], v3
    v_smfmac_f32_16x16x64_bf16 v[40:43], v[24:27], a[88:95], v3
    v_smfmac_f32_16x16x64_bf16 v[36:39], v[28:31], a[40:47], v3
    v_smfmac_f32_16x16x64_bf16 v[40:43], v[28:31], a[96:103], v3
    v_smfmac_f32_16x16x64_bf16 v[36:39], v[32:35], a[48:55], v3
    ds_read_b128 v[56:59], v1 offset:38912
    ds_read_b128 v[60:63], v1 offset:39936
    v_smfmac_f32_16x16x64_bf16 v[40:43], v[32:35], a[104:111], v3
    v_smfmac_f32_16x16x64_bf16 v[44:47], v[8:11], a[112:119], v3
    v_smfmac_f32_16x16x64_bf16 v[44:47], v[12:15], a[120:127], v3
    v_add_f32_e64 v36, v36, v38
    v_smfmac_f32_16x16x64_bf16 v[44:47], v[16:19], a[128:135], v3
    v_add_f32_e64 v37, v37, v39
    v_smfmac_f32_16x16x64_bf16 v[44:47], v[20:23], a[136:143], v3
    s_waitcnt lgkmcnt(0)
    s_mov_b32 s44, 0
    v_cvt_pk_bf16_f32 v4, v36, v37
    v_smfmac_f32_16x16x64_bf16 v[48:51], v[8:11], v[56:63], v3
    ds_read_b128 v[56:59], v1 offset:40960
    ds_read_b128 v[60:63], v1 offset:41984
    ds_write_b32 v7, v4 offset:2048
    v_mov_b64_e64 v[38:39], 0
    v_smfmac_f32_16x16x64_bf16 v[44:47], v[24:27], a[144:151], v3
    v_mov_b64_e64 v[36:37], 0
    v_smfmac_f32_16x16x64_bf16 v[44:47], v[28:31], a[152:159], v3
    v_add_f32_e64 v40, v40, v42
    v_smfmac_f32_16x16x64_bf16 v[44:47], v[32:35], a[160:167], v3
    v_add_f32_e64 v41, v41, v43
    v_smfmac_f32_16x16x64_bf16 v[52:55], v[8:11], a[168:175], v3
    v_cvt_pk_bf16_f32 v5, v40, v41
    v_smfmac_f32_16x16x64_bf16 v[52:55], v[12:15], a[176:183], v3
    ds_write_b32 v7, v5 offset:2052
    v_mov_b64_e64 v[42:43], 0
    v_smfmac_f32_16x16x64_bf16 v[52:55], v[16:19], a[184:191], v3
    s_waitcnt lgkmcnt(0)
    v_mov_b64 v[40:41], 0
    v_smfmac_f32_16x16x64_bf16 v[48:51], v[12:15], v[56:63], v3
    ds_read_b128 v[56:59], v1 offset:43008
    ds_read_b128 v[60:63], v1 offset:44032
    v_add_f32_e64 v44, v44, v46
    v_smfmac_f32_16x16x64_bf16 v[52:55], v[20:23], a[192:199], v3
    v_add_f32_e64 v45, v45, v47
    v_smfmac_f32_16x16x64_bf16 v[52:55], v[24:27], a[200:207], v3
    v_cvt_pk_bf16_f32 v4, v44, v45
    v_smfmac_f32_16x16x64_bf16 v[52:55], v[28:31], a[208:215], v3
    ds_write_b32 v7, v4 offset:2056
    v_mov_b64_e64 v[46:47], 0
    v_smfmac_f32_16x16x64_bf16 v[52:55], v[32:35], a[216:223], v3
    v_mov_b64_e64 v[44:45], 0
    v_smfmac_f32_16x16x64_bf16 v[36:39], v[8:11], a[224:231], v3
    v_smfmac_f32_16x16x64_bf16 v[36:39], v[12:15], a[232:239], v3
    s_waitcnt lgkmcnt(0)
    s_mov_b32 s44, 0
    v_smfmac_f32_16x16x64_bf16 v[48:51], v[16:19], v[56:63], v3
    ds_read_b128 v[56:59], v1 offset:45056
    ds_read_b128 v[60:63], v1 offset:46080
    v_add_f32_e64 v52, v52, v54
    v_smfmac_f32_16x16x64_bf16 v[36:39], v[16:19], a[240:247], v3
    v_add_f32_e64 v53, v53, v55
    v_smfmac_f32_16x16x64_bf16 v[36:39], v[20:23], a[248:255], v3
    v_cvt_pk_bf16_f32 v5, v52, v53
    v_smfmac_f32_16x16x64_bf16 v[36:39], v[24:27], v[64:71], v3
    ds_write_b32 v7, v5 offset:2060
    v_mov_b64_e64 v[54:55], 0
    v_smfmac_f32_16x16x64_bf16 v[36:39], v[28:31], v[72:79], v3
    v_mov_b64_e64 v[52:53], 0
    v_smfmac_f32_16x16x64_bf16 v[36:39], v[32:35], v[80:87], v3
    v_smfmac_f32_16x16x64_bf16 v[40:43], v[8:11], v[88:95], v3
    s_waitcnt lgkmcnt(0)
    s_mov_b32 s44, 0
    v_smfmac_f32_16x16x64_bf16 v[48:51], v[20:23], v[56:63], v3
    ds_read_b128 v[56:59], v1 offset:47104
    ds_read_b128 v[60:63], v1 offset:48128
    v_smfmac_f32_16x16x64_bf16 v[40:43], v[12:15], v[96:103], v3
    v_add_f32_e64 v36, v36, v38
    v_smfmac_f32_16x16x64_bf16 v[40:43], v[16:19], v[104:111], v3
    v_add_f32_e64 v37, v37, v39
    v_smfmac_f32_16x16x64_bf16 v[40:43], v[20:23], v[112:119], v3
    v_cvt_pk_bf16_f32 v4, v36, v37
    v_smfmac_f32_16x16x64_bf16 v[40:43], v[24:27], v[120:127], v3
    ds_write_b32 v7, v4 offset:3072
    v_mov_b64_e64 v[38:39], 0
    v_smfmac_f32_16x16x64_bf16 v[40:43], v[28:31], v[128:135], v3
    v_mov_b64_e64 v[36:37], 0
    v_smfmac_f32_16x16x64_bf16 v[40:43], v[32:35], v[136:143], v3
    s_waitcnt lgkmcnt(0)
    s_mov_b32 s44, 0
    v_smfmac_f32_16x16x64_bf16 v[48:51], v[24:27], v[56:63], v3
    ds_read_b128 v[56:59], v1 offset:49152
    ds_read_b128 v[60:63], v1 offset:50176
    v_smfmac_f32_16x16x64_bf16 v[44:47], v[8:11], v[144:151], v3
    v_smfmac_f32_16x16x64_bf16 v[44:47], v[12:15], v[152:159], v3
    v_add_f32_e64 v40, v40, v42
    v_smfmac_f32_16x16x64_bf16 v[44:47], v[16:19], v[160:167], v3
    v_add_f32_e64 v41, v41, v43
    v_smfmac_f32_16x16x64_bf16 v[44:47], v[20:23], v[168:175], v3
    v_cvt_pk_bf16_f32 v5, v40, v41
    v_smfmac_f32_16x16x64_bf16 v[44:47], v[24:27], v[176:183], v3
    ds_write_b32 v7, v5 offset:3076
    v_mov_b64_e64 v[42:43], 0
    v_smfmac_f32_16x16x64_bf16 v[44:47], v[28:31], v[184:191], v3
    s_waitcnt lgkmcnt(0)
    v_mov_b64 v[40:41], 0
    v_smfmac_f32_16x16x64_bf16 v[48:51], v[28:31], v[56:63], v3
    ds_read_b128 v[56:59], v1 offset:51200
    ds_read_b128 v[60:63], v1 offset:52224
    v_smfmac_f32_16x16x64_bf16 v[44:47], v[32:35], v[192:199], v3
    v_smfmac_f32_16x16x64_bf16 v[52:55], v[8:11], v[200:207], v3
    v_smfmac_f32_16x16x64_bf16 v[52:55], v[12:15], v[208:215], v3
    v_smfmac_f32_16x16x64_bf16 v[52:55], v[16:19], v[216:223], v3
    v_add_f32_e64 v44, v44, v46
    v_smfmac_f32_16x16x64_bf16 v[52:55], v[20:23], v[224:231], v3
    v_add_f32_e64 v45, v45, v47
    v_smfmac_f32_16x16x64_bf16 v[52:55], v[24:27], v[232:239], v3
    s_waitcnt lgkmcnt(0)
    s_mov_b32 s44, 0
    v_cvt_pk_bf16_f32 v4, v44, v45
    v_smfmac_f32_16x16x64_bf16 v[48:51], v[32:35], v[56:63], v3
    ds_write_b32 v7, v4 offset:3080
    v_mov_b64_e64 v[46:47], 0
    v_smfmac_f32_16x16x64_bf16 v[52:55], v[28:31], v[240:247], v3
    v_mov_b64_e64 v[44:45], 0
    v_smfmac_f32_16x16x64_bf16 v[52:55], v[32:35], v[248:255], v3
    s_branch L_vb2_y
L_vb3_step:
    s_sleep 9
    v_mov_b32 v5, -1
    s_mov_b32 s31, 200000
L_vb3_probe:
    buffer_load_dword v5, v6, s[8:11], s25 offen offset:3072 sc1
    s_waitcnt vmcnt(2)
    v_cmp_eq_u32 vcc, -1, v5
    s_sub_u32 s31, s31, 1
    s_cbranch_scc1 L_fail
    s_cbranch_vccnz L_vb3_probe
    s_add_u32 s32, s30, 1
    v_mov_b32 v4, s32
    s_barrier
    buffer_load_dwordx4 v[24:27], v2, s[8:11], s25 offen offset:0 sc1
    buffer_load_dwordx4 v[28:31], v2, s[8:11], s25 offen offset:1024 sc1
    buffer_load_dwordx4 v[32:35], v2, s[8:11], s25 offen offset:2048 sc1
    buffer_load_dwordx4 v[8:11], v2, s[8:11], s24 offen offset:0 sc1
    buffer_load_dwordx4 v[12:15], v2, s[8:11], s24 offen offset:1024 sc1
    buffer_load_dwordx4 v[16:19], v2, s[8:11], s24 offen offset:2048 sc1
    buffer_load_dwordx4 v[20:23], v2, s[8:11], s24 offen offset:3072 sc1
    s_waitcnt vmcnt(6)
    .p2align 3
    v_smfmac_f32_16x16x64_bf16 v[36:39], v[24:27], a[32:39], v3
    ds_write_b128 v2, v[24:27] offset:4096
    v_smfmac_f32_16x16x64_bf16 v[40:43], v[24:27], a[88:95], v3
    s_waitcnt vmcnt(5)
    s_mov_b32 s44, 0
    v_smfmac_f32_16x16x64_bf16 v[36:39], v[28:31], a[40:47], v3
    ds_write_b128 v2, v[28:31] offset:5120
    v_smfmac_f32_16x16x64_bf16 v[40:43], v[28:31], a[96:103], v3
    s_waitcnt vmcnt(4)
    s_mov_b32 s44, 0
    v_smfmac_f32_16x16x64_bf16 v[36:39], v[32:35], a[48:55], v3
    ds_write_b128 v2, v[32:35] offset:6144
    v_smfmac_f32_16x16x64_bf16 v[40:43], v[32:35], a[104:111], v3
    s_waitcnt vmcnt(3)
    ds_write_b32 v0, v4 offset:16388
    s_mov_b32 s44, 0
    v_smfmac_f32_16x16x64_bf16 v[36:39], v[8:11], a[0:7], v3
    v_smfmac_f32_16x16x64_bf16 v[40:43], v[8:11], a[56:63], v3
    s_waitcnt vmcnt(2)
    s_mov_b32 s44, 0
    v_smfmac_f32_16x16x64_bf16 v[36:39], v[12:15], a[8:15], v3
    v_smfmac_f32_16x16x64_bf16 v[40:43], v[12:15], a[64:71], v3
    s_waitcnt vmcnt(1)
    s_mov_b32 s44, 0
    v_smfmac_f32_16x16x64_bf16 v[36:39], v[16:19], a[16:23], v3
    v_smfmac_f32_16x16x64_bf16 v[40:43], v[16:19], a[72:79], v3
    s_waitcnt vmcnt(0)
    s_mov_b32 s44, 0
    v_smfmac_f32_16x16x64_bf16 v[36:39], v[20:23], a[24:31], v3
    ds_read_b128 v[56:59], v1 offset:38912
    ds_read_b128 v[60:63], v1 offset:39936
    v_smfmac_f32_16x16x64_bf16 v[40:43], v[20:23], a[80:87], v3
    v_smfmac_f32_16x16x64_bf16 v[44:47], v[8:11], a[112:119], v3
    v_smfmac_f32_16x16x64_bf16 v[44:47], v[12:15], a[120:127], v3
    v_add_f32_e64 v36, v36, v38
    v_smfmac_f32_16x16x64_bf16 v[44:47], v[16:19], a[128:135], v3
    v_add_f32_e64 v37, v37, v39
    v_smfmac_f32_16x16x64_bf16 v[44:47], v[20:23], a[136:143], v3
    s_waitcnt lgkmcnt(0)
    v_cmp_u_f32 vcc, v36, v37
    v_smfmac_f32_16x16x64_bf16 v[48:51], v[8:11], v[56:63], v3
    ds_read_b128 v[56:59], v1 offset:40960
    ds_read_b128 v[60:63], v1 offset:41984
    v_cvt_pk_bf16_f32 v4, v36, v37
    v_smfmac_f32_16x16x64_bf16 v[44:47], v[24:27], a[144:151], v3
    ds_write_b32 v7, v4 offset:2048
    v_mov_b64_e64 v[38:39], 0
    v_smfmac_f32_16x16x64_bf16 v[44:47], v[28:31], a[152:159], v3
    s_cbranch_vccnz L_vb3_nan
    v_mov_b64 v[36:37], 0
    v_smfmac_f32_16x16x64_bf16 v[44:47], v[32:35], a[160:167], v3
    v_add_f32_e64 v40, v40, v42
    v_smfmac_f32_16x16x64_bf16 v[52:55], v[8:11], a[168:175], v3
    v_add_f32_e64 v41, v41, v43
    v_smfmac_f32_16x16x64_bf16 v[52:55], v[12:15], a[176:183], v3
    v_cvt_pk_bf16_f32 v5, v40, v41
    v_smfmac_f32_16x16x64_bf16 v[52:55], v[16:19], a[184:191], v3
    s_waitcnt lgkmcnt(0)
    ds_write_b32 v7, v5 offset:2052
    v_mov_b64 v[42:43], 0
    v_smfmac_f32_16x16x64_bf16 v[48:51], v[12:15], v[56:63], v3
    ds_read_b128 v[56:59], v1 offset:43008
    ds_read_b128 v[60:63], v1 offset:44032
    v_mov_b64_e64 v[40:41], 0
    v_smfmac_f32_16x16x64_bf16 v[52:55], v[20:23], a[192:199], v3
    v_add_f32_e64 v44, v44, v46
    v_smfmac_f32_16x16x64_bf16 v[52:55], v[24:27], a[200:207], v3
    v_add_f32_e64 v45, v45, v47
    v_smfmac_f32_16x16x64_bf16 v[52:55], v[28:31], a[208:215], v3
    v_cvt_pk_bf16_f32 v4, v44, v45
    v_smfmac_f32_16x16x64_bf16 v[52:55], v[32:35], a[216:223], v3
    ds_write_b32 v7, v4 offset:2056
    v_mov_b64_e64 v[46:47], 0
    v_smfmac_f32_16x16x64_bf16 v[36:39], v[8:11], a[224:231], v3
    v_mov_b64_e64 v[44:45], 0
    v_smfmac_f32_16x16x64_bf16 v[36:39], v[12:15], a[232:239], v3
    s_waitcnt lgkmcnt(0)
    s_mov_b32 s44, 0
    v_smfmac_f32_16x16x64_bf16 v[48:51], v[16:19], v[56:63], v3
    ds_read_b128 v[56:59], v1 offset:45056
    ds_read_b128 v[60:63], v1 offset:46080
    v_add_f32_e64 v52, v52, v54
    v_smfmac_f32_16x16x64_bf16 v[36:39], v[16:19], a[240:247], v3
    v_add_f32_e64 v53, v53, v55
    v_smfmac_f32_16x16x64_bf16 v[36:39], v[20:23], a[248:255], v3
    v_cvt_pk_bf16_f32 v5, v52, v53
    v_smfmac_f32_16x16x64_bf16 v[36:39], v[24:27], v[64:71], v3
    ds_write_b32 v7, v5 offset:2060
    v_mov_b64_e64 v[54:55], 0
    v_smfmac_f32_16x16x64_bf16 v[36:39], v[28:31], v[72:79], v3
    v_mov_b64_e64 v[52:53], 0
    v_smfmac_f32_16x16x64_bf16 v[36:39], v[32:35], v[80:87], v3
    v_smfmac_f32_16x16x64_bf16 v[40:43], v[8:11], v[88:95], v3
    s_waitcnt lgkmcnt(0)
    s_mov_b32 s44, 0
    v_smfmac_f32_16x16x64_bf16 v[48:51], v[20:23], v[56:63], v3
    ds_read_b128 v[56:59], v1 offset:47104
    ds_read_b128 v[60:63], v1 offset:48128
    v_smfmac_f32_16x16x64_bf16 v[40:43], v[12:15], v[96:103], v3
    v_add_f32_e64 v36, v36, v38
    v_smfmac_f32_16x16x64_bf16 v[40:43], v[16:19], v[104:111], v3
    v_add_f32_e64 v37, v37, v39
    v_smfmac_f32_16x16x64_bf16 v[40:43], v[20:23], v[112:119], v3
    v_cvt_pk_bf16_f32 v4, v36, v37
    v_smfmac_f32_16x16x64_bf16 v[40:43], v[24:27], v[120:127], v3
    ds_write_b32 v7, v4 offset:3072
    v_mov_b64_e64 v[38:39], 0
    v_smfmac_f32_16x16x64_bf16 v[40:43], v[28:31], v[128:135], v3
    v_mov_b64_e64 v[36:37], 0
    v_smfmac_f32_16x16x64_bf16 v[40:43], v[32:35], v[136:143], v3
    s_waitcnt lgkmcnt(0)
    s_mov_b32 s44, 0
    v_smfmac_f32_16x16x64_bf16 v[48:51], v[24:27], v[56:63], v3
    ds_read_b128 v[56:59], v1 offset:49152
    ds_read_b128 v[60:63], v1 offset:50176
    v_smfmac_f32_16x16x64_bf16 v[44:47], v[8:11], v[144:151], v3
    v_smfmac_f32_16x16x64_bf16 v[44:47], v[12:15], v[152:159], v3
    v_add_f32_e64 v40, v40, v42
    v_smfmac_f32_16x16x64_bf16 v[44:47], v[16:19], v[160:167], v3
    v_add_f32_e64 v41, v41, v43
    v_smfmac_f32_16x16x64_bf16 v[44:47], v[20:23], v[168:175], v3
    v_cvt_pk_bf16_f32 v5, v40, v41
    v_smfmac_f32_16x16x64_bf16 v[44:47], v[24:27], v[176:183], v3
    ds_write_b32 v7, v5 offset:3076
    v_mov_b64_e64 v[42:43], 0
    v_smfmac_f32_16x16x64_bf16 v[44:47], v[28:31], v[184:191], v3
    s_waitcnt lgkmcnt(0)
    v_mov_b64 v[40:41], 0
    v_smfmac_f32_16x16x64_bf16 v[48:51], v[28:31], v[56:63], v3
    ds_read_b128 v[56:59], v1 offset:51200
    ds_read_b128 v[60:63], v1 offset:52224
    v_smfmac_f32_16x16x64_bf16 v[44:47], v[32:35], v[192:199], v3
    v_smfmac_f32_16x16x64_bf16 v[52:55], v[8:11], v[200:207], v3
    v_smfmac_f32_16x16x64_bf16 v[52:55], v[12:15], v[208:215], v3
    v_smfmac_f32_16x16x64_bf16 v[52:55], v[16:19], v[216:223], v3
    v_add_f32_e64 v44, v44, v46
    v_smfmac_f32_16x16x64_bf16 v[52:55], v[20:23], v[224:231], v3
    v_add_f32_e64 v45, v45, v47
    v_smfmac_f32_16x16x64_bf16 v[52:55], v[24:27], v[232:239], v3
    s_waitcnt lgkmcnt(0)
    s_mov_b32 s44, 0
    v_cvt_pk_bf16_f32 v4, v44, v45
    v_smfmac_f32_16x16x64_bf16 v[48:51], v[32:35], v[56:63], v3
    ds_write_b32 v7, v4 offset:3080
    v_mov_b64_e64 v[46:47], 0
    v_smfmac_f32_16x16x64_bf16 v[52:55], v[28:31], v[240:247], v3
    v_mov_b64_e64 v[44:45], 0
    v_smfmac_f32_16x16x64_bf16 v[52:55], v[32:35], v[248:255], v3
L_vb3_y:
    s_nop 7
    v_add_f32 v48, v48, v50
    v_add_f32 v49, v49, v51
    v_cvt_pk_bf16_f32 v5, v48, v49
    ds_write_b32 v7, v5 offset:1036
    v_mov_b64 v[50:51], 0
    v_mov_b64 v[48:49], 0
    v_add_f32 v52, v52, v54
    v_add_f32 v53, v53, v55
    v_cvt_pk_bf16_f32 v5, v52, v53
    ds_write_b32 v7, v5 offset:3084
    v_mov_b64 v[54:55], 0
    v_mov_b64 v[52:53], 0
    s_waitcnt lgkmcnt(0)
    s_barrier
    s_add_u32 s24, s24, 8192
    s_add_u32 s25, s25, 8192
    s_add_u32 s30, s30, 1
    s_cmp_le_u32 s30, 63
    s_cbranch_scc1 L_vb3_step
    s_branch L_done
L_vb3_nan:
    s_mov_b32 s31, 0
    s_waitcnt lgkmcnt(0)
L_vb3_nan_l:
    buffer_load_dwordx4 v[8:11], v2, s[8:11], s24 offen offset:0 sc1
    buffer_load_dwordx4 v[12:15], v2, s[8:11], s24 offen offset:1024 sc1
    buffer_load_dwordx4 v[16:19], v2, s[8:11], s24 offen offset:2048 sc1
    buffer_load_dwordx4 v[20:23], v2, s[8:11], s24 offen offset:3072 sc1
    buffer_load_dwordx4 v[24:27], v2, s[8:11], s25 offen offset:0 sc1
    buffer_load_dwordx4 v[28:31], v2, s[8:11], s25 offen offset:1024 sc1
    buffer_load_dwordx4 v[32:35], v2, s[8:11], s25 offen offset:2048 sc1
    s_waitcnt vmcnt(0)
    v_max3_u32 v4, v8, v9, v10
    v_max3_u32 v4, v4, v11, v12
    v_max3_u32 v4, v4, v13, v14
    v_max3_u32 v4, v4, v15, v16
    v_max3_u32 v4, v4, v17, v18
    v_max3_u32 v4, v4, v19, v20
    v_max3_u32 v4, v4, v21, v22
    v_max3_u32 v4, v4, v23, v24
    v_max3_u32 v4, v4, v25, v26
    v_max3_u32 v4, v4, v27, v28
    v_max3_u32 v4, v4, v29, v30
    v_max3_u32 v4, v4, v31, v32
    v_max3_u32 v4, v4, v33, v34
    v_max_u32 v4, v4, v35
    v_cmp_eq_u32 vcc, -1, v4
    s_cbranch_vccz L_vb3_nan_go
    s_add_u32 s31, s31, 1
    s_cmp_lt_u32 s31, 200000
    s_cbranch_scc1 L_vb3_nan_l
    s_branch L_fail
L_vb3_nan_go:
    v_mov_b64 v[36:37], 0
    v_mov_b64 v[38:39], 0
    v_mov_b64 v[40:41], 0
    v_mov_b64 v[42:43], 0
    v_mov_b64 v[44:45], 0
    v_mov_b64 v[46:47], 0
    v_mov_b64 v[48:49], 0
    v_mov_b64 v[50:51], 0
    v_mov_b64 v[52:53], 0
    v_mov_b64 v[54:55], 0
    s_nop 1
    v_smfmac_f32_16x16x64_bf16 v[36:39], v[24:27], a[32:39], v3
    v_smfmac_f32_16x16x64_bf16 v[40:43], v[24:27], a[88:95], v3
    v_smfmac_f32_16x16x64_bf16 v[36:39], v[28:31], a[40:47], v3
    v_smfmac_f32_16x16x64_bf16 v[40:43], v[28:31], a[96:103], v3
    v_smfmac_f32_16x16x64_bf16 v[36:39], v[32:35], a[48:55], v3
    v_smfmac_f32_16x16x64_bf16 v[40:43], v[32:35], a[104:111], v3
    v_smfmac_f32_16x16x64_bf16 v[36:39], v[8:11], a[0:7], v3
    v_smfmac_f32_16x16x64_bf16 v[40:43], v[8:11], a[56:63], v3
    v_smfmac_f32_16x16x64_bf16 v[36:39], v[12:15], a[8:15], v3
    v_smfmac_f32_16x16x64_bf16 v[40:43], v[12:15], a[64:71], v3
    v_smfmac_f32_16x16x64_bf16 v[36:39], v[16:19], a[16:23], v3
    v_smfmac_f32_16x16x64_bf16 v[40:43], v[16:19], a[72:79], v3
    v_smfmac_f32_16x16x64_bf16 v[36:39], v[20:23], a[24:31], v3
    ds_read_b128 v[56:59], v1 offset:38912
    ds_read_b128 v[60:63], v1 offset:39936
    v_smfmac_f32_16x16x64_bf16 v[40:43], v[20:23], a[80:87], v3
    v_smfmac_f32_16x16x64_bf16 v[44:47], v[8:11], a[112:119], v3
    v_smfmac_f32_16x16x64_bf16 v[44:47], v[12:15], a[120:127], v3
    v_add_f32_e64 v36, v36, v38
    v_smfmac_f32_16x16x64_bf16 v[44:47], v[16:19], a[128:135], v3
    v_add_f32_e64 v37, v37, v39
    v_smfmac_f32_16x16x64_bf16 v[44:47], v[20:23], a[136:143], v3
    s_waitcnt lgkmcnt(0)
    s_mov_b32 s44, 0
    v_cvt_pk_bf16_f32 v4, v36, v37
    v_smfmac_f32_16x16x64_bf16 v[48:51], v[8:11], v[56:63], v3
    ds_read_b128 v[56:59], v1 offset:40960
    ds_read_b128 v[60:63], v1 offset:41984
    ds_write_b32 v7, v4 offset:2048
    v_mov_b64_e64 v[38:39], 0
    v_smfmac_f32_16x16x64_bf16 v[44:47], v[24:27], a[144:151], v3
    v_mov_b64_e64 v[36:37], 0
    v_smfmac_f32_16x16x64_bf16 v[44:47], v[28:31], a[152:159], v3
    v_add_f32_e64 v40, v40, v42
    v_smfmac_f32_16x16x64_bf16 v[44:47], v[32:35], a[160:167], v3
    v_add_f32_e64 v41, v41, v43
    v_smfmac_f32_16x16x64_bf16 v[52:55], v[8:11], a[168:175], v3
    v_cvt_pk_bf16_f32 v5, v40, v41
    v_smfmac_f32_16x16x64_bf16 v[52:55], v[12:15], a[176:183], v3
    ds_write_b32 v7, v5 offset:2052
    v_mov_b64_e64 v[42:43], 0
    v_smfmac_f32_16x16x64_bf16 v[52:55], v[16:19], a[184:191], v3
    s_waitcnt lgkmcnt(0)
    v_mov_b64 v[40:41], 0
    v_smfmac_f32_16x16x64_bf16 v[48:51], v[12:15], v[56:63], v3
    ds_read_b128 v[56:59], v1 offset:43008
    ds_read_b128 v[60:63], v1 offset:44032
    v_add_f32_e64 v44, v44, v46
    v_smfmac_f32_16x16x64_bf16 v[52:55], v[20:23], a[192:199], v3
    v_add_f32_e64 v45, v45, v47
    v_smfmac_f32_16x16x64_bf16 v[52:55], v[24:27], a[200:207], v3
    v_cvt_pk_bf16_f32 v4, v44, v45
    v_smfmac_f32_16x16x64_bf16 v[52:55], v[28:31], a[208:215], v3
    ds_write_b32 v7, v4 offset:2056
    v_mov_b64_e64 v[46:47], 0
    v_smfmac_f32_16x16x64_bf16 v[52:55], v[32:35], a[216:223], v3
    v_mov_b64_e64 v[44:45], 0
    v_smfmac_f32_16x16x64_bf16 v[36:39], v[8:11], a[224:231], v3
    v_smfmac_f32_16x16x64_bf16 v[36:39], v[12:15], a[232:239], v3
    s_waitcnt lgkmcnt(0)
    s_mov_b32 s44, 0
    v_smfmac_f32_16x16x64_bf16 v[48:51], v[16:19], v[56:63], v3
    ds_read_b128 v[56:59], v1 offset:45056
    ds_read_b128 v[60:63], v1 offset:46080
    v_add_f32_e64 v52, v52, v54
    v_smfmac_f32_16x16x64_bf16 v[36:39], v[16:19], a[240:247], v3
    v_add_f32_e64 v53, v53, v55
    v_smfmac_f32_16x16x64_bf16 v[36:39], v[20:23], a[248:255], v3
    v_cvt_pk_bf16_f32 v5, v52, v53
    v_smfmac_f32_16x16x64_bf16 v[36:39], v[24:27], v[64:71], v3
    ds_write_b32 v7, v5 offset:2060
    v_mov_b64_e64 v[54:55], 0
    v_smfmac_f32_16x16x64_bf16 v[36:39], v[28:31], v[72:79], v3
    v_mov_b64_e64 v[52:53], 0
    v_smfmac_f32_16x16x64_bf16 v[36:39], v[32:35], v[80:87], v3
    v_smfmac_f32_16x16x64_bf16 v[40:43], v[8:11], v[88:95], v3
    s_waitcnt lgkmcnt(0)
    s_mov_b32 s44, 0
    v_smfmac_f32_16x16x64_bf16 v[48:51], v[20:23], v[56:63], v3
    ds_read_b128 v[56:59], v1 offset:47104
    ds_read_b128 v[60:63], v1 offset:48128
    v_smfmac_f32_16x16x64_bf16 v[40:43], v[12:15], v[96:103], v3
    v_add_f32_e64 v36, v36, v38
    v_smfmac_f32_16x16x64_bf16 v[40:43], v[16:19], v[104:111], v3
    v_add_f32_e64 v37, v37, v39
    v_smfmac_f32_16x16x64_bf16 v[40:43], v[20:23], v[112:119], v3
    v_cvt_pk_bf16_f32 v4, v36, v37
    v_smfmac_f32_16x16x64_bf16 v[40:43], v[24:27], v[120:127], v3
    ds_write_b32 v7, v4 offset:3072
    v_mov_b64_e64 v[38:39], 0
    v_smfmac_f32_16x16x64_bf16 v[40:43], v[28:31], v[128:135], v3
    v_mov_b64_e64 v[36:37], 0
    v_smfmac_f32_16x16x64_bf16 v[40:43], v[32:35], v[136:143], v3
    s_waitcnt lgkmcnt(0)
    s_mov_b32 s44, 0
    v_smfmac_f32_16x16x64_bf16 v[48:51], v[24:27], v[56:63], v3
    ds_read_b128 v[56:59], v1 offset:49152
    ds_read_b128 v[60:63], v1 offset:50176
    v_smfmac_f32_16x16x64_bf16 v[44:47], v[8:11], v[144:151], v3
    v_smfmac_f32_16x16x64_bf16 v[44:47], v[12:15], v[152:159], v3
    v_add_f32_e64 v40, v40, v42
    v_smfmac_f32_16x16x64_bf16 v[44:47], v[16:19], v[160:167], v3
    v_add_f32_e64 v41, v41, v43
    v_smfmac_f32_16x16x64_bf16 v[44:47], v[20:23], v[168:175], v3
    v_cvt_pk_bf16_f32 v5, v40, v41
    v_smfmac_f32_16x16x64_bf16 v[44:47], v[24:27], v[176:183], v3
    ds_write_b32 v7, v5 offset:3076
    v_mov_b64_e64 v[42:43], 0
    v_smfmac_f32_16x16x64_bf16 v[44:47], v[28:31], v[184:191], v3
    s_waitcnt lgkmcnt(0)
    v_mov_b64 v[40:41], 0
    v_smfmac_f32_16x16x64_bf16 v[48:51], v[28:31], v[56:63], v3
    ds_read_b128 v[56:59], v1 offset:51200
    ds_read_b128 v[60:63], v1 offset:52224
    v_smfmac_f32_16x16x64_bf16 v[44:47], v[32:35], v[192:199], v3
    v_smfmac_f32_16x16x64_bf16 v[52:55], v[8:11], v[200:207], v3
    v_smfmac_f32_16x16x64_bf16 v[52:55], v[12:15], v[208:215], v3
    v_smfmac_f32_16x16x64_bf16 v[52:55], v[16:19], v[216:223], v3
    v_add_f32_e64 v44, v44, v46
    v_smfmac_f32_16x16x64_bf16 v[52:55], v[20:23], v[224:231], v3
    v_add_f32_e64 v45, v45, v47
    v_smfmac_f32_16x16x64_bf16 v[52:55], v[24:27], v[232:239], v3
    s_waitcnt lgkmcnt(0)
    s_mov_b32 s44, 0
    v_cvt_pk_bf16_f32 v4, v44, v45
    v_smfmac_f32_16x16x64_bf16 v[48:51], v[32:35], v[56:63], v3
    ds_write_b32 v7, v4 offset:3080
    v_mov_b64_e64 v[46:47], 0
    v_smfmac_f32_16x16x64_bf16 v[52:55], v[28:31], v[240:247], v3
    v_mov_b64_e64 v[44:45], 0
    v_smfmac_f32_16x16x64_bf16 v[52:55], v[32:35], v[248:255], v3
    s_branch L_vb3_y
L_pref:
    s_sub_u32 s21, s21, 30
    s_mov_b32 s46, 0
    v_min_u32 v60, 63, v1
    v_mul_u32_u24 v60, 128, v60
    s_lshl_b32 s3, s46, 7
    s_add_u32 s3, s3, 46833664
    s_mov_b32 s47, 200000
L_pf_na0:
    buffer_load_dwordx2 v[62:63], v60, s[8:11], s3 offen sc1
    s_waitcnt vmcnt(0)
    v_xor_b32 v62, s96, v62
    v_xor_b32 v63, s97, v63
    v_or_b32 v62, v62, v63
    v_cmp_ne_u32 vcc, 0, v62
    s_cbranch_vccz L_pf_na0_ok
    s_sub_u32 s47, s47, 1
    s_cbranch_scc0 L_pf_na0
    s_branch L_fail
L_pf_na0_ok:
    s_mov_b32 s46, 64
    v_min_u32 v60, 63, v1
    v_mul_u32_u24 v60, 128, v60
    s_lshl_b32 s3, s46, 7
    s_add_u32 s3, s3, 46833664
    s_mov_b32 s47, 200000
L_pf_na1:
    buffer_load_dwordx2 v[62:63], v60, s[8:11], s3 offen sc1
    s_waitcnt vmcnt(0)
    v_xor_b32 v62, s96, v62
    v_xor_b32 v63, s97, v63
    v_or_b32 v62, v62, v63
    v_cmp_ne_u32 vcc, 0, v62
    s_cbranch_vccz L_pf_na1_ok
    s_sub_u32 s47, s47, 1
    s_cbranch_scc0 L_pf_na1
    s_branch L_fail
L_pf_na1_ok:
    s_mov_b32 s46, 128
    v_min_u32 v60, 63, v1
    v_mul_u32_u24 v60, 128, v60
    s_lshl_b32 s3, s46, 7
    s_add_u32 s3, s3, 46833664
    s_mov_b32 s47, 200000
L_pf_na2:
    buffer_load_dwordx2 v[62:63], v60, s[8:11], s3 offen sc1
    s_waitcnt vmcnt(0)
    v_xor_b32 v62, s96, v62
    v_xor_b32 v63, s97, v63
    v_or_b32 v62, v62, v63
    v_cmp_ne_u32 vcc, 0, v62
    s_cbranch_vccz L_pf_na2_ok
    s_sub_u32 s47, s47, 1
    s_cbranch_scc0 L_pf_na2
    s_branch L_fail
L_pf_na2_ok:
    s_mov_b32 s46, 192
    v_min_u32 v60, 63, v1
    v_mul_u32_u24 v60, 128, v60
    s_lshl_b32 s3, s46, 7
    s_add_u32 s3, s3, 46833664
    s_mov_b32 s47, 200000
L_pf_na3:
    buffer_load_dwordx2 v[62:63], v60, s[8:11], s3 offen sc1
    s_waitcnt vmcnt(0)
    v_xor_b32 v62, s96, v62
    v_xor_b32 v63, s97, v63
    v_or_b32 v62, v62, v63
    v_cmp_ne_u32 vcc, 0, v62
    s_cbranch_vccz L_pf_na3_ok
    s_sub_u32 s47, s47, 1
    s_cbranch_scc0 L_pf_na3
    s_branch L_fail
L_pf_na3_ok:
    s_mov_b32 s46, 256
    v_min_u32 v60, 63, v1
    v_mul_u32_u24 v60, 128, v60
    s_lshl_b32 s3, s46, 7
    s_add_u32 s3, s3, 46833664
    s_mov_b32 s47, 200000
L_pf_na4:
    buffer_load_dwordx2 v[62:63], v60, s[8:11], s3 offen sc1
    s_waitcnt vmcnt(0)
    v_xor_b32 v62, s96, v62
    v_xor_b32 v63, s97, v63
    v_or_b32 v62, v62, v63
    v_cmp_ne_u32 vcc, 0, v62
    s_cbranch_vccz L_pf_na4_ok
    s_sub_u32 s47, s47, 1
    s_cbranch_scc0 L_pf_na4
    s_branch L_fail
L_pf_na4_ok:
    v_lshlrev_b32 v2, 7, v1
    v_min_u32 v3, 27, v1
    v_lshlrev_b32 v3, 2, v3
    s_lshl_b32 s32, s21, 2
    s_add_u32 s32, s32, s20
    s_cmp_eq_u32 s32, 7
    s_cbranch_scc1 L_gate
    s_cmp_ge_u32 s32, 5
    s_cbranch_scc1 L_relay
    s_cmp_lg_u32 s32, 0
    s_cbranch_scc1 L_pf_s0
    s_mov_b32 s60, 44302336
    s_mov_b32 s80, 8192
    s_mov_b32 s61, 44826624
    s_mov_b32 s81, 11264
    s_mov_b32 s62, 44829696
    s_mov_b32 s82, 11264
    s_mov_b32 s63, 12845056
    s_mov_b32 s83, 32768
    s_mov_b32 s64, 12853248
    s_mov_b32 s84, 32768
    s_mov_b32 s65, 12861440
    s_mov_b32 s85, 32768
    s_mov_b32 s66, 12869632
    s_mov_b32 s86, 32768
L_pf_s0:
    s_cmp_lg_u32 s32, 1
    s_cbranch_scc1 L_pf_s1
    s_mov_b32 s60, 268435456
    s_mov_b32 s80, 0
    s_mov_b32 s61, 268435456
    s_mov_b32 s81, 0
    s_mov_b32 s62, 268435456
    s_mov_b32 s82, 0
    s_mov_b32 s63, 268435456
    s_mov_b32 s83, 0
    s_mov_b32 s64, 268435456
    s_mov_b32 s84, 0
    s_mov_b32 s65, 268435456
    s_mov_b32 s85, 0
    s_mov_b32 s66, 268435456
    s_mov_b32 s86, 0
L_pf_s1:
    s_cmp_lg_u32 s32, 2
    s_cbranch_scc1 L_pf_s2
    s_mov_b32 s60, 268435456
    s_mov_b32 s80, 0
    s_mov_b32 s61, 268435456
    s_mov_b32 s81, 0
    s_mov_b32 s62, 268435456
    s_mov_b32 s82, 0
    s_mov_b32 s63, 268435456
    s_mov_b32 s83, 0
    s_mov_b32 s64, 268435456
    s_mov_b32 s84, 0
    s_mov_b32 s65, 268435456
    s_mov_b32 s85, 0
    s_mov_b32 s66, 268435456
    s_mov_b32 s86, 0
L_pf_s2:
    s_cmp_lg_u32 s32, 3
    s_cbranch_scc1 L_pf_s3
    s_mov_b32 s60, 268435456
    s_mov_b32 s80, 0
    s_mov_b32 s61, 268435456
    s_mov_b32 s81, 0
    s_mov_b32 s62, 268435456
    s_mov_b32 s82, 0
    s_mov_b32 s63, 268435456
    s_mov_b32 s83, 0
    s_mov_b32 s64, 268435456
    s_mov_b32 s84, 0
    s_mov_b32 s65, 268435456
    s_mov_b32 s85, 0
    s_mov_b32 s66, 268435456
    s_mov_b32 s86, 0
L_pf_s3:
    s_cmp_lg_u32 s32, 4
    s_cbranch_scc1 L_pf_s4
    s_mov_b32 s60, 268435456
    s_mov_b32 s80, 0
    s_mov_b32 s61, 268435456
    s_mov_b32 s81, 0
    s_mov_b32 s62, 268435456
    s_mov_b32 s82, 0
    s_mov_b32 s63, 268435456
    s_mov_b32 s83, 0
    s_mov_b32 s64, 268435456
    s_mov_b32 s84, 0
    s_mov_b32 s65, 268435456
    s_mov_b32 s85, 0
    s_mov_b32 s66, 268435456
    s_mov_b32 s86, 0
L_pf_s4:
    s_mov_b32 s30, 0
    s_mov_b32 s24, 44309504
L_pf_step:
    s_mov_b32 s31, 200000
L_pf_wait:
    buffer_load_dword v4, v3, s[8:11], s24 offen sc1
    s_waitcnt vmcnt(0)
    v_cmp_eq_u32 vcc, -1, v4
    s_cbranch_vccz L_pf_go
    s_sleep 1
    s_sub_u32 s31, s31, 1
    s_cbranch_scc0 L_pf_wait
    s_branch L_fail
L_pf_go:
    buffer_load_dword v8, v2, s[8:11], s60 offen
    s_add_u32 s60, s60, s80
    buffer_load_dword v9, v2, s[8:11], s61 offen
    s_add_u32 s61, s61, s81
    buffer_load_dword v10, v2, s[8:11], s62 offen
    s_add_u32 s62, s62, s82
    buffer_load_dword v11, v2, s[8:11], s63 offen
    s_add_u32 s63, s63, s83
    buffer_load_dword v12, v2, s[8:11], s64 offen
    s_add_u32 s64, s64, s84
    buffer_load_dword v13, v2, s[8:11], s65 offen
    s_add_u32 s65, s65, s85
    buffer_load_dword v14, v2, s[8:11], s66 offen
    s_add_u32 s66, s66, s86
    s_cmp_ge_u32 s30, 2
    s_cselect_b32 s33, 8192, 0
    s_add_u32 s24, s24, s33
    s_add_u32 s30, s30, 1
    s_cmp_lt_u32 s30, 64
    s_cbranch_scc1 L_pf_step
    s_branch L_done
L_relay:
    v_mov_b64 v[40:41], 0
    v_mov_b64 v[42:43], 0
    v_lshlrev_b32 v2, 4, v1
    s_sub_u32 s30, s32, 5
    s_lshl_b32 s24, s30, 13
    s_add_u32 s35, s24, 45547520
    s_add_u32 s24, s24, 44302336
L_relay_step:
    s_mov_b32 s31, 200000
    s_add_u32 s25, s24, 4096
    s_add_u32 s33, s35, 4096
L_relay_hint:
    buffer_load_dword v4, v3, s[8:11], s25 offen offset:3072 sc1
    s_waitcnt vmcnt(0)
    v_cmp_eq_u32 vcc, -1, v4
    s_cbranch_vccz L_relay_wait
    s_sleep 1
    s_sub_u32 s31, s31, 1
    s_cbranch_scc0 L_relay_hint
    s_branch L_fail
L_relay_wait:
    buffer_load_dwordx4 v[8:11], v2, s[8:11], s24 offen offset:0 sc1
    buffer_load_dwordx4 v[12:15], v2, s[8:11], s24 offen offset:1024 sc1
    buffer_load_dwordx4 v[16:19], v2, s[8:11], s24 offen offset:2048 sc1
    buffer_load_dwordx4 v[20:23], v2, s[8:11], s24 offen offset:3072 sc1
    buffer_load_dwordx4 v[24:27], v2, s[8:11], s25 offen offset:0 sc1
    buffer_load_dwordx4 v[28:31], v2, s[8:11], s25 offen offset:1024 sc1
    buffer_load_dwordx4 v[32:35], v2, s[8:11], s25 offen offset:2048 sc1
    s_waitcnt vmcnt(0)
    v_max3_u32 v4, v8, v9, v10
    v_max3_u32 v4, v4, v11, v12
    v_max3_u32 v4, v4, v13, v14
    v_max3_u32 v4, v4, v15, v16
    v_max3_u32 v4, v4, v17, v18
    v_max3_u32 v4, v4, v19, v20
    v_max3_u32 v4, v4, v21, v22
    v_max3_u32 v4, v4, v23, v24
    v_max3_u32 v4, v4, v25, v26
    v_max3_u32 v4, v4, v27, v28
    v_max3_u32 v4, v4, v29, v30
    v_max3_u32 v4, v4, v31, v32
    v_max3_u32 v4, v4, v33, v34
    v_max_u32 v4, v4, v35
    v_cmp_eq_u32 vcc, -1, v4
    s_cbranch_vccz L_relay_go
    s_sub_u32 s31, s31, 1
    s_cbranch_scc0 L_relay_wait
    s_branch L_fail
L_relay_go:
    buffer_store_dwordx4 v[8:11], v2, s[8:11], s35 offen offset:0 sc1
    buffer_store_dwordx4 v[12:15], v2, s[8:11], s35 offen offset:1024 sc1
    buffer_store_dwordx4 v[16:19], v2, s[8:11], s35 offen offset:2048 sc1
    buffer_store_dwordx4 v[20:23], v2, s[8:11], s35 offen offset:3072 sc1
    buffer_store_dwordx4 v[24:27], v2, s[8:11], s33 offen offset:0 sc1
    buffer_store_dwordx4 v[28:31], v2, s[8:11], s33 offen offset:1024 sc1
    buffer_store_dwordx4 v[32:35], v2, s[8:11], s33 offen offset:2048 sc1
    s_add_u32 s24, s24, 16384
    s_add_u32 s35, s35, 16384
    s_add_u32 s30, s30, 2
    s_cmp_lt_u32 s30, 64
    s_cbranch_scc1 L_relay_step
    s_branch L_done
L_gate:
    v_min_u32 v3, 27, v1
    v_lshlrev_b32 v3, 7, v3
    v_add_u32 v2, 7280, v2
    v_mov_b32 v5, 0x40000000
    v_cmp_gt_u32 vcc, 8, v1
    v_mov_b32 v6, 0
    v_cndmask_b32 v2, v5, v2, vcc
    s_mov_b32 s30, 0
    s_mov_b32 s39, 46094336
    s_mov_b32 s24, 44302336
L_gate_step:
    s_cmp_ge_u32 s30, 64
    s_cbranch_scc1 L_gate_go
    s_mov_b32 s31, 200000
L_gate_wait:
    buffer_load_dword v4, v3, s[8:11], s39 offen sc1
    s_waitcnt vmcnt(0)
    v_cmp_eq_u32 vcc, -1, v4
    s_cbranch_vccz L_gate_go
    s_sub_u32 s31, s31, 1
    s_cbranch_scc0 L_gate_wait
    s_branch L_fail
L_gate_go:
    s_cmp_lt_u32 s30, 0
    s_cbranch_scc1 L_gate_next
    buffer_store_dword v6, v2, s[8:11], s24 offen
    s_add_u32 s24, s24, 8192
L_gate_next:
    s_add_u32 s39, s39, 11264
    s_add_u32 s30, s30, 1
    s_cmp_lt_u32 s30, 64
    s_cbranch_scc1 L_gate_step
    s_branch L_done
L_help:
    s_lshr_b32 s21, s23, 5
    s_sub_u32 s21, s21, 1
    s_and_b32 s22, s23, 31
    v_lshlrev_b32 v2, 4, v1
    v_mov_b32 v3, 0
    v_mov_b64 v[96:97], 0
    v_mov_b64 v[98:99], 0
    s_and_b32 s24, s22, 7
    s_lshl_b32 s32, s21, 3
    s_add_u32 s32, s32, s24
    s_lshr_b32 s27, s22, 3
    s_mul_i32 s28, s27, 28672
    s_mul_i32 s24, s20, 7168
    s_add_u32 s28, s28, s24
    s_add_u32 s28, s28, 54363136
    s_mov_b32 s34, 0
    s_mov_b32 s35, 0
    s_cmp_ge_u32 s32, 28
    s_cselect_b32 s26, 28, 0
    s_sub_u32 s26, s32, s26
    s_and_b32 s33, s26, 1
    s_lshl_b32 s33, s33, 3
    s_lshl_b32 s24, s20, 1
    s_add_u32 s33, s33, s24
    s_mul_i32 s30, s27, 11264
    s_lshl_b32 s24, s26, 7
    s_add_u32 s30, s30, s24
    s_add_u32 s30, s30, 46094336
    s_lshr_b32 s26, s26, 1
    s_cmp_ge_u32 s32, 28
    s_cbranch_scc1 H_t
    v_bfe_u32 v4, v1, 5, 1
    v_lshlrev_b32 v4, 8, v4
    v_bfe_u32 v6, v1, 0, 4
    v_lshl_add_u32 v4, v6, 4, v4
    v_bfe_u32 v6, v1, 4, 1
    v_lshl_add_u32 v5, v6, 14, v4
    v_mul_u32_u24 v6, 114688, v6
    v_add_u32 v4, v4, v6
    s_lshl_b32 s24, s26, 2
    s_lshr_b32 s25, s33, 3
    s_lshl_b32 s25, s25, 1
    s_add_u32 s24, s24, s25
    s_mul_i32 s24, s24, 56
    s_and_b32 s25, s33, 7
    s_mul_i32 s25, s25, 7
    s_add_u32 s24, s24, s25
    s_lshl_b32 s24, s24, 11
    s_add_u32 s24, s24, 6422528
    s_mul_i32 s29, s27, 458752
    s_lshl_b32 s25, s26, 15
    s_add_u32 s29, s29, s25
    s_lshl_b32 s25, s33, 10
    s_add_u32 s29, s29, s25
    s_add_u32 s29, s29, 14942208
    s_and_b32 s25, s33, 8
    s_mul_i32 s25, s25, 7
    s_lshr_b32 s3, s26, 1
    s_add_u32 s25, s25, s3
    s_add_u32 s25, s25, 112
    v_min_u32 v60, 7, v1
    v_mul_u32_u24 v60, 896, v60
    s_lshl_b32 s3, s25, 7
    s_add_u32 s3, s3, 46833664
    s_mov_b32 s47, 200000
H_u_nw:
    buffer_load_dwordx2 v[62:63], v60, s[8:11], s3 offen sc1
    s_waitcnt vmcnt(0)
    v_xor_b32 v62, s96, v62
    v_xor_b32 v63, s97, v63
    v_or_b32 v62, v62, v63
    v_cmp_ne_u32 vcc, 0, v62
    s_cbranch_vccz H_u_nw_ok
    s_sub_u32 s47, s47, 1
    s_cbranch_scc0 H_u_nw
    s_branch L_fail
H_u_nw_ok:
    buffer_load_dwordx4 a[0:3], v4, s[8:11], s24 offen offset:0
    buffer_load_dwordx4 a[4:7], v4, s[8:11], s24 offen offset:512
    buffer_load_dwordx4 a[8:11], v4, s[8:11], s24 offen offset:1024
    buffer_load_dwordx4 a[12:15], v4, s[8:11], s24 offen offset:1536
    buffer_load_dwordx4 a[16:19], v4, s[8:11], s24 offen offset:2048
    buffer_load_dwordx4 a[20:23], v4, s[8:11], s24 offen offset:2560
    buffer_load_dwordx4 a[24:27], v4, s[8:11], s24 offen offset:3072
    buffer_load_dwordx4 a[28:31], v4, s[8:11], s24 offen offset:3584
    s_add_u32 s24, s24, 4096
    buffer_load_dwordx4 a[32:35], v4, s[8:11], s24 offen offset:0
    buffer_load_dwordx4 a[36:39], v4, s[8:11], s24 offen offset:512
    buffer_load_dwordx4 a[40:43], v4, s[8:11], s24 offen offset:1024
    buffer_load_dwordx4 a[44:47], v4, s[8:11], s24 offen offset:1536
    buffer_load_dwordx4 a[48:51], v4, s[8:11], s24 offen offset:2048
    buffer_load_dwordx4 a[52:55], v4, s[8:11], s24 offen offset:2560
    buffer_load_dwordx4 a[56:59], v4, s[8:11], s24 offen offset:3072
    buffer_load_dwordx4 a[60:63], v4, s[8:11], s24 offen offset:3584
    s_add_u32 s24, s24, 4096
    buffer_load_dwordx4 a[64:67], v4, s[8:11], s24 offen offset:0
    buffer_load_dwordx4 a[68:71], v4, s[8:11], s24 offen offset:512
    buffer_load_dwordx4 a[72:75], v4, s[8:11], s24 offen offset:1024
    buffer_load_dwordx4 a[76:79], v4, s[8:11], s24 offen offset:1536
    buffer_load_dwordx4 a[80:83], v4, s[8:11], s24 offen offset:2048
    buffer_load_dwordx4 a[84:87], v4, s[8:11], s24 offen offset:2560
    buffer_load_dwordx4 a[88:91], v4, s[8:11], s24 offen offset:3072
    buffer_load_dwordx4 a[92:95], v4, s[8:11], s24 offen offset:3584
    s_add_u32 s24, s24, 4096
    buffer_load_dwordx4 a[96:99], v4, s[8:11], s24 offen offset:0
    buffer_load_dwordx4 a[100:103], v4, s[8:11], s24 offen offset:512
    buffer_load_dwordx4 a[104:107], v4, s[8:11], s24 offen offset:1024
    buffer_load_dwordx4 a[108:111], v4, s[8:11], s24 offen offset:1536
    s_add_u32 s24, s24, 2048
    buffer_load_dwordx4 a[112:115], v4, s[8:11], s24 offen offset:0
    buffer_load_dwordx4 a[116:119], v4, s[8:11], s24 offen offset:512
    buffer_load_dwordx4 a[120:123], v4, s[8:11], s24 offen offset:1024
    buffer_load_dwordx4 a[124:127], v4, s[8:11], s24 offen offset:1536
    buffer_load_dwordx4 a[128:131], v4, s[8:11], s24 offen offset:2048
    buffer_load_dwordx4 a[132:135], v4, s[8:11], s24 offen offset:2560
    buffer_load_dwordx4 a[136:139], v4, s[8:11], s24 offen offset:3072
    buffer_load_dwordx4 a[140:143], v4, s[8:11], s24 offen offset:3584
    s_add_u32 s24, s24, 4096
    buffer_load_dwordx4 a[144:147], v4, s[8:11], s24 offen offset:0
    buffer_load_dwordx4 a[148:151], v4, s[8:11], s24 offen offset:512
    buffer_load_dwordx4 a[152:155], v4, s[8:11], s24 offen offset:1024
    buffer_load_dwordx4 a[156:159], v4, s[8:11], s24 offen offset:1536
    buffer_load_dwordx4 a[160:163], v4, s[8:11], s24 offen offset:2048
    buffer_load_dwordx4 a[164:167], v4, s[8:11], s24 offen offset:2560
    buffer_load_dwordx4 a[168:171], v4, s[8:11], s24 offen offset:3072
    buffer_load_dwordx4 a[172:175], v4, s[8:11], s24 offen offset:3584
    s_add_u32 s24, s24, 4096
    buffer_load_dwordx4 a[176:179], v4, s[8:11], s24 offen offset:0
    buffer_load_dwordx4 a[180:183], v4, s[8:11], s24 offen offset:512
    buffer_load_dwordx4 a[184:187], v4, s[8:11], s24 offen offset:1024
    buffer_load_dwordx4 a[188:191], v4, s[8:11], s24 offen offset:1536
    buffer_load_dwordx4 a[192:195], v4, s[8:11], s24 offen offset:2048
    buffer_load_dwordx4 a[196:199], v4, s[8:11], s24 offen offset:2560
    buffer_load_dwordx4 a[200:203], v4, s[8:11], s24 offen offset:3072
    buffer_load_dwordx4 a[204:207], v4, s[8:11], s24 offen offset:3584
    s_add_u32 s24, s24, 4096
    buffer_load_dwordx4 a[208:211], v4, s[8:11], s24 offen offset:0
    buffer_load_dwordx4 a[212:215], v4, s[8:11], s24 offen offset:512
    buffer_load_dwordx4 a[216:219], v4, s[8:11], s24 offen offset:1024
    buffer_load_dwordx4 a[220:223], v4, s[8:11], s24 offen offset:1536
    s_add_u32 s24, s24, 2048
    s_mov_b32 s46, 0
    v_min_u32 v60, 63, v1
    v_mul_u32_u24 v60, 128, v60
    s_lshl_b32 s3, s46, 7
    s_add_u32 s3, s3, 46833664
    s_mov_b32 s47, 200000
H_u_na0:
    buffer_load_dwordx2 v[62:63], v60, s[8:11], s3 offen sc1
    s_waitcnt vmcnt(0)
    v_xor_b32 v62, s96, v62
    v_xor_b32 v63, s97, v63
    v_or_b32 v62, v62, v63
    v_cmp_ne_u32 vcc, 0, v62
    s_cbranch_vccz H_u_na0_ok
    s_sub_u32 s47, s47, 1
    s_cbranch_scc0 H_u_na0
    s_branch L_fail
H_u_na0_ok:
    s_mov_b32 s46, 64
    v_min_u32 v60, 63, v1
    v_mul_u32_u24 v60, 128, v60
    s_lshl_b32 s3, s46, 7
    s_add_u32 s3, s3, 46833664
    s_mov_b32 s47, 200000
H_u_na1:
    buffer_load_dwordx2 v[62:63], v60, s[8:11], s3 offen sc1
    s_waitcnt vmcnt(0)
    v_xor_b32 v62, s96, v62
    v_xor_b32 v63, s97, v63
    v_or_b32 v62, v62, v63
    v_cmp_ne_u32 vcc, 0, v62
    s_cbranch_vccz H_u_na1_ok
    s_sub_u32 s47, s47, 1
    s_cbranch_scc0 H_u_na1
    s_branch L_fail
H_u_na1_ok:
    s_mov_b32 s46, 128
    v_min_u32 v60, 63, v1
    v_mul_u32_u24 v60, 128, v60
    s_lshl_b32 s3, s46, 7
    s_add_u32 s3, s3, 46833664
    s_mov_b32 s47, 200000
H_u_na2:
    buffer_load_dwordx2 v[62:63], v60, s[8:11], s3 offen sc1
    s_waitcnt vmcnt(0)
    v_xor_b32 v62, s96, v62
    v_xor_b32 v63, s97, v63
    v_or_b32 v62, v62, v63
    v_cmp_ne_u32 vcc, 0, v62
    s_cbranch_vccz H_u_na2_ok
    s_sub_u32 s47, s47, 1
    s_cbranch_scc0 H_u_na2
    s_branch L_fail
H_u_na2_ok:
    s_mov_b32 s46, 192
    v_min_u32 v60, 63, v1
    v_mul_u32_u24 v60, 128, v60
    s_lshl_b32 s3, s46, 7
    s_add_u32 s3, s3, 46833664
    s_mov_b32 s47, 200000
H_u_na3:
    buffer_load_dwordx2 v[62:63], v60, s[8:11], s3 offen sc1
    s_waitcnt vmcnt(0)
    v_xor_b32 v62, s96, v62
    v_xor_b32 v63, s97, v63
    v_or_b32 v62, v62, v63
    v_cmp_ne_u32 vcc, 0, v62
    s_cbranch_vccz H_u_na3_ok
    s_sub_u32 s47, s47, 1
    s_cbranch_scc0 H_u_na3
    s_branch L_fail
H_u_na3_ok:
    s_mov_b32 s46, 256
    v_min_u32 v60, 63, v1
    v_mul_u32_u24 v60, 128, v60
    s_lshl_b32 s3, s46, 7
    s_add_u32 s3, s3, 46833664
    s_mov_b32 s47, 200000
H_u_na4:
    buffer_load_dwordx2 v[62:63], v60, s[8:11], s3 offen sc1
    s_waitcnt vmcnt(0)
    v_xor_b32 v62, s96, v62
    v_xor_b32 v63, s97, v63
    v_or_b32 v62, v62, v63
    v_cmp_ne_u32 vcc, 0, v62
    s_cbranch_vccz H_u_na4_ok
    s_sub_u32 s47, s47, 1
    s_cbranch_scc0 H_u_na4
    s_branch L_fail
H_u_na4_ok:
    s_mul_i32 s24, s20, 7168
    s_add_u32 s24, s24, s34
    s_add_u32 s25, s28, 4096
    s_mov_b32 m0, s24
    s_add_u32 s24, s24, 4096
    buffer_load_dwordx4 v2, s[8:11], s28 offen offset:0 lds
    buffer_load_dwordx4 v2, s[8:11], s28 offen offset:1024 lds
    buffer_load_dwordx4 v2, s[8:11], s28 offen offset:2048 lds
    buffer_load_dwordx4 v2, s[8:11], s28 offen offset:3072 lds
    s_mov_b32 m0, s24
    s_add_u32 s24, s24, 4096
    buffer_load_dwordx4 v2, s[8:11], s25 offen offset:0 lds
    buffer_load_dwordx4 v2, s[8:11], s25 offen offset:1024 lds
    buffer_load_dwordx4 v2, s[8:11], s25 offen offset:2048 lds
    s_add_u32 s28, s28, 114688
    s_add_u32 s34, s34, 28672
    s_cmp_eq_u32 s34, 86016
    s_cselect_b32 s34, 0, s34
    s_mul_i32 s24, s20, 7168
    s_add_u32 s24, s24, s34
    s_add_u32 s25, s28, 4096
    s_mov_b32 m0, s24
    s_add_u32 s24, s24, 4096
    buffer_load_dwordx4 v2, s[8:11], s28 offen offset:0 lds
    buffer_load_dwordx4 v2, s[8:11], s28 offen offset:1024 lds
    buffer_load_dwordx4 v2, s[8:11], s28 offen offset:2048 lds
    buffer_load_dwordx4 v2, s[8:11], s28 offen offset:3072 lds
    s_mov_b32 m0, s24
    s_add_u32 s24, s24, 4096
    buffer_load_dwordx4 v2, s[8:11], s25 offen offset:0 lds
    buffer_load_dwordx4 v2, s[8:11], s25 offen offset:1024 lds
    buffer_load_dwordx4 v2, s[8:11], s25 offen offset:2048 lds
    s_add_u32 s28, s28, 114688
    s_add_u32 s34, s34, 28672
    s_cmp_eq_u32 s34, 86016
    s_cselect_b32 s34, 0, s34
    s_waitcnt vmcnt(7)
    s_barrier
    s_mul_i32 s24, s20, 7168
    s_add_u32 s24, s24, s34
    s_add_u32 s25, s28, 4096
    s_mov_b32 m0, s24
    s_add_u32 s24, s24, 4096
    buffer_load_dwordx4 v2, s[8:11], s28 offen offset:0 lds
    buffer_load_dwordx4 v2, s[8:11], s28 offen offset:1024 lds
    buffer_load_dwordx4 v2, s[8:11], s28 offen offset:2048 lds
    buffer_load_dwordx4 v2, s[8:11], s28 offen offset:3072 lds
    s_mov_b32 m0, s24
    s_add_u32 s24, s24, 4096
    buffer_load_dwordx4 v2, s[8:11], s25 offen offset:0 lds
    buffer_load_dwordx4 v2, s[8:11], s25 offen offset:1024 lds
    buffer_load_dwordx4 v2, s[8:11], s25 offen offset:2048 lds
    s_add_u32 s28, s28, 114688
    s_add_u32 s34, s34, 28672
    s_cmp_eq_u32 s34, 86016
    s_cselect_b32 s34, 0, s34
    v_add_u32 v8, s35, v2
    s_add_u32 s35, s35, 28672
    s_cmp_eq_u32 s35, 86016
    s_cselect_b32 s35, 0, s35
    ds_read_b128 v[80:83], v8 offset:0
    ds_read_b128 v[84:87], v8 offset:1024
    ds_read_b128 v[88:91], v8 offset:2048
    ds_read_b128 v[92:95], v8 offset:3072
    s_waitcnt lgkmcnt(3)
    v_mfma_f32_32x32x16_bf16 v[16:31], v[80:83], a[0:3], 0
    v_mfma_f32_32x32x16_bf16 v[32:47], v[80:83], a[112:115], 0
    ds_read_b128 v[80:83], v8 offset:4096
    s_waitcnt lgkmcnt(3)
    v_mfma_f32_32x32x16_bf16 v[16:31], v[84:87], a[4:7], v[16:31]
    v_mfma_f32_32x32x16_bf16 v[32:47], v[84:87], a[116:119], v[32:47]
    ds_read_b128 v[84:87], v8 offset:5120
    s_waitcnt lgkmcnt(3)
    v_mfma_f32_32x32x16_bf16 v[16:31], v[88:91], a[8:11], v[16:31]
    v_mfma_f32_32x32x16_bf16 v[32:47], v[88:91], a[120:123], v[32:47]
    ds_read_b128 v[88:91], v8 offset:6144
    s_waitcnt lgkmcnt(3)
    v_mfma_f32_32x32x16_bf16 v[16:31], v[92:95], a[12:15], v[16:31]
    v_mfma_f32_32x32x16_bf16 v[32:47], v[92:95], a[124:127], v[32:47]
    ds_read_b128 v[92:95], v8 offset:7168
    s_waitcnt lgkmcnt(3)
    v_mfma_f32_32x32x16_bf16 v[16:31], v[80:83], a[16:19], v[16:31]
    v_mfma_f32_32x32x16_bf16 v[32:47], v[80:83], a[128:131], v[32:47]
    ds_read_b128 v[80:83], v8 offset:8192
    s_waitcnt lgkmcnt(3)
    v_mfma_f32_32x32x16_bf16 v[16:31], v[84:87], a[20:23], v[16:31]
    v_mfma_f32_32x32x16_bf16 v[32:47], v[84:87], a[132:135], v[32:47]
    ds_read_b128 v[84:87], v8 offset:9216
    s_waitcnt lgkmcnt(3)
    v_mfma_f32_32x32x16_bf16 v[16:31], v[88:91], a[24:27], v[16:31]
    v_mfma_f32_32x32x16_bf16 v[32:47], v[88:91], a[136:139], v[32:47]
    ds_read_b128 v[88:91], v8 offset:10240
    s_waitcnt lgkmcnt(3)
    v_mfma_f32_32x32x16_bf16 v[16:31], v[92:95], a[28:31], v[16:31]
    v_mfma_f32_32x32x16_bf16 v[32:47], v[92:95], a[140:143], v[32:47]
    ds_read_b128 v[92:95], v8 offset:11264
    s_waitcnt lgkmcnt(3)
    v_mfma_f32_32x32x16_bf16 v[16:31], v[80:83], a[32:35], v[16:31]
    v_mfma_f32_32x32x16_bf16 v[32:47], v[80:83], a[144:147], v[32:47]
    ds_read_b128 v[80:83], v8 offset:12288
    s_waitcnt lgkmcnt(3)
    v_mfma_f32_32x32x16_bf16 v[16:31], v[84:87], a[36:39], v[16:31]
    v_mfma_f32_32x32x16_bf16 v[32:47], v[84:87], a[148:151], v[32:47]
    ds_read_b128 v[84:87], v8 offset:13312
    s_waitcnt lgkmcnt(3)
    v_mfma_f32_32x32x16_bf16 v[16:31], v[88:91], a[40:43], v[16:31]
    v_mfma_f32_32x32x16_bf16 v[32:47], v[88:91], a[152:155], v[32:47]
    ds_read_b128 v[88:91], v8 offset:14336
    s_waitcnt lgkmcnt(3)
    v_mfma_f32_32x32x16_bf16 v[16:31], v[92:95], a[44:47], v[16:31]
    v_mfma_f32_32x32x16_bf16 v[32:47], v[92:95], a[156:159], v[32:47]
    ds_read_b128 v[92:95], v8 offset:15360
    s_waitcnt lgkmcnt(3)
    v_mfma_f32_32x32x16_bf16 v[16:31], v[80:83], a[48:51], v[16:31]
    v_mfma_f32_32x32x16_bf16 v[32:47], v[80:83], a[160:163], v[32:47]
    ds_read_b128 v[80:83], v8 offset:16384
    s_waitcnt lgkmcnt(3)
    v_mfma_f32_32x32x16_bf16 v[16:31], v[84:87], a[52:55], v[16:31]
    v_mfma_f32_32x32x16_bf16 v[32:47], v[84:87], a[164:167], v[32:47]
    ds_read_b128 v[84:87], v8 offset:17408
    s_waitcnt lgkmcnt(3)
    v_mfma_f32_32x32x16_bf16 v[16:31], v[88:91], a[56:59], v[16:31]
    v_mfma_f32_32x32x16_bf16 v[32:47], v[88:91], a[168:171], v[32:47]
    ds_read_b128 v[88:91], v8 offset:18432
    s_waitcnt lgkmcnt(3)
    v_mfma_f32_32x32x16_bf16 v[16:31], v[92:95], a[60:63], v[16:31]
    v_mfma_f32_32x32x16_bf16 v[32:47], v[92:95], a[172:175], v[32:47]
    ds_read_b128 v[92:95], v8 offset:19456
    s_waitcnt lgkmcnt(3)
    v_mfma_f32_32x32x16_bf16 v[16:31], v[80:83], a[64:67], v[16:31]
    v_mfma_f32_32x32x16_bf16 v[32:47], v[80:83], a[176:179], v[32:47]
    ds_read_b128 v[80:83], v8 offset:20480
    s_waitcnt lgkmcnt(3)
    v_mfma_f32_32x32x16_bf16 v[16:31], v[84:87], a[68:71], v[16:31]
    v_mfma_f32_32x32x16_bf16 v[32:47], v[84:87], a[180:183], v[32:47]
    ds_read_b128 v[84:87], v8 offset:21504
    s_waitcnt lgkmcnt(3)
    v_mfma_f32_32x32x16_bf16 v[16:31], v[88:91], a[72:75], v[16:31]
    v_mfma_f32_32x32x16_bf16 v[32:47], v[88:91], a[184:187], v[32:47]
    ds_read_b128 v[88:91], v8 offset:22528
    s_waitcnt lgkmcnt(3)
    v_mfma_f32_32x32x16_bf16 v[16:31], v[92:95], a[76:79], v[16:31]
    v_mfma_f32_32x32x16_bf16 v[32:47], v[92:95], a[188:191], v[32:47]
    ds_read_b128 v[92:95], v8 offset:23552
    s_waitcnt lgkmcnt(3)
    v_mfma_f32_32x32x16_bf16 v[16:31], v[80:83], a[80:83], v[16:31]
    v_mfma_f32_32x32x16_bf16 v[32:47], v[80:83], a[192:195], v[32:47]
    ds_read_b128 v[80:83], v8 offset:24576
    s_waitcnt lgkmcnt(3)
    v_mfma_f32_32x32x16_bf16 v[16:31], v[84:87], a[84:87], v[16:31]
    v_mfma_f32_32x32x16_bf16 v[32:47], v[84:87], a[196:199], v[32:47]
    ds_read_b128 v[84:87], v8 offset:25600
    s_waitcnt lgkmcnt(3)
    v_mfma_f32_32x32x16_bf16 v[16:31], v[88:91], a[88:91], v[16:31]
    v_mfma_f32_32x32x16_bf16 v[32:47], v[88:91], a[200:203], v[32:47]
    ds_read_b128 v[88:91], v8 offset:26624
    s_waitcnt lgkmcnt(3)
    v_mfma_f32_32x32x16_bf16 v[16:31], v[92:95], a[92:95], v[16:31]
    v_mfma_f32_32x32x16_bf16 v[32:47], v[92:95], a[204:207], v[32:47]
    ds_read_b128 v[92:95], v8 offset:27648
    s_waitcnt lgkmcnt(3)
    v_mfma_f32_32x32x16_bf16 v[16:31], v[80:83], a[96:99], v[16:31]
    v_mfma_f32_32x32x16_bf16 v[32:47], v[80:83], a[208:211], v[32:47]
    s_waitcnt lgkmcnt(2)
    v_mfma_f32_32x32x16_bf16 v[16:31], v[84:87], a[100:103], v[16:31]
    v_mfma_f32_32x32x16_bf16 v[32:47], v[84:87], a[212:215], v[32:47]
    s_waitcnt lgkmcnt(1)
    v_mfma_f32_32x32x16_bf16 v[16:31], v[88:91], a[104:107], v[16:31]
    v_mfma_f32_32x32x16_bf16 v[32:47], v[88:91], a[216:219], v[32:47]
    s_waitcnt lgkmcnt(0)
    v_mfma_f32_32x32x16_bf16 v[16:31], v[92:95], a[108:111], v[16:31]
    v_mfma_f32_32x32x16_bf16 v[32:47], v[92:95], a[220:223], v[32:47]
    s_nop 7
    s_nop 3
    s_add_u32 s26, s29, 1024
    v_cvt_pk_bf16_f32 v16, v16, v17
    v_cvt_pk_bf16_f32 v17, v18, v19
    v_cvt_pk_bf16_f32 v18, v20, v21
    v_cvt_pk_bf16_f32 v19, v22, v23
    buffer_store_dwordx4 v[16:19], v5, s[8:11], s29 offen offset:0 sc1
    v_cvt_pk_bf16_f32 v24, v24, v25
    v_cvt_pk_bf16_f32 v25, v26, v27
    v_cvt_pk_bf16_f32 v26, v28, v29
    v_cvt_pk_bf16_f32 v27, v30, v31
    buffer_store_dwordx4 v[24:27], v5, s[8:11], s29 offen offset:512 sc1
    v_cvt_pk_bf16_f32 v32, v32, v33
    v_cvt_pk_bf16_f32 v33, v34, v35
    v_cvt_pk_bf16_f32 v34, v36, v37
    v_cvt_pk_bf16_f32 v35, v38, v39
    buffer_store_dwordx4 v[32:35], v5, s[8:11], s26 offen offset:0 sc1
    v_cvt_pk_bf16_f32 v40, v40, v41
    v_cvt_pk_bf16_f32 v41, v42, v43
    v_cvt_pk_bf16_f32 v42, v44, v45
    v_cvt_pk_bf16_f32 v43, v46, v47
    buffer_store_dwordx4 v[40:43], v5, s[8:11], s26 offen offset:512 sc1
    s_add_u32 s29, s29, 1835008
    s_waitcnt vmcnt(0)
    s_barrier
    s_cmp_lg_u32 s20, 0
    s_cbranch_scc1 H_nf_6
    s_mov_b64 exec, 0xff
    buffer_store_dwordx4 v[96:99], v2, s[8:11], s30 offen sc1
    s_mov_b64 exec, -1
H_nf_6:
    s_add_u32 s30, s30, 45056
    s_mul_i32 s24, s20, 7168
    s_add_u32 s24, s24, s34
    s_add_u32 s25, s28, 4096
    s_mov_b32 m0, s24
    s_add_u32 s24, s24, 4096
    buffer_load_dwordx4 v2, s[8:11], s28 offen offset:0 lds
    buffer_load_dwordx4 v2, s[8:11], s28 offen offset:1024 lds
    buffer_load_dwordx4 v2, s[8:11], s28 offen offset:2048 lds
    buffer_load_dwordx4 v2, s[8:11], s28 offen offset:3072 lds
    s_mov_b32 m0, s24
    s_add_u32 s24, s24, 4096
    buffer_load_dwordx4 v2, s[8:11], s25 offen offset:0 lds
    buffer_load_dwordx4 v2, s[8:11], s25 offen offset:1024 lds
    buffer_load_dwordx4 v2, s[8:11], s25 offen offset:2048 lds
    s_add_u32 s28, s28, 114688
    s_add_u32 s34, s34, 28672
    s_cmp_eq_u32 s34, 86016
    s_cselect_b32 s34, 0, s34
    v_add_u32 v8, s35, v2
    s_add_u32 s35, s35, 28672
    s_cmp_eq_u32 s35, 86016
    s_cselect_b32 s35, 0, s35
    ds_read_b128 v[80:83], v8 offset:0
    ds_read_b128 v[84:87], v8 offset:1024
    ds_read_b128 v[88:91], v8 offset:2048
    ds_read_b128 v[92:95], v8 offset:3072
    s_waitcnt lgkmcnt(3)
    v_mfma_f32_32x32x16_bf16 v[48:63], v[80:83], a[0:3], 0
    v_mfma_f32_32x32x16_bf16 v[64:79], v[80:83], a[112:115], 0
    ds_read_b128 v[80:83], v8 offset:4096
    s_waitcnt lgkmcnt(3)
    v_mfma_f32_32x32x16_bf16 v[48:63], v[84:87], a[4:7], v[48:63]
    v_mfma_f32_32x32x16_bf16 v[64:79], v[84:87], a[116:119], v[64:79]
    ds_read_b128 v[84:87], v8 offset:5120
    s_waitcnt lgkmcnt(3)
    v_mfma_f32_32x32x16_bf16 v[48:63], v[88:91], a[8:11], v[48:63]
    v_mfma_f32_32x32x16_bf16 v[64:79], v[88:91], a[120:123], v[64:79]
    ds_read_b128 v[88:91], v8 offset:6144
    s_waitcnt lgkmcnt(3)
    v_mfma_f32_32x32x16_bf16 v[48:63], v[92:95], a[12:15], v[48:63]
    v_mfma_f32_32x32x16_bf16 v[64:79], v[92:95], a[124:127], v[64:79]
    ds_read_b128 v[92:95], v8 offset:7168
    s_waitcnt lgkmcnt(3)
    v_mfma_f32_32x32x16_bf16 v[48:63], v[80:83], a[16:19], v[48:63]
    v_mfma_f32_32x32x16_bf16 v[64:79], v[80:83], a[128:131], v[64:79]
    ds_read_b128 v[80:83], v8 offset:8192
    s_waitcnt lgkmcnt(3)
    v_mfma_f32_32x32x16_bf16 v[48:63], v[84:87], a[20:23], v[48:63]
    v_mfma_f32_32x32x16_bf16 v[64:79], v[84:87], a[132:135], v[64:79]
    ds_read_b128 v[84:87], v8 offset:9216
    s_waitcnt lgkmcnt(3)
    v_mfma_f32_32x32x16_bf16 v[48:63], v[88:91], a[24:27], v[48:63]
    v_mfma_f32_32x32x16_bf16 v[64:79], v[88:91], a[136:139], v[64:79]
    ds_read_b128 v[88:91], v8 offset:10240
    s_waitcnt lgkmcnt(3)
    v_mfma_f32_32x32x16_bf16 v[48:63], v[92:95], a[28:31], v[48:63]
    v_mfma_f32_32x32x16_bf16 v[64:79], v[92:95], a[140:143], v[64:79]
    ds_read_b128 v[92:95], v8 offset:11264
    s_waitcnt lgkmcnt(3)
    v_mfma_f32_32x32x16_bf16 v[48:63], v[80:83], a[32:35], v[48:63]
    v_mfma_f32_32x32x16_bf16 v[64:79], v[80:83], a[144:147], v[64:79]
    ds_read_b128 v[80:83], v8 offset:12288
    s_waitcnt lgkmcnt(3)
    v_mfma_f32_32x32x16_bf16 v[48:63], v[84:87], a[36:39], v[48:63]
    v_mfma_f32_32x32x16_bf16 v[64:79], v[84:87], a[148:151], v[64:79]
    ds_read_b128 v[84:87], v8 offset:13312
    s_waitcnt lgkmcnt(3)
    v_mfma_f32_32x32x16_bf16 v[48:63], v[88:91], a[40:43], v[48:63]
    v_mfma_f32_32x32x16_bf16 v[64:79], v[88:91], a[152:155], v[64:79]
    ds_read_b128 v[88:91], v8 offset:14336
    s_waitcnt lgkmcnt(3)
    v_mfma_f32_32x32x16_bf16 v[48:63], v[92:95], a[44:47], v[48:63]
    v_mfma_f32_32x32x16_bf16 v[64:79], v[92:95], a[156:159], v[64:79]
    ds_read_b128 v[92:95], v8 offset:15360
    s_waitcnt lgkmcnt(3)
    v_mfma_f32_32x32x16_bf16 v[48:63], v[80:83], a[48:51], v[48:63]
    v_mfma_f32_32x32x16_bf16 v[64:79], v[80:83], a[160:163], v[64:79]
    ds_read_b128 v[80:83], v8 offset:16384
    s_waitcnt lgkmcnt(3)
    v_mfma_f32_32x32x16_bf16 v[48:63], v[84:87], a[52:55], v[48:63]
    v_mfma_f32_32x32x16_bf16 v[64:79], v[84:87], a[164:167], v[64:79]
    ds_read_b128 v[84:87], v8 offset:17408
    s_waitcnt lgkmcnt(3)
    v_mfma_f32_32x32x16_bf16 v[48:63], v[88:91], a[56:59], v[48:63]
    v_mfma_f32_32x32x16_bf16 v[64:79], v[88:91], a[168:171], v[64:79]
    ds_read_b128 v[88:91], v8 offset:18432
    s_waitcnt lgkmcnt(3)
    v_mfma_f32_32x32x16_bf16 v[48:63], v[92:95], a[60:63], v[48:63]
    v_mfma_f32_32x32x16_bf16 v[64:79], v[92:95], a[172:175], v[64:79]
    ds_read_b128 v[92:95], v8 offset:19456
    s_waitcnt lgkmcnt(3)
    v_mfma_f32_32x32x16_bf16 v[48:63], v[80:83], a[64:67], v[48:63]
    v_mfma_f32_32x32x16_bf16 v[64:79], v[80:83], a[176:179], v[64:79]
    ds_read_b128 v[80:83], v8 offset:20480
    s_waitcnt lgkmcnt(3)
    v_mfma_f32_32x32x16_bf16 v[48:63], v[84:87], a[68:71], v[48:63]
    v_mfma_f32_32x32x16_bf16 v[64:79], v[84:87], a[180:183], v[64:79]
    ds_read_b128 v[84:87], v8 offset:21504
    s_waitcnt lgkmcnt(3)
    v_mfma_f32_32x32x16_bf16 v[48:63], v[88:91], a[72:75], v[48:63]
    v_mfma_f32_32x32x16_bf16 v[64:79], v[88:91], a[184:187], v[64:79]
    ds_read_b128 v[88:91], v8 offset:22528
    s_waitcnt lgkmcnt(3)
    v_mfma_f32_32x32x16_bf16 v[48:63], v[92:95], a[76:79], v[48:63]
    v_mfma_f32_32x32x16_bf16 v[64:79], v[92:95], a[188:191], v[64:79]
    ds_read_b128 v[92:95], v8 offset:23552
    s_waitcnt lgkmcnt(3)
    v_mfma_f32_32x32x16_bf16 v[48:63], v[80:83], a[80:83], v[48:63]
    v_mfma_f32_32x32x16_bf16 v[64:79], v[80:83], a[192:195], v[64:79]
    ds_read_b128 v[80:83], v8 offset:24576
    s_waitcnt lgkmcnt(3)
    v_mfma_f32_32x32x16_bf16 v[48:63], v[84:87], a[84:87], v[48:63]
    v_mfma_f32_32x32x16_bf16 v[64:79], v[84:87], a[196:199], v[64:79]
    ds_read_b128 v[84:87], v8 offset:25600
    s_waitcnt lgkmcnt(3)
    v_mfma_f32_32x32x16_bf16 v[48:63], v[88:91], a[88:91], v[48:63]
    v_mfma_f32_32x32x16_bf16 v[64:79], v[88:91], a[200:203], v[64:79]
    ds_read_b128 v[88:91], v8 offset:26624
    s_waitcnt lgkmcnt(3)
    v_mfma_f32_32x32x16_bf16 v[48:63], v[92:95], a[92:95], v[48:63]
    v_mfma_f32_32x32x16_bf16 v[64:79], v[92:95], a[204:207], v[64:79]
    ds_read_b128 v[92:95], v8 offset:27648
    s_waitcnt lgkmcnt(3)
    v_mfma_f32_32x32x16_bf16 v[48:63], v[80:83], a[96:99], v[48:63]
    v_mfma_f32_32x32x16_bf16 v[64:79], v[80:83], a[208:211], v[64:79]
    s_waitcnt lgkmcnt(2)
    v_mfma_f32_32x32x16_bf16 v[48:63], v[84:87], a[100:103], v[48:63]
    v_mfma_f32_32x32x16_bf16 v[64:79], v[84:87], a[212:215], v[64:79]
    s_waitcnt lgkmcnt(1)
    v_mfma_f32_32x32x16_bf16 v[48:63], v[88:91], a[104:107], v[48:63]
    v_mfma_f32_32x32x16_bf16 v[64:79], v[88:91], a[216:219], v[64:79]
    s_waitcnt lgkmcnt(0)
    v_mfma_f32_32x32x16_bf16 v[48:63], v[92:95], a[108:111], v[48:63]
    v_mfma_f32_32x32x16_bf16 v[64:79], v[92:95], a[220:223], v[64:79]
    s_mov_b32 s31, 2
    s_barrier
    s_mul_i32 s24, s20, 7168
    s_add_u32 s24, s24, s34
    s_add_u32 s25, s28, 4096
    s_mov_b32 m0, s24
    s_add_u32 s24, s24, 4096
    buffer_load_dwordx4 v2, s[8:11], s28 offen offset:0 lds
    buffer_load_dwordx4 v2, s[8:11], s28 offen offset:1024 lds
    buffer_load_dwordx4 v2, s[8:11], s28 offen offset:2048 lds
    buffer_load_dwordx4 v2, s[8:11], s28 offen offset:3072 lds
    s_mov_b32 m0, s24
    s_add_u32 s24, s24, 4096
    buffer_load_dwordx4 v2, s[8:11], s25 offen offset:0 lds
    buffer_load_dwordx4 v2, s[8:11], s25 offen offset:1024 lds
    buffer_load_dwordx4 v2, s[8:11], s25 offen offset:2048 lds
    s_add_u32 s28, s28, 114688
    s_add_u32 s34, s34, 28672
    s_cmp_eq_u32 s34, 86016
    s_cselect_b32 s34, 0, s34
    v_add_u32 v8, s35, v2
    s_add_u32 s35, s35, 28672
    s_cmp_eq_u32 s35, 86016
    s_cselect_b32 s35, 0, s35
    ds_read_b128 v[80:83], v8 offset:0
    ds_read_b128 v[84:87], v8 offset:1024
    ds_read_b128 v[88:91], v8 offset:2048
    ds_read_b128 v[92:95], v8 offset:3072
    s_waitcnt lgkmcnt(3)
    v_mfma_f32_32x32x16_bf16 v[16:31], v[80:83], a[0:3], 0
    v_mfma_f32_32x32x16_bf16 v[32:47], v[80:83], a[112:115], 0
    ds_read_b128 v[80:83], v8 offset:4096
    s_waitcnt lgkmcnt(3)
    v_mfma_f32_32x32x16_bf16 v[16:31], v[84:87], a[4:7], v[16:31]
    s_add_u32 s26, s29, 1024
    v_mfma_f32_32x32x16_bf16 v[32:47], v[84:87], a[116:119], v[32:47]
    v_cvt_pk_bf16_f32 v48, v48, v49
    ds_read_b128 v[84:87], v8 offset:5120
    s_waitcnt lgkmcnt(3)
    v_mfma_f32_32x32x16_bf16 v[16:31], v[88:91], a[8:11], v[16:31]
    v_cvt_pk_bf16_f32 v49, v50, v51
    v_mfma_f32_32x32x16_bf16 v[32:47], v[88:91], a[120:123], v[32:47]
    v_cvt_pk_bf16_f32 v50, v52, v53
    ds_read_b128 v[88:91], v8 offset:6144
    s_waitcnt lgkmcnt(3)
    v_mfma_f32_32x32x16_bf16 v[16:31], v[92:95], a[12:15], v[16:31]
    v_cvt_pk_bf16_f32 v51, v54, v55
    v_mfma_f32_32x32x16_bf16 v[32:47], v[92:95], a[124:127], v[32:47]
    buffer_store_dwordx4 v[48:51], v5, s[8:11], s29 offen offset:0 sc1
    ds_read_b128 v[92:95], v8 offset:7168
    s_waitcnt lgkmcnt(3)
    v_mfma_f32_32x32x16_bf16 v[16:31], v[80:83], a[16:19], v[16:31]
    v_cvt_pk_bf16_f32 v56, v56, v57
    v_mfma_f32_32x32x16_bf16 v[32:47], v[80:83], a[128:131], v[32:47]
    v_cvt_pk_bf16_f32 v57, v58, v59
    ds_read_b128 v[80:83], v8 offset:8192
    s_waitcnt lgkmcnt(3)
    v_mfma_f32_32x32x16_bf16 v[16:31], v[84:87], a[20:23], v[16:31]
    v_cvt_pk_bf16_f32 v58, v60, v61
    v_mfma_f32_32x32x16_bf16 v[32:47], v[84:87], a[132:135], v[32:47]
    v_cvt_pk_bf16_f32 v59, v62, v63
    ds_read_b128 v[84:87], v8 offset:9216
    s_waitcnt lgkmcnt(3)
    v_mfma_f32_32x32x16_bf16 v[16:31], v[88:91], a[24:27], v[16:31]
    buffer_store_dwordx4 v[56:59], v5, s[8:11], s29 offen offset:512 sc1
    v_mfma_f32_32x32x16_bf16 v[32:47], v[88:91], a[136:139], v[32:47]
    v_cvt_pk_bf16_f32 v64, v64, v65
    ds_read_b128 v[88:91], v8 offset:10240
    s_waitcnt lgkmcnt(3)
    v_mfma_f32_32x32x16_bf16 v[16:31], v[92:95], a[28:31], v[16:31]
    v_cvt_pk_bf16_f32 v65, v66, v67
    v_mfma_f32_32x32x16_bf16 v[32:47], v[92:95], a[140:143], v[32:47]
    v_cvt_pk_bf16_f32 v66, v68, v69
    ds_read_b128 v[92:95], v8 offset:11264
    s_waitcnt lgkmcnt(3)
    v_mfma_f32_32x32x16_bf16 v[16:31], v[80:83], a[32:35], v[16:31]
    v_cvt_pk_bf16_f32 v67, v70, v71
    v_mfma_f32_32x32x16_bf16 v[32:47], v[80:83], a[144:147], v[32:47]
    buffer_store_dwordx4 v[64:67], v5, s[8:11], s26 offen offset:0 sc1
    ds_read_b128 v[80:83], v8 offset:12288
    s_waitcnt lgkmcnt(3)
    v_mfma_f32_32x32x16_bf16 v[16:31], v[84:87], a[36:39], v[16:31]
    v_cvt_pk_bf16_f32 v72, v72, v73
    v_mfma_f32_32x32x16_bf16 v[32:47], v[84:87], a[148:151], v[32:47]
    v_cvt_pk_bf16_f32 v73, v74, v75
    ds_read_b128 v[84:87], v8 offset:13312
    s_waitcnt lgkmcnt(3)
    v_mfma_f32_32x32x16_bf16 v[16:31], v[88:91], a[40:43], v[16:31]
    v_cvt_pk_bf16_f32 v74, v76, v77
    v_mfma_f32_32x32x16_bf16 v[32:47], v[88:91], a[152:155], v[32:47]
    v_cvt_pk_bf16_f32 v75, v78, v79
    ds_read_b128 v[88:91], v8 offset:14336
    s_waitcnt lgkmcnt(3)
    v_mfma_f32_32x32x16_bf16 v[16:31], v[92:95], a[44:47], v[16:31]
    buffer_store_dwordx4 v[72:75], v5, s[8:11], s26 offen offset:512 sc1
    v_mfma_f32_32x32x16_bf16 v[32:47], v[92:95], a[156:159], v[32:47]
    s_add_u32 s29, s29, 1835008
    ds_read_b128 v[92:95], v8 offset:15360
    s_waitcnt lgkmcnt(3)
    v_mfma_f32_32x32x16_bf16 v[16:31], v[80:83], a[48:51], v[16:31]
    v_mfma_f32_32x32x16_bf16 v[32:47], v[80:83], a[160:163], v[32:47]
    ds_read_b128 v[80:83], v8 offset:16384
    s_waitcnt lgkmcnt(3)
    v_mfma_f32_32x32x16_bf16 v[16:31], v[84:87], a[52:55], v[16:31]
    v_mfma_f32_32x32x16_bf16 v[32:47], v[84:87], a[164:167], v[32:47]
    ds_read_b128 v[84:87], v8 offset:17408
    s_waitcnt lgkmcnt(3)
    v_mfma_f32_32x32x16_bf16 v[16:31], v[88:91], a[56:59], v[16:31]
    v_mfma_f32_32x32x16_bf16 v[32:47], v[88:91], a[168:171], v[32:47]
    ds_read_b128 v[88:91], v8 offset:18432
    s_waitcnt lgkmcnt(3)
    v_mfma_f32_32x32x16_bf16 v[16:31], v[92:95], a[60:63], v[16:31]
    v_mfma_f32_32x32x16_bf16 v[32:47], v[92:95], a[172:175], v[32:47]
    ds_read_b128 v[92:95], v8 offset:19456
    s_waitcnt lgkmcnt(3)
    v_mfma_f32_32x32x16_bf16 v[16:31], v[80:83], a[64:67], v[16:31]
    v_mfma_f32_32x32x16_bf16 v[32:47], v[80:83], a[176:179], v[32:47]
    ds_read_b128 v[80:83], v8 offset:20480
    s_waitcnt lgkmcnt(3)
    v_mfma_f32_32x32x16_bf16 v[16:31], v[84:87], a[68:71], v[16:31]
    v_mfma_f32_32x32x16_bf16 v[32:47], v[84:87], a[180:183], v[32:47]
    ds_read_b128 v[84:87], v8 offset:21504
    s_waitcnt lgkmcnt(3)
    v_mfma_f32_32x32x16_bf16 v[16:31], v[88:91], a[72:75], v[16:31]
    v_mfma_f32_32x32x16_bf16 v[32:47], v[88:91], a[184:187], v[32:47]
    ds_read_b128 v[88:91], v8 offset:22528
    s_waitcnt lgkmcnt(3)
    v_mfma_f32_32x32x16_bf16 v[16:31], v[92:95], a[76:79], v[16:31]
    v_mfma_f32_32x32x16_bf16 v[32:47], v[92:95], a[188:191], v[32:47]
    ds_read_b128 v[92:95], v8 offset:23552
    s_waitcnt lgkmcnt(3)
    v_mfma_f32_32x32x16_bf16 v[16:31], v[80:83], a[80:83], v[16:31]
    v_mfma_f32_32x32x16_bf16 v[32:47], v[80:83], a[192:195], v[32:47]
    ds_read_b128 v[80:83], v8 offset:24576
    s_waitcnt lgkmcnt(3)
    v_mfma_f32_32x32x16_bf16 v[16:31], v[84:87], a[84:87], v[16:31]
    v_mfma_f32_32x32x16_bf16 v[32:47], v[84:87], a[196:199], v[32:47]
    ds_read_b128 v[84:87], v8 offset:25600
    s_waitcnt lgkmcnt(3)
    v_mfma_f32_32x32x16_bf16 v[16:31], v[88:91], a[88:91], v[16:31]
    v_mfma_f32_32x32x16_bf16 v[32:47], v[88:91], a[200:203], v[32:47]
    ds_read_b128 v[88:91], v8 offset:26624
    s_waitcnt lgkmcnt(3)
    v_mfma_f32_32x32x16_bf16 v[16:31], v[92:95], a[92:95], v[16:31]
    v_mfma_f32_32x32x16_bf16 v[32:47], v[92:95], a[204:207], v[32:47]
    ds_read_b128 v[92:95], v8 offset:27648
    s_waitcnt lgkmcnt(3)
    v_mfma_f32_32x32x16_bf16 v[16:31], v[80:83], a[96:99], v[16:31]
    v_mfma_f32_32x32x16_bf16 v[32:47], v[80:83], a[208:211], v[32:47]
    s_waitcnt lgkmcnt(2)
    v_mfma_f32_32x32x16_bf16 v[16:31], v[84:87], a[100:103], v[16:31]
    v_mfma_f32_32x32x16_bf16 v[32:47], v[84:87], a[212:215], v[32:47]
    s_waitcnt lgkmcnt(1)
    v_mfma_f32_32x32x16_bf16 v[16:31], v[88:91], a[104:107], v[16:31]
    v_mfma_f32_32x32x16_bf16 v[32:47], v[88:91], a[216:219], v[32:47]
    s_waitcnt lgkmcnt(0)
    v_mfma_f32_32x32x16_bf16 v[16:31], v[92:95], a[108:111], v[16:31]
    v_mfma_f32_32x32x16_bf16 v[32:47], v[92:95], a[220:223], v[32:47]
    s_waitcnt vmcnt(11)
    s_branch H_u_mid
H_u_loop:
    s_waitcnt vmcnt(15)
    s_barrier
    s_add_u32 s31, s31, 1
    s_cmp_lt_u32 s31, 5
    s_cbranch_scc1 H_n3_7
    s_cmp_lg_u32 s20, 0
    s_cbranch_scc1 H_nf_8
    s_mov_b64 exec, 0xff
    buffer_store_dwordx4 v[96:99], v2, s[8:11], s30 offen sc1
    s_mov_b64 exec, -1
H_nf_8:
    s_add_u32 s30, s30, 45056
H_n3_7:
    s_cmp_eq_u32 s31, 16
    s_cbranch_scc1 H_u_end
    s_mul_i32 s24, s20, 7168
    s_add_u32 s24, s24, s34
    s_add_u32 s25, s28, 4096
    s_mov_b32 m0, s24
    s_add_u32 s24, s24, 4096
    buffer_load_dwordx4 v2, s[8:11], s28 offen offset:0 lds
    buffer_load_dwordx4 v2, s[8:11], s28 offen offset:1024 lds
    buffer_load_dwordx4 v2, s[8:11], s28 offen offset:2048 lds
    buffer_load_dwordx4 v2, s[8:11], s28 offen offset:3072 lds
    s_mov_b32 m0, s24
    s_add_u32 s24, s24, 4096
    buffer_load_dwordx4 v2, s[8:11], s25 offen offset:0 lds
    buffer_load_dwordx4 v2, s[8:11], s25 offen offset:1024 lds
    buffer_load_dwordx4 v2, s[8:11], s25 offen offset:2048 lds
    s_add_u32 s28, s28, 114688
    s_add_u32 s34, s34, 28672
    s_cmp_eq_u32 s34, 86016
    s_cselect_b32 s34, 0, s34
    v_add_u32 v8, s35, v2
    s_add_u32 s35, s35, 28672
    s_cmp_eq_u32 s35, 86016
    s_cselect_b32 s35, 0, s35
    ds_read_b128 v[80:83], v8 offset:0
    ds_read_b128 v[84:87], v8 offset:1024
    ds_read_b128 v[88:91], v8 offset:2048
    ds_read_b128 v[92:95], v8 offset:3072
    s_waitcnt lgkmcnt(3)
    v_mfma_f32_32x32x16_bf16 v[16:31], v[80:83], a[0:3], 0
    v_mfma_f32_32x32x16_bf16 v[32:47], v[80:83], a[112:115], 0
    ds_read_b128 v[80:83], v8 offset:4096
    s_waitcnt lgkmcnt(3)
    v_mfma_f32_32x32x16_bf16 v[16:31], v[84:87], a[4:7], v[16:31]
    s_add_u32 s26, s29, 1024
    v_mfma_f32_32x32x16_bf16 v[32:47], v[84:87], a[116:119], v[32:47]
    v_cvt_pk_bf16_f32 v48, v48, v49
    ds_read_b128 v[84:87], v8 offset:5120
    s_waitcnt lgkmcnt(3)
    v_mfma_f32_32x32x16_bf16 v[16:31], v[88:91], a[8:11], v[16:31]
    v_cvt_pk_bf16_f32 v49, v50, v51
    v_mfma_f32_32x32x16_bf16 v[32:47], v[88:91], a[120:123], v[32:47]
    v_cvt_pk_bf16_f32 v50, v52, v53
    ds_read_b128 v[88:91], v8 offset:6144
    s_waitcnt lgkmcnt(3)
    v_mfma_f32_32x32x16_bf16 v[16:31], v[92:95], a[12:15], v[16:31]
    v_cvt_pk_bf16_f32 v51, v54, v55
    v_mfma_f32_32x32x16_bf16 v[32:47], v[92:95], a[124:127], v[32:47]
    buffer_store_dwordx4 v[48:51], v5, s[8:11], s29 offen offset:0 sc1
    ds_read_b128 v[92:95], v8 offset:7168
    s_waitcnt lgkmcnt(3)
    v_mfma_f32_32x32x16_bf16 v[16:31], v[80:83], a[16:19], v[16:31]
    v_cvt_pk_bf16_f32 v56, v56, v57
    v_mfma_f32_32x32x16_bf16 v[32:47], v[80:83], a[128:131], v[32:47]
    v_cvt_pk_bf16_f32 v57, v58, v59
    ds_read_b128 v[80:83], v8 offset:8192
    s_waitcnt lgkmcnt(3)
    v_mfma_f32_32x32x16_bf16 v[16:31], v[84:87], a[20:23], v[16:31]
    v_cvt_pk_bf16_f32 v58, v60, v61
    v_mfma_f32_32x32x16_bf16 v[32:47], v[84:87], a[132:135], v[32:47]
    v_cvt_pk_bf16_f32 v59, v62, v63
    ds_read_b128 v[84:87], v8 offset:9216
    s_waitcnt lgkmcnt(3)
    v_mfma_f32_32x32x16_bf16 v[16:31], v[88:91], a[24:27], v[16:31]
    buffer_store_dwordx4 v[56:59], v5, s[8:11], s29 offen offset:512 sc1
    v_mfma_f32_32x32x16_bf16 v[32:47], v[88:91], a[136:139], v[32:47]
    v_cvt_pk_bf16_f32 v64, v64, v65
    ds_read_b128 v[88:91], v8 offset:10240
    s_waitcnt lgkmcnt(3)
    v_mfma_f32_32x32x16_bf16 v[16:31], v[92:95], a[28:31], v[16:31]
    v_cvt_pk_bf16_f32 v65, v66, v67
    v_mfma_f32_32x32x16_bf16 v[32:47], v[92:95], a[140:143], v[32:47]
    v_cvt_pk_bf16_f32 v66, v68, v69
    ds_read_b128 v[92:95], v8 offset:11264
    s_waitcnt lgkmcnt(3)
    v_mfma_f32_32x32x16_bf16 v[16:31], v[80:83], a[32:35], v[16:31]
    v_cvt_pk_bf16_f32 v67, v70, v71
    v_mfma_f32_32x32x16_bf16 v[32:47], v[80:83], a[144:147], v[32:47]
    buffer_store_dwordx4 v[64:67], v5, s[8:11], s26 offen offset:0 sc1
    ds_read_b128 v[80:83], v8 offset:12288
    s_waitcnt lgkmcnt(3)
    v_mfma_f32_32x32x16_bf16 v[16:31], v[84:87], a[36:39], v[16:31]
    v_cvt_pk_bf16_f32 v72, v72, v73
    v_mfma_f32_32x32x16_bf16 v[32:47], v[84:87], a[148:151], v[32:47]
    v_cvt_pk_bf16_f32 v73, v74, v75
    ds_read_b128 v[84:87], v8 offset:13312
    s_waitcnt lgkmcnt(3)
    v_mfma_f32_32x32x16_bf16 v[16:31], v[88:91], a[40:43], v[16:31]
    v_cvt_pk_bf16_f32 v74, v76, v77
    v_mfma_f32_32x32x16_bf16 v[32:47], v[88:91], a[152:155], v[32:47]
    v_cvt_pk_bf16_f32 v75, v78, v79
    ds_read_b128 v[88:91], v8 offset:14336
    s_waitcnt lgkmcnt(3)
    v_mfma_f32_32x32x16_bf16 v[16:31], v[92:95], a[44:47], v[16:31]
    buffer_store_dwordx4 v[72:75], v5, s[8:11], s26 offen offset:512 sc1
    v_mfma_f32_32x32x16_bf16 v[32:47], v[92:95], a[156:159], v[32:47]
    s_add_u32 s29, s29, 1835008
    ds_read_b128 v[92:95], v8 offset:15360
    s_waitcnt lgkmcnt(3)
    v_mfma_f32_32x32x16_bf16 v[16:31], v[80:83], a[48:51], v[16:31]
    v_mfma_f32_32x32x16_bf16 v[32:47], v[80:83], a[160:163], v[32:47]
    ds_read_b128 v[80:83], v8 offset:16384
    s_waitcnt lgkmcnt(3)
    v_mfma_f32_32x32x16_bf16 v[16:31], v[84:87], a[52:55], v[16:31]
    v_mfma_f32_32x32x16_bf16 v[32:47], v[84:87], a[164:167], v[32:47]
    ds_read_b128 v[84:87], v8 offset:17408
    s_waitcnt lgkmcnt(3)
    v_mfma_f32_32x32x16_bf16 v[16:31], v[88:91], a[56:59], v[16:31]
    v_mfma_f32_32x32x16_bf16 v[32:47], v[88:91], a[168:171], v[32:47]
    ds_read_b128 v[88:91], v8 offset:18432
    s_waitcnt lgkmcnt(3)
    v_mfma_f32_32x32x16_bf16 v[16:31], v[92:95], a[60:63], v[16:31]
    v_mfma_f32_32x32x16_bf16 v[32:47], v[92:95], a[172:175], v[32:47]
    ds_read_b128 v[92:95], v8 offset:19456
    s_waitcnt lgkmcnt(3)
    v_mfma_f32_32x32x16_bf16 v[16:31], v[80:83], a[64:67], v[16:31]
    v_mfma_f32_32x32x16_bf16 v[32:47], v[80:83], a[176:179], v[32:47]
    ds_read_b128 v[80:83], v8 offset:20480
    s_waitcnt lgkmcnt(3)
    v_mfma_f32_32x32x16_bf16 v[16:31], v[84:87], a[68:71], v[16:31]
    v_mfma_f32_32x32x16_bf16 v[32:47], v[84:87], a[180:183], v[32:47]
    ds_read_b128 v[84:87], v8 offset:21504
    s_waitcnt lgkmcnt(3)
    v_mfma_f32_32x32x16_bf16 v[16:31], v[88:91], a[72:75], v[16:31]
    v_mfma_f32_32x32x16_bf16 v[32:47], v[88:91], a[184:187], v[32:47]
    ds_read_b128 v[88:91], v8 offset:22528
    s_waitcnt lgkmcnt(3)
    v_mfma_f32_32x32x16_bf16 v[16:31], v[92:95], a[76:79], v[16:31]
    v_mfma_f32_32x32x16_bf16 v[32:47], v[92:95], a[188:191], v[32:47]
    ds_read_b128 v[92:95], v8 offset:23552
    s_waitcnt lgkmcnt(3)
    v_mfma_f32_32x32x16_bf16 v[16:31], v[80:83], a[80:83], v[16:31]
    v_mfma_f32_32x32x16_bf16 v[32:47], v[80:83], a[192:195], v[32:47]
    ds_read_b128 v[80:83], v8 offset:24576
    s_waitcnt lgkmcnt(3)
    v_mfma_f32_32x32x16_bf16 v[16:31], v[84:87], a[84:87], v[16:31]
    v_mfma_f32_32x32x16_bf16 v[32:47], v[84:87], a[196:199], v[32:47]
    ds_read_b128 v[84:87], v8 offset:25600
    s_waitcnt lgkmcnt(3)
    v_mfma_f32_32x32x16_bf16 v[16:31], v[88:91], a[88:91], v[16:31]
    v_mfma_f32_32x32x16_bf16 v[32:47], v[88:91], a[200:203], v[32:47]
    ds_read_b128 v[88:91], v8 offset:26624
    s_waitcnt lgkmcnt(3)
    v_mfma_f32_32x32x16_bf16 v[16:31], v[92:95], a[92:95], v[16:31]
    v_mfma_f32_32x32x16_bf16 v[32:47], v[92:95], a[204:207], v[32:47]
    ds_read_b128 v[92:95], v8 offset:27648
    s_waitcnt lgkmcnt(3)
    v_mfma_f32_32x32x16_bf16 v[16:31], v[80:83], a[96:99], v[16:31]
    v_mfma_f32_32x32x16_bf16 v[32:47], v[80:83], a[208:211], v[32:47]
    s_waitcnt lgkmcnt(2)
    v_mfma_f32_32x32x16_bf16 v[16:31], v[84:87], a[100:103], v[16:31]
    v_mfma_f32_32x32x16_bf16 v[32:47], v[84:87], a[212:215], v[32:47]
    s_waitcnt lgkmcnt(1)
    v_mfma_f32_32x32x16_bf16 v[16:31], v[88:91], a[104:107], v[16:31]
    v_mfma_f32_32x32x16_bf16 v[32:47], v[88:91], a[216:219], v[32:47]
    s_waitcnt lgkmcnt(0)
    v_mfma_f32_32x32x16_bf16 v[16:31], v[92:95], a[108:111], v[16:31]
    v_mfma_f32_32x32x16_bf16 v[32:47], v[92:95], a[220:223], v[32:47]
    s_waitcnt vmcnt(15)
H_u_mid:
    s_barrier
    s_add_u32 s31, s31, 1
    s_cmp_lt_u32 s31, 5
    s_cbranch_scc1 H_n3_9
    s_cmp_lg_u32 s20, 0
    s_cbranch_scc1 H_nf_10
    s_mov_b64 exec, 0xff
    buffer_store_dwordx4 v[96:99], v2, s[8:11], s30 offen sc1
    s_mov_b64 exec, -1
H_nf_10:
    s_add_u32 s30, s30, 45056
H_n3_9:
    s_cmp_lg_u32 s31, 11
    s_cbranch_scc1 H_nw_11
    s_cmp_ge_u32 s22, 28
    s_cbranch_scc1 H_nw_11
    s_load_dwordx2 s[56:57], s[0:1], 64
    s_load_dwordx2 s[58:59], s[0:1], 80
    v_lshlrev_b32 v9, 7, v0
    s_mul_i32 s24, s22, 57344
    v_add_u32 v9, s24, v9
    s_waitcnt lgkmcnt(0)
    v_add_u32 v10, 24576, v9
    global_load_dword v11, v9, s[56:57]
    global_load_dword v11, v10, s[56:57]
    global_load_dword v11, v9, s[58:59]
    global_load_dword v11, v10, s[58:59]
H_nw_11:
    s_mul_i32 s24, s20, 7168
    s_add_u32 s24, s24, s34
    s_add_u32 s25, s28, 4096
    s_mov_b32 m0, s24
    s_add_u32 s24, s24, 4096
    buffer_load_dwordx4 v2, s[8:11], s28 offen offset:0 lds
    buffer_load_dwordx4 v2, s[8:11], s28 offen offset:1024 lds
    buffer_load_dwordx4 v2, s[8:11], s28 offen offset:2048 lds
    buffer_load_dwordx4 v2, s[8:11], s28 offen offset:3072 lds
    s_mov_b32 m0, s24
    s_add_u32 s24, s24, 4096
    buffer_load_dwordx4 v2, s[8:11], s25 offen offset:0 lds
    buffer_load_dwordx4 v2, s[8:11], s25 offen offset:1024 lds
    buffer_load_dwordx4 v2, s[8:11], s25 offen offset:2048 lds
    s_add_u32 s28, s28, 114688
    s_add_u32 s34, s34, 28672
    s_cmp_eq_u32 s34, 86016
    s_cselect_b32 s34, 0, s34
    v_add_u32 v8, s35, v2
    s_add_u32 s35, s35, 28672
    s_cmp_eq_u32 s35, 86016
    s_cselect_b32 s35, 0, s35
    ds_read_b128 v[80:83], v8 offset:0
    ds_read_b128 v[84:87], v8 offset:1024
    ds_read_b128 v[88:91], v8 offset:2048
    ds_read_b128 v[92:95], v8 offset:3072
    s_waitcnt lgkmcnt(3)
    v_mfma_f32_32x32x16_bf16 v[48:63], v[80:83], a[0:3], 0
    v_mfma_f32_32x32x16_bf16 v[64:79], v[80:83], a[112:115], 0
    ds_read_b128 v[80:83], v8 offset:4096
    s_waitcnt lgkmcnt(3)
    v_mfma_f32_32x32x16_bf16 v[48:63], v[84:87], a[4:7], v[48:63]
    s_add_u32 s26, s29, 1024
    v_mfma_f32_32x32x16_bf16 v[64:79], v[84:87], a[116:119], v[64:79]
    v_cvt_pk_bf16_f32 v16, v16, v17
    ds_read_b128 v[84:87], v8 offset:5120
    s_waitcnt lgkmcnt(3)
    v_mfma_f32_32x32x16_bf16 v[48:63], v[88:91], a[8:11], v[48:63]
    v_cvt_pk_bf16_f32 v17, v18, v19
    v_mfma_f32_32x32x16_bf16 v[64:79], v[88:91], a[120:123], v[64:79]
    v_cvt_pk_bf16_f32 v18, v20, v21
    ds_read_b128 v[88:91], v8 offset:6144
    s_waitcnt lgkmcnt(3)
    v_mfma_f32_32x32x16_bf16 v[48:63], v[92:95], a[12:15], v[48:63]
    v_cvt_pk_bf16_f32 v19, v22, v23
    v_mfma_f32_32x32x16_bf16 v[64:79], v[92:95], a[124:127], v[64:79]
    buffer_store_dwordx4 v[16:19], v5, s[8:11], s29 offen offset:0 sc1
    ds_read_b128 v[92:95], v8 offset:7168
    s_waitcnt lgkmcnt(3)
    v_mfma_f32_32x32x16_bf16 v[48:63], v[80:83], a[16:19], v[48:63]
    v_cvt_pk_bf16_f32 v24, v24, v25
    v_mfma_f32_32x32x16_bf16 v[64:79], v[80:83], a[128:131], v[64:79]
    v_cvt_pk_bf16_f32 v25, v26, v27
    ds_read_b128 v[80:83], v8 offset:8192
    s_waitcnt lgkmcnt(3)
    v_mfma_f32_32x32x16_bf16 v[48:63], v[84:87], a[20:23], v[48:63]
    v_cvt_pk_bf16_f32 v26, v28, v29
    v_mfma_f32_32x32x16_bf16 v[64:79], v[84:87], a[132:135], v[64:79]
    v_cvt_pk_bf16_f32 v27, v30, v31
    ds_read_b128 v[84:87], v8 offset:9216
    s_waitcnt lgkmcnt(3)
    v_mfma_f32_32x32x16_bf16 v[48:63], v[88:91], a[24:27], v[48:63]
    buffer_store_dwordx4 v[24:27], v5, s[8:11], s29 offen offset:512 sc1
    v_mfma_f32_32x32x16_bf16 v[64:79], v[88:91], a[136:139], v[64:79]
    v_cvt_pk_bf16_f32 v32, v32, v33
    ds_read_b128 v[88:91], v8 offset:10240
    s_waitcnt lgkmcnt(3)
    v_mfma_f32_32x32x16_bf16 v[48:63], v[92:95], a[28:31], v[48:63]
    v_cvt_pk_bf16_f32 v33, v34, v35
    v_mfma_f32_32x32x16_bf16 v[64:79], v[92:95], a[140:143], v[64:79]
    v_cvt_pk_bf16_f32 v34, v36, v37
    ds_read_b128 v[92:95], v8 offset:11264
    s_waitcnt lgkmcnt(3)
    v_mfma_f32_32x32x16_bf16 v[48:63], v[80:83], a[32:35], v[48:63]
    v_cvt_pk_bf16_f32 v35, v38, v39
    v_mfma_f32_32x32x16_bf16 v[64:79], v[80:83], a[144:147], v[64:79]
    buffer_store_dwordx4 v[32:35], v5, s[8:11], s26 offen offset:0 sc1
    ds_read_b128 v[80:83], v8 offset:12288
    s_waitcnt lgkmcnt(3)
    v_mfma_f32_32x32x16_bf16 v[48:63], v[84:87], a[36:39], v[48:63]
    v_cvt_pk_bf16_f32 v40, v40, v41
    v_mfma_f32_32x32x16_bf16 v[64:79], v[84:87], a[148:151], v[64:79]
    v_cvt_pk_bf16_f32 v41, v42, v43
    ds_read_b128 v[84:87], v8 offset:13312
    s_waitcnt lgkmcnt(3)
    v_mfma_f32_32x32x16_bf16 v[48:63], v[88:91], a[40:43], v[48:63]
    v_cvt_pk_bf16_f32 v42, v44, v45
    v_mfma_f32_32x32x16_bf16 v[64:79], v[88:91], a[152:155], v[64:79]
    v_cvt_pk_bf16_f32 v43, v46, v47
    ds_read_b128 v[88:91], v8 offset:14336
    s_waitcnt lgkmcnt(3)
    v_mfma_f32_32x32x16_bf16 v[48:63], v[92:95], a[44:47], v[48:63]
    buffer_store_dwordx4 v[40:43], v5, s[8:11], s26 offen offset:512 sc1
    v_mfma_f32_32x32x16_bf16 v[64:79], v[92:95], a[156:159], v[64:79]
    s_add_u32 s29, s29, 1835008
    ds_read_b128 v[92:95], v8 offset:15360
    s_waitcnt lgkmcnt(3)
    v_mfma_f32_32x32x16_bf16 v[48:63], v[80:83], a[48:51], v[48:63]
    v_mfma_f32_32x32x16_bf16 v[64:79], v[80:83], a[160:163], v[64:79]
    ds_read_b128 v[80:83], v8 offset:16384
    s_waitcnt lgkmcnt(3)
    v_mfma_f32_32x32x16_bf16 v[48:63], v[84:87], a[52:55], v[48:63]
    v_mfma_f32_32x32x16_bf16 v[64:79], v[84:87], a[164:167], v[64:79]
    ds_read_b128 v[84:87], v8 offset:17408
    s_waitcnt lgkmcnt(3)
    v_mfma_f32_32x32x16_bf16 v[48:63], v[88:91], a[56:59], v[48:63]
    v_mfma_f32_32x32x16_bf16 v[64:79], v[88:91], a[168:171], v[64:79]
    ds_read_b128 v[88:91], v8 offset:18432
    s_waitcnt lgkmcnt(3)
    v_mfma_f32_32x32x16_bf16 v[48:63], v[92:95], a[60:63], v[48:63]
    v_mfma_f32_32x32x16_bf16 v[64:79], v[92:95], a[172:175], v[64:79]
    ds_read_b128 v[92:95], v8 offset:19456
    s_waitcnt lgkmcnt(3)
    v_mfma_f32_32x32x16_bf16 v[48:63], v[80:83], a[64:67], v[48:63]
    v_mfma_f32_32x32x16_bf16 v[64:79], v[80:83], a[176:179], v[64:79]
    ds_read_b128 v[80:83], v8 offset:20480
    s_waitcnt lgkmcnt(3)
    v_mfma_f32_32x32x16_bf16 v[48:63], v[84:87], a[68:71], v[48:63]
    v_mfma_f32_32x32x16_bf16 v[64:79], v[84:87], a[180:183], v[64:79]
    ds_read_b128 v[84:87], v8 offset:21504
    s_waitcnt lgkmcnt(3)
    v_mfma_f32_32x32x16_bf16 v[48:63], v[88:91], a[72:75], v[48:63]
    v_mfma_f32_32x32x16_bf16 v[64:79], v[88:91], a[184:187], v[64:79]
    ds_read_b128 v[88:91], v8 offset:22528
    s_waitcnt lgkmcnt(3)
    v_mfma_f32_32x32x16_bf16 v[48:63], v[92:95], a[76:79], v[48:63]
    v_mfma_f32_32x32x16_bf16 v[64:79], v[92:95], a[188:191], v[64:79]
    ds_read_b128 v[92:95], v8 offset:23552
    s_waitcnt lgkmcnt(3)
    v_mfma_f32_32x32x16_bf16 v[48:63], v[80:83], a[80:83], v[48:63]
    v_mfma_f32_32x32x16_bf16 v[64:79], v[80:83], a[192:195], v[64:79]
    ds_read_b128 v[80:83], v8 offset:24576
    s_waitcnt lgkmcnt(3)
    v_mfma_f32_32x32x16_bf16 v[48:63], v[84:87], a[84:87], v[48:63]
    v_mfma_f32_32x32x16_bf16 v[64:79], v[84:87], a[196:199], v[64:79]
    ds_read_b128 v[84:87], v8 offset:25600
    s_waitcnt lgkmcnt(3)
    v_mfma_f32_32x32x16_bf16 v[48:63], v[88:91], a[88:91], v[48:63]
    v_mfma_f32_32x32x16_bf16 v[64:79], v[88:91], a[200:203], v[64:79]
    ds_read_b128 v[88:91], v8 offset:26624
    s_waitcnt lgkmcnt(3)
    v_mfma_f32_32x32x16_bf16 v[48:63], v[92:95], a[92:95], v[48:63]
    v_mfma_f32_32x32x16_bf16 v[64:79], v[92:95], a[204:207], v[64:79]
    ds_read_b128 v[92:95], v8 offset:27648
    s_waitcnt lgkmcnt(3)
    v_mfma_f32_32x32x16_bf16 v[48:63], v[80:83], a[96:99], v[48:63]
    v_mfma_f32_32x32x16_bf16 v[64:79], v[80:83], a[208:211], v[64:79]
    s_waitcnt lgkmcnt(2)
    v_mfma_f32_32x32x16_bf16 v[48:63], v[84:87], a[100:103], v[48:63]
    v_mfma_f32_32x32x16_bf16 v[64:79], v[84:87], a[212:215], v[64:79]
    s_waitcnt lgkmcnt(1)
    v_mfma_f32_32x32x16_bf16 v[48:63], v[88:91], a[104:107], v[48:63]
    v_mfma_f32_32x32x16_bf16 v[64:79], v[88:91], a[216:219], v[64:79]
    s_waitcnt lgkmcnt(0)
    v_mfma_f32_32x32x16_bf16 v[48:63], v[92:95], a[108:111], v[48:63]
    v_mfma_f32_32x32x16_bf16 v[64:79], v[92:95], a[220:223], v[64:79]
    s_branch H_u_loop
H_u_end:
    s_add_u32 s26, s29, 1024
    v_cvt_pk_bf16_f32 v48, v48, v49
    v_cvt_pk_bf16_f32 v49, v50, v51
    v_cvt_pk_bf16_f32 v50, v52, v53
    v_cvt_pk_bf16_f32 v51, v54, v55
    buffer_store_dwordx4 v[48:51], v5, s[8:11], s29 offen offset:0 sc1
    v_cvt_pk_bf16_f32 v56, v56, v57
    v_cvt_pk_bf16_f32 v57, v58, v59
    v_cvt_pk_bf16_f32 v58, v60, v61
    v_cvt_pk_bf16_f32 v59, v62, v63
    buffer_store_dwordx4 v[56:59], v5, s[8:11], s29 offen offset:512 sc1
    v_cvt_pk_bf16_f32 v64, v64, v65
    v_cvt_pk_bf16_f32 v65, v66, v67
    v_cvt_pk_bf16_f32 v66, v68, v69
    v_cvt_pk_bf16_f32 v67, v70, v71
    buffer_store_dwordx4 v[64:67], v5, s[8:11], s26 offen offset:0 sc1
    v_cvt_pk_bf16_f32 v72, v72, v73
    v_cvt_pk_bf16_f32 v73, v74, v75
    v_cvt_pk_bf16_f32 v74, v76, v77
    v_cvt_pk_bf16_f32 v75, v78, v79
    buffer_store_dwordx4 v[72:75], v5, s[8:11], s26 offen offset:512 sc1
    s_add_u32 s29, s29, 1835008
    s_waitcnt vmcnt(0)
    s_barrier
    s_cmp_lg_u32 s20, 0
    s_cbranch_scc1 H_nf_12
    s_mov_b64 exec, 0xff
    buffer_store_dwordx4 v[96:99], v2, s[8:11], s30 offen sc1
    s_mov_b64 exec, -1
H_nf_12:
    s_add_u32 s30, s30, 45056
    s_cmp_lg_u32 s20, 0
    s_cbranch_scc1 H_nf_13
    s_mov_b64 exec, 0xff
    buffer_store_dwordx4 v[96:99], v2, s[8:11], s30 offen sc1
    s_mov_b64 exec, -1
H_nf_13:
    s_add_u32 s30, s30, 45056
    s_cmp_lg_u32 s20, 0
    s_cbranch_scc1 H_nf_14
    s_mov_b64 exec, 0xff
    buffer_store_dwordx4 v[96:99], v2, s[8:11], s30 offen sc1
    s_mov_b64 exec, -1
H_nf_14:
    s_add_u32 s30, s30, 45056
    s_branch H_trail
H_t:
    v_bfe_u32 v4, v1, 5, 1
    v_lshlrev_b32 v4, 8, v4
    v_bfe_u32 v6, v1, 3, 1
    v_lshl_add_u32 v4, v6, 7, v4
    v_bfe_u32 v6, v1, 1, 1
    v_lshl_add_u32 v4, v6, 6, v4
    v_bfe_u32 v6, v1, 2, 1
    v_lshl_add_u32 v4, v6, 5, v4
    v_bfe_u32 v6, v1, 0, 1
    v_lshl_add_u32 v4, v6, 4, v4
    v_bfe_u32 v6, v1, 4, 1
    v_mul_u32_u24 v6, 14336, v6
    v_add_u32 v4, v4, v6
    v_mov_b32 v5, v2
    s_mul_i32 s24, s33, 196
    s_mul_i32 s25, s26, 14
    s_add_u32 s24, s24, s25
    s_lshl_b32 s24, s24, 11
    s_mul_i32 s29, s27, 458752
    s_lshl_b32 s25, s26, 11
    s_add_u32 s29, s29, s25
    s_mul_i32 s25, s33, 28672
    s_add_u32 s29, s29, s25
    s_add_u32 s29, s29, 56198144
    s_add_u32 s30, s30, 3584
    s_and_b32 s25, s33, 8
    s_mul_i32 s25, s25, 7
    s_lshr_b32 s3, s26, 1
    s_add_u32 s25, s25, s3
    v_min_u32 v60, 7, v1
    v_mul_u32_u24 v60, 896, v60
    s_lshl_b32 s3, s25, 7
    s_add_u32 s3, s3, 46833664
    s_mov_b32 s47, 200000
H_t_nw:
    buffer_load_dwordx2 v[62:63], v60, s[8:11], s3 offen sc1
    s_waitcnt vmcnt(0)
    v_xor_b32 v62, s96, v62
    v_xor_b32 v63, s97, v63
    v_or_b32 v62, v62, v63
    v_cmp_ne_u32 vcc, 0, v62
    s_cbranch_vccz H_t_nw_ok
    s_sub_u32 s47, s47, 1
    s_cbranch_scc0 H_t_nw
    s_branch L_fail
H_t_nw_ok:
    buffer_load_dwordx4 a[0:3], v4, s[8:11], s24 offen offset:0
    buffer_load_dwordx4 a[4:7], v4, s[8:11], s24 offen offset:512
    buffer_load_dwordx4 a[8:11], v4, s[8:11], s24 offen offset:1024
    buffer_load_dwordx4 a[12:15], v4, s[8:11], s24 offen offset:1536
    buffer_load_dwordx4 a[16:19], v4, s[8:11], s24 offen offset:2048
    buffer_load_dwordx4 a[20:23], v4, s[8:11], s24 offen offset:2560
    buffer_load_dwordx4 a[24:27], v4, s[8:11], s24 offen offset:3072
    buffer_load_dwordx4 a[28:31], v4, s[8:11], s24 offen offset:3584
    s_add_u32 s24, s24, 4096
    buffer_load_dwordx4 a[32:35], v4, s[8:11], s24 offen offset:0
    buffer_load_dwordx4 a[36:39], v4, s[8:11], s24 offen offset:512
    buffer_load_dwordx4 a[40:43], v4, s[8:11], s24 offen offset:1024
    buffer_load_dwordx4 a[44:47], v4, s[8:11], s24 offen offset:1536
    buffer_load_dwordx4 a[48:51], v4, s[8:11], s24 offen offset:2048
    buffer_load_dwordx4 a[52:55], v4, s[8:11], s24 offen offset:2560
    buffer_load_dwordx4 a[56:59], v4, s[8:11], s24 offen offset:3072
    buffer_load_dwordx4 a[60:63], v4, s[8:11], s24 offen offset:3584
    s_add_u32 s24, s24, 4096
    buffer_load_dwordx4 a[64:67], v4, s[8:11], s24 offen offset:0
    buffer_load_dwordx4 a[68:71], v4, s[8:11], s24 offen offset:512
    buffer_load_dwordx4 a[72:75], v4, s[8:11], s24 offen offset:1024
    buffer_load_dwordx4 a[76:79], v4, s[8:11], s24 offen offset:1536
    buffer_load_dwordx4 a[80:83], v4, s[8:11], s24 offen offset:2048
    buffer_load_dwordx4 a[84:87], v4, s[8:11], s24 offen offset:2560
    buffer_load_dwordx4 a[88:91], v4, s[8:11], s24 offen offset:3072
    buffer_load_dwordx4 a[92:95], v4, s[8:11], s24 offen offset:3584
    s_add_u32 s24, s24, 4096
    buffer_load_dwordx4 a[96:99], v4, s[8:11], s24 offen offset:0
    buffer_load_dwordx4 a[100:103], v4, s[8:11], s24 offen offset:512
    buffer_load_dwordx4 a[104:107], v4, s[8:11], s24 offen offset:1024
    buffer_load_dwordx4 a[108:111], v4, s[8:11], s24 offen offset:1536
    s_add_u32 s24, s24, 389120
    buffer_load_dwordx4 a[112:115], v4, s[8:11], s24 offen offset:0
    buffer_load_dwordx4 a[116:119], v4, s[8:11], s24 offen offset:512
    buffer_load_dwordx4 a[120:123], v4, s[8:11], s24 offen offset:1024
    buffer_load_dwordx4 a[124:127], v4, s[8:11], s24 offen offset:1536
    buffer_load_dwordx4 a[128:131], v4, s[8:11], s24 offen offset:2048
    buffer_load_dwordx4 a[132:135], v4, s[8:11], s24 offen offset:2560
    buffer_load_dwordx4 a[136:139], v4, s[8:11], s24 offen offset:3072
    buffer_load_dwordx4 a[140:143], v4, s[8:11], s24 offen offset:3584
    s_add_u32 s24, s24, 4096
    buffer_load_dwordx4 a[144:147], v4, s[8:11], s24 offen offset:0
    buffer_load_dwordx4 a[148:151], v4, s[8:11], s24 offen offset:512
    buffer_load_dwordx4 a[152:155], v4, s[8:11], s24 offen offset:1024
    buffer_load_dwordx4 a[156:159], v4, s[8:11], s24 offen offset:1536
    buffer_load_dwordx4 a[160:163], v4, s[8:11], s24 offen offset:2048
    buffer_load_dwordx4 a[164:167], v4, s[8:11], s24 offen offset:2560
    buffer_load_dwordx4 a[168:171], v4, s[8:11], s24 offen offset:3072
    buffer_load_dwordx4 a[172:175], v4, s[8:11], s24 offen offset:3584
    s_add_u32 s24, s24, 4096
    buffer_load_dwordx4 a[176:179], v4, s[8:11], s24 offen offset:0
    buffer_load_dwordx4 a[180:183], v4, s[8:11], s24 offen offset:512
    buffer_load_dwordx4 a[184:187], v4, s[8:11], s24 offen offset:1024
    buffer_load_dwordx4 a[188:191], v4, s[8:11], s24 offen offset:1536
    buffer_load_dwordx4 a[192:195], v4, s[8:11], s24 offen offset:2048
    buffer_load_dwordx4 a[196:199], v4, s[8:11], s24 offen offset:2560
    buffer_load_dwordx4 a[200:203], v4, s[8:11], s24 offen offset:3072
    buffer_load_dwordx4 a[204:207], v4, s[8:11], s24 offen offset:3584
    s_add_u32 s24, s24, 4096
    buffer_load_dwordx4 a[208:211], v4, s[8:11], s24 offen offset:0
    buffer_load_dwordx4 a[212:215], v4, s[8:11], s24 offen offset:512
    buffer_load_dwordx4 a[216:219], v4, s[8:11], s24 offen offset:1024
    buffer_load_dwordx4 a[220:223], v4, s[8:11], s24 offen offset:1536
    s_add_u32 s24, s24, 389120
    s_mov_b32 s46, 0
    v_min_u32 v60, 63, v1
    v_mul_u32_u24 v60, 128, v60
    s_lshl_b32 s3, s46, 7
    s_add_u32 s3, s3, 46833664
    s_mov_b32 s47, 200000
H_t_na0:
    buffer_load_dwordx2 v[62:63], v60, s[8:11], s3 offen sc1
    s_waitcnt vmcnt(0)
    v_xor_b32 v62, s96, v62
    v_xor_b32 v63, s97, v63
    v_or_b32 v62, v62, v63
    v_cmp_ne_u32 vcc, 0, v62
    s_cbranch_vccz H_t_na0_ok
    s_sub_u32 s47, s47, 1
    s_cbranch_scc0 H_t_na0
    s_branch L_fail
H_t_na0_ok:
    s_mov_b32 s46, 64
    v_min_u32 v60, 63, v1
    v_mul_u32_u24 v60, 128, v60
    s_lshl_b32 s3, s46, 7
    s_add_u32 s3, s3, 46833664
    s_mov_b32 s47, 200000
H_t_na1:
    buffer_load_dwordx2 v[62:63], v60, s[8:11], s3 offen sc1
    s_waitcnt vmcnt(0)
    v_xor_b32 v62, s96, v62
    v_xor_b32 v63, s97, v63
    v_or_b32 v62, v62, v63
    v_cmp_ne_u32 vcc, 0, v62
    s_cbranch_vccz H_t_na1_ok
    s_sub_u32 s47, s47, 1
    s_cbranch_scc0 H_t_na1
    s_branch L_fail
H_t_na1_ok:
    s_mov_b32 s46, 128
    v_min_u32 v60, 63, v1
    v_mul_u32_u24 v60, 128, v60
    s_lshl_b32 s3, s46, 7
    s_add_u32 s3, s3, 46833664
    s_mov_b32 s47, 200000
H_t_na2:
    buffer_load_dwordx2 v[62:63], v60, s[8:11], s3 offen sc1
    s_waitcnt vmcnt(0)
    v_xor_b32 v62, s96, v62
    v_xor_b32 v63, s97, v63
    v_or_b32 v62, v62, v63
    v_cmp_ne_u32 vcc, 0, v62
    s_cbranch_vccz H_t_na2_ok
    s_sub_u32 s47, s47, 1
    s_cbranch_scc0 H_t_na2
    s_branch L_fail
H_t_na2_ok:
    s_mov_b32 s46, 192
    v_min_u32 v60, 63, v1
    v_mul_u32_u24 v60, 128, v60
    s_lshl_b32 s3, s46, 7
    s_add_u32 s3, s3, 46833664
    s_mov_b32 s47, 200000
H_t_na3:
    buffer_load_dwordx2 v[62:63], v60, s[8:11], s3 offen sc1
    s_waitcnt vmcnt(0)
    v_xor_b32 v62, s96, v62
    v_xor_b32 v63, s97, v63
    v_or_b32 v62, v62, v63
    v_cmp_ne_u32 vcc, 0, v62
    s_cbranch_vccz H_t_na3_ok
    s_sub_u32 s47, s47, 1
    s_cbranch_scc0 H_t_na3
    s_branch L_fail
H_t_na3_ok:
    s_mov_b32 s46, 256
    v_min_u32 v60, 63, v1
    v_mul_u32_u24 v60, 128, v60
    s_lshl_b32 s3, s46, 7
    s_add_u32 s3, s3, 46833664
    s_mov_b32 s47, 200000
H_t_na4:
    buffer_load_dwordx2 v[62:63], v60, s[8:11], s3 offen sc1
    s_waitcnt vmcnt(0)
    v_xor_b32 v62, s96, v62
    v_xor_b32 v63, s97, v63
    v_or_b32 v62, v62, v63
    v_cmp_ne_u32 vcc, 0, v62
    s_cbranch_vccz H_t_na4_ok
    s_sub_u32 s47, s47, 1
    s_cbranch_scc0 H_t_na4
    s_branch L_fail
H_t_na4_ok:
    s_mul_i32 s24, s20, 7168
    s_add_u32 s24, s24, s34
    s_add_u32 s25, s28, 4096
    s_mov_b32 m0, s24
    s_add_u32 s24, s24, 4096
    buffer_load_dwordx4 v2, s[8:11], s28 offen offset:0 lds
    buffer_load_dwordx4 v2, s[8:11], s28 offen offset:1024 lds
    buffer_load_dwordx4 v2, s[8:11], s28 offen offset:2048 lds
    buffer_load_dwordx4 v2, s[8:11], s28 offen offset:3072 lds
    s_mov_b32 m0, s24
    s_add_u32 s24, s24, 4096
    buffer_load_dwordx4 v2, s[8:11], s25 offen offset:0 lds
    buffer_load_dwordx4 v2, s[8:11], s25 offen offset:1024 lds
    buffer_load_dwordx4 v2, s[8:11], s25 offen offset:2048 lds
    s_add_u32 s28, s28, 114688
    s_add_u32 s34, s34, 28672
    s_cmp_eq_u32 s34, 86016
    s_cselect_b32 s34, 0, s34
    s_mul_i32 s24, s20, 7168
    s_add_u32 s24, s24, s34
    s_add_u32 s25, s28, 4096
    s_mov_b32 m0, s24
    s_add_u32 s24, s24, 4096
    buffer_load_dwordx4 v2, s[8:11], s28 offen offset:0 lds
    buffer_load_dwordx4 v2, s[8:11], s28 offen offset:1024 lds
    buffer_load_dwordx4 v2, s[8:11], s28 offen offset:2048 lds
    buffer_load_dwordx4 v2, s[8:11], s28 offen offset:3072 lds
    s_mov_b32 m0, s24
    s_add_u32 s24, s24, 4096
    buffer_load_dwordx4 v2, s[8:11], s25 offen offset:0 lds
    buffer_load_dwordx4 v2, s[8:11], s25 offen offset:1024 lds
    buffer_load_dwordx4 v2, s[8:11], s25 offen offset:2048 lds
    s_add_u32 s28, s28, 114688
    s_add_u32 s34, s34, 28672
    s_cmp_eq_u32 s34, 86016
    s_cselect_b32 s34, 0, s34
    s_waitcnt vmcnt(7)
    s_barrier
    s_mul_i32 s24, s20, 7168
    s_add_u32 s24, s24, s34
    s_add_u32 s25, s28, 4096
    s_mov_b32 m0, s24
    s_add_u32 s24, s24, 4096
    buffer_load_dwordx4 v2, s[8:11], s28 offen offset:0 lds
    buffer_load_dwordx4 v2, s[8:11], s28 offen offset:1024 lds
    buffer_load_dwordx4 v2, s[8:11], s28 offen offset:2048 lds
    buffer_load_dwordx4 v2, s[8:11], s28 offen offset:3072 lds
    s_mov_b32 m0, s24
    s_add_u32 s24, s24, 4096
    buffer_load_dwordx4 v2, s[8:11], s25 offen offset:0 lds
    buffer_load_dwordx4 v2, s[8:11], s25 offen offset:1024 lds
    buffer_load_dwordx4 v2, s[8:11], s25 offen offset:2048 lds
    s_add_u32 s28, s28, 114688
    s_add_u32 s34, s34, 28672
    s_cmp_eq_u32 s34, 86016
    s_cselect_b32 s34, 0, s34
    v_add_u32 v8, s35, v2
    s_add_u32 s35, s35, 28672
    s_cmp_eq_u32 s35, 86016
    s_cselect_b32 s35, 0, s35
    ds_read_b128 v[80:83], v8 offset:0
    ds_read_b128 v[84:87], v8 offset:1024
    ds_read_b128 v[88:91], v8 offset:2048
    ds_read_b128 v[92:95], v8 offset:3072
    s_waitcnt lgkmcnt(3)
    v_mfma_f32_32x32x16_bf16 v[16:31], a[0:3], v[80:83], 0
    v_mfma_f32_32x32x16_bf16 v[32:47], a[112:115], v[80:83], 0
    ds_read_b128 v[80:83], v8 offset:4096
    s_waitcnt lgkmcnt(3)
    v_mfma_f32_32x32x16_bf16 v[16:31], a[4:7], v[84:87], v[16:31]
    v_mfma_f32_32x32x16_bf16 v[32:47], a[116:119], v[84:87], v[32:47]
    ds_read_b128 v[84:87], v8 offset:5120
    s_waitcnt lgkmcnt(3)
    v_mfma_f32_32x32x16_bf16 v[16:31], a[8:11], v[88:91], v[16:31]
    v_mfma_f32_32x32x16_bf16 v[32:47], a[120:123], v[88:91], v[32:47]
    ds_read_b128 v[88:91], v8 offset:6144
    s_waitcnt lgkmcnt(3)
    v_mfma_f32_32x32x16_bf16 v[16:31], a[12:15], v[92:95], v[16:31]
    v_mfma_f32_32x32x16_bf16 v[32:47], a[124:127], v[92:95], v[32:47]
    ds_read_b128 v[92:95], v8 offset:7168
    s_waitcnt lgkmcnt(3)
    v_mfma_f32_32x32x16_bf16 v[16:31], a[16:19], v[80:83], v[16:31]
    v_mfma_f32_32x32x16_bf16 v[32:47], a[128:131], v[80:83], v[32:47]
    ds_read_b128 v[80:83], v8 offset:8192
    s_waitcnt lgkmcnt(3)
    v_mfma_f32_32x32x16_bf16 v[16:31], a[20:23], v[84:87], v[16:31]
    v_mfma_f32_32x32x16_bf16 v[32:47], a[132:135], v[84:87], v[32:47]
    ds_read_b128 v[84:87], v8 offset:9216
    s_waitcnt lgkmcnt(3)
    v_mfma_f32_32x32x16_bf16 v[16:31], a[24:27], v[88:91], v[16:31]
    v_mfma_f32_32x32x16_bf16 v[32:47], a[136:139], v[88:91], v[32:47]
    ds_read_b128 v[88:91], v8 offset:10240
    s_waitcnt lgkmcnt(3)
    v_mfma_f32_32x32x16_bf16 v[16:31], a[28:31], v[92:95], v[16:31]
    v_mfma_f32_32x32x16_bf16 v[32:47], a[140:143], v[92:95], v[32:47]
    ds_read_b128 v[92:95], v8 offset:11264
    s_waitcnt lgkmcnt(3)
    v_mfma_f32_32x32x16_bf16 v[16:31], a[32:35], v[80:83], v[16:31]
    v_mfma_f32_32x32x16_bf16 v[32:47], a[144:147], v[80:83], v[32:47]
    ds_read_b128 v[80:83], v8 offset:12288
    s_waitcnt lgkmcnt(3)
    v_mfma_f32_32x32x16_bf16 v[16:31], a[36:39], v[84:87], v[16:31]
    v_mfma_f32_32x32x16_bf16 v[32:47], a[148:151], v[84:87], v[32:47]
    ds_read_b128 v[84:87], v8 offset:13312
    s_waitcnt lgkmcnt(3)
    v_mfma_f32_32x32x16_bf16 v[16:31], a[40:43], v[88:91], v[16:31]
    v_mfma_f32_32x32x16_bf16 v[32:47], a[152:155], v[88:91], v[32:47]
    ds_read_b128 v[88:91], v8 offset:14336
    s_waitcnt lgkmcnt(3)
    v_mfma_f32_32x32x16_bf16 v[16:31], a[44:47], v[92:95], v[16:31]
    v_mfma_f32_32x32x16_bf16 v[32:47], a[156:159], v[92:95], v[32:47]
    ds_read_b128 v[92:95], v8 offset:15360
    s_waitcnt lgkmcnt(3)
    v_mfma_f32_32x32x16_bf16 v[16:31], a[48:51], v[80:83], v[16:31]
    v_mfma_f32_32x32x16_bf16 v[32:47], a[160:163], v[80:83], v[32:47]
    ds_read_b128 v[80:83], v8 offset:16384
    s_waitcnt lgkmcnt(3)
    v_mfma_f32_32x32x16_bf16 v[16:31], a[52:55], v[84:87], v[16:31]
    v_mfma_f32_32x32x16_bf16 v[32:47], a[164:167], v[84:87], v[32:47]
    ds_read_b128 v[84:87], v8 offset:17408
    s_waitcnt lgkmcnt(3)
    v_mfma_f32_32x32x16_bf16 v[16:31], a[56:59], v[88:91], v[16:31]
    v_mfma_f32_32x32x16_bf16 v[32:47], a[168:171], v[88:91], v[32:47]
    ds_read_b128 v[88:91], v8 offset:18432
    s_waitcnt lgkmcnt(3)
    v_mfma_f32_32x32x16_bf16 v[16:31], a[60:63], v[92:95], v[16:31]
    v_mfma_f32_32x32x16_bf16 v[32:47], a[172:175], v[92:95], v[32:47]
    ds_read_b128 v[92:95], v8 offset:19456
    s_waitcnt lgkmcnt(3)
    v_mfma_f32_32x32x16_bf16 v[16:31], a[64:67], v[80:83], v[16:31]
    v_mfma_f32_32x32x16_bf16 v[32:47], a[176:179], v[80:83], v[32:47]
    ds_read_b128 v[80:83], v8 offset:20480
    s_waitcnt lgkmcnt(3)
    v_mfma_f32_32x32x16_bf16 v[16:31], a[68:71], v[84:87], v[16:31]
    v_mfma_f32_32x32x16_bf16 v[32:47], a[180:183], v[84:87], v[32:47]
    ds_read_b128 v[84:87], v8 offset:21504
    s_waitcnt lgkmcnt(3)
    v_mfma_f32_32x32x16_bf16 v[16:31], a[72:75], v[88:91], v[16:31]
    v_mfma_f32_32x32x16_bf16 v[32:47], a[184:187], v[88:91], v[32:47]
    ds_read_b128 v[88:91], v8 offset:22528
    s_waitcnt lgkmcnt(3)
    v_mfma_f32_32x32x16_bf16 v[16:31], a[76:79], v[92:95], v[16:31]
    v_mfma_f32_32x32x16_bf16 v[32:47], a[188:191], v[92:95], v[32:47]
    ds_read_b128 v[92:95], v8 offset:23552
    s_waitcnt lgkmcnt(3)
    v_mfma_f32_32x32x16_bf16 v[16:31], a[80:83], v[80:83], v[16:31]
    v_mfma_f32_32x32x16_bf16 v[32:47], a[192:195], v[80:83], v[32:47]
    ds_read_b128 v[80:83], v8 offset:24576
    s_waitcnt lgkmcnt(3)
    v_mfma_f32_32x32x16_bf16 v[16:31], a[84:87], v[84:87], v[16:31]
    v_mfma_f32_32x32x16_bf16 v[32:47], a[196:199], v[84:87], v[32:47]
    ds_read_b128 v[84:87], v8 offset:25600
    s_waitcnt lgkmcnt(3)
    v_mfma_f32_32x32x16_bf16 v[16:31], a[88:91], v[88:91], v[16:31]
    v_mfma_f32_32x32x16_bf16 v[32:47], a[200:203], v[88:91], v[32:47]
    ds_read_b128 v[88:91], v8 offset:26624
    s_waitcnt lgkmcnt(3)
    v_mfma_f32_32x32x16_bf16 v[16:31], a[92:95], v[92:95], v[16:31]
    v_mfma_f32_32x32x16_bf16 v[32:47], a[204:207], v[92:95], v[32:47]
    ds_read_b128 v[92:95], v8 offset:27648
    s_waitcnt lgkmcnt(3)
    v_mfma_f32_32x32x16_bf16 v[16:31], a[96:99], v[80:83], v[16:31]
    v_mfma_f32_32x32x16_bf16 v[32:47], a[208:211], v[80:83], v[32:47]
    s_waitcnt lgkmcnt(2)
    v_mfma_f32_32x32x16_bf16 v[16:31], a[100:103], v[84:87], v[16:31]
    v_mfma_f32_32x32x16_bf16 v[32:47], a[212:215], v[84:87], v[32:47]
    s_waitcnt lgkmcnt(1)
    v_mfma_f32_32x32x16_bf16 v[16:31], a[104:107], v[88:91], v[16:31]
    v_mfma_f32_32x32x16_bf16 v[32:47], a[216:219], v[88:91], v[32:47]
    s_waitcnt lgkmcnt(0)
    v_mfma_f32_32x32x16_bf16 v[16:31], a[108:111], v[92:95], v[16:31]
    v_mfma_f32_32x32x16_bf16 v[32:47], a[220:223], v[92:95], v[32:47]
    s_nop 7
    s_nop 3
    s_add_u32 s26, s29, 28672
    v_cvt_pk_bf16_f32 v16, v16, v17
    v_cvt_pk_bf16_f32 v17, v18, v19
    v_cvt_pk_bf16_f32 v18, v20, v21
    v_cvt_pk_bf16_f32 v19, v22, v23
    buffer_store_dwordx4 v[16:19], v5, s[8:11], s29 offen offset:0 sc1
    v_cvt_pk_bf16_f32 v24, v24, v25
    v_cvt_pk_bf16_f32 v25, v26, v27
    v_cvt_pk_bf16_f32 v26, v28, v29
    v_cvt_pk_bf16_f32 v27, v30, v31
    buffer_store_dwordx4 v[24:27], v5, s[8:11], s29 offen offset:1024 sc1
    v_cvt_pk_bf16_f32 v32, v32, v33
    v_cvt_pk_bf16_f32 v33, v34, v35
    v_cvt_pk_bf16_f32 v34, v36, v37
    v_cvt_pk_bf16_f32 v35, v38, v39
    buffer_store_dwordx4 v[32:35], v5, s[8:11], s26 offen offset:0 sc1
    v_cvt_pk_bf16_f32 v40, v40, v41
    v_cvt_pk_bf16_f32 v41, v42, v43
    v_cvt_pk_bf16_f32 v42, v44, v45
    v_cvt_pk_bf16_f32 v43, v46, v47
    buffer_store_dwordx4 v[40:43], v5, s[8:11], s26 offen offset:1024 sc1
    s_add_u32 s29, s29, 1835008
    s_waitcnt vmcnt(0)
    s_barrier
    s_cmp_lg_u32 s20, 0
    s_cbranch_scc1 H_nf_15
    s_mov_b64 exec, 0xff
    buffer_store_dwordx4 v[96:99], v2, s[8:11], s30 offen sc1
    s_mov_b64 exec, -1
H_nf_15:
    s_add_u32 s30, s30, 45056
    s_mul_i32 s24, s20, 7168
    s_add_u32 s24, s24, s34
    s_add_u32 s25, s28, 4096
    s_mov_b32 m0, s24
    s_add_u32 s24, s24, 4096
    buffer_load_dwordx4 v2, s[8:11], s28 offen offset:0 lds
    buffer_load_dwordx4 v2, s[8:11], s28 offen offset:1024 lds
    buffer_load_dwordx4 v2, s[8:11], s28 offen offset:2048 lds
    buffer_load_dwordx4 v2, s[8:11], s28 offen offset:3072 lds
    s_mov_b32 m0, s24
    s_add_u32 s24, s24, 4096
    buffer_load_dwordx4 v2, s[8:11], s25 offen offset:0 lds
    buffer_load_dwordx4 v2, s[8:11], s25 offen offset:1024 lds
    buffer_load_dwordx4 v2, s[8:11], s25 offen offset:2048 lds
    s_add_u32 s28, s28, 114688
    s_add_u32 s34, s34, 28672
    s_cmp_eq_u32 s34, 86016
    s_cselect_b32 s34, 0, s34
    v_add_u32 v8, s35, v2
    s_add_u32 s35, s35, 28672
    s_cmp_eq_u32 s35, 86016
    s_cselect_b32 s35, 0, s35
    ds_read_b128 v[80:83], v8 offset:0
    ds_read_b128 v[84:87], v8 offset:1024
    ds_read_b128 v[88:91], v8 offset:2048
    ds_read_b128 v[92:95], v8 offset:3072
    s_waitcnt lgkmcnt(3)
    v_mfma_f32_32x32x16_bf16 v[48:63], a[0:3], v[80:83], 0
    v_mfma_f32_32x32x16_bf16 v[64:79], a[112:115], v[80:83], 0
    ds_read_b128 v[80:83], v8 offset:4096
    s_waitcnt lgkmcnt(3)
    v_mfma_f32_32x32x16_bf16 v[48:63], a[4:7], v[84:87], v[48:63]
    v_mfma_f32_32x32x16_bf16 v[64:79], a[116:119], v[84:87], v[64:79]
    ds_read_b128 v[84:87], v8 offset:5120
    s_waitcnt lgkmcnt(3)
    v_mfma_f32_32x32x16_bf16 v[48:63], a[8:11], v[88:91], v[48:63]
    v_mfma_f32_32x32x16_bf16 v[64:79], a[120:123], v[88:91], v[64:79]
    ds_read_b128 v[88:91], v8 offset:6144
    s_waitcnt lgkmcnt(3)
    v_mfma_f32_32x32x16_bf16 v[48:63], a[12:15], v[92:95], v[48:63]
    v_mfma_f32_32x32x16_bf16 v[64:79], a[124:127], v[92:95], v[64:79]
    ds_read_b128 v[92:95], v8 offset:7168
    s_waitcnt lgkmcnt(3)
    v_mfma_f32_32x32x16_bf16 v[48:63], a[16:19], v[80:83], v[48:63]
    v_mfma_f32_32x32x16_bf16 v[64:79], a[128:131], v[80:83], v[64:79]
    ds_read_b128 v[80:83], v8 offset:8192
    s_waitcnt lgkmcnt(3)
    v_mfma_f32_32x32x16_bf16 v[48:63], a[20:23], v[84:87], v[48:63]
    v_mfma_f32_32x32x16_bf16 v[64:79], a[132:135], v[84:87], v[64:79]
    ds_read_b128 v[84:87], v8 offset:9216
    s_waitcnt lgkmcnt(3)
    v_mfma_f32_32x32x16_bf16 v[48:63], a[24:27], v[88:91], v[48:63]
    v_mfma_f32_32x32x16_bf16 v[64:79], a[136:139], v[88:91], v[64:79]
    ds_read_b128 v[88:91], v8 offset:10240
    s_waitcnt lgkmcnt(3)
    v_mfma_f32_32x32x16_bf16 v[48:63], a[28:31], v[92:95], v[48:63]
    v_mfma_f32_32x32x16_bf16 v[64:79], a[140:143], v[92:95], v[64:79]
    ds_read_b128 v[92:95], v8 offset:11264
    s_waitcnt lgkmcnt(3)
    v_mfma_f32_32x32x16_bf16 v[48:63], a[32:35], v[80:83], v[48:63]
    v_mfma_f32_32x32x16_bf16 v[64:79], a[144:147], v[80:83], v[64:79]
    ds_read_b128 v[80:83], v8 offset:12288
    s_waitcnt lgkmcnt(3)
    v_mfma_f32_32x32x16_bf16 v[48:63], a[36:39], v[84:87], v[48:63]
    v_mfma_f32_32x32x16_bf16 v[64:79], a[148:151], v[84:87], v[64:79]
    ds_read_b128 v[84:87], v8 offset:13312
    s_waitcnt lgkmcnt(3)
    v_mfma_f32_32x32x16_bf16 v[48:63], a[40:43], v[88:91], v[48:63]
    v_mfma_f32_32x32x16_bf16 v[64:79], a[152:155], v[88:91], v[64:79]
    ds_read_b128 v[88:91], v8 offset:14336
    s_waitcnt lgkmcnt(3)
    v_mfma_f32_32x32x16_bf16 v[48:63], a[44:47], v[92:95], v[48:63]
    v_mfma_f32_32x32x16_bf16 v[64:79], a[156:159], v[92:95], v[64:79]
    ds_read_b128 v[92:95], v8 offset:15360
    s_waitcnt lgkmcnt(3)
    v_mfma_f32_32x32x16_bf16 v[48:63], a[48:51], v[80:83], v[48:63]
    v_mfma_f32_32x32x16_bf16 v[64:79], a[160:163], v[80:83], v[64:79]
    ds_read_b128 v[80:83], v8 offset:16384
    s_waitcnt lgkmcnt(3)
    v_mfma_f32_32x32x16_bf16 v[48:63], a[52:55], v[84:87], v[48:63]
    v_mfma_f32_32x32x16_bf16 v[64:79], a[164:167], v[84:87], v[64:79]
    ds_read_b128 v[84:87], v8 offset:17408
    s_waitcnt lgkmcnt(3)
    v_mfma_f32_32x32x16_bf16 v[48:63], a[56:59], v[88:91], v[48:63]
    v_mfma_f32_32x32x16_bf16 v[64:79], a[168:171], v[88:91], v[64:79]
    ds_read_b128 v[88:91], v8 offset:18432
    s_waitcnt lgkmcnt(3)
    v_mfma_f32_32x32x16_bf16 v[48:63], a[60:63], v[92:95], v[48:63]
    v_mfma_f32_32x32x16_bf16 v[64:79], a[172:175], v[92:95], v[64:79]
    ds_read_b128 v[92:95], v8 offset:19456
    s_waitcnt lgkmcnt(3)
    v_mfma_f32_32x32x16_bf16 v[48:63], a[64:67], v[80:83], v[48:63]
    v_mfma_f32_32x32x16_bf16 v[64:79], a[176:179], v[80:83], v[64:79]
    ds_read_b128 v[80:83], v8 offset:20480
    s_waitcnt lgkmcnt(3)
    v_mfma_f32_32x32x16_bf16 v[48:63], a[68:71], v[84:87], v[48:63]
    v_mfma_f32_32x32x16_bf16 v[64:79], a[180:183], v[84:87], v[64:79]
    ds_read_b128 v[84:87], v8 offset:21504
    s_waitcnt lgkmcnt(3)
    v_mfma_f32_32x32x16_bf16 v[48:63], a[72:75], v[88:91], v[48:63]
    v_mfma_f32_32x32x16_bf16 v[64:79], a[184:187], v[88:91], v[64:79]
    ds_read_b128 v[88:91], v8 offset:22528
    s_waitcnt lgkmcnt(3)
    v_mfma_f32_32x32x16_bf16 v[48:63], a[76:79], v[92:95], v[48:63]
    v_mfma_f32_32x32x16_bf16 v[64:79], a[188:191], v[92:95], v[64:79]
    ds_read_b128 v[92:95], v8 offset:23552
    s_waitcnt lgkmcnt(3)
    v_mfma_f32_32x32x16_bf16 v[48:63], a[80:83], v[80:83], v[48:63]
    v_mfma_f32_32x32x16_bf16 v[64:79], a[192:195], v[80:83], v[64:79]
    ds_read_b128 v[80:83], v8 offset:24576
    s_waitcnt lgkmcnt(3)
    v_mfma_f32_32x32x16_bf16 v[48:63], a[84:87], v[84:87], v[48:63]
    v_mfma_f32_32x32x16_bf16 v[64:79], a[196:199], v[84:87], v[64:79]
    ds_read_b128 v[84:87], v8 offset:25600
    s_waitcnt lgkmcnt(3)
    v_mfma_f32_32x32x16_bf16 v[48:63], a[88:91], v[88:91], v[48:63]
    v_mfma_f32_32x32x16_bf16 v[64:79], a[200:203], v[88:91], v[64:79]
    ds_read_b128 v[88:91], v8 offset:26624
    s_waitcnt lgkmcnt(3)
    v_mfma_f32_32x32x16_bf16 v[48:63], a[92:95], v[92:95], v[48:63]
    v_mfma_f32_32x32x16_bf16 v[64:79], a[204:207], v[92:95], v[64:79]
    ds_read_b128 v[92:95], v8 offset:27648
    s_waitcnt lgkmcnt(3)
    v_mfma_f32_32x32x16_bf16 v[48:63], a[96:99], v[80:83], v[48:63]
    v_mfma_f32_32x32x16_bf16 v[64:79], a[208:211], v[80:83], v[64:79]
    s_waitcnt lgkmcnt(2)
    v_mfma_f32_32x32x16_bf16 v[48:63], a[100:103], v[84:87], v[48:63]
    v_mfma_f32_32x32x16_bf16 v[64:79], a[212:215], v[84:87], v[64:79]
    s_waitcnt lgkmcnt(1)
    v_mfma_f32_32x32x16_bf16 v[48:63], a[104:107], v[88:91], v[48:63]
    v_mfma_f32_32x32x16_bf16 v[64:79], a[216:219], v[88:91], v[64:79]
    s_waitcnt lgkmcnt(0)
    v_mfma_f32_32x32x16_bf16 v[48:63], a[108:111], v[92:95], v[48:63]
    v_mfma_f32_32x32x16_bf16 v[64:79], a[220:223], v[92:95], v[64:79]
    s_mov_b32 s31, 2
    s_barrier
    s_mul_i32 s24, s20, 7168
    s_add_u32 s24, s24, s34
    s_add_u32 s25, s28, 4096
    s_mov_b32 m0, s24
    s_add_u32 s24, s24, 4096
    buffer_load_dwordx4 v2, s[8:11], s28 offen offset:0 lds
    buffer_load_dwordx4 v2, s[8:11], s28 offen offset:1024 lds
    buffer_load_dwordx4 v2, s[8:11], s28 offen offset:2048 lds
    buffer_load_dwordx4 v2, s[8:11], s28 offen offset:3072 lds
    s_mov_b32 m0, s24
    s_add_u32 s24, s24, 4096
    buffer_load_dwordx4 v2, s[8:11], s25 offen offset:0 lds
    buffer_load_dwordx4 v2, s[8:11], s25 offen offset:1024 lds
    buffer_load_dwordx4 v2, s[8:11], s25 offen offset:2048 lds
    s_add_u32 s28, s28, 114688
    s_add_u32 s34, s34, 28672
    s_cmp_eq_u32 s34, 86016
    s_cselect_b32 s34, 0, s34
    v_add_u32 v8, s35, v2
    s_add_u32 s35, s35, 28672
    s_cmp_eq_u32 s35, 86016
    s_cselect_b32 s35, 0, s35
    ds_read_b128 v[80:83], v8 offset:0
    ds_read_b128 v[84:87], v8 offset:1024
    ds_read_b128 v[88:91], v8 offset:2048
    ds_read_b128 v[92:95], v8 offset:3072
    s_waitcnt lgkmcnt(3)
    v_mfma_f32_32x32x16_bf16 v[16:31], a[0:3], v[80:83], 0
    v_mfma_f32_32x32x16_bf16 v[32:47], a[112:115], v[80:83], 0
    ds_read_b128 v[80:83], v8 offset:4096
    s_waitcnt lgkmcnt(3)
    v_mfma_f32_32x32x16_bf16 v[16:31], a[4:7], v[84:87], v[16:31]
    s_add_u32 s26, s29, 28672
    v_mfma_f32_32x32x16_bf16 v[32:47], a[116:119], v[84:87], v[32:47]
    v_cvt_pk_bf16_f32 v48, v48, v49
    ds_read_b128 v[84:87], v8 offset:5120
    s_waitcnt lgkmcnt(3)
    v_mfma_f32_32x32x16_bf16 v[16:31], a[8:11], v[88:91], v[16:31]
    v_cvt_pk_bf16_f32 v49, v50, v51
    v_mfma_f32_32x32x16_bf16 v[32:47], a[120:123], v[88:91], v[32:47]
    v_cvt_pk_bf16_f32 v50, v52, v53
    ds_read_b128 v[88:91], v8 offset:6144
    s_waitcnt lgkmcnt(3)
    v_mfma_f32_32x32x16_bf16 v[16:31], a[12:15], v[92:95], v[16:31]
    v_cvt_pk_bf16_f32 v51, v54, v55
    v_mfma_f32_32x32x16_bf16 v[32:47], a[124:127], v[92:95], v[32:47]
    buffer_store_dwordx4 v[48:51], v5, s[8:11], s29 offen offset:0 sc1
    ds_read_b128 v[92:95], v8 offset:7168
    s_waitcnt lgkmcnt(3)
    v_mfma_f32_32x32x16_bf16 v[16:31], a[16:19], v[80:83], v[16:31]
    v_cvt_pk_bf16_f32 v56, v56, v57
    v_mfma_f32_32x32x16_bf16 v[32:47], a[128:131], v[80:83], v[32:47]
    v_cvt_pk_bf16_f32 v57, v58, v59
    ds_read_b128 v[80:83], v8 offset:8192
    s_waitcnt lgkmcnt(3)
    v_mfma_f32_32x32x16_bf16 v[16:31], a[20:23], v[84:87], v[16:31]
    v_cvt_pk_bf16_f32 v58, v60, v61
    v_mfma_f32_32x32x16_bf16 v[32:47], a[132:135], v[84:87], v[32:47]
    v_cvt_pk_bf16_f32 v59, v62, v63
    ds_read_b128 v[84:87], v8 offset:9216
    s_waitcnt lgkmcnt(3)
    v_mfma_f32_32x32x16_bf16 v[16:31], a[24:27], v[88:91], v[16:31]
    buffer_store_dwordx4 v[56:59], v5, s[8:11], s29 offen offset:1024 sc1
    v_mfma_f32_32x32x16_bf16 v[32:47], a[136:139], v[88:91], v[32:47]
    v_cvt_pk_bf16_f32 v64, v64, v65
    ds_read_b128 v[88:91], v8 offset:10240
    s_waitcnt lgkmcnt(3)
    v_mfma_f32_32x32x16_bf16 v[16:31], a[28:31], v[92:95], v[16:31]
    v_cvt_pk_bf16_f32 v65, v66, v67
    v_mfma_f32_32x32x16_bf16 v[32:47], a[140:143], v[92:95], v[32:47]
    v_cvt_pk_bf16_f32 v66, v68, v69
    ds_read_b128 v[92:95], v8 offset:11264
    s_waitcnt lgkmcnt(3)
    v_mfma_f32_32x32x16_bf16 v[16:31], a[32:35], v[80:83], v[16:31]
    v_cvt_pk_bf16_f32 v67, v70, v71
    v_mfma_f32_32x32x16_bf16 v[32:47], a[144:147], v[80:83], v[32:47]
    buffer_store_dwordx4 v[64:67], v5, s[8:11], s26 offen offset:0 sc1
    ds_read_b128 v[80:83], v8 offset:12288
    s_waitcnt lgkmcnt(3)
    v_mfma_f32_32x32x16_bf16 v[16:31], a[36:39], v[84:87], v[16:31]
    v_cvt_pk_bf16_f32 v72, v72, v73
    v_mfma_f32_32x32x16_bf16 v[32:47], a[148:151], v[84:87], v[32:47]
    v_cvt_pk_bf16_f32 v73, v74, v75
    ds_read_b128 v[84:87], v8 offset:13312
    s_waitcnt lgkmcnt(3)
    v_mfma_f32_32x32x16_bf16 v[16:31], a[40:43], v[88:91], v[16:31]
    v_cvt_pk_bf16_f32 v74, v76, v77
    v_mfma_f32_32x32x16_bf16 v[32:47], a[152:155], v[88:91], v[32:47]
    v_cvt_pk_bf16_f32 v75, v78, v79
    ds_read_b128 v[88:91], v8 offset:14336
    s_waitcnt lgkmcnt(3)
    v_mfma_f32_32x32x16_bf16 v[16:31], a[44:47], v[92:95], v[16:31]
    buffer_store_dwordx4 v[72:75], v5, s[8:11], s26 offen offset:1024 sc1
    v_mfma_f32_32x32x16_bf16 v[32:47], a[156:159], v[92:95], v[32:47]
    s_add_u32 s29, s29, 1835008
    ds_read_b128 v[92:95], v8 offset:15360
    s_waitcnt lgkmcnt(3)
    v_mfma_f32_32x32x16_bf16 v[16:31], a[48:51], v[80:83], v[16:31]
    v_mfma_f32_32x32x16_bf16 v[32:47], a[160:163], v[80:83], v[32:47]
    ds_read_b128 v[80:83], v8 offset:16384
    s_waitcnt lgkmcnt(3)
    v_mfma_f32_32x32x16_bf16 v[16:31], a[52:55], v[84:87], v[16:31]
    v_mfma_f32_32x32x16_bf16 v[32:47], a[164:167], v[84:87], v[32:47]
    ds_read_b128 v[84:87], v8 offset:17408
    s_waitcnt lgkmcnt(3)
    v_mfma_f32_32x32x16_bf16 v[16:31], a[56:59], v[88:91], v[16:31]
    v_mfma_f32_32x32x16_bf16 v[32:47], a[168:171], v[88:91], v[32:47]
    ds_read_b128 v[88:91], v8 offset:18432
    s_waitcnt lgkmcnt(3)
    v_mfma_f32_32x32x16_bf16 v[16:31], a[60:63], v[92:95], v[16:31]
    v_mfma_f32_32x32x16_bf16 v[32:47], a[172:175], v[92:95], v[32:47]
    ds_read_b128 v[92:95], v8 offset:19456
    s_waitcnt lgkmcnt(3)
    v_mfma_f32_32x32x16_bf16 v[16:31], a[64:67], v[80:83], v[16:31]
    v_mfma_f32_32x32x16_bf16 v[32:47], a[176:179], v[80:83], v[32:47]
    ds_read_b128 v[80:83], v8 offset:20480
    s_waitcnt lgkmcnt(3)
    v_mfma_f32_32x32x16_bf16 v[16:31], a[68:71], v[84:87], v[16:31]
    v_mfma_f32_32x32x16_bf16 v[32:47], a[180:183], v[84:87], v[32:47]
    ds_read_b128 v[84:87], v8 offset:21504
    s_waitcnt lgkmcnt(3)
    v_mfma_f32_32x32x16_bf16 v[16:31], a[72:75], v[88:91], v[16:31]
    v_mfma_f32_32x32x16_bf16 v[32:47], a[184:187], v[88:91], v[32:47]
    ds_read_b128 v[88:91], v8 offset:22528
    s_waitcnt lgkmcnt(3)
    v_mfma_f32_32x32x16_bf16 v[16:31], a[76:79], v[92:95], v[16:31]
    v_mfma_f32_32x32x16_bf16 v[32:47], a[188:191], v[92:95], v[32:47]
    ds_read_b128 v[92:95], v8 offset:23552
    s_waitcnt lgkmcnt(3)
    v_mfma_f32_32x32x16_bf16 v[16:31], a[80:83], v[80:83], v[16:31]
    v_mfma_f32_32x32x16_bf16 v[32:47], a[192:195], v[80:83], v[32:47]
    ds_read_b128 v[80:83], v8 offset:24576
    s_waitcnt lgkmcnt(3)
    v_mfma_f32_32x32x16_bf16 v[16:31], a[84:87], v[84:87], v[16:31]
    v_mfma_f32_32x32x16_bf16 v[32:47], a[196:199], v[84:87], v[32:47]
    ds_read_b128 v[84:87], v8 offset:25600
    s_waitcnt lgkmcnt(3)
    v_mfma_f32_32x32x16_bf16 v[16:31], a[88:91], v[88:91], v[16:31]
    v_mfma_f32_32x32x16_bf16 v[32:47], a[200:203], v[88:91], v[32:47]
    ds_read_b128 v[88:91], v8 offset:26624
    s_waitcnt lgkmcnt(3)
    v_mfma_f32_32x32x16_bf16 v[16:31], a[92:95], v[92:95], v[16:31]
    v_mfma_f32_32x32x16_bf16 v[32:47], a[204:207], v[92:95], v[32:47]
    ds_read_b128 v[92:95], v8 offset:27648
    s_waitcnt lgkmcnt(3)
    v_mfma_f32_32x32x16_bf16 v[16:31], a[96:99], v[80:83], v[16:31]
    v_mfma_f32_32x32x16_bf16 v[32:47], a[208:211], v[80:83], v[32:47]
    s_waitcnt lgkmcnt(2)
    v_mfma_f32_32x32x16_bf16 v[16:31], a[100:103], v[84:87], v[16:31]
    v_mfma_f32_32x32x16_bf16 v[32:47], a[212:215], v[84:87], v[32:47]
    s_waitcnt lgkmcnt(1)
    v_mfma_f32_32x32x16_bf16 v[16:31], a[104:107], v[88:91], v[16:31]
    v_mfma_f32_32x32x16_bf16 v[32:47], a[216:219], v[88:91], v[32:47]
    s_waitcnt lgkmcnt(0)
    v_mfma_f32_32x32x16_bf16 v[16:31], a[108:111], v[92:95], v[16:31]
    v_mfma_f32_32x32x16_bf16 v[32:47], a[220:223], v[92:95], v[32:47]
    s_waitcnt vmcnt(11)
    s_branch H_t_mid
H_t_loop:
    s_waitcnt vmcnt(15)
    s_barrier
    s_add_u32 s31, s31, 1
    s_cmp_lt_u32 s31, 5
    s_cbranch_scc1 H_n3_16
    s_cmp_lg_u32 s20, 0
    s_cbranch_scc1 H_nf_17
    s_mov_b64 exec, 0xff
    buffer_store_dwordx4 v[96:99], v2, s[8:11], s30 offen sc1
    s_mov_b64 exec, -1
H_nf_17:
    s_add_u32 s30, s30, 45056
H_n3_16:
    s_cmp_eq_u32 s31, 16
    s_cbranch_scc1 H_t_end
    s_mul_i32 s24, s20, 7168
    s_add_u32 s24, s24, s34
    s_add_u32 s25, s28, 4096
    s_mov_b32 m0, s24
    s_add_u32 s24, s24, 4096
    buffer_load_dwordx4 v2, s[8:11], s28 offen offset:0 lds
    buffer_load_dwordx4 v2, s[8:11], s28 offen offset:1024 lds
    buffer_load_dwordx4 v2, s[8:11], s28 offen offset:2048 lds
    buffer_load_dwordx4 v2, s[8:11], s28 offen offset:3072 lds
    s_mov_b32 m0, s24
    s_add_u32 s24, s24, 4096
    buffer_load_dwordx4 v2, s[8:11], s25 offen offset:0 lds
    buffer_load_dwordx4 v2, s[8:11], s25 offen offset:1024 lds
    buffer_load_dwordx4 v2, s[8:11], s25 offen offset:2048 lds
    s_add_u32 s28, s28, 114688
    s_add_u32 s34, s34, 28672
    s_cmp_eq_u32 s34, 86016
    s_cselect_b32 s34, 0, s34
    v_add_u32 v8, s35, v2
    s_add_u32 s35, s35, 28672
    s_cmp_eq_u32 s35, 86016
    s_cselect_b32 s35, 0, s35
    ds_read_b128 v[80:83], v8 offset:0
    ds_read_b128 v[84:87], v8 offset:1024
    ds_read_b128 v[88:91], v8 offset:2048
    ds_read_b128 v[92:95], v8 offset:3072
    s_waitcnt lgkmcnt(3)
    v_mfma_f32_32x32x16_bf16 v[16:31], a[0:3], v[80:83], 0
    v_mfma_f32_32x32x16_bf16 v[32:47], a[112:115], v[80:83], 0
    ds_read_b128 v[80:83], v8 offset:4096
    s_waitcnt lgkmcnt(3)
    v_mfma_f32_32x32x16_bf16 v[16:31], a[4:7], v[84:87], v[16:31]
    s_add_u32 s26, s29, 28672
    v_mfma_f32_32x32x16_bf16 v[32:47], a[116:119], v[84:87], v[32:47]
    v_cvt_pk_bf16_f32 v48, v48, v49
    ds_read_b128 v[84:87], v8 offset:5120
    s_waitcnt lgkmcnt(3)
    v_mfma_f32_32x32x16_bf16 v[16:31], a[8:11], v[88:91], v[16:31]
    v_cvt_pk_bf16_f32 v49, v50, v51
    v_mfma_f32_32x32x16_bf16 v[32:47], a[120:123], v[88:91], v[32:47]
    v_cvt_pk_bf16_f32 v50, v52, v53
    ds_read_b128 v[88:91], v8 offset:6144
    s_waitcnt lgkmcnt(3)
    v_mfma_f32_32x32x16_bf16 v[16:31], a[12:15], v[92:95], v[16:31]
    v_cvt_pk_bf16_f32 v51, v54, v55
    v_mfma_f32_32x32x16_bf16 v[32:47], a[124:127], v[92:95], v[32:47]
    buffer_store_dwordx4 v[48:51], v5, s[8:11], s29 offen offset:0 sc1
    ds_read_b128 v[92:95], v8 offset:7168
    s_waitcnt lgkmcnt(3)
    v_mfma_f32_32x32x16_bf16 v[16:31], a[16:19], v[80:83], v[16:31]
    v_cvt_pk_bf16_f32 v56, v56, v57
    v_mfma_f32_32x32x16_bf16 v[32:47], a[128:131], v[80:83], v[32:47]
    v_cvt_pk_bf16_f32 v57, v58, v59
    ds_read_b128 v[80:83], v8 offset:8192
    s_waitcnt lgkmcnt(3)
    v_mfma_f32_32x32x16_bf16 v[16:31], a[20:23], v[84:87], v[16:31]
    v_cvt_pk_bf16_f32 v58, v60, v61
    v_mfma_f32_32x32x16_bf16 v[32:47], a[132:135], v[84:87], v[32:47]
    v_cvt_pk_bf16_f32 v59, v62, v63
    ds_read_b128 v[84:87], v8 offset:9216
    s_waitcnt lgkmcnt(3)
    v_mfma_f32_32x32x16_bf16 v[16:31], a[24:27], v[88:91], v[16:31]
    buffer_store_dwordx4 v[56:59], v5, s[8:11], s29 offen offset:1024 sc1
    v_mfma_f32_32x32x16_bf16 v[32:47], a[136:139], v[88:91], v[32:47]
    v_cvt_pk_bf16_f32 v64, v64, v65
    ds_read_b128 v[88:91], v8 offset:10240
    s_waitcnt lgkmcnt(3)
    v_mfma_f32_32x32x16_bf16 v[16:31], a[28:31], v[92:95], v[16:31]
    v_cvt_pk_bf16_f32 v65, v66, v67
    v_mfma_f32_32x32x16_bf16 v[32:47], a[140:143], v[92:95], v[32:47]
    v_cvt_pk_bf16_f32 v66, v68, v69
    ds_read_b128 v[92:95], v8 offset:11264
    s_waitcnt lgkmcnt(3)
    v_mfma_f32_32x32x16_bf16 v[16:31], a[32:35], v[80:83], v[16:31]
    v_cvt_pk_bf16_f32 v67, v70, v71
    v_mfma_f32_32x32x16_bf16 v[32:47], a[144:147], v[80:83], v[32:47]
    buffer_store_dwordx4 v[64:67], v5, s[8:11], s26 offen offset:0 sc1
    ds_read_b128 v[80:83], v8 offset:12288
    s_waitcnt lgkmcnt(3)
    v_mfma_f32_32x32x16_bf16 v[16:31], a[36:39], v[84:87], v[16:31]
    v_cvt_pk_bf16_f32 v72, v72, v73
    v_mfma_f32_32x32x16_bf16 v[32:47], a[148:151], v[84:87], v[32:47]
    v_cvt_pk_bf16_f32 v73, v74, v75
    ds_read_b128 v[84:87], v8 offset:13312
    s_waitcnt lgkmcnt(3)
    v_mfma_f32_32x32x16_bf16 v[16:31], a[40:43], v[88:91], v[16:31]
    v_cvt_pk_bf16_f32 v74, v76, v77
    v_mfma_f32_32x32x16_bf16 v[32:47], a[152:155], v[88:91], v[32:47]
    v_cvt_pk_bf16_f32 v75, v78, v79
    ds_read_b128 v[88:91], v8 offset:14336
    s_waitcnt lgkmcnt(3)
    v_mfma_f32_32x32x16_bf16 v[16:31], a[44:47], v[92:95], v[16:31]
    buffer_store_dwordx4 v[72:75], v5, s[8:11], s26 offen offset:1024 sc1
    v_mfma_f32_32x32x16_bf16 v[32:47], a[156:159], v[92:95], v[32:47]
    s_add_u32 s29, s29, 1835008
    ds_read_b128 v[92:95], v8 offset:15360
    s_waitcnt lgkmcnt(3)
    v_mfma_f32_32x32x16_bf16 v[16:31], a[48:51], v[80:83], v[16:31]
    v_mfma_f32_32x32x16_bf16 v[32:47], a[160:163], v[80:83], v[32:47]
    ds_read_b128 v[80:83], v8 offset:16384
    s_waitcnt lgkmcnt(3)
    v_mfma_f32_32x32x16_bf16 v[16:31], a[52:55], v[84:87], v[16:31]
    v_mfma_f32_32x32x16_bf16 v[32:47], a[164:167], v[84:87], v[32:47]
    ds_read_b128 v[84:87], v8 offset:17408
    s_waitcnt lgkmcnt(3)
    v_mfma_f32_32x32x16_bf16 v[16:31], a[56:59], v[88:91], v[16:31]
    v_mfma_f32_32x32x16_bf16 v[32:47], a[168:171], v[88:91], v[32:47]
    ds_read_b128 v[88:91], v8 offset:18432
    s_waitcnt lgkmcnt(3)
    v_mfma_f32_32x32x16_bf16 v[16:31], a[60:63], v[92:95], v[16:31]
    v_mfma_f32_32x32x16_bf16 v[32:47], a[172:175], v[92:95], v[32:47]
    ds_read_b128 v[92:95], v8 offset:19456
    s_waitcnt lgkmcnt(3)
    v_mfma_f32_32x32x16_bf16 v[16:31], a[64:67], v[80:83], v[16:31]
    v_mfma_f32_32x32x16_bf16 v[32:47], a[176:179], v[80:83], v[32:47]
    ds_read_b128 v[80:83], v8 offset:20480
    s_waitcnt lgkmcnt(3)
    v_mfma_f32_32x32x16_bf16 v[16:31], a[68:71], v[84:87], v[16:31]
    v_mfma_f32_32x32x16_bf16 v[32:47], a[180:183], v[84:87], v[32:47]
    ds_read_b128 v[84:87], v8 offset:21504
    s_waitcnt lgkmcnt(3)
    v_mfma_f32_32x32x16_bf16 v[16:31], a[72:75], v[88:91], v[16:31]
    v_mfma_f32_32x32x16_bf16 v[32:47], a[184:187], v[88:91], v[32:47]
    ds_read_b128 v[88:91], v8 offset:22528
    s_waitcnt lgkmcnt(3)
    v_mfma_f32_32x32x16_bf16 v[16:31], a[76:79], v[92:95], v[16:31]
    v_mfma_f32_32x32x16_bf16 v[32:47], a[188:191], v[92:95], v[32:47]
    ds_read_b128 v[92:95], v8 offset:23552
    s_waitcnt lgkmcnt(3)
    v_mfma_f32_32x32x16_bf16 v[16:31], a[80:83], v[80:83], v[16:31]
    v_mfma_f32_32x32x16_bf16 v[32:47], a[192:195], v[80:83], v[32:47]
    ds_read_b128 v[80:83], v8 offset:24576
    s_waitcnt lgkmcnt(3)
    v_mfma_f32_32x32x16_bf16 v[16:31], a[84:87], v[84:87], v[16:31]
    v_mfma_f32_32x32x16_bf16 v[32:47], a[196:199], v[84:87], v[32:47]
    ds_read_b128 v[84:87], v8 offset:25600
    s_waitcnt lgkmcnt(3)
    v_mfma_f32_32x32x16_bf16 v[16:31], a[88:91], v[88:91], v[16:31]
    v_mfma_f32_32x32x16_bf16 v[32:47], a[200:203], v[88:91], v[32:47]
    ds_read_b128 v[88:91], v8 offset:26624
    s_waitcnt lgkmcnt(3)
    v_mfma_f32_32x32x16_bf16 v[16:31], a[92:95], v[92:95], v[16:31]
    v_mfma_f32_32x32x16_bf16 v[32:47], a[204:207], v[92:95], v[32:47]
    ds_read_b128 v[92:95], v8 offset:27648
    s_waitcnt lgkmcnt(3)
    v_mfma_f32_32x32x16_bf16 v[16:31], a[96:99], v[80:83], v[16:31]
    v_mfma_f32_32x32x16_bf16 v[32:47], a[208:211], v[80:83], v[32:47]
    s_waitcnt lgkmcnt(2)
    v_mfma_f32_32x32x16_bf16 v[16:31], a[100:103], v[84:87], v[16:31]
    v_mfma_f32_32x32x16_bf16 v[32:47], a[212:215], v[84:87], v[32:47]
    s_waitcnt lgkmcnt(1)
    v_mfma_f32_32x32x16_bf16 v[16:31], a[104:107], v[88:91], v[16:31]
    v_mfma_f32_32x32x16_bf16 v[32:47], a[216:219], v[88:91], v[32:47]
    s_waitcnt lgkmcnt(0)
    v_mfma_f32_32x32x16_bf16 v[16:31], a[108:111], v[92:95], v[16:31]
    v_mfma_f32_32x32x16_bf16 v[32:47], a[220:223], v[92:95], v[32:47]
    s_waitcnt vmcnt(15)
H_t_mid:
    s_barrier
    s_add_u32 s31, s31, 1
    s_cmp_lt_u32 s31, 5
    s_cbranch_scc1 H_n3_18
    s_cmp_lg_u32 s20, 0
    s_cbranch_scc1 H_nf_19
    s_mov_b64 exec, 0xff
    buffer_store_dwordx4 v[96:99], v2, s[8:11], s30 offen sc1
    s_mov_b64 exec, -1
H_nf_19:
    s_add_u32 s30, s30, 45056
H_n3_18:
    s_cmp_lg_u32 s31, 11
    s_cbranch_scc1 H_nw_20
    s_cmp_ge_u32 s22, 28
    s_cbranch_scc1 H_nw_20
    s_load_dwordx2 s[56:57], s[0:1], 64
    s_load_dwordx2 s[58:59], s[0:1], 80
    v_lshlrev_b32 v9, 7, v0
    s_mul_i32 s24, s22, 57344
    v_add_u32 v9, s24, v9
    s_waitcnt lgkmcnt(0)
    v_add_u32 v10, 24576, v9
    global_load_dword v11, v9, s[56:57]
    global_load_dword v11, v10, s[56:57]
    global_load_dword v11, v9, s[58:59]
    global_load_dword v11, v10, s[58:59]
H_nw_20:
    s_mul_i32 s24, s20, 7168
    s_add_u32 s24, s24, s34
    s_add_u32 s25, s28, 4096
    s_mov_b32 m0, s24
    s_add_u32 s24, s24, 4096
    buffer_load_dwordx4 v2, s[8:11], s28 offen offset:0 lds
    buffer_load_dwordx4 v2, s[8:11], s28 offen offset:1024 lds
    buffer_load_dwordx4 v2, s[8:11], s28 offen offset:2048 lds
    buffer_load_dwordx4 v2, s[8:11], s28 offen offset:3072 lds
    s_mov_b32 m0, s24
    s_add_u32 s24, s24, 4096
    buffer_load_dwordx4 v2, s[8:11], s25 offen offset:0 lds
    buffer_load_dwordx4 v2, s[8:11], s25 offen offset:1024 lds
    buffer_load_dwordx4 v2, s[8:11], s25 offen offset:2048 lds
    s_add_u32 s28, s28, 114688
    s_add_u32 s34, s34, 28672
    s_cmp_eq_u32 s34, 86016
    s_cselect_b32 s34, 0, s34
    v_add_u32 v8, s35, v2
    s_add_u32 s35, s35, 28672
    s_cmp_eq_u32 s35, 86016
    s_cselect_b32 s35, 0, s35
    ds_read_b128 v[80:83], v8 offset:0
    ds_read_b128 v[84:87], v8 offset:1024
    ds_read_b128 v[88:91], v8 offset:2048
    ds_read_b128 v[92:95], v8 offset:3072
    s_waitcnt lgkmcnt(3)
    v_mfma_f32_32x32x16_bf16 v[48:63], a[0:3], v[80:83], 0
    v_mfma_f32_32x32x16_bf16 v[64:79], a[112:115], v[80:83], 0
    ds_read_b128 v[80:83], v8 offset:4096
    s_waitcnt lgkmcnt(3)
    v_mfma_f32_32x32x16_bf16 v[48:63], a[4:7], v[84:87], v[48:63]
    s_add_u32 s26, s29, 28672
    v_mfma_f32_32x32x16_bf16 v[64:79], a[116:119], v[84:87], v[64:79]
    v_cvt_pk_bf16_f32 v16, v16, v17
    ds_read_b128 v[84:87], v8 offset:5120
    s_waitcnt lgkmcnt(3)
    v_mfma_f32_32x32x16_bf16 v[48:63], a[8:11], v[88:91], v[48:63]
    v_cvt_pk_bf16_f32 v17, v18, v19
    v_mfma_f32_32x32x16_bf16 v[64:79], a[120:123], v[88:91], v[64:79]
    v_cvt_pk_bf16_f32 v18, v20, v21
    ds_read_b128 v[88:91], v8 offset:6144
    s_waitcnt lgkmcnt(3)
    v_mfma_f32_32x32x16_bf16 v[48:63], a[12:15], v[92:95], v[48:63]
    v_cvt_pk_bf16_f32 v19, v22, v23
    v_mfma_f32_32x32x16_bf16 v[64:79], a[124:127], v[92:95], v[64:79]
    buffer_store_dwordx4 v[16:19], v5, s[8:11], s29 offen offset:0 sc1
    ds_read_b128 v[92:95], v8 offset:7168
    s_waitcnt lgkmcnt(3)
    v_mfma_f32_32x32x16_bf16 v[48:63], a[16:19], v[80:83], v[48:63]
    v_cvt_pk_bf16_f32 v24, v24, v25
    v_mfma_f32_32x32x16_bf16 v[64:79], a[128:131], v[80:83], v[64:79]
    v_cvt_pk_bf16_f32 v25, v26, v27
    ds_read_b128 v[80:83], v8 offset:8192
    s_waitcnt lgkmcnt(3)
    v_mfma_f32_32x32x16_bf16 v[48:63], a[20:23], v[84:87], v[48:63]
    v_cvt_pk_bf16_f32 v26, v28, v29
    v_mfma_f32_32x32x16_bf16 v[64:79], a[132:135], v[84:87], v[64:79]
    v_cvt_pk_bf16_f32 v27, v30, v31
    ds_read_b128 v[84:87], v8 offset:9216
    s_waitcnt lgkmcnt(3)
    v_mfma_f32_32x32x16_bf16 v[48:63], a[24:27], v[88:91], v[48:63]
    buffer_store_dwordx4 v[24:27], v5, s[8:11], s29 offen offset:1024 sc1
    v_mfma_f32_32x32x16_bf16 v[64:79], a[136:139], v[88:91], v[64:79]
    v_cvt_pk_bf16_f32 v32, v32, v33
    ds_read_b128 v[88:91], v8 offset:10240
    s_waitcnt lgkmcnt(3)
    v_mfma_f32_32x32x16_bf16 v[48:63], a[28:31], v[92:95], v[48:63]
    v_cvt_pk_bf16_f32 v33, v34, v35
    v_mfma_f32_32x32x16_bf16 v[64:79], a[140:143], v[92:95], v[64:79]
    v_cvt_pk_bf16_f32 v34, v36, v37
    ds_read_b128 v[92:95], v8 offset:11264
    s_waitcnt lgkmcnt(3)
    v_mfma_f32_32x32x16_bf16 v[48:63], a[32:35], v[80:83], v[48:63]
    v_cvt_pk_bf16_f32 v35, v38, v39
    v_mfma_f32_32x32x16_bf16 v[64:79], a[144:147], v[80:83], v[64:79]
    buffer_store_dwordx4 v[32:35], v5, s[8:11], s26 offen offset:0 sc1
    ds_read_b128 v[80:83], v8 offset:12288
    s_waitcnt lgkmcnt(3)
    v_mfma_f32_32x32x16_bf16 v[48:63], a[36:39], v[84:87], v[48:63]
    v_cvt_pk_bf16_f32 v40, v40, v41
    v_mfma_f32_32x32x16_bf16 v[64:79], a[148:151], v[84:87], v[64:79]
    v_cvt_pk_bf16_f32 v41, v42, v43
    ds_read_b128 v[84:87], v8 offset:13312
    s_waitcnt lgkmcnt(3)
    v_mfma_f32_32x32x16_bf16 v[48:63], a[40:43], v[88:91], v[48:63]
    v_cvt_pk_bf16_f32 v42, v44, v45
    v_mfma_f32_32x32x16_bf16 v[64:79], a[152:155], v[88:91], v[64:79]
    v_cvt_pk_bf16_f32 v43, v46, v47
    ds_read_b128 v[88:91], v8 offset:14336
    s_waitcnt lgkmcnt(3)
    v_mfma_f32_32x32x16_bf16 v[48:63], a[44:47], v[92:95], v[48:63]
    buffer_store_dwordx4 v[40:43], v5, s[8:11], s26 offen offset:1024 sc1
    v_mfma_f32_32x32x16_bf16 v[64:79], a[156:159], v[92:95], v[64:79]
    s_add_u32 s29, s29, 1835008
    ds_read_b128 v[92:95], v8 offset:15360
    s_waitcnt lgkmcnt(3)
    v_mfma_f32_32x32x16_bf16 v[48:63], a[48:51], v[80:83], v[48:63]
    v_mfma_f32_32x32x16_bf16 v[64:79], a[160:163], v[80:83], v[64:79]
    ds_read_b128 v[80:83], v8 offset:16384
    s_waitcnt lgkmcnt(3)
    v_mfma_f32_32x32x16_bf16 v[48:63], a[52:55], v[84:87], v[48:63]
    v_mfma_f32_32x32x16_bf16 v[64:79], a[164:167], v[84:87], v[64:79]
    ds_read_b128 v[84:87], v8 offset:17408
    s_waitcnt lgkmcnt(3)
    v_mfma_f32_32x32x16_bf16 v[48:63], a[56:59], v[88:91], v[48:63]
    v_mfma_f32_32x32x16_bf16 v[64:79], a[168:171], v[88:91], v[64:79]
    ds_read_b128 v[88:91], v8 offset:18432
    s_waitcnt lgkmcnt(3)
    v_mfma_f32_32x32x16_bf16 v[48:63], a[60:63], v[92:95], v[48:63]
    v_mfma_f32_32x32x16_bf16 v[64:79], a[172:175], v[92:95], v[64:79]
    ds_read_b128 v[92:95], v8 offset:19456
    s_waitcnt lgkmcnt(3)
    v_mfma_f32_32x32x16_bf16 v[48:63], a[64:67], v[80:83], v[48:63]
    v_mfma_f32_32x32x16_bf16 v[64:79], a[176:179], v[80:83], v[64:79]
    ds_read_b128 v[80:83], v8 offset:20480
    s_waitcnt lgkmcnt(3)
    v_mfma_f32_32x32x16_bf16 v[48:63], a[68:71], v[84:87], v[48:63]
    v_mfma_f32_32x32x16_bf16 v[64:79], a[180:183], v[84:87], v[64:79]
    ds_read_b128 v[84:87], v8 offset:21504
    s_waitcnt lgkmcnt(3)
    v_mfma_f32_32x32x16_bf16 v[48:63], a[72:75], v[88:91], v[48:63]
    v_mfma_f32_32x32x16_bf16 v[64:79], a[184:187], v[88:91], v[64:79]
    ds_read_b128 v[88:91], v8 offset:22528
    s_waitcnt lgkmcnt(3)
    v_mfma_f32_32x32x16_bf16 v[48:63], a[76:79], v[92:95], v[48:63]
    v_mfma_f32_32x32x16_bf16 v[64:79], a[188:191], v[92:95], v[64:79]
    ds_read_b128 v[92:95], v8 offset:23552
    s_waitcnt lgkmcnt(3)
    v_mfma_f32_32x32x16_bf16 v[48:63], a[80:83], v[80:83], v[48:63]
    v_mfma_f32_32x32x16_bf16 v[64:79], a[192:195], v[80:83], v[64:79]
    ds_read_b128 v[80:83], v8 offset:24576
    s_waitcnt lgkmcnt(3)
    v_mfma_f32_32x32x16_bf16 v[48:63], a[84:87], v[84:87], v[48:63]
    v_mfma_f32_32x32x16_bf16 v[64:79], a[196:199], v[84:87], v[64:79]
    ds_read_b128 v[84:87], v8 offset:25600
    s_waitcnt lgkmcnt(3)
    v_mfma_f32_32x32x16_bf16 v[48:63], a[88:91], v[88:91], v[48:63]
    v_mfma_f32_32x32x16_bf16 v[64:79], a[200:203], v[88:91], v[64:79]
    ds_read_b128 v[88:91], v8 offset:26624
    s_waitcnt lgkmcnt(3)
    v_mfma_f32_32x32x16_bf16 v[48:63], a[92:95], v[92:95], v[48:63]
    v_mfma_f32_32x32x16_bf16 v[64:79], a[204:207], v[92:95], v[64:79]
    ds_read_b128 v[92:95], v8 offset:27648
    s_waitcnt lgkmcnt(3)
    v_mfma_f32_32x32x16_bf16 v[48:63], a[96:99], v[80:83], v[48:63]
    v_mfma_f32_32x32x16_bf16 v[64:79], a[208:211], v[80:83], v[64:79]
    s_waitcnt lgkmcnt(2)
    v_mfma_f32_32x32x16_bf16 v[48:63], a[100:103], v[84:87], v[48:63]
    v_mfma_f32_32x32x16_bf16 v[64:79], a[212:215], v[84:87], v[64:79]
    s_waitcnt lgkmcnt(1)
    v_mfma_f32_32x32x16_bf16 v[48:63], a[104:107], v[88:91], v[48:63]
    v_mfma_f32_32x32x16_bf16 v[64:79], a[216:219], v[88:91], v[64:79]
    s_waitcnt lgkmcnt(0)
    v_mfma_f32_32x32x16_bf16 v[48:63], a[108:111], v[92:95], v[48:63]
    v_mfma_f32_32x32x16_bf16 v[64:79], a[220:223], v[92:95], v[64:79]
    s_branch H_t_loop
H_t_end:
    s_add_u32 s26, s29, 28672
    v_cvt_pk_bf16_f32 v48, v48, v49
    v_cvt_pk_bf16_f32 v49, v50, v51
    v_cvt_pk_bf16_f32 v50, v52, v53
    v_cvt_pk_bf16_f32 v51, v54, v55
    buffer_store_dwordx4 v[48:51], v5, s[8:11], s29 offen offset:0 sc1
    v_cvt_pk_bf16_f32 v56, v56, v57
    v_cvt_pk_bf16_f32 v57, v58, v59
    v_cvt_pk_bf16_f32 v58, v60, v61
    v_cvt_pk_bf16_f32 v59, v62, v63
    buffer_store_dwordx4 v[56:59], v5, s[8:11], s29 offen offset:1024 sc1
    v_cvt_pk_bf16_f32 v64, v64, v65
    v_cvt_pk_bf16_f32 v65, v66, v67
    v_cvt_pk_bf16_f32 v66, v68, v69
    v_cvt_pk_bf16_f32 v67, v70, v71
    buffer_store_dwordx4 v[64:67], v5, s[8:11], s26 offen offset:0 sc1
    v_cvt_pk_bf16_f32 v72, v72, v73
    v_cvt_pk_bf16_f32 v73, v74, v75
    v_cvt_pk_bf16_f32 v74, v76, v77
    v_cvt_pk_bf16_f32 v75, v78, v79
    buffer_store_dwordx4 v[72:75], v5, s[8:11], s26 offen offset:1024 sc1
    s_add_u32 s29, s29, 1835008
    s_waitcnt vmcnt(0)
    s_barrier
    s_cmp_lg_u32 s20, 0
    s_cbranch_scc1 H_nf_21
    s_mov_b64 exec, 0xff
    buffer_store_dwordx4 v[96:99], v2, s[8:11], s30 offen sc1
    s_mov_b64 exec, -1
H_nf_21:
    s_add_u32 s30, s30, 45056
    s_cmp_lg_u32 s20, 0
    s_cbranch_scc1 H_nf_22
    s_mov_b64 exec, 0xff
    buffer_store_dwordx4 v[96:99], v2, s[8:11], s30 offen sc1
    s_mov_b64 exec, -1
H_nf_22:
    s_add_u32 s30, s30, 45056
    s_cmp_lg_u32 s20, 0
    s_cbranch_scc1 H_nf_23
    s_mov_b64 exec, 0xff
    buffer_store_dwordx4 v[96:99], v2, s[8:11], s30 offen sc1
    s_mov_b64 exec, -1
H_nf_23:
    s_add_u32 s30, s30, 45056
    s_branch H_trail
H_trail:
    s_load_dwordx2 s[56:57], s[0:1], 0
    s_load_dwordx4 s[60:63], s[0:1], 64
    s_load_dwordx2 s[64:65], s[0:1], 80
    s_load_dwordx2 s[66:67], s[0:1], 104
    s_waitcnt lgkmcnt(0)
    s_mov_b32 s36, s56
    s_mov_b32 s37, s57
    s_mov_b32 s38, 1835008
    s_mov_b32 s39, 0x20000
    s_mov_b32 s40, s60
    s_mov_b32 s41, s61
    s_mov_b32 s42, 1605632
    s_mov_b32 s43, 0x20000
    s_mov_b32 s44, s62
    s_mov_b32 s45, s63
    s_mov_b32 s46, 3584
    s_mov_b32 s47, 0x20000
    s_mov_b32 s48, s64
    s_mov_b32 s49, s65
    s_mov_b32 s50, 1605632
    s_mov_b32 s51, 0x20000
    s_mov_b32 s52, s66
    s_mov_b32 s53, s67
    s_mov_b32 s54, 1835008
    s_mov_b32 s55, 0x20000
    s_cmp_ge_u32 s22, 30
    s_cbranch_scc1 H_y
    v_lshrrev_b32 v8, 4, v1
    v_and_b32 v9, 15, v1
    s_cmp_ge_u32 s22, 28
    s_cbranch_scc1 H_nomlp
    v_lshrrev_b32 v6, 3, v0
    v_mul_u32_u24 v6, 3584, v6
    v_and_b32 v7, 7, v0
    v_lshl_add_u32 v6, v7, 4, v6
    s_lshl_b32 s29, s22, 7
    s_lshl_b32 s30, s20, 10
    s_mov_b32 m0, s30
    s_add_u32 s30, s30, 4096
    buffer_load_dwordx4 v6, s[40:43], s29 offen lds
    s_add_u32 s29, s29, 114688
    s_mov_b32 m0, s30
    s_add_u32 s30, s30, 4096
    buffer_load_dwordx4 v6, s[40:43], s29 offen lds
    s_add_u32 s29, s29, 114688
    s_mov_b32 m0, s30
    s_add_u32 s30, s30, 4096
    buffer_load_dwordx4 v6, s[40:43], s29 offen lds
    s_add_u32 s29, s29, 114688
    s_mov_b32 m0, s30
    s_add_u32 s30, s30, 4096
    buffer_load_dwordx4 v6, s[40:43], s29 offen lds
    s_add_u32 s29, s29, 114688
    s_mov_b32 m0, s30
    s_add_u32 s30, s30, 4096
    buffer_load_dwordx4 v6, s[40:43], s29 offen lds
    s_add_u32 s29, s29, 114688
    s_mov_b32 m0, s30
    s_add_u32 s30, s30, 4096
    buffer_load_dwordx4 v6, s[40:43], s29 offen lds
    s_add_u32 s29, s29, 114688
    s_mov_b32 m0, s30
    s_add_u32 s30, s30, 4096
    buffer_load_dwordx4 v6, s[40:43], s29 offen lds
    s_add_u32 s29, s29, 114688
    s_mov_b32 m0, s30
    s_add_u32 s30, s30, 4096
    buffer_load_dwordx4 v6, s[40:43], s29 offen lds
    s_add_u32 s29, s29, 114688
    s_mov_b32 m0, s30
    s_add_u32 s30, s30, 4096
    buffer_load_dwordx4 v6, s[40:43], s29 offen lds
    s_add_u32 s29, s29, 114688
    s_mov_b32 m0, s30
    s_add_u32 s30, s30, 4096
    buffer_load_dwordx4 v6, s[40:43], s29 offen lds
    s_add_u32 s29, s29, 114688
    s_mov_b32 m0, s30
    s_add_u32 s30, s30, 4096
    buffer_load_dwordx4 v6, s[40:43], s29 offen lds
    s_add_u32 s29, s29, 114688
    s_mov_b32 m0, s30
    s_add_u32 s30, s30, 4096
    buffer_load_dwordx4 v6, s[40:43], s29 offen lds
    s_add_u32 s29, s29, 114688
    s_mov_b32 m0, s30
    s_add_u32 s30, s30, 4096
    buffer_load_dwordx4 v6, s[40:43], s29 offen lds
    s_add_u32 s29, s29, 114688
    s_mov_b32 m0, s30
    s_add_u32 s30, s30, 4096
    buffer_load_dwordx4 v6, s[40:43], s29 offen lds
    s_add_u32 s29, s29, 114688
    v_lshrrev_b32 v6, 1, v0
    v_mul_u32_u24 v6, 896, v6
    v_and_b32 v7, 1, v0
    v_lshl_add_u32 v6, v7, 4, v6
    s_lshl_b32 s29, s22, 5
    s_mov_b32 m0, s30
    s_add_u32 s30, s30, 4096
    buffer_load_dwordx4 v6, s[48:51], s29 offen lds
    s_add_u32 s29, s29, 114688
    s_mov_b32 m0, s30
    s_add_u32 s30, s30, 4096
    buffer_load_dwordx4 v6, s[48:51], s29 offen lds
    s_add_u32 s29, s29, 114688
    s_mov_b32 m0, s30
    s_add_u32 s30, s30, 4096
    buffer_load_dwordx4 v6, s[48:51], s29 offen lds
    s_add_u32 s29, s29, 114688
    s_mov_b32 m0, s30
    s_add_u32 s30, s30, 4096
    buffer_load_dwordx4 v6, s[48:51], s29 offen lds
    s_add_u32 s29, s29, 114688
    s_mov_b32 m0, s30
    s_add_u32 s30, s30, 4096
    buffer_load_dwordx4 v6, s[48:51], s29 offen lds
    s_add_u32 s29, s29, 114688
    s_mov_b32 m0, s30
    s_add_u32 s30, s30, 4096
    buffer_load_dwordx4 v6, s[48:51], s29 offen lds
    s_add_u32 s29, s29, 114688
    s_mov_b32 m0, s30
    s_add_u32 s30, s30, 4096
    buffer_load_dwordx4 v6, s[48:51], s29 offen lds
    s_add_u32 s29, s29, 114688
    s_mov_b32 m0, s30
    s_add_u32 s30, s30, 4096
    buffer_load_dwordx4 v6, s[48:51], s29 offen lds
    s_add_u32 s29, s29, 114688
    s_mov_b32 m0, s30
    s_add_u32 s30, s30, 4096
    buffer_load_dwordx4 v6, s[48:51], s29 offen lds
    s_add_u32 s29, s29, 114688
    s_mov_b32 m0, s30
    s_add_u32 s30, s30, 4096
    buffer_load_dwordx4 v6, s[48:51], s29 offen lds
    s_add_u32 s29, s29, 114688
    s_mov_b32 m0, s30
    s_add_u32 s30, s30, 4096
    buffer_load_dwordx4 v6, s[48:51], s29 offen lds
    s_add_u32 s29, s29, 114688
    s_mov_b32 m0, s30
    s_add_u32 s30, s30, 4096
    buffer_load_dwordx4 v6, s[48:51], s29 offen lds
    s_add_u32 s29, s29, 114688
    s_mov_b32 m0, s30
    s_add_u32 s30, s30, 4096
    buffer_load_dwordx4 v6, s[48:51], s29 offen lds
    s_add_u32 s29, s29, 114688
    s_mov_b32 m0, s30
    s_add_u32 s30, s30, 4096
    buffer_load_dwordx4 v6, s[48:51], s29 offen lds
    s_add_u32 s29, s29, 114688
    s_and_b32 s31, s20, 1
    s_lshl_b32 s29, s31, 6
    s_lshl_b32 s30, s22, 7
    s_add_u32 s29, s29, s30
    v_lshlrev_b32 v7, 3, v8
    buffer_load_dwordx2 v[22:23], v7, s[44:47], s29 offen
    buffer_load_dwordx2 v[24:25], v7, s[44:47], s29 offen offset:32
    v_lshlrev_b32 v7, 4, v8
    s_lshl_b32 s29, s22, 6
    s_add_u32 s29, s29, 85567232
    buffer_load_dwordx4 v[18:21], v7, s[8:11], s29 offen
    v_bfe_u32 v6, v1, 4, 2
    v_lshlrev_b32 v6, 10, v6
    v_bfe_u32 v7, v1, 2, 2
    v_lshl_add_u32 v6, v7, 7, v6
    v_bfe_u32 v7, v1, 0, 2
    v_lshl_add_u32 v6, v7, 3, v6
    s_lshl_b32 s31, s31, 6
    v_add_u32 v6, s31, v6
    s_waitcnt vmcnt(0)
    s_barrier
    ds_read_b64_tr_b16 a[0:1], v6 offset:0
    ds_read_b64_tr_b16 a[2:3], v6 offset:512
    ds_read_b64_tr_b16 a[4:5], v6 offset:4096
    ds_read_b64_tr_b16 a[6:7], v6 offset:4608
    ds_read_b64_tr_b16 a[8:9], v6 offset:8192
    ds_read_b64_tr_b16 a[10:11], v6 offset:8704
    ds_read_b64_tr_b16 a[12:13], v6 offset:12288
    ds_read_b64_tr_b16 a[14:15], v6 offset:12800
    ds_read_b64_tr_b16 a[16:17], v6 offset:16384
    ds_read_b64_tr_b16 a[18:19], v6 offset:16896
    ds_read_b64_tr_b16 a[20:21], v6 offset:20480
    ds_read_b64_tr_b16 a[22:23], v6 offset:20992
    ds_read_b64_tr_b16 a[24:25], v6 offset:24576
    ds_read_b64_tr_b16 a[26:27], v6 offset:25088
    ds_read_b64_tr_b16 a[28:29], v6 offset:28672
    ds_read_b64_tr_b16 a[30:31], v6 offset:29184
    ds_read_b64_tr_b16 a[32:33], v6 offset:32768
    ds_read_b64_tr_b16 a[34:35], v6 offset:33280
    ds_read_b64_tr_b16 a[36:37], v6 offset:36864
    ds_read_b64_tr_b16 a[38:39], v6 offset:37376
    ds_read_b64_tr_b16 a[40:41], v6 offset:40960
    ds_read_b64_tr_b16 a[42:43], v6 offset:41472
    ds_read_b64_tr_b16 a[44:45], v6 offset:45056
    ds_read_b64_tr_b16 a[46:47], v6 offset:45568
    ds_read_b64_tr_b16 a[48:49], v6 offset:49152
    ds_read_b64_tr_b16 a[50:51], v6 offset:49664
    ds_read_b64_tr_b16 a[52:53], v6 offset:53248
    ds_read_b64_tr_b16 a[54:55], v6 offset:53760
    ds_read_b64_tr_b16 a[56:57], v6 offset:32
    ds_read_b64_tr_b16 a[58:59], v6 offset:544
    ds_read_b64_tr_b16 a[60:61], v6 offset:4128
    ds_read_b64_tr_b16 a[62:63], v6 offset:4640
    ds_read_b64_tr_b16 a[64:65], v6 offset:8224
    ds_read_b64_tr_b16 a[66:67], v6 offset:8736
    ds_read_b64_tr_b16 a[68:69], v6 offset:12320
    ds_read_b64_tr_b16 a[70:71], v6 offset:12832
    ds_read_b64_tr_b16 a[72:73], v6 offset:16416
    ds_read_b64_tr_b16 a[74:75], v6 offset:16928
    ds_read_b64_tr_b16 a[76:77], v6 offset:20512
    ds_read_b64_tr_b16 a[78:79], v6 offset:21024
    ds_read_b64_tr_b16 a[80:81], v6 offset:24608
    ds_read_b64_tr_b16 a[82:83], v6 offset:25120
    ds_read_b64_tr_b16 a[84:85], v6 offset:28704
    ds_read_b64_tr_b16 a[86:87], v6 offset:29216
    ds_read_b64_tr_b16 a[88:89], v6 offset:32800
    ds_read_b64_tr_b16 a[90:91], v6 offset:33312
    ds_read_b64_tr_b16 a[92:93], v6 offset:36896
    ds_read_b64_tr_b16 a[94:95], v6 offset:37408
    ds_read_b64_tr_b16 a[96:97], v6 offset:40992
    ds_read_b64_tr_b16 a[98:99], v6 offset:41504
    ds_read_b64_tr_b16 a[100:101], v6 offset:45088
    ds_read_b64_tr_b16 a[102:103], v6 offset:45600
    ds_read_b64_tr_b16 a[104:105], v6 offset:49184
    ds_read_b64_tr_b16 a[106:107], v6 offset:49696
    ds_read_b64_tr_b16 a[108:109], v6 offset:53280
    ds_read_b64_tr_b16 a[110:111], v6 offset:53792
    v_bfe_u32 v6, v1, 4, 2
    v_lshlrev_b32 v6, 7, v6
    v_bfe_u32 v7, v1, 2, 2
    v_lshl_add_u32 v6, v7, 5, v6
    v_bfe_u32 v7, v1, 0, 2
    v_lshl_add_u32 v6, v7, 3, v6
    v_add_u32 v6, 0xe000, v6
    s_mul_i32 s31, s20, 14336
    v_add_u32 v6, s31, v6
    ds_read_b64_tr_b16 a[112:113], v6 offset:0
    ds_read_b64_tr_b16 a[114:115], v6 offset:512
    ds_read_b64_tr_b16 a[116:117], v6 offset:1024
    ds_read_b64_tr_b16 a[118:119], v6 offset:1536
    ds_read_b64_tr_b16 a[120:121], v6 offset:2048
    ds_read_b64_tr_b16 a[122:123], v6 offset:2560
    ds_read_b64_tr_b16 a[124:125], v6 offset:3072
    ds_read_b64_tr_b16 a[126:127], v6 offset:3584
    ds_read_b64_tr_b16 a[128:129], v6 offset:4096
    ds_read_b64_tr_b16 a[130:131], v6 offset:4608
    ds_read_b64_tr_b16 a[132:133], v6 offset:5120
    ds_read_b64_tr_b16 a[134:135], v6 offset:5632
    ds_read_b64_tr_b16 a[136:137], v6 offset:6144
    ds_read_b64_tr_b16 a[138:139], v6 offset:6656
    ds_read_b64_tr_b16 a[140:141], v6 offset:7168
    ds_read_b64_tr_b16 a[142:143], v6 offset:7680
    ds_read_b64_tr_b16 a[144:145], v6 offset:8192
    ds_read_b64_tr_b16 a[146:147], v6 offset:8704
    ds_read_b64_tr_b16 a[148:149], v6 offset:9216
    ds_read_b64_tr_b16 a[150:151], v6 offset:9728
    ds_read_b64_tr_b16 a[152:153], v6 offset:10240
    ds_read_b64_tr_b16 a[154:155], v6 offset:10752
    ds_read_b64_tr_b16 a[156:157], v6 offset:11264
    ds_read_b64_tr_b16 a[158:159], v6 offset:11776
    ds_read_b64_tr_b16 a[160:161], v6 offset:12288
    ds_read_b64_tr_b16 a[162:163], v6 offset:12800
    ds_read_b64_tr_b16 a[164:165], v6 offset:13312
    ds_read_b64_tr_b16 a[166:167], v6 offset:13824
    v_lshlrev_b32 v10, 16, v22
    v_and_b32 v11, 0xffff0000, v22
    v_lshlrev_b32 v12, 16, v23
    v_and_b32 v13, 0xffff0000, v23
    v_lshlrev_b32 v14, 16, v24
    v_and_b32 v15, 0xffff0000, v24
    v_lshlrev_b32 v16, 16, v25
    v_and_b32 v17, 0xffff0000, v25
    s_waitcnt lgkmcnt(0)
    s_barrier
    v_lshlrev_b32 v6, 4, v0
    s_mov_b32 s29, 85563648
    buffer_load_dwordx4 v[24:27], v6, s[8:11], s29 offen
    v_mov_b32 v28, 0
    v_cmp_lt_u32 vcc, 111, v0
    s_nop 1
    v_cndmask_b32 v28, v28, 1.0, vcc
    s_waitcnt vmcnt(0)
    v_add_f32 v24, v24, v28
    v_add_f32 v25, v25, v28
    v_add_f32 v26, v26, v28
    v_add_f32 v27, v27, v28
    ds_write_b128 v6, v[24:27] offset:40960
    s_waitcnt lgkmcnt(0)
    s_barrier
H_nomlp:
    v_min_u32 v22, 55, v1
    v_lshlrev_b32 v22, 7, v22
    s_mov_b32 s28, 46770176
    s_mov_b32 s33, 400000
H_all0:
    buffer_load_dword v23, v22, s[8:11], s28 offen offset:0 sc1
    s_waitcnt vmcnt(0)
    v_cmp_eq_u32 vcc, -1, v23
    s_cbranch_vccz H_all0_ok
    s_sub_u32 s33, s33, 1
    s_cbranch_scc0 H_all0
    s_branch L_fail
H_all0_ok:
    s_mov_b32 s28, 46781440
    s_mov_b32 s33, 400000
H_all1:
    buffer_load_dword v23, v22, s[8:11], s28 offen offset:0 sc1
    s_waitcnt vmcnt(0)
    v_cmp_eq_u32 vcc, -1, v23
    s_cbranch_vccz H_all1_ok
    s_sub_u32 s33, s33, 1
    s_cbranch_scc0 H_all1
    s_branch L_fail
H_all1_ok:
    s_mov_b32 s28, 46792704
    s_mov_b32 s33, 400000
H_all2:
    buffer_load_dword v23, v22, s[8:11], s28 offen offset:0 sc1
    s_waitcnt vmcnt(0)
    v_cmp_eq_u32 vcc, -1, v23
    s_cbranch_vccz H_all2_ok
    s_sub_u32 s33, s33, 1
    s_cbranch_scc0 H_all2
    s_branch L_fail
H_all2_ok:
    s_mov_b32 s28, 46803968
    s_mov_b32 s33, 400000
H_all3:
    buffer_load_dword v23, v22, s[8:11], s28 offen offset:0 sc1
    s_waitcnt vmcnt(0)
    v_cmp_eq_u32 vcc, -1, v23
    s_cbranch_vccz H_all3_ok
    s_sub_u32 s33, s33, 1
    s_cbranch_scc0 H_all3
    s_branch L_fail
H_all3_ok:
    s_cmp_eq_u32 s21, 1
    s_cselect_b32 s27, 0, s21
    s_cmp_eq_u32 s21, 0
    s_cselect_b32 s27, 7, s27
    s_cmp_ge_u32 s22, 16
    s_cbranch_scc1 H_seg
    s_cmp_ge_u32 s20, 2
    s_cbranch_scc1 H_seg
    v_bfe_u32 v200, v1, 5, 1
    v_lshlrev_b32 v200, 10, v200
    v_bfe_u32 v6, v1, 4, 1
    v_lshl_add_u32 v200, v6, 9, v200
    v_bfe_u32 v6, v1, 0, 4
    v_lshl_add_u32 v200, v6, 4, v200
    s_mul_i32 s29, s27, 458752
    s_mul_i32 s30, s22, 28672
    s_add_u32 s29, s29, s30
    s_lshl_b32 s30, s20, 8
    s_add_u32 s29, s29, s30
    s_add_u32 s29, s29, 56198144
    buffer_load_dwordx4 a[168:171], v200, s[8:11], s29 offen offset:0 sc1
    buffer_load_dwordx4 a[172:175], v200, s[8:11], s29 offen offset:2048 sc1
    s_add_u32 s29, s29, 4096
    buffer_load_dwordx4 a[176:179], v200, s[8:11], s29 offen offset:0 sc1
    buffer_load_dwordx4 a[180:183], v200, s[8:11], s29 offen offset:2048 sc1
    s_add_u32 s29, s29, 4096
    buffer_load_dwordx4 a[184:187], v200, s[8:11], s29 offen offset:0 sc1
    buffer_load_dwordx4 a[188:191], v200, s[8:11], s29 offen offset:2048 sc1
    s_add_u32 s29, s29, 4096
    buffer_load_dwordx4 a[192:195], v200, s[8:11], s29 offen offset:0 sc1
    buffer_load_dwordx4 a[196:199], v200, s[8:11], s29 offen offset:2048 sc1
    s_add_u32 s29, s29, 4096
    buffer_load_dwordx4 a[200:203], v200, s[8:11], s29 offen offset:0 sc1
    buffer_load_dwordx4 a[204:207], v200, s[8:11], s29 offen offset:2048 sc1
    s_add_u32 s29, s29, 4096
    buffer_load_dwordx4 a[208:211], v200, s[8:11], s29 offen offset:0 sc1
    buffer_load_dwordx4 a[212:215], v200, s[8:11], s29 offen offset:2048 sc1
    s_add_u32 s29, s29, 4096
    buffer_load_dwordx4 a[216:219], v200, s[8:11], s29 offen offset:0 sc1
    buffer_load_dwordx4 a[220:223], v200, s[8:11], s29 offen offset:2048 sc1
    s_add_u32 s29, s29, 4096
    v_bfe_u32 v200, v1, 3, 1
    v_lshlrev_b32 v200, 12, v200
    v_bfe_u32 v6, v1, 4, 1
    v_lshl_add_u32 v200, v6, 8, v200
    v_bfe_u32 v6, v1, 0, 3
    v_lshl_add_u32 v200, v6, 4, v200
    v_bfe_u32 v6, v1, 5, 1
    v_mul_u32_u24 v7, 5120, v6
    v_add_u32 v201, v200, v7
    v_lshl_add_u32 v200, v6, 9, v200
    s_lshl_b32 s29, s27, 15
    s_add_u32 s29, s29, 12845056
    buffer_load_dwordx4 v[32:35], v200, s[8:11], s29 offen offset:0
    buffer_load_dwordx4 v[36:39], v200, s[8:11], s29 offen offset:128
    buffer_load_dwordx4 v[40:43], v200, s[8:11], s29 offen offset:1024
    buffer_load_dwordx4 v[44:47], v200, s[8:11], s29 offen offset:1152
    buffer_load_dwordx4 v[48:51], v200, s[8:11], s29 offen offset:2048
    buffer_load_dwordx4 v[52:55], v200, s[8:11], s29 offen offset:2176
    buffer_load_dwordx4 v[56:59], v201, s[8:11], s29 offen offset:3072
    buffer_load_dwordx4 v[60:63], v201, s[8:11], s29 offen offset:3200
    s_lshl_b32 s29, s27, 15
    s_add_u32 s29, s29, 12853248
    buffer_load_dwordx4 v[64:67], v200, s[8:11], s29 offen offset:512
    buffer_load_dwordx4 v[68:71], v200, s[8:11], s29 offen offset:640
    buffer_load_dwordx4 v[72:75], v200, s[8:11], s29 offen offset:1536
    buffer_load_dwordx4 v[76:79], v200, s[8:11], s29 offen offset:1664
    buffer_load_dwordx4 v[80:83], v200, s[8:11], s29 offen offset:2560
    buffer_load_dwordx4 v[84:87], v200, s[8:11], s29 offen offset:2688
    s_lshl_b32 s29, s27, 15
    s_add_u32 s29, s29, 12861440
    buffer_load_dwordx4 v[88:91], v200, s[8:11], s29 offen offset:0
    buffer_load_dwordx4 v[92:95], v200, s[8:11], s29 offen offset:128
    buffer_load_dwordx4 v[96:99], v200, s[8:11], s29 offen offset:1024
    buffer_load_dwordx4 v[100:103], v200, s[8:11], s29 offen offset:1152
    buffer_load_dwordx4 v[104:107], v200, s[8:11], s29 offen offset:2048
    buffer_load_dwordx4 v[108:111], v200, s[8:11], s29 offen offset:2176
    buffer_load_dwordx4 v[112:115], v201, s[8:11], s29 offen offset:3072
    buffer_load_dwordx4 v[116:119], v201, s[8:11], s29 offen offset:3200
    s_lshl_b32 s29, s27, 15
    s_add_u32 s29, s29, 12869632
    buffer_load_dwordx4 v[120:123], v200, s[8:11], s29 offen offset:512
    buffer_load_dwordx4 v[124:127], v200, s[8:11], s29 offen offset:640
    buffer_load_dwordx4 v[128:131], v200, s[8:11], s29 offen offset:1536
    buffer_load_dwordx4 v[132:135], v200, s[8:11], s29 offen offset:1664
    buffer_load_dwordx4 v[136:139], v200, s[8:11], s29 offen offset:2560
    buffer_load_dwordx4 v[140:143], v200, s[8:11], s29 offen offset:2688
    s_waitcnt vmcnt(26)
    v_mfma_f32_16x16x32_bf16 v[24:27], v[32:35], a[168:171], 0
    v_mfma_f32_16x16x32_bf16 v[28:31], v[36:39], a[168:171], 0
    s_waitcnt vmcnt(24)
    v_mfma_f32_16x16x32_bf16 v[24:27], v[40:43], a[172:175], v[24:27]
    v_mfma_f32_16x16x32_bf16 v[28:31], v[44:47], a[172:175], v[28:31]
    s_waitcnt vmcnt(22)
    v_mfma_f32_16x16x32_bf16 v[24:27], v[48:51], a[176:179], v[24:27]
    v_mfma_f32_16x16x32_bf16 v[28:31], v[52:55], a[176:179], v[28:31]
    s_waitcnt vmcnt(20)
    v_mfma_f32_16x16x32_bf16 v[24:27], v[56:59], a[180:183], v[24:27]
    v_mfma_f32_16x16x32_bf16 v[28:31], v[60:63], a[180:183], v[28:31]
    s_waitcnt vmcnt(18)
    v_mfma_f32_16x16x32_bf16 v[24:27], v[64:67], a[184:187], v[24:27]
    v_mfma_f32_16x16x32_bf16 v[28:31], v[68:71], a[184:187], v[28:31]
    s_waitcnt vmcnt(16)
    v_mfma_f32_16x16x32_bf16 v[24:27], v[72:75], a[188:191], v[24:27]
    v_mfma_f32_16x16x32_bf16 v[28:31], v[76:79], a[188:191], v[28:31]
    s_waitcnt vmcnt(14)
    v_mfma_f32_16x16x32_bf16 v[24:27], v[80:83], a[192:195], v[24:27]
    v_mfma_f32_16x16x32_bf16 v[28:31], v[84:87], a[192:195], v[28:31]
    s_waitcnt vmcnt(12)
    v_mfma_f32_16x16x32_bf16 v[24:27], v[88:91], a[196:199], v[24:27]
    v_mfma_f32_16x16x32_bf16 v[28:31], v[92:95], a[196:199], v[28:31]
    s_waitcnt vmcnt(10)
    v_mfma_f32_16x16x32_bf16 v[24:27], v[96:99], a[200:203], v[24:27]
    v_mfma_f32_16x16x32_bf16 v[28:31], v[100:103], a[200:203], v[28:31]
    s_waitcnt vmcnt(8)
    v_mfma_f32_16x16x32_bf16 v[24:27], v[104:107], a[204:207], v[24:27]
    v_mfma_f32_16x16x32_bf16 v[28:31], v[108:111], a[204:207], v[28:31]
    s_waitcnt vmcnt(6)
    v_mfma_f32_16x16x32_bf16 v[24:27], v[112:115], a[208:211], v[24:27]
    v_mfma_f32_16x16x32_bf16 v[28:31], v[116:119], a[208:211], v[28:31]
    s_waitcnt vmcnt(4)
    v_mfma_f32_16x16x32_bf16 v[24:27], v[120:123], a[212:215], v[24:27]
    v_mfma_f32_16x16x32_bf16 v[28:31], v[124:127], a[212:215], v[28:31]
    s_waitcnt vmcnt(2)
    v_mfma_f32_16x16x32_bf16 v[24:27], v[128:131], a[216:219], v[24:27]
    v_mfma_f32_16x16x32_bf16 v[28:31], v[132:135], a[216:219], v[28:31]
    s_waitcnt vmcnt(0)
    v_mfma_f32_16x16x32_bf16 v[24:27], v[136:139], a[220:223], v[24:27]
    v_mfma_f32_16x16x32_bf16 v[28:31], v[140:143], a[220:223], v[28:31]
    v_bfe_u32 v200, v1, 5, 1
    v_lshlrev_b32 v200, 4, v200
    v_bfe_u32 v6, v1, 4, 1
    v_lshl_add_u32 v200, v6, 2, v200
    s_lshl_b32 s29, s20, 4
    v_add_u32 v6, s29, v9
    v_sub_u32 v200, v6, v200
    v_mov_b32 v7, 0xf149f2ca
    s_nop 3
    v_cmp_gt_i32 vcc, 0, v200
    s_nop 1
    v_cndmask_b32 v24, v24, v7, vcc
    v_cmp_gt_i32 vcc, 1, v200
    s_nop 1
    v_cndmask_b32 v25, v25, v7, vcc
    v_cmp_gt_i32 vcc, 2, v200
    s_nop 1
    v_cndmask_b32 v26, v26, v7, vcc
    v_cmp_gt_i32 vcc, 3, v200
    s_nop 1
    v_cndmask_b32 v27, v27, v7, vcc
    v_cmp_gt_i32 vcc, 8, v200
    s_nop 1
    v_cndmask_b32 v28, v28, v7, vcc
    v_cmp_gt_i32 vcc, 9, v200
    s_nop 1
    v_cndmask_b32 v29, v29, v7, vcc
    v_cmp_gt_i32 vcc, 10, v200
    s_nop 1
    v_cndmask_b32 v30, v30, v7, vcc
    v_cmp_gt_i32 vcc, 11, v200
    s_nop 1
    v_cndmask_b32 v31, v31, v7, vcc
    v_accvgpr_write_b32 a224, v24
    v_accvgpr_write_b32 a225, v25
    v_accvgpr_write_b32 a226, v26
    v_accvgpr_write_b32 a227, v27
    v_accvgpr_write_b32 a228, v28
    v_accvgpr_write_b32 a229, v29
    v_accvgpr_write_b32 a230, v30
    v_accvgpr_write_b32 a231, v31
H_seg:
    s_mul_i32 s28, s27, 11264
    s_add_u32 s28, s28, 46094336
    s_add_u32 s24, s28, 10752
    s_cmp_lg_u32 s20, 3
    s_cbranch_scc1 H_nt
    s_mul_i32 s29, s27, 114688
    s_add_u32 s29, s29, 90031104
    s_mov_b32 s30, 0
    s_mul_i32 s31, s27, 40960
    s_add_u32 s31, s31, 85574656
    s_cmp_ge_u32 s22, 14
    s_cselect_b32 s29, s31, s29
    s_cselect_b32 s30, 14, s30
    s_mul_i32 s31, s27, 28672
    s_add_u32 s31, s31, 88196096
    s_cmp_ge_u32 s22, 19
    s_cselect_b32 s29, s31, s29
    s_cselect_b32 s30, 19, s30
    s_sub_u32 s30, s22, s30
    s_lshl_b32 s30, s30, 13
    s_add_u32 s29, s29, s30
    s_cmp_ge_u32 s22, 23
    s_cbranch_scc1 H_nt
    v_lshlrev_b32 v6, 7, v1
    buffer_load_dword v7, v6, s[8:11], s29 offen
H_nt:
    s_cmp_ge_u32 s22, 16
    s_cbranch_scc1 H_x2
    s_cmp_ge_u32 s20, 2
    s_cbranch_scc1 H_x1_end
    v_accvgpr_read_b32 v24, a224
    v_accvgpr_read_b32 v25, a225
    v_accvgpr_read_b32 v26, a226
    v_accvgpr_read_b32 v27, a227
    v_accvgpr_read_b32 v28, a228
    v_accvgpr_read_b32 v29, a229
    v_accvgpr_read_b32 v30, a230
    v_accvgpr_read_b32 v31, a231
    v_bfe_u32 v200, v1, 5, 1
    v_lshlrev_b32 v200, 8, v200
    v_bfe_u32 v6, v1, 2, 2
    v_lshl_add_u32 v200, v6, 6, v200
    v_bfe_u32 v6, v1, 4, 1
    v_lshl_add_u32 v200, v6, 5, v200
    v_bfe_u32 v6, v1, 0, 1
    v_lshl_add_u32 v200, v6, 4, v200
    s_lshl_b32 s29, s27, 13
    s_add_u32 s29, s29, 45547520
    s_add_u32 s30, s29, 4096
    s_mov_b32 s33, 400000
    s_cmp_eq_u32 s27, 0
    s_cbranch_scc1 H_x1_m
    s_sub_u32 s31, s29, 8192
    s_mov_b32 s33, 400000
H_x1_wm:
    buffer_load_dword v23, v3, s[8:11], s31 offen offset:0 sc1
    s_waitcnt vmcnt(0)
    v_cmp_eq_u32 vcc, -1, v23
    s_cbranch_vccz H_x1_wm_ok
    s_sleep 4
    s_sub_u32 s33, s33, 1
    s_cbranch_scc0 H_x1_wm
    s_branch L_fail
H_x1_wm_ok:
    s_mov_b32 s33, 400000
H_x1_m:
    buffer_load_dwordx4 v[144:147], v200, s[8:11], s29 offen offset:0 sc1
    buffer_load_dwordx4 v[148:151], v200, s[8:11], s29 offen offset:512 sc1
    buffer_load_dwordx4 v[152:155], v200, s[8:11], s29 offen offset:1024 sc1
    buffer_load_dwordx4 v[156:159], v200, s[8:11], s29 offen offset:1536 sc1
    buffer_load_dwordx4 v[160:163], v200, s[8:11], s29 offen offset:2048 sc1
    buffer_load_dwordx4 v[164:167], v200, s[8:11], s29 offen offset:2560 sc1
    buffer_load_dwordx4 v[168:171], v200, s[8:11], s29 offen offset:3072 sc1
    buffer_load_dwordx4 v[172:175], v200, s[8:11], s29 offen offset:3584 sc1
    buffer_load_dwordx4 v[176:179], v200, s[8:11], s30 offen offset:0 sc1
    buffer_load_dwordx4 v[180:183], v200, s[8:11], s30 offen offset:512 sc1
    buffer_load_dwordx4 v[184:187], v200, s[8:11], s30 offen offset:1024 sc1
    buffer_load_dwordx4 v[188:191], v200, s[8:11], s30 offen offset:1536 sc1
    buffer_load_dwordx4 v[192:195], v200, s[8:11], s30 offen offset:2048 sc1
    buffer_load_dwordx4 v[196:199], v200, s[8:11], s30 offen offset:2560 sc1
    s_waitcnt vmcnt(0)
    v_max3_u32 v6, v144, v145, v146
    v_max3_u32 v6, v6, v147, v148
    v_max3_u32 v6, v6, v149, v150
    v_max3_u32 v6, v6, v151, v152
    v_max3_u32 v6, v6, v153, v154
    v_max3_u32 v6, v6, v155, v156
    v_max3_u32 v6, v6, v157, v158
    v_max3_u32 v6, v6, v159, v160
    v_max3_u32 v6, v6, v161, v162
    v_max3_u32 v6, v6, v163, v164
    v_max3_u32 v6, v6, v165, v166
    v_max3_u32 v6, v6, v167, v168
    v_max3_u32 v6, v6, v169, v170
    v_max3_u32 v6, v6, v171, v172
    v_max3_u32 v6, v6, v173, v174
    v_max3_u32 v6, v6, v175, v176
    v_max3_u32 v6, v6, v177, v178
    v_max3_u32 v6, v6, v179, v180
    v_max3_u32 v6, v6, v181, v182
    v_max3_u32 v6, v6, v183, v184
    v_max3_u32 v6, v6, v185, v186
    v_max3_u32 v6, v6, v187, v188
    v_max3_u32 v6, v6, v189, v190
    v_max3_u32 v6, v6, v191, v192
    v_max3_u32 v6, v6, v193, v194
    v_max3_u32 v6, v6, v195, v196
    v_max3_u32 v6, v6, v197, v198
    v_max_u32 v6, v6, v199
    v_cmp_eq_u32 vcc, -1, v6
    s_cbranch_vccz H_x1_go
    s_sub_u32 s33, s33, 1
    s_cbranch_scc0 H_x1_m
    s_branch L_fail
H_x1_go:
    v_mfma_f32_16x16x32_bf16 v[88:91], v[144:147], a[168:171], 0
    v_mfma_f32_16x16x32_bf16 v[88:91], v[148:151], a[172:175], v[88:91]
    v_mfma_f32_16x16x32_bf16 v[88:91], v[152:155], a[176:179], v[88:91]
    v_mfma_f32_16x16x32_bf16 v[88:91], v[156:159], a[180:183], v[88:91]
    v_mfma_f32_16x16x32_bf16 v[88:91], v[160:163], a[184:187], v[88:91]
    v_mfma_f32_16x16x32_bf16 v[88:91], v[164:167], a[188:191], v[88:91]
    v_mfma_f32_16x16x32_bf16 v[88:91], v[168:171], a[192:195], v[88:91]
    v_mfma_f32_16x16x32_bf16 v[88:91], v[172:175], a[196:199], v[88:91]
    v_mfma_f32_16x16x32_bf16 v[88:91], v[176:179], a[200:203], v[88:91]
    v_mfma_f32_16x16x32_bf16 v[88:91], v[180:183], a[204:207], v[88:91]
    v_mfma_f32_16x16x32_bf16 v[88:91], v[184:187], a[208:211], v[88:91]
    v_mfma_f32_16x16x32_bf16 v[88:91], v[188:191], a[212:215], v[88:91]
    v_mfma_f32_16x16x32_bf16 v[88:91], v[192:195], a[216:219], v[88:91]
    v_mfma_f32_16x16x32_bf16 v[88:91], v[196:199], a[220:223], v[88:91]
    v_max3_f32 v92, v24, v25, v26
    v_max3_f32 v92, v92, v27, v28
    v_max3_f32 v92, v92, v29, v30
    v_max_f32 v92, v92, v31
    s_nop 3
    v_max3_f32 v92, v92, v88, v89
    v_mov_b32 v93, v92
    s_nop 1
    v_permlane16_swap_b32 v92, v93
    v_max_f32 v92, v92, v93
    v_mov_b32 v93, v92
    s_nop 1
    v_permlane32_swap_b32 v92, v93
    v_max_f32 v92, v92, v93
    v_sub_f32 v24, v24, v92
    v_sub_f32 v25, v25, v92
    v_sub_f32 v26, v26, v92
    v_sub_f32 v27, v27, v92
    v_sub_f32 v28, v28, v92
    v_sub_f32 v29, v29, v92
    v_sub_f32 v30, v30, v92
    v_sub_f32 v31, v31, v92
    v_sub_f32 v88, v88, v92
    v_sub_f32 v89, v89, v92
    v_exp_f32 v24, v24
    v_exp_f32 v25, v25
    v_exp_f32 v26, v26
    v_exp_f32 v27, v27
    v_exp_f32 v28, v28
    v_exp_f32 v29, v29
    v_exp_f32 v30, v30
    v_exp_f32 v31, v31
    v_exp_f32 v88, v88
    v_exp_f32 v89, v89
    v_add_f32 v92, v24, v25
    v_add_f32 v92, v92, v26
    v_add_f32 v92, v92, v27
    v_add_f32 v92, v92, v28
    v_add_f32 v92, v92, v29
    v_add_f32 v92, v92, v30
    v_add_f32 v92, v92, v31
    v_add_f32 v92, v92, v88
    v_add_f32 v92, v92, v89
    v_mov_b32 v93, v92
    s_nop 1
    v_permlane16_swap_b32 v92, v93
    v_add_f32 v92, v92, v93
    v_mov_b32 v93, v92
    s_nop 1
    v_permlane32_swap_b32 v92, v93
    v_add_f32 v92, v92, v93
    v_rcp_f32 v92, v92
    s_nop 0
    v_mul_f32 v24, v24, v92
    v_mul_f32 v25, v25, v92
    v_mul_f32 v26, v26, v92
    v_mul_f32 v27, v27, v92
    v_mul_f32 v28, v28, v92
    v_mul_f32 v29, v29, v92
    v_mul_f32 v30, v30, v92
    v_mul_f32 v31, v31, v92
    v_mul_f32 v88, v88, v92
    v_mul_f32 v89, v89, v92
    v_cvt_pk_bf16_f32 v24, v24, v25
    v_cvt_pk_bf16_f32 v25, v26, v27
    v_cvt_pk_bf16_f32 v26, v28, v29
    v_cvt_pk_bf16_f32 v27, v30, v31
    v_cvt_pk_bf16_f32 v88, v88, v89
    s_mul_i32 s29, s27, 40960
    s_mul_i32 s30, s20, 20480
    s_add_u32 s29, s29, s30
    s_add_u32 s29, s29, 85574656
    s_lshl_b32 s30, s22, 10
    s_add_u32 s30, s30, s29
    buffer_store_dwordx4 v[24:27], v2, s[8:11], s30 offen offset:0
    s_lshr_b32 s30, s22, 2
    s_lshl_b32 s30, s30, 10
    s_add_u32 s29, s29, s30
    s_and_b32 s30, s22, 3
    s_lshl_b32 s30, s30, 2
    s_add_u32 s29, s29, s30
    s_add_u32 s29, s29, 16384
    buffer_store_dword v88, v2, s[8:11], s29 offen offset:0
    s_waitcnt vmcnt(0)
H_x1_end:
    s_lshl_b32 s29, s22, 2
    s_add_u32 s29, s29, s24
    s_barrier
    s_cmp_lg_u32 s20, 0
    s_cbranch_scc1 H_f_24
    s_mov_b64 exec, 1
    buffer_store_dword v3, v3, s[8:11], s29 offen offset:0
    s_mov_b64 exec, -1
H_f_24:
    s_cmp_eq_u32 s27, 0
    s_cselect_b32 s25, 1, 7
    s_add_u32 s25, s25, s27
    s_cmp_ge_u32 s25, 64
    s_cbranch_scc1 H_fa
    s_cmp_ge_u32 s20, 2
    s_cbranch_scc1 H_fa
    v_bfe_u32 v200, v1, 5, 1
    v_lshlrev_b32 v200, 10, v200
    v_bfe_u32 v6, v1, 4, 1
    v_lshl_add_u32 v200, v6, 9, v200
    v_bfe_u32 v6, v1, 0, 4
    v_lshl_add_u32 v200, v6, 4, v200
    s_mul_i32 s29, s25, 458752
    s_mul_i32 s30, s22, 28672
    s_add_u32 s29, s29, s30
    s_lshl_b32 s30, s20, 8
    s_add_u32 s29, s29, s30
    s_add_u32 s29, s29, 56198144
    buffer_load_dwordx4 a[168:171], v200, s[8:11], s29 offen offset:0 sc1
    buffer_load_dwordx4 a[172:175], v200, s[8:11], s29 offen offset:2048 sc1
    s_add_u32 s29, s29, 4096
    buffer_load_dwordx4 a[176:179], v200, s[8:11], s29 offen offset:0 sc1
    buffer_load_dwordx4 a[180:183], v200, s[8:11], s29 offen offset:2048 sc1
    s_add_u32 s29, s29, 4096
    buffer_load_dwordx4 a[184:187], v200, s[8:11], s29 offen offset:0 sc1
    buffer_load_dwordx4 a[188:191], v200, s[8:11], s29 offen offset:2048 sc1
    s_add_u32 s29, s29, 4096
    buffer_load_dwordx4 a[192:195], v200, s[8:11], s29 offen offset:0 sc1
    buffer_load_dwordx4 a[196:199], v200, s[8:11], s29 offen offset:2048 sc1
    s_add_u32 s29, s29, 4096
    buffer_load_dwordx4 a[200:203], v200, s[8:11], s29 offen offset:0 sc1
    buffer_load_dwordx4 a[204:207], v200, s[8:11], s29 offen offset:2048 sc1
    s_add_u32 s29, s29, 4096
    buffer_load_dwordx4 a[208:211], v200, s[8:11], s29 offen offset:0 sc1
    buffer_load_dwordx4 a[212:215], v200, s[8:11], s29 offen offset:2048 sc1
    s_add_u32 s29, s29, 4096
    buffer_load_dwordx4 a[216:219], v200, s[8:11], s29 offen offset:0 sc1
    buffer_load_dwordx4 a[220:223], v200, s[8:11], s29 offen offset:2048 sc1
    s_add_u32 s29, s29, 4096
    v_bfe_u32 v200, v1, 3, 1
    v_lshlrev_b32 v200, 12, v200
    v_bfe_u32 v6, v1, 4, 1
    v_lshl_add_u32 v200, v6, 8, v200
    v_bfe_u32 v6, v1, 0, 3
    v_lshl_add_u32 v200, v6, 4, v200
    v_bfe_u32 v6, v1, 5, 1
    v_mul_u32_u24 v7, 5120, v6
    v_add_u32 v201, v200, v7
    v_lshl_add_u32 v200, v6, 9, v200
    s_lshl_b32 s29, s25, 15
    s_add_u32 s29, s29, 12845056
    buffer_load_dwordx4 v[32:35], v200, s[8:11], s29 offen offset:0
    buffer_load_dwordx4 v[36:39], v200, s[8:11], s29 offen offset:128
    buffer_load_dwordx4 v[40:43], v200, s[8:11], s29 offen offset:1024
    buffer_load_dwordx4 v[44:47], v200, s[8:11], s29 offen offset:1152
    buffer_load_dwordx4 v[48:51], v200, s[8:11], s29 offen offset:2048
    buffer_load_dwordx4 v[52:55], v200, s[8:11], s29 offen offset:2176
    buffer_load_dwordx4 v[56:59], v201, s[8:11], s29 offen offset:3072
    buffer_load_dwordx4 v[60:63], v201, s[8:11], s29 offen offset:3200
    s_lshl_b32 s29, s25, 15
    s_add_u32 s29, s29, 12853248
    buffer_load_dwordx4 v[64:67], v200, s[8:11], s29 offen offset:512
    buffer_load_dwordx4 v[68:71], v200, s[8:11], s29 offen offset:640
    buffer_load_dwordx4 v[72:75], v200, s[8:11], s29 offen offset:1536
    buffer_load_dwordx4 v[76:79], v200, s[8:11], s29 offen offset:1664
    buffer_load_dwordx4 v[80:83], v200, s[8:11], s29 offen offset:2560
    buffer_load_dwordx4 v[84:87], v200, s[8:11], s29 offen offset:2688
    s_lshl_b32 s29, s25, 15
    s_add_u32 s29, s29, 12861440
    buffer_load_dwordx4 v[88:91], v200, s[8:11], s29 offen offset:0
    buffer_load_dwordx4 v[92:95], v200, s[8:11], s29 offen offset:128
    buffer_load_dwordx4 v[96:99], v200, s[8:11], s29 offen offset:1024
    buffer_load_dwordx4 v[100:103], v200, s[8:11], s29 offen offset:1152
    buffer_load_dwordx4 v[104:107], v200, s[8:11], s29 offen offset:2048
    buffer_load_dwordx4 v[108:111], v200, s[8:11], s29 offen offset:2176
    buffer_load_dwordx4 v[112:115], v201, s[8:11], s29 offen offset:3072
    buffer_load_dwordx4 v[116:119], v201, s[8:11], s29 offen offset:3200
    s_lshl_b32 s29, s25, 15
    s_add_u32 s29, s29, 12869632
    buffer_load_dwordx4 v[120:123], v200, s[8:11], s29 offen offset:512
    buffer_load_dwordx4 v[124:127], v200, s[8:11], s29 offen offset:640
    buffer_load_dwordx4 v[128:131], v200, s[8:11], s29 offen offset:1536
    buffer_load_dwordx4 v[132:135], v200, s[8:11], s29 offen offset:1664
    buffer_load_dwordx4 v[136:139], v200, s[8:11], s29 offen offset:2560
    buffer_load_dwordx4 v[140:143], v200, s[8:11], s29 offen offset:2688
    s_waitcnt vmcnt(26)
    v_mfma_f32_16x16x32_bf16 v[24:27], v[32:35], a[168:171], 0
    v_mfma_f32_16x16x32_bf16 v[28:31], v[36:39], a[168:171], 0
    s_waitcnt vmcnt(24)
    v_mfma_f32_16x16x32_bf16 v[24:27], v[40:43], a[172:175], v[24:27]
    v_mfma_f32_16x16x32_bf16 v[28:31], v[44:47], a[172:175], v[28:31]
    s_waitcnt vmcnt(22)
    v_mfma_f32_16x16x32_bf16 v[24:27], v[48:51], a[176:179], v[24:27]
    v_mfma_f32_16x16x32_bf16 v[28:31], v[52:55], a[176:179], v[28:31]
    s_waitcnt vmcnt(20)
    v_mfma_f32_16x16x32_bf16 v[24:27], v[56:59], a[180:183], v[24:27]
    v_mfma_f32_16x16x32_bf16 v[28:31], v[60:63], a[180:183], v[28:31]
    s_waitcnt vmcnt(18)
    v_mfma_f32_16x16x32_bf16 v[24:27], v[64:67], a[184:187], v[24:27]
    v_mfma_f32_16x16x32_bf16 v[28:31], v[68:71], a[184:187], v[28:31]
    s_waitcnt vmcnt(16)
    v_mfma_f32_16x16x32_bf16 v[24:27], v[72:75], a[188:191], v[24:27]
    v_mfma_f32_16x16x32_bf16 v[28:31], v[76:79], a[188:191], v[28:31]
    s_waitcnt vmcnt(14)
    v_mfma_f32_16x16x32_bf16 v[24:27], v[80:83], a[192:195], v[24:27]
    v_mfma_f32_16x16x32_bf16 v[28:31], v[84:87], a[192:195], v[28:31]
    s_waitcnt vmcnt(12)
    v_mfma_f32_16x16x32_bf16 v[24:27], v[88:91], a[196:199], v[24:27]
    v_mfma_f32_16x16x32_bf16 v[28:31], v[92:95], a[196:199], v[28:31]
    s_waitcnt vmcnt(10)
    v_mfma_f32_16x16x32_bf16 v[24:27], v[96:99], a[200:203], v[24:27]
    v_mfma_f32_16x16x32_bf16 v[28:31], v[100:103], a[200:203], v[28:31]
    s_waitcnt vmcnt(8)
    v_mfma_f32_16x16x32_bf16 v[24:27], v[104:107], a[204:207], v[24:27]
    v_mfma_f32_16x16x32_bf16 v[28:31], v[108:111], a[204:207], v[28:31]
    s_waitcnt vmcnt(6)
    v_mfma_f32_16x16x32_bf16 v[24:27], v[112:115], a[208:211], v[24:27]
    v_mfma_f32_16x16x32_bf16 v[28:31], v[116:119], a[208:211], v[28:31]
    s_waitcnt vmcnt(4)
    v_mfma_f32_16x16x32_bf16 v[24:27], v[120:123], a[212:215], v[24:27]
    v_mfma_f32_16x16x32_bf16 v[28:31], v[124:127], a[212:215], v[28:31]
    s_waitcnt vmcnt(2)
    v_mfma_f32_16x16x32_bf16 v[24:27], v[128:131], a[216:219], v[24:27]
    v_mfma_f32_16x16x32_bf16 v[28:31], v[132:135], a[216:219], v[28:31]
    s_waitcnt vmcnt(0)
    v_mfma_f32_16x16x32_bf16 v[24:27], v[136:139], a[220:223], v[24:27]
    v_mfma_f32_16x16x32_bf16 v[28:31], v[140:143], a[220:223], v[28:31]
    v_bfe_u32 v200, v1, 5, 1
    v_lshlrev_b32 v200, 4, v200
    v_bfe_u32 v6, v1, 4, 1
    v_lshl_add_u32 v200, v6, 2, v200
    s_lshl_b32 s29, s20, 4
    v_add_u32 v6, s29, v9
    v_sub_u32 v200, v6, v200
    v_mov_b32 v7, 0xf149f2ca
    s_nop 3
    v_cmp_gt_i32 vcc, 0, v200
    s_nop 1
    v_cndmask_b32 v24, v24, v7, vcc
    v_cmp_gt_i32 vcc, 1, v200
    s_nop 1
    v_cndmask_b32 v25, v25, v7, vcc
    v_cmp_gt_i32 vcc, 2, v200
    s_nop 1
    v_cndmask_b32 v26, v26, v7, vcc
    v_cmp_gt_i32 vcc, 3, v200
    s_nop 1
    v_cndmask_b32 v27, v27, v7, vcc
    v_cmp_gt_i32 vcc, 8, v200
    s_nop 1
    v_cndmask_b32 v28, v28, v7, vcc
    v_cmp_gt_i32 vcc, 9, v200
    s_nop 1
    v_cndmask_b32 v29, v29, v7, vcc
    v_cmp_gt_i32 vcc, 10, v200
    s_nop 1
    v_cndmask_b32 v30, v30, v7, vcc
    v_cmp_gt_i32 vcc, 11, v200
    s_nop 1
    v_cndmask_b32 v31, v31, v7, vcc
    v_accvgpr_write_b32 a224, v24
    v_accvgpr_write_b32 a225, v25
    v_accvgpr_write_b32 a226, v26
    v_accvgpr_write_b32 a227, v27
    v_accvgpr_write_b32 a228, v28
    v_accvgpr_write_b32 a229, v29
    v_accvgpr_write_b32 a230, v30
    v_accvgpr_write_b32 a231, v31
    s_branch H_fa
H_x2:
    s_sub_u32 s34, s22, 16
    s_lshr_b32 s32, s20, 1
    s_and_b32 s31, s20, 1
    v_and_b32 v22, 1, v1
    v_lshlrev_b32 v22, 7, v22
    s_lshl_b32 s29, s34, 8
    v_add_u32 v22, s29, v22
    s_mul_i32 s29, s27, 458752
    s_lshl_b32 s30, s34, 15
    s_add_u32 s29, s29, s30
    s_lshl_b32 s30, s31, 13
    s_add_u32 s29, s29, s30
    s_add_u32 s29, s29, 14942208
    buffer_load_dwordx4 v[32:35], v2, s[8:11], s29 offen offset:0 sc1
    buffer_load_dwordx4 v[36:39], v2, s[8:11], s29 offen offset:1024 sc1
    buffer_load_dwordx4 v[40:43], v2, s[8:11], s29 offen offset:2048 sc1
    buffer_load_dwordx4 v[44:47], v2, s[8:11], s29 offen offset:3072 sc1
    s_add_u32 s29, s29, 4096
    buffer_load_dwordx4 v[48:51], v2, s[8:11], s29 offen offset:0 sc1
    buffer_load_dwordx4 v[52:55], v2, s[8:11], s29 offen offset:1024 sc1
    buffer_load_dwordx4 v[56:59], v2, s[8:11], s29 offen offset:2048 sc1
    buffer_load_dwordx4 v[60:63], v2, s[8:11], s29 offen offset:3072 sc1
    s_add_u32 s29, s29, 12288
    buffer_load_dwordx4 v[72:75], v2, s[8:11], s29 offen offset:0 sc1
    buffer_load_dwordx4 v[76:79], v2, s[8:11], s29 offen offset:1024 sc1
    buffer_load_dwordx4 v[80:83], v2, s[8:11], s29 offen offset:2048 sc1
    buffer_load_dwordx4 v[84:87], v2, s[8:11], s29 offen offset:3072 sc1
    s_add_u32 s29, s29, 4096
    buffer_load_dwordx4 v[88:91], v2, s[8:11], s29 offen offset:0 sc1
    buffer_load_dwordx4 v[92:95], v2, s[8:11], s29 offen offset:1024 sc1
    buffer_load_dwordx4 v[96:99], v2, s[8:11], s29 offen offset:2048 sc1
    buffer_load_dwordx4 v[100:103], v2, s[8:11], s29 offen offset:3072 sc1
    s_add_u32 s29, s29, 12288
    v_mul_u32_u24 v200, 896, v9
    v_lshl_add_u32 v200, v8, 3, v200
    s_lshl_b32 s30, s27, 1
    s_add_u32 s30, s30, s32
    s_mul_i32 s30, s30, 14336
    s_lshl_b32 s35, s34, 1
    s_add_u32 s35, s35, s31
    s_lshl_b32 s29, s35, 5
    s_add_u32 s30, s30, s29
    buffer_load_dwordx2 v[24:25], v200, s[36:39], s30 offen
    v_lshlrev_b32 v6, 4, v8
    s_lshl_b32 s29, s35, 6
    s_add_u32 s29, s29, 85561856
    buffer_load_dwordx4 v[28:31], v6, s[8:11], s29 offen
    s_cmp_eq_u32 s27, 63
    s_cselect_b32 s35, 6, 5
    v_and_b32 v22, 3, v1
    v_lshlrev_b32 v22, s35, v22
    s_lshl_b32 s35, s34, 8
    s_add_u32 s35, s35, 7168
    v_add_u32 v22, s35, v22
    s_mov_b32 s33, 400000
H_x2_wy:
    buffer_load_dword v23, v22, s[8:11], s28 offen offset:0 sc1
    s_waitcnt vmcnt(0)
    v_cmp_eq_u32 vcc, -1, v23
    s_cbranch_vccz H_x2_wy_ok
    s_sub_u32 s33, s33, 1
    s_cbranch_scc0 H_x2_wy
    s_branch L_fail
H_x2_wy_ok:
    s_mul_i32 s29, s27, 114688
    s_lshl_b32 s35, s34, 13
    s_add_u32 s29, s29, s35
    s_lshl_b32 s35, s31, 11
    s_add_u32 s29, s29, s35
    s_add_u32 s29, s29, 47023104
    s_add_u32 s35, s29, 4096
    buffer_load_dwordx4 v[64:67], v2, s[8:11], s29 offen offset:0 sc1
    buffer_load_dwordx4 v[68:71], v2, s[8:11], s29 offen offset:1024 sc1
    buffer_load_dwordx4 v[104:107], v2, s[8:11], s35 offen offset:0 sc1
    buffer_load_dwordx4 v[108:111], v2, s[8:11], s35 offen offset:1024 sc1
    v_lshlrev_b32 v22, 2, v9
    s_mul_i32 s29, s27, 40960
    s_mul_i32 s35, s32, 20480
    s_add_u32 s29, s29, s35
    s_add_u32 s29, s29, 85574656
    s_lshl_b32 s35, s31, 11
    s_add_u32 s35, s35, s29
    s_add_u32 s35, s35, 16384
    s_lshl_b32 s25, s31, 13
    s_add_u32 s29, s29, s25
    s_add_u32 s25, s29, 4096
    s_xor_b32 s26, s20, 1
    s_lshl_b32 s26, s26, 10
    v_add_u32 v201, s26, v2
    s_lshl_b32 s26, s20, 10
    s_mov_b32 s33, 400000
H_x2_wp:
    buffer_load_dword v23, v22, s[8:11], s24 offen offset:0 sc1
    s_waitcnt vmcnt(0)
    v_cmp_eq_u32 vcc, -1, v23
    s_cbranch_vccz H_x2_wp_ok
    s_sub_u32 s33, s33, 1
    s_cbranch_scc0 H_x2_wp
    s_branch L_fail
H_x2_wp_ok:
    buffer_load_dwordx4 v[112:115], v2, s[8:11], s29 offen offset:0 sc1
    buffer_load_dwordx4 v[116:119], v2, s[8:11], s29 offen offset:1024 sc1
    buffer_load_dwordx4 v[120:123], v2, s[8:11], s29 offen offset:2048 sc1
    buffer_load_dwordx4 v[124:127], v2, s[8:11], s29 offen offset:3072 sc1
    buffer_load_dwordx4 v[128:131], v2, s[8:11], s25 offen offset:0 sc1
    buffer_load_dwordx4 v[132:135], v2, s[8:11], s25 offen offset:1024 sc1
    buffer_load_dwordx4 v[136:139], v2, s[8:11], s25 offen offset:2048 sc1
    buffer_load_dwordx4 v[140:143], v2, s[8:11], s25 offen offset:3072 sc1
    buffer_load_dwordx4 v[144:147], v2, s[8:11], s35 offen offset:0 sc1
    buffer_load_dwordx4 v[148:151], v2, s[8:11], s35 offen offset:1024 sc1
    v_lshlrev_b32 v204, 16, v24
    v_and_b32 v205, 0xffff0000, v24
    v_lshlrev_b32 v206, 16, v25
    v_and_b32 v207, 0xffff0000, v25
    s_waitcnt vmcnt(9)
    v_mfma_f32_16x16x32_bf16 v[192:195], v[32:35], v[112:115], 0
    v_mfma_f32_16x16x32_bf16 v[196:199], v[72:75], v[112:115], 0
    s_waitcnt vmcnt(8)
    v_mfma_f32_16x16x32_bf16 v[192:195], v[36:39], v[116:119], v[192:195]
    v_mfma_f32_16x16x32_bf16 v[196:199], v[76:79], v[116:119], v[196:199]
    s_waitcnt vmcnt(7)
    v_mfma_f32_16x16x32_bf16 v[192:195], v[40:43], v[120:123], v[192:195]
    v_mfma_f32_16x16x32_bf16 v[196:199], v[80:83], v[120:123], v[196:199]
    s_waitcnt vmcnt(6)
    v_mfma_f32_16x16x32_bf16 v[192:195], v[44:47], v[124:127], v[192:195]
    v_mfma_f32_16x16x32_bf16 v[196:199], v[84:87], v[124:127], v[196:199]
    s_waitcnt vmcnt(5)
    v_mfma_f32_16x16x32_bf16 v[192:195], v[48:51], v[128:131], v[192:195]
    v_mfma_f32_16x16x32_bf16 v[196:199], v[88:91], v[128:131], v[196:199]
    s_waitcnt vmcnt(4)
    v_mfma_f32_16x16x32_bf16 v[192:195], v[52:55], v[132:135], v[192:195]
    v_mfma_f32_16x16x32_bf16 v[196:199], v[92:95], v[132:135], v[196:199]
    s_waitcnt vmcnt(3)
    v_mfma_f32_16x16x32_bf16 v[192:195], v[56:59], v[136:139], v[192:195]
    v_mfma_f32_16x16x32_bf16 v[196:199], v[96:99], v[136:139], v[196:199]
    s_waitcnt vmcnt(2)
    v_mfma_f32_16x16x32_bf16 v[192:195], v[60:63], v[140:143], v[192:195]
    v_mfma_f32_16x16x32_bf16 v[196:199], v[100:103], v[140:143], v[196:199]
    s_waitcnt vmcnt(1)
    v_mfma_f32_16x16x32_bf16 v[192:195], v[64:67], v[144:147], v[192:195]
    v_mfma_f32_16x16x32_bf16 v[196:199], v[104:107], v[144:147], v[196:199]
    s_waitcnt vmcnt(0)
    v_mfma_f32_16x16x32_bf16 v[192:195], v[68:71], v[148:151], v[192:195]
    v_mfma_f32_16x16x32_bf16 v[196:199], v[108:111], v[148:151], v[196:199]
    s_cmp_eq_u32 s31, 0
    s_cbranch_scc1 H_x2_k0
    s_nop 5
    ds_write_b128 v201, v[192:195] offset:45056
    v_mov_b32 v192, v196
    v_mov_b32 v193, v197
    v_mov_b32 v194, v198
    v_mov_b32 v195, v199
    s_branch H_x2_x
H_x2_k0:
    s_nop 5
    ds_write_b128 v201, v[196:199] offset:45056
H_x2_x:
    v_add_u32 v201, s26, v2
    s_waitcnt lgkmcnt(0)
    s_barrier
    ds_read_b128 v[196:199], v201 offset:45056
    s_add_u32 s30, s30, 88196096
    s_waitcnt lgkmcnt(0)
    v_add_f32 v192, v192, v196
    v_add_f32 v193, v193, v197
    v_add_f32 v194, v194, v198
    v_add_f32 v195, v195, v199
    v_fmac_f32 v204, v192, v28
    v_fmac_f32 v205, v193, v29
    v_fmac_f32 v206, v194, v30
    v_fmac_f32 v207, v195, v31
    v_cvt_pk_bf16_f32 v204, v204, v205
    v_cvt_pk_bf16_f32 v205, v206, v207
    buffer_store_dwordx2 v[204:205], v200, s[8:11], s30 offen offset:0
    s_lshl_b32 s29, s34, 2
    s_add_u32 s29, s29, s24
    s_waitcnt vmcnt(0)
    s_barrier
    s_cmp_lg_u32 s20, 0
    s_cbranch_scc1 H_f_25
    s_mov_b64 exec, 1
    buffer_store_dword v3, v3, s[8:11], s29 offen offset:128
    s_mov_b64 exec, -1
H_f_25:
    s_cmp_ge_u32 s22, 28
    s_cbranch_scc1 H_next
H_fa:
    v_lshrrev_b32 v24, 3, v0
    v_and_b32 v25, 7, v0
    v_lshlrev_b32 v28, 6, v25
    ds_read_b128 v[128:131], v28 offset:40960
    ds_read_b128 v[192:195], v28 offset:42752
    ds_read_b128 v[132:135], v28 offset:40976
    ds_read_b128 v[196:199], v28 offset:42768
    ds_read_b128 v[136:139], v28 offset:40992
    ds_read_b128 v[200:203], v28 offset:42784
    ds_read_b128 v[140:143], v28 offset:41008
    ds_read_b128 v[204:207], v28 offset:42800
    ds_read_b128 v[144:147], v28 offset:41472
    ds_read_b128 v[208:211], v28 offset:43264
    ds_read_b128 v[148:151], v28 offset:41488
    ds_read_b128 v[212:215], v28 offset:43280
    ds_read_b128 v[152:155], v28 offset:41504
    ds_read_b128 v[216:219], v28 offset:43296
    ds_read_b128 v[156:159], v28 offset:41520
    ds_read_b128 v[220:223], v28 offset:43312
    ds_read_b128 v[160:163], v28 offset:41984
    ds_read_b128 v[224:227], v28 offset:43776
    ds_read_b128 v[164:167], v28 offset:42000
    ds_read_b128 v[228:231], v28 offset:43792
    ds_read_b128 v[168:171], v28 offset:42016
    ds_read_b128 v[232:235], v28 offset:43808
    ds_read_b128 v[172:175], v28 offset:42032
    ds_read_b128 v[236:239], v28 offset:43824
    ds_read_b128 v[176:179], v28 offset:42496
    ds_read_b128 v[240:243], v28 offset:44288
    ds_read_b128 v[180:183], v28 offset:42512
    ds_read_b128 v[244:247], v28 offset:44304
    ds_read_b128 v[184:187], v28 offset:42528
    ds_read_b128 v[248:251], v28 offset:44320
    ds_read_b128 v[188:191], v28 offset:42544
    ds_read_b128 v[252:255], v28 offset:44336
    v_mul_u32_u24 v26, 896, v24
    v_lshl_add_u32 v26, v25, 5, v26
    v_add_u32 v27, 768, v26
    v_mov_b32 v6, 0x40000000
    v_cmp_gt_u32 vcc, 4, v25
    v_mov_b32 v30, 0
    v_mov_b32 v31, 1.0
    v_cndmask_b32 v27, v6, v27, vcc
    v_cndmask_b32 v29, v30, v31, vcc
    v_min_u32 v22, 13, v1
    v_lshlrev_b32 v22, 2, v22
    s_mov_b32 s33, 400000
H_fa_wx:
    buffer_load_dword v23, v22, s[8:11], s24 offen offset:128 sc1
    s_waitcnt vmcnt(0)
    v_cmp_eq_u32 vcc, -1, v23
    s_cbranch_vccz H_fa_wx_ok
    s_sub_u32 s33, s33, 1
    s_cbranch_scc0 H_fa_wx
    s_branch L_fail
H_fa_wx_ok:
    s_mul_i32 s29, s27, 28672
    s_add_u32 s29, s29, 88196096
    buffer_load_dwordx4 v[32:35], v26, s[8:11], s29 offen offset:0 sc1
    buffer_load_dwordx4 v[36:39], v26, s[8:11], s29 offen offset:16 sc1
    buffer_load_dwordx4 v[40:43], v26, s[8:11], s29 offen offset:256 sc1
    buffer_load_dwordx4 v[44:47], v26, s[8:11], s29 offen offset:272 sc1
    buffer_load_dwordx4 v[48:51], v26, s[8:11], s29 offen offset:512 sc1
    buffer_load_dwordx4 v[52:55], v26, s[8:11], s29 offen offset:528 sc1
    buffer_load_dwordx4 v[56:59], v27, s[8:11], s29 offen offset:0 sc1
    buffer_load_dwordx4 v[60:63], v27, s[8:11], s29 offen offset:16 sc1
    s_waitcnt vmcnt(7)
    v_lshlrev_b32 v64, 16, v32
    v_and_b32 v65, 0xffff0000, v32
    v_lshlrev_b32 v66, 16, v33
    v_and_b32 v67, 0xffff0000, v33
    v_pk_add_f32 v[30:31], v[64:65], v[66:67]
    v_lshlrev_b32 v68, 16, v34
    v_and_b32 v69, 0xffff0000, v34
    v_pk_add_f32 v[30:31], v[30:31], v[68:69]
    v_lshlrev_b32 v70, 16, v35
    v_and_b32 v71, 0xffff0000, v35
    v_pk_add_f32 v[30:31], v[30:31], v[70:71]
    s_waitcnt vmcnt(6)
    v_lshlrev_b32 v72, 16, v36
    v_and_b32 v73, 0xffff0000, v36
    v_pk_add_f32 v[30:31], v[30:31], v[72:73]
    v_lshlrev_b32 v74, 16, v37
    v_and_b32 v75, 0xffff0000, v37
    v_pk_add_f32 v[30:31], v[30:31], v[74:75]
    v_lshlrev_b32 v76, 16, v38
    v_and_b32 v77, 0xffff0000, v38
    v_pk_add_f32 v[30:31], v[30:31], v[76:77]
    v_lshlrev_b32 v78, 16, v39
    v_and_b32 v79, 0xffff0000, v39
    v_pk_add_f32 v[30:31], v[30:31], v[78:79]
    s_waitcnt vmcnt(5)
    v_lshlrev_b32 v80, 16, v40
    v_and_b32 v81, 0xffff0000, v40
    v_pk_add_f32 v[30:31], v[30:31], v[80:81]
    v_lshlrev_b32 v82, 16, v41
    v_and_b32 v83, 0xffff0000, v41
    v_pk_add_f32 v[30:31], v[30:31], v[82:83]
    v_lshlrev_b32 v84, 16, v42
    v_and_b32 v85, 0xffff0000, v42
    v_pk_add_f32 v[30:31], v[30:31], v[84:85]
    v_lshlrev_b32 v86, 16, v43
    v_and_b32 v87, 0xffff0000, v43
    v_pk_add_f32 v[30:31], v[30:31], v[86:87]
    s_waitcnt vmcnt(4)
    v_lshlrev_b32 v88, 16, v44
    v_and_b32 v89, 0xffff0000, v44
    v_pk_add_f32 v[30:31], v[30:31], v[88:89]
    v_lshlrev_b32 v90, 16, v45
    v_and_b32 v91, 0xffff0000, v45
    v_pk_add_f32 v[30:31], v[30:31], v[90:91]
    v_lshlrev_b32 v92, 16, v46
    v_and_b32 v93, 0xffff0000, v46
    v_pk_add_f32 v[30:31], v[30:31], v[92:93]
    v_lshlrev_b32 v94, 16, v47
    v_and_b32 v95, 0xffff0000, v47
    v_pk_add_f32 v[30:31], v[30:31], v[94:95]
    s_waitcnt vmcnt(3)
    v_lshlrev_b32 v96, 16, v48
    v_and_b32 v97, 0xffff0000, v48
    v_pk_add_f32 v[30:31], v[30:31], v[96:97]
    v_lshlrev_b32 v98, 16, v49
    v_and_b32 v99, 0xffff0000, v49
    v_pk_add_f32 v[30:31], v[30:31], v[98:99]
    v_lshlrev_b32 v100, 16, v50
    v_and_b32 v101, 0xffff0000, v50
    v_pk_add_f32 v[30:31], v[30:31], v[100:101]
    v_lshlrev_b32 v102, 16, v51
    v_and_b32 v103, 0xffff0000, v51
    v_pk_add_f32 v[30:31], v[30:31], v[102:103]
    s_waitcnt vmcnt(2)
    v_lshlrev_b32 v104, 16, v52
    v_and_b32 v105, 0xffff0000, v52
    v_pk_add_f32 v[30:31], v[30:31], v[104:105]
    v_lshlrev_b32 v106, 16, v53
    v_and_b32 v107, 0xffff0000, v53
    v_pk_add_f32 v[30:31], v[30:31], v[106:107]
    v_lshlrev_b32 v108, 16, v54
    v_and_b32 v109, 0xffff0000, v54
    v_pk_add_f32 v[30:31], v[30:31], v[108:109]
    v_lshlrev_b32 v110, 16, v55
    v_and_b32 v111, 0xffff0000, v55
    v_pk_add_f32 v[30:31], v[30:31], v[110:111]
    s_waitcnt vmcnt(1)
    v_lshlrev_b32 v112, 16, v56
    v_and_b32 v113, 0xffff0000, v56
    v_pk_add_f32 v[30:31], v[30:31], v[112:113]
    v_lshlrev_b32 v114, 16, v57
    v_and_b32 v115, 0xffff0000, v57
    v_pk_add_f32 v[30:31], v[30:31], v[114:115]
    v_lshlrev_b32 v116, 16, v58
    v_and_b32 v117, 0xffff0000, v58
    v_pk_add_f32 v[30:31], v[30:31], v[116:117]
    v_lshlrev_b32 v118, 16, v59
    v_and_b32 v119, 0xffff0000, v59
    v_pk_add_f32 v[30:31], v[30:31], v[118:119]
    s_waitcnt vmcnt(0)
    v_lshlrev_b32 v120, 16, v60
    v_and_b32 v121, 0xffff0000, v60
    v_pk_add_f32 v[30:31], v[30:31], v[120:121]
    v_lshlrev_b32 v122, 16, v61
    v_and_b32 v123, 0xffff0000, v61
    v_pk_add_f32 v[30:31], v[30:31], v[122:123]
    v_lshlrev_b32 v124, 16, v62
    v_and_b32 v125, 0xffff0000, v62
    v_pk_add_f32 v[30:31], v[30:31], v[124:125]
    v_lshlrev_b32 v126, 16, v63
    v_and_b32 v127, 0xffff0000, v63
    v_pk_add_f32 v[30:31], v[30:31], v[126:127]
    v_add_f32 v30, v30, v31
    s_nop 1
    v_add_f32_dpp v30, v30, v30 quad_perm:[1,0,3,2] row_mask:0xf bank_mask:0xf
    s_nop 1
    v_add_f32_dpp v30, v30, v30 quad_perm:[2,3,0,1] row_mask:0xf bank_mask:0xf
    s_nop 1
    v_add_f32_dpp v30, v30, v30 row_half_mirror row_mask:0xf bank_mask:0xf
    v_mul_f32 v30, 0xbb124925, v30
    v_mov_b64 v[32:33], 0
    v_mov_b64 v[34:35], 0
    v_pk_add_f32 v[64:65], v[64:65], v[30:31] op_sel_hi:[1,0]
    v_pk_add_f32 v[66:67], v[66:67], v[30:31] op_sel_hi:[1,0]
    v_pk_add_f32 v[68:69], v[68:69], v[30:31] op_sel_hi:[1,0]
    v_pk_add_f32 v[70:71], v[70:71], v[30:31] op_sel_hi:[1,0]
    v_pk_add_f32 v[72:73], v[72:73], v[30:31] op_sel_hi:[1,0]
    v_pk_add_f32 v[74:75], v[74:75], v[30:31] op_sel_hi:[1,0]
    v_pk_add_f32 v[76:77], v[76:77], v[30:31] op_sel_hi:[1,0]
    v_pk_add_f32 v[78:79], v[78:79], v[30:31] op_sel_hi:[1,0]
    v_pk_add_f32 v[80:81], v[80:81], v[30:31] op_sel_hi:[1,0]
    v_pk_add_f32 v[82:83], v[82:83], v[30:31] op_sel_hi:[1,0]
    v_pk_add_f32 v[84:85], v[84:85], v[30:31] op_sel_hi:[1,0]
    v_pk_add_f32 v[86:87], v[86:87], v[30:31] op_sel_hi:[1,0]
    v_pk_add_f32 v[88:89], v[88:89], v[30:31] op_sel_hi:[1,0]
    v_pk_add_f32 v[90:91], v[90:91], v[30:31] op_sel_hi:[1,0]
    v_pk_add_f32 v[92:93], v[92:93], v[30:31] op_sel_hi:[1,0]
    v_pk_add_f32 v[94:95], v[94:95], v[30:31] op_sel_hi:[1,0]
    v_pk_add_f32 v[96:97], v[96:97], v[30:31] op_sel_hi:[1,0]
    v_pk_add_f32 v[98:99], v[98:99], v[30:31] op_sel_hi:[1,0]
    v_pk_add_f32 v[100:101], v[100:101], v[30:31] op_sel_hi:[1,0]
    v_pk_add_f32 v[102:103], v[102:103], v[30:31] op_sel_hi:[1,0]
    v_pk_add_f32 v[104:105], v[104:105], v[30:31] op_sel_hi:[1,0]
    v_pk_add_f32 v[106:107], v[106:107], v[30:31] op_sel_hi:[1,0]
    v_pk_add_f32 v[108:109], v[108:109], v[30:31] op_sel_hi:[1,0]
    v_pk_add_f32 v[110:111], v[110:111], v[30:31] op_sel_hi:[1,0]
    v_pk_add_f32 v[112:113], v[112:113], v[30:31] op_sel_hi:[1,0]
    v_pk_add_f32 v[114:115], v[114:115], v[30:31] op_sel_hi:[1,0]
    v_pk_add_f32 v[116:117], v[116:117], v[30:31] op_sel_hi:[1,0]
    v_pk_add_f32 v[118:119], v[118:119], v[30:31] op_sel_hi:[1,0]
    v_pk_add_f32 v[120:121], v[120:121], v[30:31] op_sel_hi:[1,0]
    v_pk_add_f32 v[122:123], v[122:123], v[30:31] op_sel_hi:[1,0]
    v_pk_add_f32 v[124:125], v[124:125], v[30:31] op_sel_hi:[1,0]
    v_pk_add_f32 v[126:127], v[126:127], v[30:31] op_sel_hi:[1,0]
    v_pk_fma_f32 v[32:33], v[64:65], v[64:65], v[32:33]
    v_pk_fma_f32 v[32:33], v[66:67], v[66:67], v[32:33]
    v_pk_fma_f32 v[32:33], v[68:69], v[68:69], v[32:33]
    v_pk_fma_f32 v[32:33], v[70:71], v[70:71], v[32:33]
    v_pk_fma_f32 v[32:33], v[72:73], v[72:73], v[32:33]
    v_pk_fma_f32 v[32:33], v[74:75], v[74:75], v[32:33]
    v_pk_fma_f32 v[32:33], v[76:77], v[76:77], v[32:33]
    v_pk_fma_f32 v[32:33], v[78:79], v[78:79], v[32:33]
    v_pk_fma_f32 v[32:33], v[80:81], v[80:81], v[32:33]
    v_pk_fma_f32 v[32:33], v[82:83], v[82:83], v[32:33]
    v_pk_fma_f32 v[32:33], v[84:85], v[84:85], v[32:33]
    v_pk_fma_f32 v[32:33], v[86:87], v[86:87], v[32:33]
    v_pk_fma_f32 v[32:33], v[88:89], v[88:89], v[32:33]
    v_pk_fma_f32 v[32:33], v[90:91], v[90:91], v[32:33]
    v_pk_fma_f32 v[32:33], v[92:93], v[92:93], v[32:33]
    v_pk_fma_f32 v[32:33], v[94:95], v[94:95], v[32:33]
    v_pk_fma_f32 v[32:33], v[96:97], v[96:97], v[32:33]
    v_pk_fma_f32 v[32:33], v[98:99], v[98:99], v[32:33]
    v_pk_fma_f32 v[32:33], v[100:101], v[100:101], v[32:33]
    v_pk_fma_f32 v[32:33], v[102:103], v[102:103], v[32:33]
    v_pk_fma_f32 v[32:33], v[104:105], v[104:105], v[32:33]
    v_pk_fma_f32 v[32:33], v[106:107], v[106:107], v[32:33]
    v_pk_fma_f32 v[32:33], v[108:109], v[108:109], v[32:33]
    v_pk_fma_f32 v[32:33], v[110:111], v[110:111], v[32:33]
    v_pk_fma_f32 v[34:35], v[112:113], v[112:113], v[34:35]
    v_pk_fma_f32 v[34:35], v[114:115], v[114:115], v[34:35]
    v_pk_fma_f32 v[34:35], v[116:117], v[116:117], v[34:35]
    v_pk_fma_f32 v[34:35], v[118:119], v[118:119], v[34:35]
    v_pk_fma_f32 v[34:35], v[120:121], v[120:121], v[34:35]
    v_pk_fma_f32 v[34:35], v[122:123], v[122:123], v[34:35]
    v_pk_fma_f32 v[34:35], v[124:125], v[124:125], v[34:35]
    v_pk_fma_f32 v[34:35], v[126:127], v[126:127], v[34:35]
    v_add_f32 v30, v32, v33
    v_add_f32 v31, v34, v35
    v_fmac_f32 v30, v31, v29
    s_nop 1
    v_add_f32_dpp v30, v30, v30 quad_perm:[1,0,3,2] row_mask:0xf bank_mask:0xf
    s_nop 1
    v_add_f32_dpp v30, v30, v30 quad_perm:[2,3,0,1] row_mask:0xf bank_mask:0xf
    s_nop 1
    v_add_f32_dpp v30, v30, v30 row_half_mirror row_mask:0xf bank_mask:0xf
    v_mov_b32 v31, 0x3727c5ac
    v_fmac_f32 v31, 0x3b124925, v30
    v_rsq_f32 v30, v31
    s_waitcnt lgkmcnt(0)
    v_bfe_u32 v28, v24, 0, 4
    v_lshlrev_b32 v28, 4, v28
    v_bfe_u32 v6, v24, 4, 1
    v_mul_u32_u24 v6, 14336, v6
    v_add_u32 v28, v28, v6
    v_lshl_add_u32 v28, v25, 9, v28
    v_pk_mul_f32 v[64:65], v[64:65], v[30:31] op_sel_hi:[1,0]
    v_pk_fma_f32 v[64:65], v[64:65], v[192:193], v[128:129]
    v_pk_mul_f32 v[66:67], v[66:67], v[30:31] op_sel_hi:[1,0]
    v_pk_fma_f32 v[66:67], v[66:67], v[194:195], v[130:131]
    v_pk_mul_f32 v[68:69], v[68:69], v[30:31] op_sel_hi:[1,0]
    v_pk_fma_f32 v[68:69], v[68:69], v[196:197], v[132:133]
    v_pk_mul_f32 v[70:71], v[70:71], v[30:31] op_sel_hi:[1,0]
    v_pk_fma_f32 v[70:71], v[70:71], v[198:199], v[134:135]
    v_pk_mul_f32 v[72:73], v[72:73], v[30:31] op_sel_hi:[1,0]
    v_pk_fma_f32 v[72:73], v[72:73], v[200:201], v[136:137]
    v_pk_mul_f32 v[74:75], v[74:75], v[30:31] op_sel_hi:[1,0]
    v_pk_fma_f32 v[74:75], v[74:75], v[202:203], v[138:139]
    v_pk_mul_f32 v[76:77], v[76:77], v[30:31] op_sel_hi:[1,0]
    v_pk_fma_f32 v[76:77], v[76:77], v[204:205], v[140:141]
    v_pk_mul_f32 v[78:79], v[78:79], v[30:31] op_sel_hi:[1,0]
    v_pk_fma_f32 v[78:79], v[78:79], v[206:207], v[142:143]
    v_cvt_pk_bf16_f32 v32, v64, v65
    v_cvt_pk_bf16_f32 v33, v66, v67
    v_cvt_pk_bf16_f32 v34, v68, v69
    v_cvt_pk_bf16_f32 v35, v70, v71
    v_cvt_pk_bf16_f32 v36, v72, v73
    v_cvt_pk_bf16_f32 v37, v74, v75
    v_cvt_pk_bf16_f32 v38, v76, v77
    v_cvt_pk_bf16_f32 v39, v78, v79
    ds_write_b128 v28, v[32:35] offset:0
    ds_write_b128 v28, v[36:39] offset:256
    v_pk_mul_f32 v[80:81], v[80:81], v[30:31] op_sel_hi:[1,0]
    v_pk_fma_f32 v[80:81], v[80:81], v[208:209], v[144:145]
    v_pk_mul_f32 v[82:83], v[82:83], v[30:31] op_sel_hi:[1,0]
    v_pk_fma_f32 v[82:83], v[82:83], v[210:211], v[146:147]
    v_pk_mul_f32 v[84:85], v[84:85], v[30:31] op_sel_hi:[1,0]
    v_pk_fma_f32 v[84:85], v[84:85], v[212:213], v[148:149]
    v_pk_mul_f32 v[86:87], v[86:87], v[30:31] op_sel_hi:[1,0]
    v_pk_fma_f32 v[86:87], v[86:87], v[214:215], v[150:151]
    v_pk_mul_f32 v[88:89], v[88:89], v[30:31] op_sel_hi:[1,0]
    v_pk_fma_f32 v[88:89], v[88:89], v[216:217], v[152:153]
    v_pk_mul_f32 v[90:91], v[90:91], v[30:31] op_sel_hi:[1,0]
    v_pk_fma_f32 v[90:91], v[90:91], v[218:219], v[154:155]
    v_pk_mul_f32 v[92:93], v[92:93], v[30:31] op_sel_hi:[1,0]
    v_pk_fma_f32 v[92:93], v[92:93], v[220:221], v[156:157]
    v_pk_mul_f32 v[94:95], v[94:95], v[30:31] op_sel_hi:[1,0]
    v_pk_fma_f32 v[94:95], v[94:95], v[222:223], v[158:159]
    v_cvt_pk_bf16_f32 v40, v80, v81
    v_cvt_pk_bf16_f32 v41, v82, v83
    v_cvt_pk_bf16_f32 v42, v84, v85
    v_cvt_pk_bf16_f32 v43, v86, v87
    v_cvt_pk_bf16_f32 v44, v88, v89
    v_cvt_pk_bf16_f32 v45, v90, v91
    v_cvt_pk_bf16_f32 v46, v92, v93
    v_cvt_pk_bf16_f32 v47, v94, v95
    ds_write_b128 v28, v[40:43] offset:4096
    ds_write_b128 v28, v[44:47] offset:4352
    v_pk_mul_f32 v[96:97], v[96:97], v[30:31] op_sel_hi:[1,0]
    v_pk_fma_f32 v[96:97], v[96:97], v[224:225], v[160:161]
    v_pk_mul_f32 v[98:99], v[98:99], v[30:31] op_sel_hi:[1,0]
    v_pk_fma_f32 v[98:99], v[98:99], v[226:227], v[162:163]
    v_pk_mul_f32 v[100:101], v[100:101], v[30:31] op_sel_hi:[1,0]
    v_pk_fma_f32 v[100:101], v[100:101], v[228:229], v[164:165]
    v_pk_mul_f32 v[102:103], v[102:103], v[30:31] op_sel_hi:[1,0]
    v_pk_fma_f32 v[102:103], v[102:103], v[230:231], v[166:167]
    v_pk_mul_f32 v[104:105], v[104:105], v[30:31] op_sel_hi:[1,0]
    v_pk_fma_f32 v[104:105], v[104:105], v[232:233], v[168:169]
    v_pk_mul_f32 v[106:107], v[106:107], v[30:31] op_sel_hi:[1,0]
    v_pk_fma_f32 v[106:107], v[106:107], v[234:235], v[170:171]
    v_pk_mul_f32 v[108:109], v[108:109], v[30:31] op_sel_hi:[1,0]
    v_pk_fma_f32 v[108:109], v[108:109], v[236:237], v[172:173]
    v_pk_mul_f32 v[110:111], v[110:111], v[30:31] op_sel_hi:[1,0]
    v_pk_fma_f32 v[110:111], v[110:111], v[238:239], v[174:175]
    v_cvt_pk_bf16_f32 v48, v96, v97
    v_cvt_pk_bf16_f32 v49, v98, v99
    v_cvt_pk_bf16_f32 v50, v100, v101
    v_cvt_pk_bf16_f32 v51, v102, v103
    v_cvt_pk_bf16_f32 v52, v104, v105
    v_cvt_pk_bf16_f32 v53, v106, v107
    v_cvt_pk_bf16_f32 v54, v108, v109
    v_cvt_pk_bf16_f32 v55, v110, v111
    ds_write_b128 v28, v[48:51] offset:8192
    ds_write_b128 v28, v[52:55] offset:8448
    v_pk_mul_f32 v[112:113], v[112:113], v[30:31] op_sel_hi:[1,0]
    v_pk_fma_f32 v[112:113], v[112:113], v[240:241], v[176:177]
    v_pk_mul_f32 v[114:115], v[114:115], v[30:31] op_sel_hi:[1,0]
    v_pk_fma_f32 v[114:115], v[114:115], v[242:243], v[178:179]
    v_pk_mul_f32 v[116:117], v[116:117], v[30:31] op_sel_hi:[1,0]
    v_pk_fma_f32 v[116:117], v[116:117], v[244:245], v[180:181]
    v_pk_mul_f32 v[118:119], v[118:119], v[30:31] op_sel_hi:[1,0]
    v_pk_fma_f32 v[118:119], v[118:119], v[246:247], v[182:183]
    v_pk_mul_f32 v[120:121], v[120:121], v[30:31] op_sel_hi:[1,0]
    v_pk_fma_f32 v[120:121], v[120:121], v[248:249], v[184:185]
    v_pk_mul_f32 v[122:123], v[122:123], v[30:31] op_sel_hi:[1,0]
    v_pk_fma_f32 v[122:123], v[122:123], v[250:251], v[186:187]
    v_pk_mul_f32 v[124:125], v[124:125], v[30:31] op_sel_hi:[1,0]
    v_pk_fma_f32 v[124:125], v[124:125], v[252:253], v[188:189]
    v_pk_mul_f32 v[126:127], v[126:127], v[30:31] op_sel_hi:[1,0]
    v_pk_fma_f32 v[126:127], v[126:127], v[254:255], v[190:191]
    v_cvt_pk_bf16_f32 v56, v112, v113
    v_cvt_pk_bf16_f32 v57, v114, v115
    v_cvt_pk_bf16_f32 v58, v116, v117
    v_cvt_pk_bf16_f32 v59, v118, v119
    v_cvt_pk_bf16_f32 v60, v120, v121
    v_cvt_pk_bf16_f32 v61, v122, v123
    v_cvt_pk_bf16_f32 v62, v124, v125
    v_cvt_pk_bf16_f32 v63, v126, v127
    v_cmp_gt_u32 vcc, 4, v25
    s_and_saveexec_b64 s[68:69], vcc
    ds_write_b128 v28, v[56:59] offset:12288
    ds_write_b128 v28, v[60:63] offset:12544
    s_mov_b64 exec, s[68:69]
    s_lshr_b32 s32, s20, 1
    s_mul_i32 s29, s32, 14336
    v_add_u32 v28, s29, v2
    s_waitcnt lgkmcnt(0)
    s_barrier
    ds_read_b128 v[64:67], v28 offset:0
    ds_read_b128 v[68:71], v28 offset:1024
    ds_read_b128 v[72:75], v28 offset:2048
    ds_read_b128 v[76:79], v28 offset:3072
    ds_read_b128 v[80:83], v28 offset:4096
    ds_read_b128 v[84:87], v28 offset:5120
    ds_read_b128 v[88:91], v28 offset:6144
    ds_read_b128 v[92:95], v28 offset:7168
    ds_read_b128 v[96:99], v28 offset:8192
    ds_read_b128 v[100:103], v28 offset:9216
    ds_read_b128 v[104:107], v28 offset:10240
    ds_read_b128 v[108:111], v28 offset:11264
    ds_read_b128 v[112:115], v28 offset:12288
    ds_read_b128 v[116:119], v28 offset:13312
    s_waitcnt lgkmcnt(13)
    v_mfma_f32_16x16x32_bf16 v[32:35], a[0:3], v[64:67], 0
    v_mfma_f32_16x16x32_bf16 v[36:39], a[56:59], v[64:67], 0
    s_waitcnt lgkmcnt(12)
    v_mfma_f32_16x16x32_bf16 v[32:35], a[4:7], v[68:71], v[32:35]
    v_mfma_f32_16x16x32_bf16 v[36:39], a[60:63], v[68:71], v[36:39]
    s_waitcnt lgkmcnt(11)
    v_mfma_f32_16x16x32_bf16 v[32:35], a[8:11], v[72:75], v[32:35]
    v_mfma_f32_16x16x32_bf16 v[36:39], a[64:67], v[72:75], v[36:39]
    s_waitcnt lgkmcnt(10)
    v_mfma_f32_16x16x32_bf16 v[32:35], a[12:15], v[76:79], v[32:35]
    v_mfma_f32_16x16x32_bf16 v[36:39], a[68:71], v[76:79], v[36:39]
    s_waitcnt lgkmcnt(9)
    v_mfma_f32_16x16x32_bf16 v[32:35], a[16:19], v[80:83], v[32:35]
    v_mfma_f32_16x16x32_bf16 v[36:39], a[72:75], v[80:83], v[36:39]
    s_waitcnt lgkmcnt(8)
    v_mfma_f32_16x16x32_bf16 v[32:35], a[20:23], v[84:87], v[32:35]
    v_mfma_f32_16x16x32_bf16 v[36:39], a[76:79], v[84:87], v[36:39]
    s_waitcnt lgkmcnt(7)
    v_mfma_f32_16x16x32_bf16 v[32:35], a[24:27], v[88:91], v[32:35]
    v_mfma_f32_16x16x32_bf16 v[36:39], a[80:83], v[88:91], v[36:39]
    s_waitcnt lgkmcnt(6)
    v_mfma_f32_16x16x32_bf16 v[32:35], a[28:31], v[92:95], v[32:35]
    v_mfma_f32_16x16x32_bf16 v[36:39], a[84:87], v[92:95], v[36:39]
    s_waitcnt lgkmcnt(5)
    v_mfma_f32_16x16x32_bf16 v[32:35], a[32:35], v[96:99], v[32:35]
    v_mfma_f32_16x16x32_bf16 v[36:39], a[88:91], v[96:99], v[36:39]
    s_waitcnt lgkmcnt(4)
    v_mfma_f32_16x16x32_bf16 v[32:35], a[36:39], v[100:103], v[32:35]
    v_mfma_f32_16x16x32_bf16 v[36:39], a[92:95], v[100:103], v[36:39]
    s_waitcnt lgkmcnt(3)
    v_mfma_f32_16x16x32_bf16 v[32:35], a[40:43], v[104:107], v[32:35]
    v_mfma_f32_16x16x32_bf16 v[36:39], a[96:99], v[104:107], v[36:39]
    s_waitcnt lgkmcnt(2)
    v_mfma_f32_16x16x32_bf16 v[32:35], a[44:47], v[108:111], v[32:35]
    v_mfma_f32_16x16x32_bf16 v[36:39], a[100:103], v[108:111], v[36:39]
    s_waitcnt lgkmcnt(1)
    v_mfma_f32_16x16x32_bf16 v[32:35], a[48:51], v[112:115], v[32:35]
    v_mfma_f32_16x16x32_bf16 v[36:39], a[104:107], v[112:115], v[36:39]
    s_waitcnt lgkmcnt(0)
    v_mfma_f32_16x16x32_bf16 v[32:35], a[52:55], v[116:119], v[32:35]
    v_mfma_f32_16x16x32_bf16 v[36:39], a[108:111], v[116:119], v[36:39]
    s_nop 7
    v_add_f32 v32, v32, v10
    v_add_f32 v33, v33, v11
    v_add_f32 v34, v34, v12
    v_add_f32 v35, v35, v13
    v_add_f32 v36, v36, v14
    v_add_f32 v37, v37, v15
    v_add_f32 v38, v38, v16
    v_add_f32 v39, v39, v17
    v_min_f32 v40, 0x42200000, v32
    v_mul_f32 v40, 0x3fb8aa3b, v40
    v_min_f32 v41, 0x42200000, v33
    v_mul_f32 v41, 0x3fb8aa3b, v41
    v_min_f32 v42, 0x42200000, v34
    v_mul_f32 v42, 0x3fb8aa3b, v42
    v_min_f32 v43, 0x42200000, v35
    v_mul_f32 v43, 0x3fb8aa3b, v43
    v_min_f32 v44, 0x42200000, v36
    v_mul_f32 v44, 0x3fb8aa3b, v44
    v_min_f32 v45, 0x42200000, v37
    v_mul_f32 v45, 0x3fb8aa3b, v45
    v_min_f32 v46, 0x42200000, v38
    v_mul_f32 v46, 0x3fb8aa3b, v46
    v_min_f32 v47, 0x42200000, v39
    v_mul_f32 v47, 0x3fb8aa3b, v47
    v_exp_f32 v40, v40
    v_exp_f32 v41, v41
    v_exp_f32 v42, v42
    v_exp_f32 v43, v43
    v_exp_f32 v44, v44
    v_exp_f32 v45, v45
    v_exp_f32 v46, v46
    v_exp_f32 v47, v47
    v_add_f32 v48, 2.0, v40
    v_mul_f32 v40, v40, v48
    v_add_f32 v48, 2.0, v40
    v_add_f32 v49, 2.0, v41
    v_mul_f32 v41, v41, v49
    v_add_f32 v49, 2.0, v41
    v_add_f32 v50, 2.0, v42
    v_mul_f32 v42, v42, v50
    v_add_f32 v50, 2.0, v42
    v_add_f32 v51, 2.0, v43
    v_mul_f32 v43, v43, v51
    v_add_f32 v51, 2.0, v43
    v_add_f32 v52, 2.0, v44
    v_mul_f32 v44, v44, v52
    v_add_f32 v52, 2.0, v44
    v_add_f32 v53, 2.0, v45
    v_mul_f32 v45, v45, v53
    v_add_f32 v53, 2.0, v45
    v_add_f32 v54, 2.0, v46
    v_mul_f32 v46, v46, v54
    v_add_f32 v54, 2.0, v46
    v_add_f32 v55, 2.0, v47
    v_mul_f32 v47, v47, v55
    v_add_f32 v55, 2.0, v47
    v_rcp_f32 v48, v48
    v_rcp_f32 v49, v49
    v_rcp_f32 v50, v50
    v_rcp_f32 v51, v51
    v_rcp_f32 v52, v52
    v_rcp_f32 v53, v53
    v_rcp_f32 v54, v54
    v_rcp_f32 v55, v55
    v_mul_f32 v32, v32, v40
    v_mul_f32 v33, v33, v41
    v_mul_f32 v34, v34, v42
    v_mul_f32 v35, v35, v43
    v_mul_f32 v36, v36, v44
    v_mul_f32 v37, v37, v45
    v_mul_f32 v38, v38, v46
    v_mul_f32 v39, v39, v47
    v_mul_f32 v32, v32, v48
    v_mul_f32 v33, v33, v49
    v_mul_f32 v34, v34, v50
    v_mul_f32 v35, v35, v51
    v_mul_f32 v36, v36, v52
    v_mul_f32 v37, v37, v53
    v_mul_f32 v38, v38, v54
    v_mul_f32 v39, v39, v55
    v_cvt_pk_bf16_f32 v32, v32, v33
    v_cvt_pk_bf16_f32 v33, v34, v35
    v_cvt_pk_bf16_f32 v34, v36, v37
    v_cvt_pk_bf16_f32 v35, v38, v39
    s_and_b32 s29, s20, 1
    s_lshl_b32 s30, s22, 1
    s_add_u32 s29, s29, s30
    s_lshl_b32 s29, s29, 1
    s_add_u32 s29, s29, s32
    s_lshl_b32 s29, s29, 10
    s_mul_i32 s31, s27, 114688
    s_add_u32 s31, s31, 90031104
    s_add_u32 s29, s29, s31
    buffer_store_dwordx4 v[32:35], v2, s[8:11], s29 offen offset:0
    s_waitcnt vmcnt(0)
    s_lshl_b32 s29, s22, 2
    s_add_u32 s29, s29, s24
    s_barrier
    s_cmp_lg_u32 s20, 0
    s_cbranch_scc1 H_f_26
    s_mov_b64 exec, 1
    buffer_store_dword v3, v3, s[8:11], s29 offen offset:256
    s_mov_b64 exec, -1
H_f_26:
    v_mul_u32_u24 v26, 896, v9
    v_lshl_add_u32 v26, v8, 3, v26
    s_lshl_b32 s30, s27, 1
    s_and_b32 s29, s20, 1
    s_add_u32 s30, s30, s29
    s_mul_i32 s30, s30, 14336
    s_lshl_b32 s29, s22, 5
    s_add_u32 s30, s30, s29
    s_add_u32 s29, s30, 88196096
    buffer_load_dwordx2 v[40:41], v26, s[8:11], s29 offen sc1
    v_min_u32 v22, 27, v1
    v_lshlrev_b32 v22, 2, v22
    s_mov_b32 s33, 400000
H_fb_wa:
    buffer_load_dword v23, v22, s[8:11], s24 offen offset:256 sc1
    s_waitcnt vmcnt(0)
    v_cmp_eq_u32 vcc, -1, v23
    s_cbranch_vccz H_fb_wa_ok
    s_sub_u32 s33, s33, 1
    s_cbranch_scc0 H_fb_wa
    s_branch L_fail
H_fb_wa_ok:
    s_mul_i32 s29, s20, 28672
    s_add_u32 s31, s31, s29
    buffer_load_dwordx4 v[64:67], v2, s[8:11], s31 offen offset:0 sc1
    buffer_load_dwordx4 v[68:71], v2, s[8:11], s31 offen offset:1024 sc1
    buffer_load_dwordx4 v[72:75], v2, s[8:11], s31 offen offset:2048 sc1
    buffer_load_dwordx4 v[76:79], v2, s[8:11], s31 offen offset:3072 sc1
    s_add_u32 s31, s31, 4096
    buffer_load_dwordx4 v[80:83], v2, s[8:11], s31 offen offset:0 sc1
    buffer_load_dwordx4 v[84:87], v2, s[8:11], s31 offen offset:1024 sc1
    buffer_load_dwordx4 v[88:91], v2, s[8:11], s31 offen offset:2048 sc1
    buffer_load_dwordx4 v[92:95], v2, s[8:11], s31 offen offset:3072 sc1
    s_add_u32 s31, s31, 4096
    buffer_load_dwordx4 v[96:99], v2, s[8:11], s31 offen offset:0 sc1
    buffer_load_dwordx4 v[100:103], v2, s[8:11], s31 offen offset:1024 sc1
    buffer_load_dwordx4 v[104:107], v2, s[8:11], s31 offen offset:2048 sc1
    buffer_load_dwordx4 v[108:111], v2, s[8:11], s31 offen offset:3072 sc1
    s_add_u32 s31, s31, 4096
    buffer_load_dwordx4 v[112:115], v2, s[8:11], s31 offen offset:0 sc1
    buffer_load_dwordx4 v[116:119], v2, s[8:11], s31 offen offset:1024 sc1
    buffer_load_dwordx4 v[120:123], v2, s[8:11], s31 offen offset:2048 sc1
    buffer_load_dwordx4 v[124:127], v2, s[8:11], s31 offen offset:3072 sc1
    s_add_u32 s31, s31, 4096
    buffer_load_dwordx4 v[128:131], v2, s[8:11], s31 offen offset:0 sc1
    buffer_load_dwordx4 v[132:135], v2, s[8:11], s31 offen offset:1024 sc1
    buffer_load_dwordx4 v[136:139], v2, s[8:11], s31 offen offset:2048 sc1
    buffer_load_dwordx4 v[140:143], v2, s[8:11], s31 offen offset:3072 sc1
    s_add_u32 s31, s31, 4096
    buffer_load_dwordx4 v[144:147], v2, s[8:11], s31 offen offset:0 sc1
    buffer_load_dwordx4 v[148:151], v2, s[8:11], s31 offen offset:1024 sc1
    buffer_load_dwordx4 v[152:155], v2, s[8:11], s31 offen offset:2048 sc1
    buffer_load_dwordx4 v[156:159], v2, s[8:11], s31 offen offset:3072 sc1
    s_add_u32 s31, s31, 4096
    buffer_load_dwordx4 v[160:163], v2, s[8:11], s31 offen offset:0 sc1
    buffer_load_dwordx4 v[164:167], v2, s[8:11], s31 offen offset:1024 sc1
    buffer_load_dwordx4 v[168:171], v2, s[8:11], s31 offen offset:2048 sc1
    buffer_load_dwordx4 v[172:175], v2, s[8:11], s31 offen offset:3072 sc1
    s_add_u32 s31, s31, 4096
    s_waitcnt vmcnt(27)
    v_mfma_f32_16x16x32_bf16 v[32:35], a[112:115], v[64:67], 0
    s_waitcnt vmcnt(26)
    v_mfma_f32_16x16x32_bf16 v[36:39], a[112:115], v[68:71], 0
    s_waitcnt vmcnt(25)
    v_mfma_f32_16x16x32_bf16 v[32:35], a[116:119], v[72:75], v[32:35]
    s_waitcnt vmcnt(24)
    v_mfma_f32_16x16x32_bf16 v[36:39], a[116:119], v[76:79], v[36:39]
    s_waitcnt vmcnt(23)
    v_mfma_f32_16x16x32_bf16 v[32:35], a[120:123], v[80:83], v[32:35]
    s_waitcnt vmcnt(22)
    v_mfma_f32_16x16x32_bf16 v[36:39], a[120:123], v[84:87], v[36:39]
    s_waitcnt vmcnt(21)
    v_mfma_f32_16x16x32_bf16 v[32:35], a[124:127], v[88:91], v[32:35]
    s_waitcnt vmcnt(20)
    v_mfma_f32_16x16x32_bf16 v[36:39], a[124:127], v[92:95], v[36:39]
    s_waitcnt vmcnt(19)
    v_mfma_f32_16x16x32_bf16 v[32:35], a[128:131], v[96:99], v[32:35]
    s_waitcnt vmcnt(18)
    v_mfma_f32_16x16x32_bf16 v[36:39], a[128:131], v[100:103], v[36:39]
    s_waitcnt vmcnt(17)
    v_mfma_f32_16x16x32_bf16 v[32:35], a[132:135], v[104:107], v[32:35]
    s_waitcnt vmcnt(16)
    v_mfma_f32_16x16x32_bf16 v[36:39], a[132:135], v[108:111], v[36:39]
    s_waitcnt vmcnt(15)
    v_mfma_f32_16x16x32_bf16 v[32:35], a[136:139], v[112:115], v[32:35]
    s_waitcnt vmcnt(14)
    v_mfma_f32_16x16x32_bf16 v[36:39], a[136:139], v[116:119], v[36:39]
    s_waitcnt vmcnt(13)
    v_mfma_f32_16x16x32_bf16 v[32:35], a[140:143], v[120:123], v[32:35]
    s_waitcnt vmcnt(12)
    v_mfma_f32_16x16x32_bf16 v[36:39], a[140:143], v[124:127], v[36:39]
    s_waitcnt vmcnt(11)
    v_mfma_f32_16x16x32_bf16 v[32:35], a[144:147], v[128:131], v[32:35]
    s_waitcnt vmcnt(10)
    v_mfma_f32_16x16x32_bf16 v[36:39], a[144:147], v[132:135], v[36:39]
    s_waitcnt vmcnt(9)
    v_mfma_f32_16x16x32_bf16 v[32:35], a[148:151], v[136:139], v[32:35]
    s_waitcnt vmcnt(8)
    v_mfma_f32_16x16x32_bf16 v[36:39], a[148:151], v[140:143], v[36:39]
    s_waitcnt vmcnt(7)
    v_mfma_f32_16x16x32_bf16 v[32:35], a[152:155], v[144:147], v[32:35]
    s_waitcnt vmcnt(6)
    v_mfma_f32_16x16x32_bf16 v[36:39], a[152:155], v[148:151], v[36:39]
    s_waitcnt vmcnt(5)
    v_mfma_f32_16x16x32_bf16 v[32:35], a[156:159], v[152:155], v[32:35]
    s_waitcnt vmcnt(4)
    v_mfma_f32_16x16x32_bf16 v[36:39], a[156:159], v[156:159], v[36:39]
    s_waitcnt vmcnt(3)
    v_mfma_f32_16x16x32_bf16 v[32:35], a[160:163], v[160:163], v[32:35]
    s_waitcnt vmcnt(2)
    v_mfma_f32_16x16x32_bf16 v[36:39], a[160:163], v[164:167], v[36:39]
    s_waitcnt vmcnt(1)
    v_mfma_f32_16x16x32_bf16 v[32:35], a[164:167], v[168:171], v[32:35]
    s_waitcnt vmcnt(0)
    v_mfma_f32_16x16x32_bf16 v[36:39], a[164:167], v[172:175], v[36:39]
    s_lshl_b32 s29, s20, 11
    v_add_u32 v27, s29, v2
    s_nop 5
    ds_write_b128 v27, v[32:35] offset:32768
    ds_write_b128 v27, v[36:39] offset:33792
    s_waitcnt lgkmcnt(0)
    s_barrier
    s_cmp_ge_u32 s20, 2
    s_cbranch_scc1 H_next
    s_lshl_b32 s29, s20, 10
    v_add_u32 v27, s29, v2
    ds_read_b128 v[48:51], v27 offset:32768
    ds_read_b128 v[52:55], v27 offset:34816
    ds_read_b128 v[56:59], v27 offset:36864
    ds_read_b128 v[60:63], v27 offset:38912
    v_lshlrev_b32 v44, 16, v40
    v_and_b32 v45, 0xffff0000, v40
    v_lshlrev_b32 v46, 16, v41
    v_and_b32 v47, 0xffff0000, v41
    s_waitcnt lgkmcnt(0)
    v_add_f32 v48, v48, v52
    v_add_f32 v56, v56, v60
    v_add_f32 v48, v48, v56
    v_fmac_f32 v44, v48, v18
    v_add_f32 v49, v49, v53
    v_add_f32 v57, v57, v61
    v_add_f32 v49, v49, v57
    v_fmac_f32 v45, v49, v19
    v_add_f32 v50, v50, v54
    v_add_f32 v58, v58, v62
    v_add_f32 v50, v50, v58
    v_fmac_f32 v46, v50, v20
    v_add_f32 v51, v51, v55
    v_add_f32 v59, v59, v63
    v_add_f32 v51, v51, v59
    v_fmac_f32 v47, v51, v21
    v_cvt_pk_bf16_f32 v44, v44, v45
    v_cvt_pk_bf16_f32 v45, v46, v47
    buffer_store_dwordx2 v[44:45], v26, s[52:55], s30 offen
H_next:
    s_cmp_eq_u32 s27, 0
    s_cselect_b32 s25, 1, 7
    s_add_u32 s27, s27, s25
    s_cmp_lt_u32 s27, 64
    s_cbranch_scc1 H_seg
    s_branch L_done
H_y:
    s_lshl_b32 s27, s21, 1
    s_add_u32 s27, s27, s22
    s_sub_u32 s27, s27, 30
    s_lshl_b32 s29, s27, 2
    s_add_u32 s29, s29, s20
    s_mul_i32 s29, s29, 114688
    s_add_u32 s29, s29, 6422528
    buffer_load_dwordx4 a[0:3], v2, s[8:11], s29 offen offset:0
    buffer_load_dwordx4 a[4:7], v2, s[8:11], s29 offen offset:1024
    buffer_load_dwordx4 a[8:11], v2, s[8:11], s29 offen offset:2048
    buffer_load_dwordx4 a[12:15], v2, s[8:11], s29 offen offset:3072
    s_add_u32 s29, s29, 4096
    buffer_load_dwordx4 a[16:19], v2, s[8:11], s29 offen offset:0
    buffer_load_dwordx4 a[20:23], v2, s[8:11], s29 offen offset:1024
    buffer_load_dwordx4 a[24:27], v2, s[8:11], s29 offen offset:2048
    buffer_load_dwordx4 a[28:31], v2, s[8:11], s29 offen offset:3072
    s_add_u32 s29, s29, 4096
    buffer_load_dwordx4 a[32:35], v2, s[8:11], s29 offen offset:0
    buffer_load_dwordx4 a[36:39], v2, s[8:11], s29 offen offset:1024
    buffer_load_dwordx4 a[40:43], v2, s[8:11], s29 offen offset:2048
    buffer_load_dwordx4 a[44:47], v2, s[8:11], s29 offen offset:3072
    s_add_u32 s29, s29, 4096
    buffer_load_dwordx4 a[48:51], v2, s[8:11], s29 offen offset:0
    buffer_load_dwordx4 a[52:55], v2, s[8:11], s29 offen offset:1024
    buffer_load_dwordx4 a[56:59], v2, s[8:11], s29 offen offset:2048
    buffer_load_dwordx4 a[60:63], v2, s[8:11], s29 offen offset:3072
    s_add_u32 s29, s29, 4096
    buffer_load_dwordx4 a[64:67], v2, s[8:11], s29 offen offset:0
    buffer_load_dwordx4 a[68:71], v2, s[8:11], s29 offen offset:1024
    buffer_load_dwordx4 a[72:75], v2, s[8:11], s29 offen offset:2048
    buffer_load_dwordx4 a[76:79], v2, s[8:11], s29 offen offset:3072
    s_add_u32 s29, s29, 4096
    buffer_load_dwordx4 a[80:83], v2, s[8:11], s29 offen offset:0
    buffer_load_dwordx4 a[84:87], v2, s[8:11], s29 offen offset:1024
    buffer_load_dwordx4 a[88:91], v2, s[8:11], s29 offen offset:2048
    buffer_load_dwordx4 a[92:95], v2, s[8:11], s29 offen offset:3072
    s_add_u32 s29, s29, 4096
    buffer_load_dwordx4 a[96:99], v2, s[8:11], s29 offen offset:0
    buffer_load_dwordx4 a[100:103], v2, s[8:11], s29 offen offset:1024
    buffer_load_dwordx4 a[104:107], v2, s[8:11], s29 offen offset:2048
    buffer_load_dwordx4 a[108:111], v2, s[8:11], s29 offen offset:3072
    s_add_u32 s29, s29, 4096
    buffer_load_dwordx4 a[112:115], v2, s[8:11], s29 offen offset:0
    buffer_load_dwordx4 a[116:119], v2, s[8:11], s29 offen offset:1024
    buffer_load_dwordx4 a[120:123], v2, s[8:11], s29 offen offset:2048
    buffer_load_dwordx4 a[124:127], v2, s[8:11], s29 offen offset:3072
    s_add_u32 s29, s29, 4096
    buffer_load_dwordx4 a[128:131], v2, s[8:11], s29 offen offset:0
    buffer_load_dwordx4 a[132:135], v2, s[8:11], s29 offen offset:1024
    buffer_load_dwordx4 a[136:139], v2, s[8:11], s29 offen offset:2048
    buffer_load_dwordx4 a[140:143], v2, s[8:11], s29 offen offset:3072
    s_add_u32 s29, s29, 4096
    buffer_load_dwordx4 a[144:147], v2, s[8:11], s29 offen offset:0
    buffer_load_dwordx4 a[148:151], v2, s[8:11], s29 offen offset:1024
    buffer_load_dwordx4 a[152:155], v2, s[8:11], s29 offen offset:2048
    buffer_load_dwordx4 a[156:159], v2, s[8:11], s29 offen offset:3072
    s_add_u32 s29, s29, 4096
    buffer_load_dwordx4 a[160:163], v2, s[8:11], s29 offen offset:0
    buffer_load_dwordx4 a[164:167], v2, s[8:11], s29 offen offset:1024
    buffer_load_dwordx4 a[168:171], v2, s[8:11], s29 offen offset:2048
    buffer_load_dwordx4 a[172:175], v2, s[8:11], s29 offen offset:3072
    s_add_u32 s29, s29, 4096
    buffer_load_dwordx4 a[176:179], v2, s[8:11], s29 offen offset:0
    buffer_load_dwordx4 a[180:183], v2, s[8:11], s29 offen offset:1024
    buffer_load_dwordx4 a[184:187], v2, s[8:11], s29 offen offset:2048
    buffer_load_dwordx4 a[188:191], v2, s[8:11], s29 offen offset:3072
    s_add_u32 s29, s29, 4096
    buffer_load_dwordx4 a[192:195], v2, s[8:11], s29 offen offset:0
    buffer_load_dwordx4 a[196:199], v2, s[8:11], s29 offen offset:1024
    buffer_load_dwordx4 a[200:203], v2, s[8:11], s29 offen offset:2048
    buffer_load_dwordx4 a[204:207], v2, s[8:11], s29 offen offset:3072
    s_add_u32 s29, s29, 4096
    buffer_load_dwordx4 a[208:211], v2, s[8:11], s29 offen offset:0
    buffer_load_dwordx4 a[212:215], v2, s[8:11], s29 offen offset:1024
    buffer_load_dwordx4 a[216:219], v2, s[8:11], s29 offen offset:2048
    buffer_load_dwordx4 a[220:223], v2, s[8:11], s29 offen offset:3072
    s_add_u32 s29, s29, 4096
    buffer_load_dwordx4 a[224:227], v2, s[8:11], s29 offen offset:0
    buffer_load_dwordx4 a[228:231], v2, s[8:11], s29 offen offset:1024
    buffer_load_dwordx4 a[232:235], v2, s[8:11], s29 offen offset:2048
    buffer_load_dwordx4 a[236:239], v2, s[8:11], s29 offen offset:3072
    s_add_u32 s29, s29, 4096
    buffer_load_dwordx4 a[240:243], v2, s[8:11], s29 offen offset:0
    buffer_load_dwordx4 a[244:247], v2, s[8:11], s29 offen offset:1024
    buffer_load_dwordx4 a[248:251], v2, s[8:11], s29 offen offset:2048
    buffer_load_dwordx4 a[252:255], v2, s[8:11], s29 offen offset:3072
    s_add_u32 s29, s29, 4096
    buffer_load_dwordx4 v[64:67], v2, s[8:11], s29 offen offset:0
    buffer_load_dwordx4 v[68:71], v2, s[8:11], s29 offen offset:1024
    buffer_load_dwordx4 v[72:75], v2, s[8:11], s29 offen offset:2048
    buffer_load_dwordx4 v[76:79], v2, s[8:11], s29 offen offset:3072
    s_add_u32 s29, s29, 4096
    buffer_load_dwordx4 v[80:83], v2, s[8:11], s29 offen offset:0
    buffer_load_dwordx4 v[84:87], v2, s[8:11], s29 offen offset:1024
    buffer_load_dwordx4 v[88:91], v2, s[8:11], s29 offen offset:2048
    buffer_load_dwordx4 v[92:95], v2, s[8:11], s29 offen offset:3072
    s_add_u32 s29, s29, 4096
    buffer_load_dwordx4 v[96:99], v2, s[8:11], s29 offen offset:0
    buffer_load_dwordx4 v[100:103], v2, s[8:11], s29 offen offset:1024
    buffer_load_dwordx4 v[104:107], v2, s[8:11], s29 offen offset:2048
    buffer_load_dwordx4 v[108:111], v2, s[8:11], s29 offen offset:3072
    s_add_u32 s29, s29, 4096
    buffer_load_dwordx4 v[112:115], v2, s[8:11], s29 offen offset:0
    buffer_load_dwordx4 v[116:119], v2, s[8:11], s29 offen offset:1024
    buffer_load_dwordx4 v[120:123], v2, s[8:11], s29 offen offset:2048
    buffer_load_dwordx4 v[124:127], v2, s[8:11], s29 offen offset:3072
    s_add_u32 s29, s29, 4096
    buffer_load_dwordx4 v[128:131], v2, s[8:11], s29 offen offset:0
    buffer_load_dwordx4 v[132:135], v2, s[8:11], s29 offen offset:1024
    buffer_load_dwordx4 v[136:139], v2, s[8:11], s29 offen offset:2048
    buffer_load_dwordx4 v[140:143], v2, s[8:11], s29 offen offset:3072
    s_add_u32 s29, s29, 4096
    buffer_load_dwordx4 v[144:147], v2, s[8:11], s29 offen offset:0
    buffer_load_dwordx4 v[148:151], v2, s[8:11], s29 offen offset:1024
    buffer_load_dwordx4 v[152:155], v2, s[8:11], s29 offen offset:2048
    buffer_load_dwordx4 v[156:159], v2, s[8:11], s29 offen offset:3072
    s_add_u32 s29, s29, 4096
    buffer_load_dwordx4 v[160:163], v2, s[8:11], s29 offen offset:0
    buffer_load_dwordx4 v[164:167], v2, s[8:11], s29 offen offset:1024
    buffer_load_dwordx4 v[168:171], v2, s[8:11], s29 offen offset:2048
    buffer_load_dwordx4 v[172:175], v2, s[8:11], s29 offen offset:3072
    s_add_u32 s29, s29, 4096
    buffer_load_dwordx4 v[176:179], v2, s[8:11], s29 offen offset:0
    buffer_load_dwordx4 v[180:183], v2, s[8:11], s29 offen offset:1024
    buffer_load_dwordx4 v[184:187], v2, s[8:11], s29 offen offset:2048
    buffer_load_dwordx4 v[188:191], v2, s[8:11], s29 offen offset:3072
    s_add_u32 s29, s29, 4096
    buffer_load_dwordx4 v[192:195], v2, s[8:11], s29 offen offset:0
    buffer_load_dwordx4 v[196:199], v2, s[8:11], s29 offen offset:1024
    buffer_load_dwordx4 v[200:203], v2, s[8:11], s29 offen offset:2048
    buffer_load_dwordx4 v[204:207], v2, s[8:11], s29 offen offset:3072
    s_add_u32 s29, s29, 4096
    buffer_load_dwordx4 v[208:211], v2, s[8:11], s29 offen offset:0
    buffer_load_dwordx4 v[212:215], v2, s[8:11], s29 offen offset:1024
    buffer_load_dwordx4 v[216:219], v2, s[8:11], s29 offen offset:2048
    buffer_load_dwordx4 v[220:223], v2, s[8:11], s29 offen offset:3072
    s_add_u32 s29, s29, 4096
    buffer_load_dwordx4 v[224:227], v2, s[8:11], s29 offen offset:0
    buffer_load_dwordx4 v[228:231], v2, s[8:11], s29 offen offset:1024
    buffer_load_dwordx4 v[232:235], v2, s[8:11], s29 offen offset:2048
    buffer_load_dwordx4 v[236:239], v2, s[8:11], s29 offen offset:3072
    s_add_u32 s29, s29, 4096
    buffer_load_dwordx4 v[240:243], v2, s[8:11], s29 offen offset:0
    buffer_load_dwordx4 v[244:247], v2, s[8:11], s29 offen offset:1024
    buffer_load_dwordx4 v[248:251], v2, s[8:11], s29 offen offset:2048
    buffer_load_dwordx4 v[252:255], v2, s[8:11], s29 offen offset:3072
    s_add_u32 s29, s29, 4096
    v_mov_b32 v5, 0x4444
    v_mov_b32 v6, 0xeeee
    v_and_b32 v7, 2, v1
    v_cmp_ne_u32 vcc, 0, v7
    s_nop 1
    v_cndmask_b32 v4, v5, v6, vcc
    s_lshl_b32 s34, s27, 13
    s_and_b32 s29, s20, 1
    s_lshl_b32 s29, s29, 12
    s_add_u32 s34, s34, s29
    s_lshr_b32 s29, s20, 1
    s_lshl_b32 s29, s29, 11
    s_add_u32 s34, s34, s29
    s_add_u32 s34, s34, 47023104
    s_lshl_b32 s28, s27, 8
    s_add_u32 s28, s28, 46090240
    s_mov_b32 s35, 45547520
    s_mov_b32 s36, 45551616
    s_mov_b32 s27, 0
    v_mov_b64 v[36:37], 0
    v_mov_b64 v[38:39], 0
    v_mov_b64 v[40:41], 0
    v_mov_b64 v[42:43], 0
    v_mov_b64 v[44:45], 0
    v_mov_b64 v[46:47], 0
    v_mov_b64 v[56:57], 0
    v_mov_b64 v[58:59], 0
    s_lshl_b32 s29, s20, 5
    s_add_u32 s28, s28, s29
H_y_seg:
    s_mov_b32 s33, 400000
H_y_m:
    buffer_load_dwordx4 v[8:11], v2, s[8:11], s35 offen offset:0 sc1
    buffer_load_dwordx4 v[12:15], v2, s[8:11], s35 offen offset:1024 sc1
    buffer_load_dwordx4 v[16:19], v2, s[8:11], s35 offen offset:2048 sc1
    buffer_load_dwordx4 v[20:23], v2, s[8:11], s35 offen offset:3072 sc1
    buffer_load_dwordx4 v[24:27], v2, s[8:11], s36 offen offset:0 sc1
    buffer_load_dwordx4 v[28:31], v2, s[8:11], s36 offen offset:1024 sc1
    buffer_load_dwordx4 v[32:35], v2, s[8:11], s36 offen offset:2048 sc1
    s_waitcnt vmcnt(0)
    s_cmp_lg_u32 s33, 400000
    s_cbranch_scc1 H_y_nf
    s_mov_b64 exec, 3
    buffer_store_dwordx4 v[56:59], v2, s[8:11], s28 offen sc1
    s_mov_b64 exec, -1
H_y_nf:
    v_max3_u32 v5, v8, v9, v10
    v_max3_u32 v5, v5, v11, v12
    v_max3_u32 v5, v5, v13, v14
    v_max3_u32 v5, v5, v15, v16
    v_max3_u32 v5, v5, v17, v18
    v_max3_u32 v5, v5, v19, v20
    v_max3_u32 v5, v5, v21, v22
    v_max3_u32 v5, v5, v23, v24
    v_max3_u32 v5, v5, v25, v26
    v_max3_u32 v5, v5, v27, v28
    v_max3_u32 v5, v5, v29, v30
    v_max3_u32 v5, v5, v31, v32
    v_max3_u32 v5, v5, v33, v34
    v_max_u32 v5, v5, v35
    v_cmp_eq_u32 vcc, -1, v5
    s_cbranch_vccz H_y_go
    s_sleep 2
    s_sub_u32 s33, s33, 1
    s_cbranch_scc0 H_y_m
    s_branch L_fail
H_y_go:
    v_smfmac_f32_16x16x64_bf16 v[36:39], v[8:11], a[0:7], v4
    v_smfmac_f32_16x16x64_bf16 v[36:39], v[12:15], a[8:15], v4
    v_smfmac_f32_16x16x64_bf16 v[36:39], v[16:19], a[16:23], v4
    v_smfmac_f32_16x16x64_bf16 v[36:39], v[20:23], a[24:31], v4
    v_smfmac_f32_16x16x64_bf16 v[36:39], v[24:27], a[32:39], v4
    v_smfmac_f32_16x16x64_bf16 v[36:39], v[28:31], a[40:47], v4
    v_smfmac_f32_16x16x64_bf16 v[36:39], v[32:35], a[48:55], v4
    v_smfmac_f32_16x16x64_bf16 v[40:43], v[8:11], a[56:63], v4
    v_smfmac_f32_16x16x64_bf16 v[40:43], v[12:15], a[64:71], v4
    v_smfmac_f32_16x16x64_bf16 v[40:43], v[16:19], a[72:79], v4
    v_add_f32_e64 v36, v36, v38
    v_smfmac_f32_16x16x64_bf16 v[40:43], v[20:23], a[80:87], v4
    v_add_f32_e64 v37, v37, v39
    v_smfmac_f32_16x16x64_bf16 v[40:43], v[24:27], a[88:95], v4
    v_cvt_pk_bf16_f32 v48, v36, v37
    v_smfmac_f32_16x16x64_bf16 v[40:43], v[28:31], a[96:103], v4
    v_mov_b64_e64 v[36:37], 0
    v_smfmac_f32_16x16x64_bf16 v[40:43], v[32:35], a[104:111], v4
    v_mov_b64_e64 v[38:39], 0
    v_smfmac_f32_16x16x64_bf16 v[44:47], v[8:11], a[112:119], v4
    v_smfmac_f32_16x16x64_bf16 v[44:47], v[12:15], a[120:127], v4
    v_smfmac_f32_16x16x64_bf16 v[44:47], v[16:19], a[128:135], v4
    v_add_f32_e64 v40, v40, v42
    v_smfmac_f32_16x16x64_bf16 v[44:47], v[20:23], a[136:143], v4
    v_add_f32_e64 v41, v41, v43
    v_smfmac_f32_16x16x64_bf16 v[44:47], v[24:27], a[144:151], v4
    v_cvt_pk_bf16_f32 v49, v40, v41
    v_smfmac_f32_16x16x64_bf16 v[44:47], v[28:31], a[152:159], v4
    v_mov_b64_e64 v[40:41], 0
    v_smfmac_f32_16x16x64_bf16 v[44:47], v[32:35], a[160:167], v4
    v_mov_b64_e64 v[42:43], 0
    v_smfmac_f32_16x16x64_bf16 v[36:39], v[8:11], a[168:175], v4
    v_smfmac_f32_16x16x64_bf16 v[36:39], v[12:15], a[176:183], v4
    v_smfmac_f32_16x16x64_bf16 v[36:39], v[16:19], a[184:191], v4
    v_add_f32_e64 v44, v44, v46
    v_smfmac_f32_16x16x64_bf16 v[36:39], v[20:23], a[192:199], v4
    v_add_f32_e64 v45, v45, v47
    v_smfmac_f32_16x16x64_bf16 v[36:39], v[24:27], a[200:207], v4
    v_cvt_pk_bf16_f32 v50, v44, v45
    v_smfmac_f32_16x16x64_bf16 v[36:39], v[28:31], a[208:215], v4
    v_mov_b64_e64 v[44:45], 0
    v_smfmac_f32_16x16x64_bf16 v[36:39], v[32:35], a[216:223], v4
    v_mov_b64_e64 v[46:47], 0
    v_smfmac_f32_16x16x64_bf16 v[40:43], v[8:11], a[224:231], v4
    v_smfmac_f32_16x16x64_bf16 v[40:43], v[12:15], a[232:239], v4
    v_smfmac_f32_16x16x64_bf16 v[40:43], v[16:19], a[240:247], v4
    v_add_f32_e64 v36, v36, v38
    v_smfmac_f32_16x16x64_bf16 v[40:43], v[20:23], a[248:255], v4
    v_add_f32_e64 v37, v37, v39
    v_smfmac_f32_16x16x64_bf16 v[40:43], v[24:27], v[64:71], v4
    v_cvt_pk_bf16_f32 v51, v36, v37
    v_smfmac_f32_16x16x64_bf16 v[40:43], v[28:31], v[72:79], v4
    v_mov_b64_e64 v[36:37], 0
    v_smfmac_f32_16x16x64_bf16 v[40:43], v[32:35], v[80:87], v4
    v_mov_b64_e64 v[38:39], 0
    v_smfmac_f32_16x16x64_bf16 v[44:47], v[8:11], v[88:95], v4
    v_smfmac_f32_16x16x64_bf16 v[44:47], v[12:15], v[96:103], v4
    v_smfmac_f32_16x16x64_bf16 v[44:47], v[16:19], v[104:111], v4
    v_add_f32_e64 v40, v40, v42
    v_smfmac_f32_16x16x64_bf16 v[44:47], v[20:23], v[112:119], v4
    v_add_f32_e64 v41, v41, v43
    v_smfmac_f32_16x16x64_bf16 v[44:47], v[24:27], v[120:127], v4
    v_cvt_pk_bf16_f32 v52, v40, v41
    v_smfmac_f32_16x16x64_bf16 v[44:47], v[28:31], v[128:135], v4
    v_mov_b64_e64 v[40:41], 0
    v_smfmac_f32_16x16x64_bf16 v[44:47], v[32:35], v[136:143], v4
    v_mov_b64_e64 v[42:43], 0
    v_smfmac_f32_16x16x64_bf16 v[36:39], v[8:11], v[144:151], v4
    v_smfmac_f32_16x16x64_bf16 v[36:39], v[12:15], v[152:159], v4
    v_smfmac_f32_16x16x64_bf16 v[36:39], v[16:19], v[160:167], v4
    v_add_f32_e64 v44, v44, v46
    v_smfmac_f32_16x16x64_bf16 v[36:39], v[20:23], v[168:175], v4
    v_add_f32_e64 v45, v45, v47
    v_smfmac_f32_16x16x64_bf16 v[36:39], v[24:27], v[176:183], v4
    v_cvt_pk_bf16_f32 v53, v44, v45
    v_smfmac_f32_16x16x64_bf16 v[36:39], v[28:31], v[184:191], v4
    v_mov_b64_e64 v[44:45], 0
    v_smfmac_f32_16x16x64_bf16 v[36:39], v[32:35], v[192:199], v4
    v_mov_b64_e64 v[46:47], 0
    v_smfmac_f32_16x16x64_bf16 v[40:43], v[8:11], v[200:207], v4
    v_smfmac_f32_16x16x64_bf16 v[40:43], v[12:15], v[208:215], v4
    v_smfmac_f32_16x16x64_bf16 v[40:43], v[16:19], v[216:223], v4
    v_add_f32_e64 v36, v36, v38
    v_smfmac_f32_16x16x64_bf16 v[40:43], v[20:23], v[224:231], v4
    v_add_f32_e64 v37, v37, v39
    v_smfmac_f32_16x16x64_bf16 v[40:43], v[24:27], v[232:239], v4
    v_cvt_pk_bf16_f32 v54, v36, v37
    v_smfmac_f32_16x16x64_bf16 v[40:43], v[28:31], v[240:247], v4
    v_mov_b64_e64 v[36:37], 0
    v_smfmac_f32_16x16x64_bf16 v[40:43], v[32:35], v[248:255], v4
    v_mov_b64_e64 v[38:39], 0
    s_nop 7
    v_add_f32 v40, v40, v42
    v_add_f32 v41, v41, v43
    v_cvt_pk_bf16_f32 v55, v40, v41
    v_mov_b64 v[40:41], 0
    v_mov_b64 v[42:43], 0
    buffer_store_dwordx4 v[48:51], v2, s[8:11], s34 offen offset:0 sc1
    buffer_store_dwordx4 v[52:55], v2, s[8:11], s34 offen offset:1024 sc1
    s_add_u32 s35, s35, 8192
    s_add_u32 s36, s36, 8192
    s_add_u32 s34, s34, 114688
    s_add_u32 s28, s28, 11264
    s_add_u32 s27, s27, 1
    s_cmp_lt_u32 s27, 63
    s_cbranch_scc1 H_y_seg
    s_waitcnt vmcnt(0)
    s_mov_b64 exec, 3
    buffer_store_dwordx4 v[56:59], v2, s[8:11], s28 offen sc1
    s_mov_b64 exec, -1
    s_branch L_done
L_any:
    s_cmp_ge_u32 s23, 32
    s_cbranch_scc1 L_help_any
    s_mov_b32 s21, s23
    s_cmp_ge_u32 s21, 30
    s_cbranch_scc1 L_pref_any
    s_cmp_ge_u32 s21, 16
    s_cbranch_scc1 L_value_any
    v_lshlrev_b32 v92, 4, v1
    v_lshlrev_b32 v119, 7, v1
    s_mul_i32 s32, s21, 7
    v_min_u32 v60, 6, v1
    v_mul_u32_u24 v60, 128, v60
    s_lshl_b32 s3, s32, 7
    s_add_u32 s3, s3, 46833664
    s_mov_b32 s47, 200000
L_sc_nw_any:
    buffer_load_dwordx2 v[62:63], v60, s[8:11], s3 offen sc1
    s_waitcnt vmcnt(0)
    v_xor_b32 v62, s96, v62
    v_xor_b32 v63, s97, v63
    v_or_b32 v62, v62, v63
    v_cmp_ne_u32 vcc, 0, v62
    s_cbranch_vccz L_sc_nw_ok_any
    s_sub_u32 s47, s47, 1
    s_cbranch_scc0 L_sc_nw_any
    s_branch L_fail
L_sc_nw_ok_any:
    s_lshl_b32 s32, s21, 2
    s_add_u32 s32, s32, s20
    s_mul_i32 s32, s32, 100352
    s_mul_i32 s33, s20, 7
    s_lshr_b32 s33, s33, 2
    s_lshl_b32 s37, s33, 11
    s_add_u32 s37, s37, s32
    buffer_load_dwordx4 a[0:3], v92, s[8:11], s37 offen offset:0
    buffer_load_dwordx4 a[4:7], v92, s[8:11], s37 offen offset:1024
    s_add_u32 s37, s37, 14336
    buffer_load_dwordx4 a[56:59], v92, s[8:11], s37 offen offset:0
    buffer_load_dwordx4 a[60:63], v92, s[8:11], s37 offen offset:1024
    s_add_u32 s37, s37, 14336
    buffer_load_dwordx4 a[112:115], v92, s[8:11], s37 offen offset:0
    buffer_load_dwordx4 a[116:119], v92, s[8:11], s37 offen offset:1024
    s_add_u32 s37, s37, 14336
    buffer_load_dwordx4 a[168:171], v92, s[8:11], s37 offen offset:0
    buffer_load_dwordx4 a[172:175], v92, s[8:11], s37 offen offset:1024
    s_add_u32 s37, s37, 14336
    buffer_load_dwordx4 a[224:227], v92, s[8:11], s37 offen offset:0
    buffer_load_dwordx4 a[228:231], v92, s[8:11], s37 offen offset:1024
    s_add_u32 s37, s37, 14336
    buffer_load_dwordx4 v[144:147], v92, s[8:11], s37 offen offset:0
    buffer_load_dwordx4 v[148:151], v92, s[8:11], s37 offen offset:1024
    s_add_u32 s37, s37, 14336
    buffer_load_dwordx4 v[200:203], v92, s[8:11], s37 offen offset:0
    buffer_load_dwordx4 v[204:207], v92, s[8:11], s37 offen offset:1024
    s_lshl_b32 s64, s33, 10
    s_add_u32 s64, s64, 44302336
    s_add_u32 s33, s33, 1
    s_cmp_eq_u32 s33, 7
    s_cselect_b32 s33, 0, s33
    s_lshl_b32 s37, s33, 11
    s_add_u32 s37, s37, s32
    buffer_load_dwordx4 a[8:11], v92, s[8:11], s37 offen offset:0
    buffer_load_dwordx4 a[12:15], v92, s[8:11], s37 offen offset:1024
    s_add_u32 s37, s37, 14336
    buffer_load_dwordx4 a[64:67], v92, s[8:11], s37 offen offset:0
    buffer_load_dwordx4 a[68:71], v92, s[8:11], s37 offen offset:1024
    s_add_u32 s37, s37, 14336
    buffer_load_dwordx4 a[120:123], v92, s[8:11], s37 offen offset:0
    buffer_load_dwordx4 a[124:127], v92, s[8:11], s37 offen offset:1024
    s_add_u32 s37, s37, 14336
    buffer_load_dwordx4 a[176:179], v92, s[8:11], s37 offen offset:0
    buffer_load_dwordx4 a[180:183], v92, s[8:11], s37 offen offset:1024
    s_add_u32 s37, s37, 14336
    buffer_load_dwordx4 a[232:235], v92, s[8:11], s37 offen offset:0
    buffer_load_dwordx4 a[236:239], v92, s[8:11], s37 offen offset:1024
    s_add_u32 s37, s37, 14336
    buffer_load_dwordx4 v[152:155], v92, s[8:11], s37 offen offset:0
    buffer_load_dwordx4 v[156:159], v92, s[8:11], s37 offen offset:1024
    s_add_u32 s37, s37, 14336
    buffer_load_dwordx4 v[208:211], v92, s[8:11], s37 offen offset:0
    buffer_load_dwordx4 v[212:215], v92, s[8:11], s37 offen offset:1024
    s_lshl_b32 s65, s33, 10
    s_add_u32 s65, s65, 44302336
    s_add_u32 s33, s33, 1
    s_cmp_eq_u32 s33, 7
    s_cselect_b32 s33, 0, s33
    s_lshl_b32 s37, s33, 11
    s_add_u32 s37, s37, s32
    buffer_load_dwordx4 a[16:19], v92, s[8:11], s37 offen offset:0
    buffer_load_dwordx4 a[20:23], v92, s[8:11], s37 offen offset:1024
    s_add_u32 s37, s37, 14336
    buffer_load_dwordx4 a[72:75], v92, s[8:11], s37 offen offset:0
    buffer_load_dwordx4 a[76:79], v92, s[8:11], s37 offen offset:1024
    s_add_u32 s37, s37, 14336
    buffer_load_dwordx4 a[128:131], v92, s[8:11], s37 offen offset:0
    buffer_load_dwordx4 a[132:135], v92, s[8:11], s37 offen offset:1024
    s_add_u32 s37, s37, 14336
    buffer_load_dwordx4 a[184:187], v92, s[8:11], s37 offen offset:0
    buffer_load_dwordx4 a[188:191], v92, s[8:11], s37 offen offset:1024
    s_add_u32 s37, s37, 14336
    buffer_load_dwordx4 a[240:243], v92, s[8:11], s37 offen offset:0
    buffer_load_dwordx4 a[244:247], v92, s[8:11], s37 offen offset:1024
    s_add_u32 s37, s37, 14336
    buffer_load_dwordx4 v[160:163], v92, s[8:11], s37 offen offset:0
    buffer_load_dwordx4 v[164:167], v92, s[8:11], s37 offen offset:1024
    s_add_u32 s37, s37, 14336
    buffer_load_dwordx4 v[216:219], v92, s[8:11], s37 offen offset:0
    buffer_load_dwordx4 v[220:223], v92, s[8:11], s37 offen offset:1024
    s_lshl_b32 s66, s33, 10
    s_add_u32 s66, s66, 44302336
    s_add_u32 s33, s33, 1
    s_cmp_eq_u32 s33, 7
    s_cselect_b32 s33, 0, s33
    s_lshl_b32 s37, s33, 11
    s_add_u32 s37, s37, s32
    buffer_load_dwordx4 a[24:27], v92, s[8:11], s37 offen offset:0
    buffer_load_dwordx4 a[28:31], v92, s[8:11], s37 offen offset:1024
    s_add_u32 s37, s37, 14336
    buffer_load_dwordx4 a[80:83], v92, s[8:11], s37 offen offset:0
    buffer_load_dwordx4 a[84:87], v92, s[8:11], s37 offen offset:1024
    s_add_u32 s37, s37, 14336
    buffer_load_dwordx4 a[136:139], v92, s[8:11], s37 offen offset:0
    buffer_load_dwordx4 a[140:143], v92, s[8:11], s37 offen offset:1024
    s_add_u32 s37, s37, 14336
    buffer_load_dwordx4 a[192:195], v92, s[8:11], s37 offen offset:0
    buffer_load_dwordx4 a[196:199], v92, s[8:11], s37 offen offset:1024
    s_add_u32 s37, s37, 14336
    buffer_load_dwordx4 a[248:251], v92, s[8:11], s37 offen offset:0
    buffer_load_dwordx4 a[252:255], v92, s[8:11], s37 offen offset:1024
    s_add_u32 s37, s37, 14336
    buffer_load_dwordx4 v[168:171], v92, s[8:11], s37 offen offset:0
    buffer_load_dwordx4 v[172:175], v92, s[8:11], s37 offen offset:1024
    s_add_u32 s37, s37, 14336
    buffer_load_dwordx4 v[224:227], v92, s[8:11], s37 offen offset:0
    buffer_load_dwordx4 v[228:231], v92, s[8:11], s37 offen offset:1024
    s_lshl_b32 s67, s33, 10
    s_add_u32 s67, s67, 44302336
    s_add_u32 s33, s33, 1
    s_cmp_eq_u32 s33, 7
    s_cselect_b32 s33, 0, s33
    s_lshl_b32 s37, s33, 11
    s_add_u32 s37, s37, s32
    buffer_load_dwordx4 a[32:35], v92, s[8:11], s37 offen offset:0
    buffer_load_dwordx4 a[36:39], v92, s[8:11], s37 offen offset:1024
    s_add_u32 s37, s37, 14336
    buffer_load_dwordx4 a[88:91], v92, s[8:11], s37 offen offset:0
    buffer_load_dwordx4 a[92:95], v92, s[8:11], s37 offen offset:1024
    s_add_u32 s37, s37, 14336
    buffer_load_dwordx4 a[144:147], v92, s[8:11], s37 offen offset:0
    buffer_load_dwordx4 a[148:151], v92, s[8:11], s37 offen offset:1024
    s_add_u32 s37, s37, 14336
    buffer_load_dwordx4 a[200:203], v92, s[8:11], s37 offen offset:0
    buffer_load_dwordx4 a[204:207], v92, s[8:11], s37 offen offset:1024
    s_add_u32 s37, s37, 14336
    buffer_load_dwordx4 v[120:123], v92, s[8:11], s37 offen offset:0
    buffer_load_dwordx4 v[124:127], v92, s[8:11], s37 offen offset:1024
    s_add_u32 s37, s37, 14336
    buffer_load_dwordx4 v[176:179], v92, s[8:11], s37 offen offset:0
    buffer_load_dwordx4 v[180:183], v92, s[8:11], s37 offen offset:1024
    s_add_u32 s37, s37, 14336
    buffer_load_dwordx4 v[232:235], v92, s[8:11], s37 offen offset:0
    buffer_load_dwordx4 v[236:239], v92, s[8:11], s37 offen offset:1024
    s_lshl_b32 s68, s33, 10
    s_add_u32 s68, s68, 44302336
    s_add_u32 s33, s33, 1
    s_cmp_eq_u32 s33, 7
    s_cselect_b32 s33, 0, s33
    s_lshl_b32 s37, s33, 11
    s_add_u32 s37, s37, s32
    buffer_load_dwordx4 a[40:43], v92, s[8:11], s37 offen offset:0
    buffer_load_dwordx4 a[44:47], v92, s[8:11], s37 offen offset:1024
    s_add_u32 s37, s37, 14336
    buffer_load_dwordx4 a[96:99], v92, s[8:11], s37 offen offset:0
    buffer_load_dwordx4 a[100:103], v92, s[8:11], s37 offen offset:1024
    s_add_u32 s37, s37, 14336
    buffer_load_dwordx4 a[152:155], v92, s[8:11], s37 offen offset:0
    buffer_load_dwordx4 a[156:159], v92, s[8:11], s37 offen offset:1024
    s_add_u32 s37, s37, 14336
    buffer_load_dwordx4 a[208:211], v92, s[8:11], s37 offen offset:0
    buffer_load_dwordx4 a[212:215], v92, s[8:11], s37 offen offset:1024
    s_add_u32 s37, s37, 14336
    buffer_load_dwordx4 v[128:131], v92, s[8:11], s37 offen offset:0
    buffer_load_dwordx4 v[132:135], v92, s[8:11], s37 offen offset:1024
    s_add_u32 s37, s37, 14336
    buffer_load_dwordx4 v[184:187], v92, s[8:11], s37 offen offset:0
    buffer_load_dwordx4 v[188:191], v92, s[8:11], s37 offen offset:1024
    s_add_u32 s37, s37, 14336
    buffer_load_dwordx4 v[240:243], v92, s[8:11], s37 offen offset:0
    buffer_load_dwordx4 v[244:247], v92, s[8:11], s37 offen offset:1024
    s_lshl_b32 s69, s33, 10
    s_add_u32 s69, s69, 44302336
    s_add_u32 s33, s33, 1
    s_cmp_eq_u32 s33, 7
    s_cselect_b32 s33, 0, s33
    s_lshl_b32 s37, s33, 11
    s_add_u32 s37, s37, s32
    buffer_load_dwordx4 a[48:51], v92, s[8:11], s37 offen offset:0
    buffer_load_dwordx4 a[52:55], v92, s[8:11], s37 offen offset:1024
    s_add_u32 s37, s37, 14336
    buffer_load_dwordx4 a[104:107], v92, s[8:11], s37 offen offset:0
    buffer_load_dwordx4 a[108:111], v92, s[8:11], s37 offen offset:1024
    s_add_u32 s37, s37, 14336
    buffer_load_dwordx4 a[160:163], v92, s[8:11], s37 offen offset:0
    buffer_load_dwordx4 a[164:167], v92, s[8:11], s37 offen offset:1024
    s_add_u32 s37, s37, 14336
    buffer_load_dwordx4 a[216:219], v92, s[8:11], s37 offen offset:0
    buffer_load_dwordx4 a[220:223], v92, s[8:11], s37 offen offset:1024
    s_add_u32 s37, s37, 14336
    buffer_load_dwordx4 v[136:139], v92, s[8:11], s37 offen offset:0
    buffer_load_dwordx4 v[140:143], v92, s[8:11], s37 offen offset:1024
    s_add_u32 s37, s37, 14336
    buffer_load_dwordx4 v[192:195], v92, s[8:11], s37 offen offset:0
    buffer_load_dwordx4 v[196:199], v92, s[8:11], s37 offen offset:1024
    s_add_u32 s37, s37, 14336
    buffer_load_dwordx4 v[248:251], v92, s[8:11], s37 offen offset:0
    buffer_load_dwordx4 v[252:255], v92, s[8:11], s37 offen offset:1024
    s_lshl_b32 s70, s33, 10
    s_add_u32 s70, s70, 44302336
    s_add_u32 s33, s33, 1
    s_cmp_eq_u32 s33, 7
    s_cselect_b32 s33, 0, s33
    s_mov_b32 s46, 0
    v_min_u32 v60, 63, v1
    v_mul_u32_u24 v60, 128, v60
    s_lshl_b32 s3, s46, 7
    s_add_u32 s3, s3, 46833664
    s_mov_b32 s47, 200000
L_sc_na0_any:
    buffer_load_dwordx2 v[62:63], v60, s[8:11], s3 offen sc1
    s_waitcnt vmcnt(0)
    v_xor_b32 v62, s96, v62
    v_xor_b32 v63, s97, v63
    v_or_b32 v62, v62, v63
    v_cmp_ne_u32 vcc, 0, v62
    s_cbranch_vccz L_sc_na0_ok_any
    s_sub_u32 s47, s47, 1
    s_cbranch_scc0 L_sc_na0_any
    s_branch L_fail
L_sc_na0_ok_any:
    s_mov_b32 s46, 64
    v_min_u32 v60, 63, v1
    v_mul_u32_u24 v60, 128, v60
    s_lshl_b32 s3, s46, 7
    s_add_u32 s3, s3, 46833664
    s_mov_b32 s47, 200000
L_sc_na1_any:
    buffer_load_dwordx2 v[62:63], v60, s[8:11], s3 offen sc1
    s_waitcnt vmcnt(0)
    v_xor_b32 v62, s96, v62
    v_xor_b32 v63, s97, v63
    v_or_b32 v62, v62, v63
    v_cmp_ne_u32 vcc, 0, v62
    s_cbranch_vccz L_sc_na1_ok_any
    s_sub_u32 s47, s47, 1
    s_cbranch_scc0 L_sc_na1_any
    s_branch L_fail
L_sc_na1_ok_any:
    s_mov_b32 s46, 128
    v_min_u32 v60, 63, v1
    v_mul_u32_u24 v60, 128, v60
    s_lshl_b32 s3, s46, 7
    s_add_u32 s3, s3, 46833664
    s_mov_b32 s47, 200000
L_sc_na2_any:
    buffer_load_dwordx2 v[62:63], v60, s[8:11], s3 offen sc1
    s_waitcnt vmcnt(0)
    v_xor_b32 v62, s96, v62
    v_xor_b32 v63, s97, v63
    v_or_b32 v62, v62, v63
    v_cmp_ne_u32 vcc, 0, v62
    s_cbranch_vccz L_sc_na2_ok_any
    s_sub_u32 s47, s47, 1
    s_cbranch_scc0 L_sc_na2_any
    s_branch L_fail
L_sc_na2_ok_any:
    s_mov_b32 s46, 192
    v_min_u32 v60, 63, v1
    v_mul_u32_u24 v60, 128, v60
    s_lshl_b32 s3, s46, 7
    s_add_u32 s3, s3, 46833664
    s_mov_b32 s47, 200000
L_sc_na3_any:
    buffer_load_dwordx2 v[62:63], v60, s[8:11], s3 offen sc1
    s_waitcnt vmcnt(0)
    v_xor_b32 v62, s96, v62
    v_xor_b32 v63, s97, v63
    v_or_b32 v62, v62, v63
    v_cmp_ne_u32 vcc, 0, v62
    s_cbranch_vccz L_sc_na3_ok_any
    s_sub_u32 s47, s47, 1
    s_cbranch_scc0 L_sc_na3_any
    s_branch L_fail
L_sc_na3_ok_any:
    s_mov_b32 s46, 256
    v_min_u32 v60, 63, v1
    v_mul_u32_u24 v60, 128, v60
    s_lshl_b32 s3, s46, 7
    s_add_u32 s3, s3, 46833664
    s_mov_b32 s47, 200000
L_sc_na4_any:
    buffer_load_dwordx2 v[62:63], v60, s[8:11], s3 offen sc1
    s_waitcnt vmcnt(0)
    v_xor_b32 v62, s96, v62
    v_xor_b32 v63, s97, v63
    v_or_b32 v62, v62, v63
    v_cmp_ne_u32 vcc, 0, v62
    s_cbranch_vccz L_sc_na4_ok_any
    s_sub_u32 s47, s47, 1
    s_cbranch_scc0 L_sc_na4_any
    s_branch L_fail
L_sc_na4_ok_any:
    v_mov_b32 v116, 0x4444
    v_mov_b32 v117, 0xeeee
    v_and_b32 v103, 2, v1
    v_cmp_ne_u32 vcc, 0, v103
    s_nop 1
    v_cndmask_b32 v93, v116, v117, vcc
    v_bfe_u32 v100, v1, 1, 1
    v_lshlrev_b32 v100, 7, v100
    v_bfe_u32 v103, v1, 3, 1
    v_lshl_add_u32 v100, v103, 6, v100
    v_bfe_u32 v103, v1, 0, 1
    v_lshl_add_u32 v100, v103, 5, v100
    v_bfe_u32 v103, v1, 2, 1
    v_lshl_add_u32 v100, v103, 2, v100
    v_bfe_u32 v103, v1, 4, 2
    v_lshl_add_u32 v100, v103, 3, v100
    s_lshl_b32 s32, s20, 11
    v_add_u32 v100, s32, v100
    v_bfe_u32 v96, v1, 4, 2
    v_lshlrev_b32 v96, 8, v96
    v_bfe_u32 v103, v1, 0, 4
    v_lshl_add_u32 v96, v103, 3, v96
    v_add_u32 v96, s32, v96
    v_lshlrev_b32 v103, 2, v1
    v_add_u32 v103, s32, v103
    v_mov_b32 v116, 0
    ds_write_b32 v103, v116 offset:1792
    v_bfe_u32 v98, v1, 1, 2
    v_lshlrev_b32 v98, 6, v98
    v_bfe_u32 v103, v1, 4, 1
    v_lshl_add_u32 v98, v103, 5, v98
    v_bfe_u32 v103, v1, 0, 1
    v_lshl_add_u32 v98, v103, 4, v98
    s_mul_i32 s33, s20, 7
    s_and_b32 s33, s33, 3
    s_lshl_b32 s33, s33, 8
    s_lshl_b32 s32, s20, 12
    s_add_u32 s33, s33, s32
    v_add_u32 v98, s33, v98
    v_add_u32 v118, s32, v92
    v_bfe_u32 v103, v1, 5, 1
    v_lshl_add_u32 v97, v103, 8, v98
    s_mul_i32 s33, s20, 1792
    s_add_u32 s33, s33, 8192
    v_bfe_u32 v103, v1, 4, 2
    v_mul_u32_u24 v117, 448, v103
    v_bfe_u32 v99, v1, 0, 4
    v_lshlrev_b32 v99, 2, v99
    v_add3_u32 v99, v99, v117, s33
    v_and_b32 v103, 31, v1
    v_cmp_gt_u32 vcc, 20, v103
    s_nop 1
    v_cndmask_b32 v101, 24, v103, vcc
    v_bfe_u32 v103, v1, 5, 1
    v_mul_u32_u24 v103, 224, v103
    v_lshl_add_u32 v101, v101, 3, v103
    s_mul_i32 s33, s20, 448
    s_add_u32 s33, s33, 8192
    v_add_u32 v101, s33, v101
    v_mov_b32 v116, 0xf149f2ca
    v_mov_b32 v117, 0xf149f2ca
    v_and_b32 v103, 31, v1
    v_mul_u32_u24 v103, 224, v103
    ds_write_b64 v103, v[116:117] offset:8384
    v_bfe_u32 v102, v1, 3, 1
    v_lshlrev_b32 v102, 8, v102
    v_bfe_u32 v103, v1, 0, 1
    v_lshl_add_u32 v102, v103, 5, v102
    v_bfe_u32 v103, v1, 5, 1
    v_lshl_add_u32 v102, v103, 4, v102
    v_bfe_u32 v103, v1, 2, 1
    v_lshl_add_u32 v102, v103, 2, v102
    v_bfe_u32 v103, v1, 1, 1
    v_lshl_add_u32 v102, v103, 3, v102
    s_lshr_b32 s32, s21, 1
    s_lshl_b32 s32, s32, 10
    s_and_b32 s33, s21, 1
    s_lshl_b32 s33, s33, 9
    s_add_u32 s32, s32, s33
    v_add_u32 v102, s32, v102
    v_bfe_u32 v116, v1, 1, 1
    v_lshlrev_b32 v116, 8, v116
    v_bfe_u32 v103, v1, 5, 1
    v_lshl_add_u32 v116, v103, 4, v116
    v_bfe_u32 v103, v1, 0, 1
    v_lshl_add_u32 v116, v103, 3, v116
    v_add_u32 v116, 0x2000, v116
    s_lshr_b32 s32, s21, 3
    s_lshl_b32 s32, s32, 10
    s_bfe_u32 s33, s21, 0x10002
    s_lshl_b32 s33, s33, 9
    s_add_u32 s32, s32, s33
    s_bfe_u32 s33, s21, 0x10000
    s_lshl_b32 s33, s33, 5
    s_add_u32 s32, s32, s33
    s_bfe_u32 s33, s21, 0x10001
    s_lshl_b32 s33, s33, 2
    s_add_u32 s32, s32, s33
    v_add_u32 v116, s32, v116
    v_and_b32 v103, 31, v1
    v_cmp_gt_u32 vcc, 16, v103
    s_nop 1
    v_cndmask_b32 v102, v116, v102, vcc
    s_lshl_b32 s32, s20, 6
    v_add_u32 v102, s32, v102
    v_cmp_gt_u32 vcc, 20, v103
    v_mov_b32 v116, 0x40000000
    s_nop 0
    v_cndmask_b32 v102, v116, v102, vcc
    s_mov_b32 s24, 44302336
    s_mov_b32 s25, 44306432
    s_mov_b32 s26, 44826624
    s_lshl_b32 s29, s20, 13
    s_add_u32 s29, s29, 12845056
    s_mul_i32 s39, s21, 0
    s_add_u32 s39, s39, s20
    s_lshl_b32 s39, s39, 13
    s_add_u32 s39, s39, 16318464
    s_cmp_lt_u32 s20, 0
    s_cbranch_scc1 L_sc_tch_any
    v_mov_b32 v119, 0x40000000
L_sc_tch_any:
    v_min_u32 v103, 28, v1
    v_lshlrev_b32 v103, 2, v103
    s_and_b32 s32, s21, 3
    s_lshl_b32 s32, s32, 7
    v_add_u32 v2, s32, v103
    v_mov_b32 v2, v103
    s_lshl_b32 s32, s21, 2
    s_add_u32 s32, s32, 10240
    s_cmp_eq_u32 s20, 0
    s_cselect_b32 s32, s32, 0x40000000
    v_lshlrev_b32 v116, 7, v1
    v_add_u32 v116, s32, v116
    v_mov_b32 v103, 0x40000000
    v_cmp_gt_u32 vcc, 1, v1
    s_nop 1
    v_cndmask_b32 v3, v103, v116, vcc
    s_mov_b32 s30, 0
    s_mov_b32 s37, 0x21800000
    s_mov_b32 s38, 0x3c000000
    v_mov_b64 v[32:33], 0
    v_mov_b64 v[34:35], 0
    v_mov_b64 v[36:37], 0
    v_mov_b64 v[38:39], 0
    v_mov_b64 v[40:41], 0
    v_mov_b64 v[42:43], 0
    v_mov_b64 v[44:45], 0
    v_mov_b64 v[46:47], 0
    v_mov_b64 v[48:49], 0
    v_mov_b64 v[50:51], 0
    v_mov_b64 v[52:53], 0
    v_mov_b64 v[54:55], 0
    v_mov_b64 v[56:57], 0
    v_mov_b64 v[58:59], 0
    v_mov_b64 v[104:105], 0
    v_mov_b64 v[106:107], 0
    v_mov_b64 v[108:109], 0
    v_mov_b64 v[110:111], 0
    v_mov_b64 v[112:113], 0
    v_mov_b64 v[114:115], 0
    v_mov_b64 v[94:95], 0
    s_add_u32 s40, s29, 4096
    s_add_u32 s41, s29, 32768
    s_add_u32 s42, s40, 32768
    buffer_load_dwordx4 v[60:63], v92, s[8:11], s29 offen offset:0
    buffer_load_dwordx4 v[64:67], v92, s[8:11], s29 offen offset:1024
    buffer_load_dwordx4 v[76:79], v92, s[8:11], s40 offen offset:0
    buffer_load_dwordx4 v[80:83], v92, s[8:11], s40 offen offset:1024
    s_waitcnt lgkmcnt(0)
L_sc_step_any:
    s_barrier
    buffer_load_dwordx4 v[68:71], v92, s[8:11], s29 offen offset:2048
    buffer_load_dwordx4 v[72:75], v92, s[8:11], s29 offen offset:3072
    buffer_load_dwordx4 v[84:87], v92, s[8:11], s40 offen offset:2048
    buffer_load_dwordx4 v[88:91], v92, s[8:11], s40 offen offset:3072
    s_cmp_lg_u32 s20, 0
    s_cbranch_scc1 L_sc_go_any
    s_sleep 2
    v_mov_b32 v0, -1
    s_mov_b32 s31, 200000
L_sc_probe_any:
    buffer_load_dword v0, v2, s[8:11], s25 offen offset:3072 sc1
    s_waitcnt vmcnt(2)
    v_cmp_eq_u32 vcc, -1, v0
    s_sub_u32 s31, s31, 1
    s_cbranch_scc1 L_fail
    s_cbranch_vccnz L_sc_probe_any
L_sc_go_any:
    s_barrier
    buffer_load_dwordx4 v[4:7], v92, s[8:11], s64 offen sc1
    s_nop 15
    buffer_load_dwordx4 v[8:11], v92, s[8:11], s65 offen sc1
    s_nop 15
    buffer_load_dwordx4 v[12:15], v92, s[8:11], s66 offen sc1
    s_nop 15
    buffer_load_dwordx4 v[16:19], v92, s[8:11], s67 offen sc1
    s_waitcnt vmcnt(3)
    .p2align 3
    v_smfmac_f32_16x16x64_bf16 v[32:35], v[4:7], a[0:7], v93
    buffer_load_dwordx4 v[20:23], v92, s[8:11], s68 offen sc1
    v_smfmac_f32_16x16x64_bf16 v[36:39], v[4:7], a[56:63], v93
    v_smfmac_f32_16x16x64_bf16 v[40:43], v[4:7], a[112:119], v93
    ds_write_b128 v118, v[4:7] offset:16384
    v_smfmac_f32_16x16x64_bf16 v[44:47], v[4:7], a[168:175], v93
    v_smfmac_f32_16x16x64_bf16 v[48:51], v[4:7], a[224:231], v93
    buffer_load_dwordx4 v[24:27], v92, s[8:11], s69 offen sc1
    v_smfmac_f32_16x16x64_bf16 v[52:55], v[4:7], v[144:151], v93
    v_smfmac_f32_16x16x64_bf16 v[56:59], v[4:7], v[200:207], v93
    s_waitcnt vmcnt(4)
    s_mov_b32 s44, 0
    v_smfmac_f32_16x16x64_bf16 v[32:35], v[8:11], a[8:15], v93
    v_smfmac_f32_16x16x64_bf16 v[36:39], v[8:11], a[64:71], v93
    buffer_load_dwordx4 v[28:31], v92, s[8:11], s70 offen sc1
    v_smfmac_f32_16x16x64_bf16 v[40:43], v[8:11], a[120:127], v93
    ds_write_b128 v118, v[8:11] offset:17408
    v_smfmac_f32_16x16x64_bf16 v[44:47], v[8:11], a[176:183], v93
    v_smfmac_f32_16x16x64_bf16 v[48:51], v[8:11], a[232:239], v93
    v_smfmac_f32_16x16x64_bf16 v[52:55], v[8:11], v[152:159], v93
    v_smfmac_f32_16x16x64_bf16 v[56:59], v[8:11], v[208:215], v93
    s_waitcnt vmcnt(4)
    s_mov_b32 s44, 0
    v_smfmac_f32_16x16x64_bf16 v[32:35], v[12:15], a[16:23], v93
    v_smfmac_f32_16x16x64_bf16 v[36:39], v[12:15], a[72:79], v93
    ds_write_b128 v118, v[12:15] offset:18432
    v_smfmac_f32_16x16x64_bf16 v[40:43], v[12:15], a[128:135], v93
    v_smfmac_f32_16x16x64_bf16 v[44:47], v[12:15], a[184:191], v93
    v_smfmac_f32_16x16x64_bf16 v[48:51], v[12:15], a[240:247], v93
    v_smfmac_f32_16x16x64_bf16 v[52:55], v[12:15], v[160:167], v93
    v_smfmac_f32_16x16x64_bf16 v[56:59], v[12:15], v[216:223], v93
    s_waitcnt vmcnt(3)
    s_mov_b32 s44, 0
    v_smfmac_f32_16x16x64_bf16 v[32:35], v[16:19], a[24:31], v93
    ds_read_b128 v[4:7], v97 offset:16384
    v_smfmac_f32_16x16x64_bf16 v[36:39], v[16:19], a[80:87], v93
    v_smfmac_f32_16x16x64_bf16 v[40:43], v[16:19], a[136:143], v93
    ds_read_b128 v[8:11], v97 offset:16896
    v_smfmac_f32_16x16x64_bf16 v[44:47], v[16:19], a[192:199], v93
    v_smfmac_f32_16x16x64_bf16 v[48:51], v[16:19], a[248:255], v93
    ds_read_b128 v[12:15], v97 offset:17408
    v_smfmac_f32_16x16x64_bf16 v[52:55], v[16:19], v[168:175], v93
    v_smfmac_f32_16x16x64_bf16 v[56:59], v[16:19], v[224:231], v93
    s_waitcnt vmcnt(0)
    s_mov_b32 s44, 0
    v_smfmac_f32_16x16x64_bf16 v[32:35], v[20:23], a[32:39], v93
    v_smfmac_f32_16x16x64_bf16 v[32:35], v[24:27], a[40:47], v93
    v_smfmac_f32_16x16x64_bf16 v[32:35], v[28:31], a[48:55], v93
    ds_read_b128 v[16:19], v98 offset:17920
    v_smfmac_f32_16x16x64_bf16 v[36:39], v[20:23], a[88:95], v93
    v_smfmac_f32_16x16x64_bf16 v[36:39], v[24:27], a[96:103], v93
    v_smfmac_f32_16x16x64_bf16 v[36:39], v[28:31], a[104:111], v93
    v_add_f32_e64 v32, v32, v34
    v_smfmac_f32_16x16x64_bf16 v[40:43], v[20:23], a[144:151], v93
    v_add_f32_e64 v33, v33, v35
    v_smfmac_f32_16x16x64_bf16 v[40:43], v[24:27], a[152:159], v93
    v_cvt_pk_bf16_f32 v32, v32, v33
    v_smfmac_f32_16x16x64_bf16 v[40:43], v[28:31], a[160:167], v93
    ds_write_b32 v100, v32 offset:0
    v_add_f32_e64 v36, v36, v38
    v_smfmac_f32_16x16x64_bf16 v[44:47], v[20:23], a[200:207], v93
    v_add_f32_e64 v37, v37, v39
    v_smfmac_f32_16x16x64_bf16 v[44:47], v[24:27], a[208:215], v93
    v_cvt_pk_bf16_f32 v36, v36, v37
    v_smfmac_f32_16x16x64_bf16 v[44:47], v[28:31], a[216:223], v93
    ds_write_b32 v100, v36 offset:256
    v_add_f32_e64 v40, v40, v42
    v_smfmac_f32_16x16x64_bf16 v[48:51], v[20:23], v[120:127], v93
    v_add_f32_e64 v41, v41, v43
    v_smfmac_f32_16x16x64_bf16 v[48:51], v[24:27], v[128:135], v93
    v_cvt_pk_bf16_f32 v40, v40, v41
    v_smfmac_f32_16x16x64_bf16 v[48:51], v[28:31], v[136:143], v93
    ds_write_b32 v100, v40 offset:512
    v_add_f32_e64 v44, v44, v46
    v_smfmac_f32_16x16x64_bf16 v[52:55], v[20:23], v[176:183], v93
    v_add_f32_e64 v45, v45, v47
    v_smfmac_f32_16x16x64_bf16 v[52:55], v[24:27], v[184:191], v93
    v_cvt_pk_bf16_f32 v44, v44, v45
    v_smfmac_f32_16x16x64_bf16 v[52:55], v[28:31], v[192:199], v93
    ds_write_b32 v100, v44 offset:768
    ds_read_b64_tr_b16 v[32:33], v96 offset:0
    ds_read_b64_tr_b16 v[34:35], v96 offset:128
    v_add_f32_e64 v48, v48, v50
    v_smfmac_f32_16x16x64_bf16 v[56:59], v[20:23], v[232:239], v93
    v_add_f32_e64 v49, v49, v51
    v_smfmac_f32_16x16x64_bf16 v[56:59], v[24:27], v[240:247], v93
    v_cvt_pk_bf16_f32 v48, v48, v49
    v_smfmac_f32_16x16x64_bf16 v[56:59], v[28:31], v[248:255], v93
    ds_write_b32 v100, v48 offset:1024
    s_waitcnt vmcnt(0) lgkmcnt(1)
    v_add_f32 v52, v52, v54
    v_smfmac_f32_16x16x64_bf16 v[104:107], v[32:35], v[60:67], v93
    v_add_f32_e64 v53, v53, v55
    v_smfmac_f32_16x16x64_bf16 v[108:111], v[32:35], v[76:83], v93
    buffer_load_dwordx4 v[60:63], v92, s[8:11], s41 offen offset:0
    v_cvt_pk_bf16_f32 v52, v52, v53
    v_smfmac_f32_16x16x64_bf16 v[112:115], v[32:35], v[4:11], v93
    ds_write_b32 v100, v52 offset:1280
    v_add_f32 v56, v56, v58
    v_add_f32 v57, v57, v59
    v_cvt_pk_bf16_f32 v56, v56, v57
    ds_write_b32 v100, v56 offset:1536
    ds_read_b64_tr_b16 v[36:37], v96 offset:1024
    ds_read_b64_tr_b16 v[38:39], v96 offset:1152
    buffer_load_dwordx4 v[64:67], v92, s[8:11], s41 offen offset:1024
    v_mfma_f32_16x16x16_bf16 v[40:43], v[94:95], v[94:95], 0
    v_mfma_f32_16x16x16_bf16 v[44:47], v[94:95], v[94:95], 0
    v_mfma_f32_16x16x16_bf16 v[48:51], v[94:95], v[94:95], 0
    s_waitcnt lgkmcnt(0)
    v_smfmac_f32_16x16x64_bf16 v[104:107], v[36:39], v[68:75], v93
    v_smfmac_f32_16x16x64_bf16 v[108:111], v[36:39], v[84:91], v93
    v_smfmac_f32_16x16x64_bf16 v[112:115], v[36:39], v[12:19], v93
    s_nop 3
    v_add_f32 v104, v104, v106
    v_add_f32 v105, v105, v107
    v_add_f32 v108, v108, v110
    v_add_f32 v109, v109, v111
    v_add_f32 v112, v112, v114
    v_add_f32 v113, v113, v115
    ds_write2_b32 v99, v104, v105 offset0:0 offset1:56
    ds_write2_b32 v99, v108, v109 offset0:16 offset1:72
    ds_write2_b32 v99, v112, v113 offset0:32 offset1:88
    v_cmp_u_f32 vcc, v104, v105
    buffer_load_dwordx4 v[76:79], v92, s[8:11], s42 offen offset:0
    v_mfma_f32_16x16x16_bf16 v[32:35], v[94:95], v[94:95], 0
    v_mfma_f32_16x16x16_bf16 v[36:39], v[94:95], v[94:95], 0
    v_mfma_f32_16x16x16_bf16 v[52:55], v[94:95], v[94:95], 0
    v_mfma_f32_16x16x16_bf16 v[56:59], v[94:95], v[94:95], 0
    s_waitcnt lgkmcnt(0)
    s_cbranch_vccnz L_sc_redo_any
    s_barrier
    ds_read_b64 v[20:21], v101 offset:0
    ds_read_b64 v[22:23], v101 offset:1792
    ds_read_b64 v[24:25], v101 offset:3584
    ds_read_b64 v[26:27], v101 offset:5376
    buffer_load_dwordx4 v[80:83], v92, s[8:11], s42 offen offset:1024
    v_mfma_f32_16x16x16_bf16 v[104:107], v[94:95], v[94:95], 0
    v_mfma_f32_16x16x16_bf16 v[108:111], v[94:95], v[94:95], 0
    v_mfma_f32_16x16x16_bf16 v[112:115], v[94:95], v[94:95], 0
    s_waitcnt lgkmcnt(2)
    v_add_f32 v20, v20, v22
    v_add_f32 v21, v21, v23
    s_waitcnt lgkmcnt(0)
    v_add_f32 v24, v24, v26
    v_add_f32 v25, v25, v27
    v_add_f32 v20, v20, v24
    v_add_f32 v21, v21, v25
    v_exp_f32 v22, v20
    v_exp_f32 v23, v21
    s_nop 0
    v_add_f32 v24, v22, v23
    s_nop 1
    v_add_f32_dpp v24, v24, v24 row_ror:8 row_mask:0xf bank_mask:0xf
    buffer_store_dword v93, v3, s[8:11], s26 offen sc1
    s_nop 0
    v_add_f32_dpp v24, v24, v24 row_ror:4 row_mask:0xf bank_mask:0xf
    s_nop 1
    v_add_f32_dpp v24, v24, v24 row_ror:2 row_mask:0xf bank_mask:0xf
    s_nop 1
    v_add_f32_dpp v24, v24, v24 row_ror:1 row_mask:0xf bank_mask:0xf
    v_mov_b32 v25, v24
    s_nop 1
    v_permlane16_swap_b32 v24, v25
    v_add_f32 v24, v24, v25
    v_subrev_u32 v25, s37, v24
    v_cmp_le_u32 vcc, s38, v25
    v_rcp_f32 v24, v24
    s_nop 0
    v_mul_f32 v22, v22, v24
    v_mul_f32 v23, v23, v24
    v_cvt_pk_bf16_f32 v22, v22, v23
    v_min_u32 v22, -2, v22
    s_cbranch_vccnz L_sc_max_any
    buffer_store_dword v22, v102, s[8:11], s26 offen sc1
    s_branch L_sc_next_any
L_sc_max_any:
    v_max_f32 v24, v20, v21
    s_nop 1
    v_max_f32_dpp v24, v24, v24 row_ror:8 row_mask:0xf bank_mask:0xf
    s_nop 1
    v_max_f32_dpp v24, v24, v24 row_ror:4 row_mask:0xf bank_mask:0xf
    s_nop 1
    v_max_f32_dpp v24, v24, v24 row_ror:2 row_mask:0xf bank_mask:0xf
    s_nop 1
    v_max_f32_dpp v24, v24, v24 row_ror:1 row_mask:0xf bank_mask:0xf
    v_mov_b32 v25, v24
    s_nop 1
    v_permlane16_swap_b32 v24, v25
    v_max_f32 v24, v24, v25
    v_sub_f32 v20, v20, v24
    v_sub_f32 v21, v21, v24
    v_exp_f32 v22, v20
    v_exp_f32 v23, v21
    s_nop 0
    v_add_f32 v24, v22, v23
    s_nop 1
    v_add_f32_dpp v24, v24, v24 row_ror:8 row_mask:0xf bank_mask:0xf
    s_nop 1
    v_add_f32_dpp v24, v24, v24 row_ror:4 row_mask:0xf bank_mask:0xf
    s_nop 1
    v_add_f32_dpp v24, v24, v24 row_ror:2 row_mask:0xf bank_mask:0xf
    s_nop 1
    v_add_f32_dpp v24, v24, v24 row_ror:1 row_mask:0xf bank_mask:0xf
    v_mov_b32 v25, v24
    s_nop 1
    v_permlane16_swap_b32 v24, v25
    v_add_f32 v24, v24, v25
    v_rcp_f32 v24, v24
    s_nop 0
    v_mul_f32 v22, v22, v24
    v_mul_f32 v23, v23, v24
    v_cvt_pk_bf16_f32 v22, v22, v23
    v_min_u32 v22, -2, v22
    buffer_store_dword v22, v102, s[8:11], s26 offen sc1
L_sc_next_any:
    s_add_u32 s24, s24, 8192
    s_add_u32 s25, s25, 8192
    s_add_u32 s26, s26, 11264
    s_add_u32 s39, s39, 458752
    s_add_u32 s29, s29, 32768
    s_add_u32 s40, s40, 32768
    s_add_u32 s41, s41, 32768
    s_add_u32 s42, s42, 32768
    s_add_u32 s30, s30, 1
    s_add_u32 s64, s64, 8192
    s_add_u32 s65, s65, 8192
    s_add_u32 s66, s66, 8192
    s_add_u32 s67, s67, 8192
    s_add_u32 s68, s68, 8192
    s_add_u32 s69, s69, 8192
    s_add_u32 s70, s70, 8192
    s_cmp_lt_u32 s30, 63
    s_cbranch_scc1 L_sc_step_any
    s_branch L_done
L_sc_redo_any:
    s_mov_b32 s31, 0
    buffer_load_dwordx4 v[60:63], v92, s[8:11], s29 offen offset:0
    buffer_load_dwordx4 v[64:67], v92, s[8:11], s29 offen offset:1024
    buffer_load_dwordx4 v[76:79], v92, s[8:11], s40 offen offset:0
L_sc_redo_l_any:
    buffer_load_dwordx4 v[4:7], v92, s[8:11], s64 offen sc1
    buffer_load_dwordx4 v[8:11], v92, s[8:11], s65 offen sc1
    buffer_load_dwordx4 v[12:15], v92, s[8:11], s66 offen sc1
    buffer_load_dwordx4 v[16:19], v92, s[8:11], s67 offen sc1
    buffer_load_dwordx4 v[20:23], v92, s[8:11], s68 offen sc1
    buffer_load_dwordx4 v[24:27], v92, s[8:11], s69 offen sc1
    buffer_load_dwordx4 v[28:31], v92, s[8:11], s70 offen sc1
    s_waitcnt vmcnt(0)
    v_max3_u32 v103, v4, v5, v6
    v_max3_u32 v103, v103, v7, v8
    v_max3_u32 v103, v103, v9, v10
    v_max3_u32 v103, v103, v11, v12
    v_max3_u32 v103, v103, v13, v14
    v_max3_u32 v103, v103, v15, v16
    v_max3_u32 v103, v103, v17, v18
    v_max3_u32 v103, v103, v19, v20
    v_max3_u32 v103, v103, v21, v22
    v_max3_u32 v103, v103, v23, v24
    v_max3_u32 v103, v103, v25, v26
    v_max3_u32 v103, v103, v27, v28
    v_max3_u32 v103, v103, v29, v30
    v_max_u32 v103, v103, v31
    v_cmp_eq_u32 vcc, -1, v103
    s_cbranch_vccz L_sc_redo_go_any
    s_add_u32 s31, s31, 1
    s_cmp_lt_u32 s31, 200000
    s_cbranch_scc1 L_sc_redo_l_any
    s_branch L_fail
L_sc_redo_go_any:
    v_mfma_f32_16x16x16_bf16 v[104:107], v[94:95], v[94:95], 0
    v_mfma_f32_16x16x16_bf16 v[108:111], v[94:95], v[94:95], 0
    v_mfma_f32_16x16x16_bf16 v[112:115], v[94:95], v[94:95], 0
    v_mfma_f32_16x16x16_bf16 v[32:35], v[94:95], v[94:95], 0
    v_mfma_f32_16x16x16_bf16 v[36:39], v[94:95], v[94:95], 0
    v_mfma_f32_16x16x16_bf16 v[40:43], v[94:95], v[94:95], 0
    v_mfma_f32_16x16x16_bf16 v[44:47], v[94:95], v[94:95], 0
    v_mfma_f32_16x16x16_bf16 v[48:51], v[94:95], v[94:95], 0
    v_mfma_f32_16x16x16_bf16 v[52:55], v[94:95], v[94:95], 0
    v_mfma_f32_16x16x16_bf16 v[56:59], v[94:95], v[94:95], 0
    ds_write_b128 v118, v[4:7] offset:16384
    ds_write_b128 v118, v[8:11] offset:17408
    ds_write_b128 v118, v[12:15] offset:18432
    v_smfmac_f32_16x16x64_bf16 v[32:35], v[4:7], a[0:7], v93
    v_smfmac_f32_16x16x64_bf16 v[36:39], v[4:7], a[56:63], v93
    v_smfmac_f32_16x16x64_bf16 v[40:43], v[4:7], a[112:119], v93
    v_smfmac_f32_16x16x64_bf16 v[44:47], v[4:7], a[168:175], v93
    v_smfmac_f32_16x16x64_bf16 v[48:51], v[4:7], a[224:231], v93
    v_smfmac_f32_16x16x64_bf16 v[52:55], v[4:7], v[144:151], v93
    v_smfmac_f32_16x16x64_bf16 v[56:59], v[4:7], v[200:207], v93
    v_smfmac_f32_16x16x64_bf16 v[32:35], v[8:11], a[8:15], v93
    v_smfmac_f32_16x16x64_bf16 v[36:39], v[8:11], a[64:71], v93
    v_smfmac_f32_16x16x64_bf16 v[40:43], v[8:11], a[120:127], v93
    v_smfmac_f32_16x16x64_bf16 v[44:47], v[8:11], a[176:183], v93
    v_smfmac_f32_16x16x64_bf16 v[48:51], v[8:11], a[232:239], v93
    v_smfmac_f32_16x16x64_bf16 v[52:55], v[8:11], v[152:159], v93
    v_smfmac_f32_16x16x64_bf16 v[56:59], v[8:11], v[208:215], v93
    v_smfmac_f32_16x16x64_bf16 v[32:35], v[12:15], a[16:23], v93
    v_smfmac_f32_16x16x64_bf16 v[36:39], v[12:15], a[72:79], v93
    v_smfmac_f32_16x16x64_bf16 v[40:43], v[12:15], a[128:135], v93
    v_smfmac_f32_16x16x64_bf16 v[44:47], v[12:15], a[184:191], v93
    v_smfmac_f32_16x16x64_bf16 v[48:51], v[12:15], a[240:247], v93
    v_smfmac_f32_16x16x64_bf16 v[52:55], v[12:15], v[160:167], v93
    v_smfmac_f32_16x16x64_bf16 v[56:59], v[12:15], v[216:223], v93
    v_smfmac_f32_16x16x64_bf16 v[32:35], v[16:19], a[24:31], v93
    v_smfmac_f32_16x16x64_bf16 v[36:39], v[16:19], a[80:87], v93
    v_smfmac_f32_16x16x64_bf16 v[40:43], v[16:19], a[136:143], v93
    v_smfmac_f32_16x16x64_bf16 v[44:47], v[16:19], a[192:199], v93
    v_smfmac_f32_16x16x64_bf16 v[48:51], v[16:19], a[248:255], v93
    v_smfmac_f32_16x16x64_bf16 v[52:55], v[16:19], v[168:175], v93
    v_smfmac_f32_16x16x64_bf16 v[56:59], v[16:19], v[224:231], v93
    ds_read_b128 v[4:7], v97 offset:16384
    ds_read_b128 v[8:11], v97 offset:16896
    ds_read_b128 v[12:15], v97 offset:17408
    v_smfmac_f32_16x16x64_bf16 v[32:35], v[20:23], a[32:39], v93
    v_smfmac_f32_16x16x64_bf16 v[32:35], v[24:27], a[40:47], v93
    v_smfmac_f32_16x16x64_bf16 v[32:35], v[28:31], a[48:55], v93
    ds_read_b128 v[16:19], v98 offset:17920
    v_smfmac_f32_16x16x64_bf16 v[36:39], v[20:23], a[88:95], v93
    v_smfmac_f32_16x16x64_bf16 v[36:39], v[24:27], a[96:103], v93
    v_smfmac_f32_16x16x64_bf16 v[36:39], v[28:31], a[104:111], v93
    v_add_f32_e64 v32, v32, v34
    v_smfmac_f32_16x16x64_bf16 v[40:43], v[20:23], a[144:151], v93
    v_add_f32_e64 v33, v33, v35
    v_smfmac_f32_16x16x64_bf16 v[40:43], v[24:27], a[152:159], v93
    v_cvt_pk_bf16_f32 v32, v32, v33
    v_smfmac_f32_16x16x64_bf16 v[40:43], v[28:31], a[160:167], v93
    ds_write_b32 v100, v32 offset:0
    v_add_f32_e64 v36, v36, v38
    v_smfmac_f32_16x16x64_bf16 v[44:47], v[20:23], a[200:207], v93
    v_add_f32_e64 v37, v37, v39
    v_smfmac_f32_16x16x64_bf16 v[44:47], v[24:27], a[208:215], v93
    v_cvt_pk_bf16_f32 v36, v36, v37
    v_smfmac_f32_16x16x64_bf16 v[44:47], v[28:31], a[216:223], v93
    ds_write_b32 v100, v36 offset:256
    v_add_f32_e64 v40, v40, v42
    v_smfmac_f32_16x16x64_bf16 v[48:51], v[20:23], v[120:127], v93
    v_add_f32_e64 v41, v41, v43
    v_smfmac_f32_16x16x64_bf16 v[48:51], v[24:27], v[128:135], v93
    v_cvt_pk_bf16_f32 v40, v40, v41
    v_smfmac_f32_16x16x64_bf16 v[48:51], v[28:31], v[136:143], v93
    ds_write_b32 v100, v40 offset:512
    v_add_f32_e64 v44, v44, v46
    v_smfmac_f32_16x16x64_bf16 v[52:55], v[20:23], v[176:183], v93
    v_add_f32_e64 v45, v45, v47
    v_smfmac_f32_16x16x64_bf16 v[52:55], v[24:27], v[184:191], v93
    v_cvt_pk_bf16_f32 v44, v44, v45
    v_smfmac_f32_16x16x64_bf16 v[52:55], v[28:31], v[192:199], v93
    ds_write_b32 v100, v44 offset:768
    ds_read_b64_tr_b16 v[32:33], v96 offset:0
    ds_read_b64_tr_b16 v[34:35], v96 offset:128
    v_add_f32_e64 v48, v48, v50
    v_smfmac_f32_16x16x64_bf16 v[56:59], v[20:23], v[232:239], v93
    v_add_f32_e64 v49, v49, v51
    v_smfmac_f32_16x16x64_bf16 v[56:59], v[24:27], v[240:247], v93
    v_cvt_pk_bf16_f32 v48, v48, v49
    v_smfmac_f32_16x16x64_bf16 v[56:59], v[28:31], v[248:255], v93
    ds_write_b32 v100, v48 offset:1024
    s_waitcnt vmcnt(0) lgkmcnt(1)
    v_add_f32 v52, v52, v54
    v_smfmac_f32_16x16x64_bf16 v[104:107], v[32:35], v[60:67], v93
    v_add_f32_e64 v53, v53, v55
    v_smfmac_f32_16x16x64_bf16 v[108:111], v[32:35], v[76:83], v93
    buffer_load_dwordx4 v[60:63], v92, s[8:11], s41 offen offset:0
    v_cvt_pk_bf16_f32 v52, v52, v53
    v_smfmac_f32_16x16x64_bf16 v[112:115], v[32:35], v[4:11], v93
    ds_write_b32 v100, v52 offset:1280
    v_add_f32 v56, v56, v58
    v_add_f32 v57, v57, v59
    v_cvt_pk_bf16_f32 v56, v56, v57
    ds_write_b32 v100, v56 offset:1536
    ds_read_b64_tr_b16 v[36:37], v96 offset:1024
    ds_read_b64_tr_b16 v[38:39], v96 offset:1152
    buffer_load_dwordx4 v[64:67], v92, s[8:11], s41 offen offset:1024
    v_mfma_f32_16x16x16_bf16 v[40:43], v[94:95], v[94:95], 0
    v_mfma_f32_16x16x16_bf16 v[44:47], v[94:95], v[94:95], 0
    v_mfma_f32_16x16x16_bf16 v[48:51], v[94:95], v[94:95], 0
    s_waitcnt lgkmcnt(0)
    v_smfmac_f32_16x16x64_bf16 v[104:107], v[36:39], v[68:75], v93
    v_smfmac_f32_16x16x64_bf16 v[108:111], v[36:39], v[84:91], v93
    v_smfmac_f32_16x16x64_bf16 v[112:115], v[36:39], v[12:19], v93
    s_nop 3
    v_add_f32 v104, v104, v106
    v_add_f32 v105, v105, v107
    v_add_f32 v108, v108, v110
    v_add_f32 v109, v109, v111
    v_add_f32 v112, v112, v114
    v_add_f32 v113, v113, v115
    ds_write2_b32 v99, v104, v105 offset0:0 offset1:56
    ds_write2_b32 v99, v108, v109 offset0:16 offset1:72
    ds_write2_b32 v99, v112, v113 offset0:32 offset1:88
    buffer_load_dwordx4 v[76:79], v92, s[8:11], s42 offen offset:0
    v_mfma_f32_16x16x16_bf16 v[32:35], v[94:95], v[94:95], 0
    v_mfma_f32_16x16x16_bf16 v[36:39], v[94:95], v[94:95], 0
    v_mfma_f32_16x16x16_bf16 v[52:55], v[94:95], v[94:95], 0
    v_mfma_f32_16x16x16_bf16 v[56:59], v[94:95], v[94:95], 0
    s_waitcnt lgkmcnt(0)
    s_barrier
    ds_read_b64 v[20:21], v101 offset:0
    ds_read_b64 v[22:23], v101 offset:1792
    ds_read_b64 v[24:25], v101 offset:3584
    ds_read_b64 v[26:27], v101 offset:5376
    buffer_load_dwordx4 v[80:83], v92, s[8:11], s42 offen offset:1024
    v_mfma_f32_16x16x16_bf16 v[104:107], v[94:95], v[94:95], 0
    v_mfma_f32_16x16x16_bf16 v[108:111], v[94:95], v[94:95], 0
    v_mfma_f32_16x16x16_bf16 v[112:115], v[94:95], v[94:95], 0
    s_waitcnt lgkmcnt(2)
    v_add_f32 v20, v20, v22
    v_add_f32 v21, v21, v23
    s_waitcnt lgkmcnt(0)
    v_add_f32 v24, v24, v26
    v_add_f32 v25, v25, v27
    v_add_f32 v20, v20, v24
    v_add_f32 v21, v21, v25
    v_exp_f32 v22, v20
    v_exp_f32 v23, v21
    s_nop 0
    v_add_f32 v24, v22, v23
    s_nop 1
    v_add_f32_dpp v24, v24, v24 row_ror:8 row_mask:0xf bank_mask:0xf
    buffer_store_dword v93, v3, s[8:11], s26 offen sc1
    s_nop 0
    v_add_f32_dpp v24, v24, v24 row_ror:4 row_mask:0xf bank_mask:0xf
    s_nop 1
    v_add_f32_dpp v24, v24, v24 row_ror:2 row_mask:0xf bank_mask:0xf
    s_nop 1
    v_add_f32_dpp v24, v24, v24 row_ror:1 row_mask:0xf bank_mask:0xf
    v_mov_b32 v25, v24
    s_nop 1
    v_permlane16_swap_b32 v24, v25
    v_add_f32 v24, v24, v25
    v_subrev_u32 v25, s37, v24
    v_cmp_le_u32 vcc, s38, v25
    v_rcp_f32 v24, v24
    s_nop 0
    v_mul_f32 v22, v22, v24
    v_mul_f32 v23, v23, v24
    v_cvt_pk_bf16_f32 v22, v22, v23
    v_min_u32 v22, -2, v22
    s_cbranch_vccnz L_sc_max_any
    buffer_store_dword v22, v102, s[8:11], s26 offen sc1
    s_branch L_sc_next_any
L_value_any:
    s_sub_u32 s21, s21, 16
    v_lshlrev_b32 v2, 4, v1
    v_mov_b32 v5, 0x4444
    v_mov_b32 v6, 0xeeee
    v_and_b32 v4, 2, v1
    v_cmp_ne_u32 vcc, 0, v4
    s_nop 1
    v_cndmask_b32 v3, v5, v6, vcc
    s_lshr_b32 s32, s21, 1
    s_add_u32 s32, s32, 112
    v_min_u32 v60, 15, v1
    v_mul_u32_u24 v60, 896, v60
    s_lshl_b32 s3, s32, 7
    s_add_u32 s3, s3, 46833664
    s_mov_b32 s47, 200000
L_va_nw_any:
    buffer_load_dwordx2 v[62:63], v60, s[8:11], s3 offen sc1
    s_waitcnt vmcnt(0)
    v_xor_b32 v62, s96, v62
    v_xor_b32 v63, s97, v63
    v_or_b32 v62, v62, v63
    v_cmp_ne_u32 vcc, 0, v62
    s_cbranch_vccz L_va_nw_ok_any
    s_sub_u32 s47, s47, 1
    s_cbranch_scc0 L_va_nw_any
    s_branch L_fail
L_va_nw_ok_any:
    s_lshl_b32 s32, s21, 2
    s_add_u32 s32, s32, s20
    s_mul_i32 s32, s32, 114688
    s_add_u32 s32, s32, 6422528
    s_and_b32 s38, s20, 1
    s_lshl_b32 s33, s38, 12
    s_add_u32 s33, s33, 8192
    v_add_u32 v7, s33, v2
    s_mov_b32 s24, 44302336
    s_mov_b32 s25, 44306432
    s_mov_b32 s30, 0
    s_cmp_ge_u32 s20, 2
    s_cbranch_scc1 L_vb_any
    buffer_load_dwordx4 a[0:3], v2, s[8:11], s32 offen offset:0
    buffer_load_dwordx4 a[4:7], v2, s[8:11], s32 offen offset:1024
    buffer_load_dwordx4 a[8:11], v2, s[8:11], s32 offen offset:2048
    buffer_load_dwordx4 a[12:15], v2, s[8:11], s32 offen offset:3072
    s_add_u32 s32, s32, 4096
    buffer_load_dwordx4 a[16:19], v2, s[8:11], s32 offen offset:0
    buffer_load_dwordx4 a[20:23], v2, s[8:11], s32 offen offset:1024
    buffer_load_dwordx4 a[24:27], v2, s[8:11], s32 offen offset:2048
    buffer_load_dwordx4 a[28:31], v2, s[8:11], s32 offen offset:3072
    s_add_u32 s32, s32, 4096
    buffer_load_dwordx4 a[32:35], v2, s[8:11], s32 offen offset:0
    buffer_load_dwordx4 a[36:39], v2, s[8:11], s32 offen offset:1024
    buffer_load_dwordx4 a[40:43], v2, s[8:11], s32 offen offset:2048
    buffer_load_dwordx4 a[44:47], v2, s[8:11], s32 offen offset:3072
    s_add_u32 s32, s32, 4096
    buffer_load_dwordx4 a[48:51], v2, s[8:11], s32 offen offset:0
    buffer_load_dwordx4 a[52:55], v2, s[8:11], s32 offen offset:1024
    buffer_load_dwordx4 a[56:59], v2, s[8:11], s32 offen offset:2048
    buffer_load_dwordx4 a[60:63], v2, s[8:11], s32 offen offset:3072
    s_add_u32 s32, s32, 4096
    buffer_load_dwordx4 a[64:67], v2, s[8:11], s32 offen offset:0
    buffer_load_dwordx4 a[68:71], v2, s[8:11], s32 offen offset:1024
    buffer_load_dwordx4 a[72:75], v2, s[8:11], s32 offen offset:2048
    buffer_load_dwordx4 a[76:79], v2, s[8:11], s32 offen offset:3072
    s_add_u32 s32, s32, 4096
    buffer_load_dwordx4 a[80:83], v2, s[8:11], s32 offen offset:0
    buffer_load_dwordx4 a[84:87], v2, s[8:11], s32 offen offset:1024
    buffer_load_dwordx4 a[88:91], v2, s[8:11], s32 offen offset:2048
    buffer_load_dwordx4 a[92:95], v2, s[8:11], s32 offen offset:3072
    s_add_u32 s32, s32, 4096
    buffer_load_dwordx4 a[96:99], v2, s[8:11], s32 offen offset:0
    buffer_load_dwordx4 a[100:103], v2, s[8:11], s32 offen offset:1024
    buffer_load_dwordx4 a[104:107], v2, s[8:11], s32 offen offset:2048
    buffer_load_dwordx4 a[108:111], v2, s[8:11], s32 offen offset:3072
    s_add_u32 s32, s32, 4096
    buffer_load_dwordx4 a[112:115], v2, s[8:11], s32 offen offset:0
    buffer_load_dwordx4 a[116:119], v2, s[8:11], s32 offen offset:1024
    buffer_load_dwordx4 a[120:123], v2, s[8:11], s32 offen offset:2048
    buffer_load_dwordx4 a[124:127], v2, s[8:11], s32 offen offset:3072
    s_add_u32 s32, s32, 4096
    buffer_load_dwordx4 a[128:131], v2, s[8:11], s32 offen offset:0
    buffer_load_dwordx4 a[132:135], v2, s[8:11], s32 offen offset:1024
    buffer_load_dwordx4 a[136:139], v2, s[8:11], s32 offen offset:2048
    buffer_load_dwordx4 a[140:143], v2, s[8:11], s32 offen offset:3072
    s_add_u32 s32, s32, 4096
    buffer_load_dwordx4 a[144:147], v2, s[8:11], s32 offen offset:0
    buffer_load_dwordx4 a[148:151], v2, s[8:11], s32 offen offset:1024
    buffer_load_dwordx4 a[152:155], v2, s[8:11], s32 offen offset:2048
    buffer_load_dwordx4 a[156:159], v2, s[8:11], s32 offen offset:3072
    s_add_u32 s32, s32, 4096
    buffer_load_dwordx4 a[160:163], v2, s[8:11], s32 offen offset:0
    buffer_load_dwordx4 a[164:167], v2, s[8:11], s32 offen offset:1024
    buffer_load_dwordx4 a[168:171], v2, s[8:11], s32 offen offset:2048
    buffer_load_dwordx4 a[172:175], v2, s[8:11], s32 offen offset:3072
    s_add_u32 s32, s32, 4096
    buffer_load_dwordx4 a[176:179], v2, s[8:11], s32 offen offset:0
    buffer_load_dwordx4 a[180:183], v2, s[8:11], s32 offen offset:1024
    buffer_load_dwordx4 a[184:187], v2, s[8:11], s32 offen offset:2048
    buffer_load_dwordx4 a[188:191], v2, s[8:11], s32 offen offset:3072
    s_add_u32 s32, s32, 4096
    buffer_load_dwordx4 a[192:195], v2, s[8:11], s32 offen offset:0
    buffer_load_dwordx4 a[196:199], v2, s[8:11], s32 offen offset:1024
    buffer_load_dwordx4 a[200:203], v2, s[8:11], s32 offen offset:2048
    buffer_load_dwordx4 a[204:207], v2, s[8:11], s32 offen offset:3072
    s_add_u32 s32, s32, 4096
    buffer_load_dwordx4 a[208:211], v2, s[8:11], s32 offen offset:0
    buffer_load_dwordx4 a[212:215], v2, s[8:11], s32 offen offset:1024
    buffer_load_dwordx4 a[216:219], v2, s[8:11], s32 offen offset:2048
    buffer_load_dwordx4 a[220:223], v2, s[8:11], s32 offen offset:3072
    s_add_u32 s32, s32, 4096
    buffer_load_dwordx4 a[224:227], v2, s[8:11], s32 offen offset:0
    buffer_load_dwordx4 a[228:231], v2, s[8:11], s32 offen offset:1024
    buffer_load_dwordx4 a[232:235], v2, s[8:11], s32 offen offset:2048
    buffer_load_dwordx4 a[236:239], v2, s[8:11], s32 offen offset:3072
    s_add_u32 s32, s32, 4096
    buffer_load_dwordx4 a[240:243], v2, s[8:11], s32 offen offset:0
    buffer_load_dwordx4 a[244:247], v2, s[8:11], s32 offen offset:1024
    buffer_load_dwordx4 a[248:251], v2, s[8:11], s32 offen offset:2048
    buffer_load_dwordx4 a[252:255], v2, s[8:11], s32 offen offset:3072
    s_add_u32 s32, s32, 4096
    buffer_load_dwordx4 v[176:179], v2, s[8:11], s32 offen offset:0
    buffer_load_dwordx4 v[180:183], v2, s[8:11], s32 offen offset:1024
    buffer_load_dwordx4 v[184:187], v2, s[8:11], s32 offen offset:2048
    buffer_load_dwordx4 v[188:191], v2, s[8:11], s32 offen offset:3072
    s_add_u32 s32, s32, 4096
    buffer_load_dwordx4 v[192:195], v2, s[8:11], s32 offen offset:0
    buffer_load_dwordx4 v[196:199], v2, s[8:11], s32 offen offset:1024
    buffer_load_dwordx4 v[200:203], v2, s[8:11], s32 offen offset:2048
    buffer_load_dwordx4 v[204:207], v2, s[8:11], s32 offen offset:3072
    s_add_u32 s32, s32, 4096
    buffer_load_dwordx4 v[208:211], v2, s[8:11], s32 offen offset:0
    buffer_load_dwordx4 v[212:215], v2, s[8:11], s32 offen offset:1024
    buffer_load_dwordx4 v[216:219], v2, s[8:11], s32 offen offset:2048
    buffer_load_dwordx4 v[220:223], v2, s[8:11], s32 offen offset:3072
    s_add_u32 s32, s32, 4096
    buffer_load_dwordx4 v[224:227], v2, s[8:11], s32 offen offset:0
    buffer_load_dwordx4 v[228:231], v2, s[8:11], s32 offen offset:1024
    buffer_load_dwordx4 v[232:235], v2, s[8:11], s32 offen offset:2048
    buffer_load_dwordx4 v[236:239], v2, s[8:11], s32 offen offset:3072
    s_add_u32 s32, s32, 4096
    buffer_load_dwordx4 v[240:243], v2, s[8:11], s32 offen offset:0
    buffer_load_dwordx4 v[244:247], v2, s[8:11], s32 offen offset:1024
    buffer_load_dwordx4 v[248:251], v2, s[8:11], s32 offen offset:2048
    buffer_load_dwordx4 v[252:255], v2, s[8:11], s32 offen offset:3072
    s_add_u32 s32, s32, 4096
    s_mov_b32 s46, 0
    v_min_u32 v60, 63, v1
    v_mul_u32_u24 v60, 128, v60
    s_lshl_b32 s3, s46, 7
    s_add_u32 s3, s3, 46833664
    s_mov_b32 s47, 200000
L_va_na0_any:
    buffer_load_dwordx2 v[62:63], v60, s[8:11], s3 offen sc1
    s_waitcnt vmcnt(0)
    v_xor_b32 v62, s96, v62
    v_xor_b32 v63, s97, v63
    v_or_b32 v62, v62, v63
    v_cmp_ne_u32 vcc, 0, v62
    s_cbranch_vccz L_va_na0_ok_any
    s_sub_u32 s47, s47, 1
    s_cbranch_scc0 L_va_na0_any
    s_branch L_fail
L_va_na0_ok_any:
    s_mov_b32 s46, 64
    v_min_u32 v60, 63, v1
    v_mul_u32_u24 v60, 128, v60
    s_lshl_b32 s3, s46, 7
    s_add_u32 s3, s3, 46833664
    s_mov_b32 s47, 200000
L_va_na1_any:
    buffer_load_dwordx2 v[62:63], v60, s[8:11], s3 offen sc1
    s_waitcnt vmcnt(0)
    v_xor_b32 v62, s96, v62
    v_xor_b32 v63, s97, v63
    v_or_b32 v62, v62, v63
    v_cmp_ne_u32 vcc, 0, v62
    s_cbranch_vccz L_va_na1_ok_any
    s_sub_u32 s47, s47, 1
    s_cbranch_scc0 L_va_na1_any
    s_branch L_fail
L_va_na1_ok_any:
    s_mov_b32 s46, 128
    v_min_u32 v60, 63, v1
    v_mul_u32_u24 v60, 128, v60
    s_lshl_b32 s3, s46, 7
    s_add_u32 s3, s3, 46833664
    s_mov_b32 s47, 200000
L_va_na2_any:
    buffer_load_dwordx2 v[62:63], v60, s[8:11], s3 offen sc1
    s_waitcnt vmcnt(0)
    v_xor_b32 v62, s96, v62
    v_xor_b32 v63, s97, v63
    v_or_b32 v62, v62, v63
    v_cmp_ne_u32 vcc, 0, v62
    s_cbranch_vccz L_va_na2_ok_any
    s_sub_u32 s47, s47, 1
    s_cbranch_scc0 L_va_na2_any
    s_branch L_fail
L_va_na2_ok_any:
    s_mov_b32 s46, 192
    v_min_u32 v60, 63, v1
    v_mul_u32_u24 v60, 128, v60
    s_lshl_b32 s3, s46, 7
    s_add_u32 s3, s3, 46833664
    s_mov_b32 s47, 200000
L_va_na3_any:
    buffer_load_dwordx2 v[62:63], v60, s[8:11], s3 offen sc1
    s_waitcnt vmcnt(0)
    v_xor_b32 v62, s96, v62
    v_xor_b32 v63, s97, v63
    v_or_b32 v62, v62, v63
    v_cmp_ne_u32 vcc, 0, v62
    s_cbranch_vccz L_va_na3_ok_any
    s_sub_u32 s47, s47, 1
    s_cbranch_scc0 L_va_na3_any
    s_branch L_fail
L_va_na3_ok_any:
    s_mov_b32 s46, 256
    v_min_u32 v60, 63, v1
    v_mul_u32_u24 v60, 128, v60
    s_lshl_b32 s3, s46, 7
    s_add_u32 s3, s3, 46833664
    s_mov_b32 s47, 200000
L_va_na4_any:
    buffer_load_dwordx2 v[62:63], v60, s[8:11], s3 offen sc1
    s_waitcnt vmcnt(0)
    v_xor_b32 v62, s96, v62
    v_xor_b32 v63, s97, v63
    v_or_b32 v62, v62, v63
    v_cmp_ne_u32 vcc, 0, v62
    s_cbranch_vccz L_va_na4_ok_any
    s_sub_u32 s47, s47, 1
    s_cbranch_scc0 L_va_na4_any
    s_branch L_fail
L_va_na4_ok_any:
    s_mul_i32 s33, s20, 28672
    v_add_u32 v166, s33, v2
    buffer_load_dwordx4 v[8:11], v2, s[8:11], s32 offen offset:0
    buffer_load_dwordx4 v[12:15], v2, s[8:11], s32 offen offset:1024
    buffer_load_dwordx4 v[16:19], v2, s[8:11], s32 offen offset:2048
    buffer_load_dwordx4 v[20:23], v2, s[8:11], s32 offen offset:3072
    s_add_u32 s32, s32, 4096
    buffer_load_dwordx4 v[24:27], v2, s[8:11], s32 offen offset:0
    buffer_load_dwordx4 v[28:31], v2, s[8:11], s32 offen offset:1024
    buffer_load_dwordx4 v[32:35], v2, s[8:11], s32 offen offset:2048
    buffer_load_dwordx4 v[36:39], v2, s[8:11], s32 offen offset:3072
    s_add_u32 s32, s32, 4096
    buffer_load_dwordx4 v[40:43], v2, s[8:11], s32 offen offset:0
    buffer_load_dwordx4 v[44:47], v2, s[8:11], s32 offen offset:1024
    buffer_load_dwordx4 v[48:51], v2, s[8:11], s32 offen offset:2048
    buffer_load_dwordx4 v[52:55], v2, s[8:11], s32 offen offset:3072
    s_add_u32 s32, s32, 4096
    buffer_load_dwordx4 v[56:59], v2, s[8:11], s32 offen offset:0
    buffer_load_dwordx4 v[60:63], v2, s[8:11], s32 offen offset:1024
    s_add_u32 s32, s32, 2048
    s_waitcnt vmcnt(0)
    ds_write_b128 v166, v[8:11] offset:24576
    ds_write_b128 v166, v[12:15] offset:25600
    ds_write_b128 v166, v[16:19] offset:26624
    ds_write_b128 v166, v[20:23] offset:27648
    ds_write_b128 v166, v[24:27] offset:28672
    ds_write_b128 v166, v[28:31] offset:29696
    ds_write_b128 v166, v[32:35] offset:30720
    ds_write_b128 v166, v[36:39] offset:31744
    ds_write_b128 v166, v[40:43] offset:32768
    ds_write_b128 v166, v[44:47] offset:33792
    ds_write_b128 v166, v[48:51] offset:34816
    ds_write_b128 v166, v[52:55] offset:35840
    ds_write_b128 v166, v[56:59] offset:36864
    ds_write_b128 v166, v[60:63] offset:37888
    s_waitcnt lgkmcnt(0)
    buffer_load_dwordx4 v[8:11], v2, s[8:11], s32 offen offset:0
    buffer_load_dwordx4 v[12:15], v2, s[8:11], s32 offen offset:1024
    buffer_load_dwordx4 v[16:19], v2, s[8:11], s32 offen offset:2048
    buffer_load_dwordx4 v[20:23], v2, s[8:11], s32 offen offset:3072
    s_add_u32 s32, s32, 4096
    buffer_load_dwordx4 v[24:27], v2, s[8:11], s32 offen offset:0
    buffer_load_dwordx4 v[28:31], v2, s[8:11], s32 offen offset:1024
    buffer_load_dwordx4 v[32:35], v2, s[8:11], s32 offen offset:2048
    buffer_load_dwordx4 v[36:39], v2, s[8:11], s32 offen offset:3072
    s_add_u32 s32, s32, 4096
    buffer_load_dwordx4 v[40:43], v2, s[8:11], s32 offen offset:0
    buffer_load_dwordx4 v[44:47], v2, s[8:11], s32 offen offset:1024
    buffer_load_dwordx4 v[48:51], v2, s[8:11], s32 offen offset:2048
    buffer_load_dwordx4 v[52:55], v2, s[8:11], s32 offen offset:3072
    s_add_u32 s32, s32, 4096
    buffer_load_dwordx4 v[56:59], v2, s[8:11], s32 offen offset:0
    buffer_load_dwordx4 v[60:63], v2, s[8:11], s32 offen offset:1024
    s_add_u32 s32, s32, 2048
    s_waitcnt vmcnt(0)
    ds_write_b128 v166, v[8:11] offset:38912
    ds_write_b128 v166, v[12:15] offset:39936
    ds_write_b128 v166, v[16:19] offset:40960
    ds_write_b128 v166, v[20:23] offset:41984
    ds_write_b128 v166, v[24:27] offset:43008
    ds_write_b128 v166, v[28:31] offset:44032
    ds_write_b128 v166, v[32:35] offset:45056
    ds_write_b128 v166, v[36:39] offset:46080
    ds_write_b128 v166, v[40:43] offset:47104
    ds_write_b128 v166, v[44:47] offset:48128
    ds_write_b128 v166, v[48:51] offset:49152
    ds_write_b128 v166, v[52:55] offset:50176
    ds_write_b128 v166, v[56:59] offset:51200
    ds_write_b128 v166, v[60:63] offset:52224
    s_waitcnt lgkmcnt(0)
    v_bfe_u32 v164, v1, 4, 2
    v_lshlrev_b32 v164, 6, v164
    v_bfe_u32 v4, v1, 1, 1
    v_lshl_add_u32 v164, v4, 5, v164
    v_bfe_u32 v4, v1, 0, 1
    v_lshl_add_u32 v164, v4, 4, v164
    v_bfe_u32 v4, v1, 2, 2
    v_lshl_add_u32 v164, v4, 2, v164
    s_lshl_b32 s33, s21, 1
    s_add_u32 s33, s33, s20
    s_lshl_b32 s33, s33, 8
    v_add_u32 v164, s33, v164
    v_mov_b32 v5, 0x5040100
    v_mov_b32 v167, 0x3020706
    v_and_b32 v4, 1, v1
    v_cmp_ne_u32 vcc, 0, v4
    s_nop 1
    v_cndmask_b32 v165, v5, v167, vcc
    s_lshl_b32 s29, s21, 15
    s_lshl_b32 s33, s20, 14
    s_add_u32 s29, s29, s33
    s_add_u32 s29, s29, 14942208
    s_mov_b32 s28, 44834816
    s_lshl_b32 s33, s20, 2
    s_add_u32 s33, s33, s21
    s_add_u32 s32, s33, 0
    s_and_b32 s32, s32, 7
    s_lshl_b32 s64, s32, 10
    s_add_u32 s64, s64, 44826624
    s_lshl_b32 s72, s32, 11
    s_add_u32 s72, s72, s29
    s_add_u32 s32, s33, 1
    s_and_b32 s32, s32, 7
    s_lshl_b32 s65, s32, 10
    s_add_u32 s65, s65, 44826624
    s_lshl_b32 s73, s32, 11
    s_add_u32 s73, s73, s29
    s_add_u32 s32, s33, 2
    s_and_b32 s32, s32, 7
    s_lshl_b32 s66, s32, 10
    s_add_u32 s66, s66, 44826624
    s_lshl_b32 s74, s32, 11
    s_add_u32 s74, s74, s29
    s_add_u32 s32, s33, 3
    s_and_b32 s32, s32, 7
    s_lshl_b32 s67, s32, 10
    s_add_u32 s67, s67, 44826624
    s_lshl_b32 s75, s32, 11
    s_add_u32 s75, s75, s29
    s_add_u32 s32, s33, 4
    s_and_b32 s32, s32, 7
    s_lshl_b32 s68, s32, 10
    s_add_u32 s68, s68, 44826624
    s_lshl_b32 s76, s32, 11
    s_add_u32 s76, s76, s29
    s_add_u32 s32, s33, 5
    s_and_b32 s32, s32, 7
    s_lshl_b32 s69, s32, 10
    s_add_u32 s69, s69, 44826624
    s_lshl_b32 s77, s32, 11
    s_add_u32 s77, s77, s29
    s_add_u32 s32, s33, 6
    s_and_b32 s32, s32, 7
    s_lshl_b32 s70, s32, 10
    s_add_u32 s70, s70, 44826624
    s_lshl_b32 s78, s32, 11
    s_add_u32 s78, s78, s29
    s_add_u32 s32, s33, 7
    s_and_b32 s32, s32, 7
    s_lshl_b32 s71, s32, 10
    s_add_u32 s71, s71, 44826624
    s_lshl_b32 s79, s32, 11
    s_add_u32 s79, s79, s29
    s_lshl_b32 s33, s21, 1
    s_add_u32 s33, s33, s20
    v_and_b32 v4, 15, v1
    v_lshlrev_b32 v4, 2, v4
    s_and_b32 s32, s33, 3
    s_lshl_b32 s32, s32, 7
    v_add_u32 v168, s32, v4
    v_mov_b32 v168, v4
    s_lshl_b32 s32, s33, 2
    s_add_u32 s32, s32, 7168
    v_lshlrev_b32 v5, 7, v1
    v_add_u32 v5, s32, v5
    v_mov_b32 v4, 0x40000000
    v_cmp_gt_u32 vcc, 1, v1
    s_nop 1
    v_cndmask_b32 v169, v4, v5, vcc
    s_mov_b32 s36, 44310528
    s_lshl_b32 s34, s33, 12
    s_add_u32 s34, s34, 46908416
    s_lshl_b32 s39, s33, 7
    s_add_u32 s39, s39, 46078976
    v_mov_b32 v128, 0
    v_mov_b32 v129, 0
    v_mov_b32 v130, 0
    v_mov_b32 v131, 0
    v_mov_b32 v132, 0
    v_mov_b32 v133, 0
    v_mov_b32 v134, 0
    v_mov_b32 v135, 0
    v_mov_b32 v136, 0
    v_mov_b32 v137, 0
    v_mov_b32 v138, 0
    v_mov_b32 v139, 0
    v_mov_b32 v140, 0
    v_mov_b32 v141, 0
    v_mov_b32 v142, 0
    v_mov_b32 v143, 0
    v_mov_b32 v171, 0
    ds_write_b64 v171, v[128:129] offset:16384
    s_waitcnt lgkmcnt(0)
L_va_step_any:
    s_barrier
    s_sleep 2
    buffer_load_dwordx4 v[8:11], v2, s[8:11], s72 offen offset:0
    buffer_load_dwordx4 v[12:15], v2, s[8:11], s72 offen offset:1024
    buffer_load_dwordx4 v[16:19], v2, s[8:11], s73 offen offset:0
    buffer_load_dwordx4 v[20:23], v2, s[8:11], s73 offen offset:1024
    buffer_load_dwordx4 v[24:27], v2, s[8:11], s74 offen offset:0
    buffer_load_dwordx4 v[28:31], v2, s[8:11], s74 offen offset:1024
    buffer_load_dwordx4 v[32:35], v2, s[8:11], s75 offen offset:0
    buffer_load_dwordx4 v[36:39], v2, s[8:11], s75 offen offset:1024
    buffer_load_dwordx4 v[40:43], v2, s[8:11], s76 offen offset:0
    buffer_load_dwordx4 v[44:47], v2, s[8:11], s76 offen offset:1024
    buffer_load_dwordx4 v[48:51], v2, s[8:11], s77 offen offset:0
    buffer_load_dwordx4 v[52:55], v2, s[8:11], s77 offen offset:1024
    buffer_load_dwordx4 v[56:59], v2, s[8:11], s78 offen offset:0
    buffer_load_dwordx4 v[60:63], v2, s[8:11], s78 offen offset:1024
    buffer_load_dwordx4 v[64:67], v2, s[8:11], s79 offen offset:0
    buffer_load_dwordx4 v[68:71], v2, s[8:11], s79 offen offset:1024
    s_mov_b32 s31, 200000
L_va_sb_any:
    ds_read_b64 v[4:5], v171 offset:16384
    s_waitcnt lgkmcnt(0)
    v_min_u32 v4, v4, v5
    v_cmp_ge_u32 vcc, s30, v4
    s_sub_u32 s31, s31, 1
    s_cbranch_scc1 L_fail
    s_cbranch_vccnz L_va_sb_any
L_va_rd_any:
    ds_read_b128 v[88:91], v2 offset:0
    ds_read_b128 v[92:95], v2 offset:1024
    ds_read_b128 v[96:99], v2 offset:2048
    ds_read_b128 v[100:103], v2 offset:3072
    ds_read_b128 v[104:107], v2 offset:4096
    ds_read_b128 v[108:111], v2 offset:5120
    ds_read_b128 v[112:115], v2 offset:6144
    s_waitcnt lgkmcnt(6)
    .p2align 3
    v_smfmac_f32_16x16x64_bf16 v[128:131], v[88:91], a[0:7], v3
    s_waitcnt lgkmcnt(5)
    s_mov_b32 s44, 0
    v_smfmac_f32_16x16x64_bf16 v[128:131], v[92:95], a[8:15], v3
    s_waitcnt lgkmcnt(4)
    s_mov_b32 s44, 0
    v_smfmac_f32_16x16x64_bf16 v[128:131], v[96:99], a[16:23], v3
    s_waitcnt lgkmcnt(3)
    s_mov_b32 s44, 0
    v_smfmac_f32_16x16x64_bf16 v[128:131], v[100:103], a[24:31], v3
    s_waitcnt lgkmcnt(2)
    s_mov_b32 s44, 0
    v_smfmac_f32_16x16x64_bf16 v[128:131], v[104:107], a[32:39], v3
    s_waitcnt lgkmcnt(1)
    s_mov_b32 s44, 0
    v_smfmac_f32_16x16x64_bf16 v[128:131], v[108:111], a[40:47], v3
    s_waitcnt lgkmcnt(0)
    s_mov_b32 s44, 0
    v_smfmac_f32_16x16x64_bf16 v[128:131], v[112:115], a[48:55], v3
    ds_read_b128 v[148:151], v166 offset:24576
    ds_read_b128 v[152:155], v166 offset:25600
    v_smfmac_f32_16x16x64_bf16 v[132:135], v[88:91], a[56:63], v3
    v_smfmac_f32_16x16x64_bf16 v[132:135], v[92:95], a[64:71], v3
    v_smfmac_f32_16x16x64_bf16 v[132:135], v[96:99], a[72:79], v3
    v_add_f32_e64 v128, v128, v130
    v_smfmac_f32_16x16x64_bf16 v[132:135], v[100:103], a[80:87], v3
    s_waitcnt lgkmcnt(0)
    v_add_f32 v129, v129, v131
    v_smfmac_f32_16x16x64_bf16 v[136:139], v[88:91], v[148:155], v3
    ds_read_b128 v[148:151], v166 offset:26624
    ds_read_b128 v[152:155], v166 offset:27648
    v_cmp_u_f32_e64 vcc, v128, v129
    v_smfmac_f32_16x16x64_bf16 v[132:135], v[104:107], a[88:95], v3
    v_cvt_pk_bf16_f32 v72, v128, v129
    v_smfmac_f32_16x16x64_bf16 v[132:135], v[108:111], a[96:103], v3
    v_mov_b64_e64 v[130:131], 0
    v_smfmac_f32_16x16x64_bf16 v[132:135], v[112:115], a[104:111], v3
    s_cbranch_vccnz L_va_nan_any
    v_mov_b64 v[128:129], 0
    v_smfmac_f32_16x16x64_bf16 v[140:143], v[88:91], a[112:119], v3
    v_smfmac_f32_16x16x64_bf16 v[140:143], v[92:95], a[120:127], v3
    s_waitcnt lgkmcnt(0)
    s_mov_b32 s44, 0
    v_smfmac_f32_16x16x64_bf16 v[136:139], v[92:95], v[148:155], v3
    ds_read_b128 v[148:151], v166 offset:28672
    ds_read_b128 v[152:155], v166 offset:29696
    v_add_f32_e64 v132, v132, v134
    v_smfmac_f32_16x16x64_bf16 v[140:143], v[96:99], a[128:135], v3
    v_add_f32_e64 v133, v133, v135
    v_smfmac_f32_16x16x64_bf16 v[140:143], v[100:103], a[136:143], v3
    v_cvt_pk_bf16_f32 v73, v132, v133
    v_smfmac_f32_16x16x64_bf16 v[140:143], v[104:107], a[144:151], v3
    v_mov_b64_e64 v[134:135], 0
    v_smfmac_f32_16x16x64_bf16 v[140:143], v[108:111], a[152:159], v3
    v_mov_b64_e64 v[132:133], 0
    v_smfmac_f32_16x16x64_bf16 v[140:143], v[112:115], a[160:167], v3
    s_waitcnt lgkmcnt(0)
    s_mov_b32 s44, 0
    v_smfmac_f32_16x16x64_bf16 v[136:139], v[96:99], v[148:155], v3
    ds_read_b128 v[148:151], v166 offset:30720
    ds_read_b128 v[152:155], v166 offset:31744
    v_smfmac_f32_16x16x64_bf16 v[128:131], v[88:91], a[168:175], v3
    v_smfmac_f32_16x16x64_bf16 v[128:131], v[92:95], a[176:183], v3
    v_add_f32_e64 v140, v140, v142
    v_smfmac_f32_16x16x64_bf16 v[128:131], v[96:99], a[184:191], v3
    v_add_f32_e64 v141, v141, v143
    v_smfmac_f32_16x16x64_bf16 v[128:131], v[100:103], a[192:199], v3
    v_cvt_pk_bf16_f32 v74, v140, v141
    v_smfmac_f32_16x16x64_bf16 v[128:131], v[104:107], a[200:207], v3
    s_waitcnt lgkmcnt(0)
    v_mov_b64 v[142:143], 0
    v_smfmac_f32_16x16x64_bf16 v[136:139], v[100:103], v[148:155], v3
    ds_read_b128 v[148:151], v166 offset:32768
    ds_read_b128 v[152:155], v166 offset:33792
    v_mov_b64_e64 v[140:141], 0
    v_smfmac_f32_16x16x64_bf16 v[128:131], v[108:111], a[208:215], v3
    v_mov_b32_e64 v170, -1
    v_smfmac_f32_16x16x64_bf16 v[128:131], v[112:115], a[216:223], v3
    v_smfmac_f32_16x16x64_bf16 v[132:135], v[88:91], a[224:231], v3
    v_smfmac_f32_16x16x64_bf16 v[132:135], v[92:95], a[232:239], v3
    v_smfmac_f32_16x16x64_bf16 v[132:135], v[96:99], a[240:247], v3
    s_waitcnt lgkmcnt(0)
    v_add_f32 v128, v128, v130
    v_smfmac_f32_16x16x64_bf16 v[136:139], v[104:107], v[148:155], v3
    ds_read_b128 v[148:151], v166 offset:34816
    ds_read_b128 v[152:155], v166 offset:35840
    v_add_f32_e64 v129, v129, v131
    v_smfmac_f32_16x16x64_bf16 v[132:135], v[100:103], a[248:255], v3
    v_cvt_pk_bf16_f32 v75, v128, v129
    v_smfmac_f32_16x16x64_bf16 v[132:135], v[104:107], v[176:183], v3
    v_mov_b64_e64 v[130:131], 0
    v_smfmac_f32_16x16x64_bf16 v[132:135], v[108:111], v[184:191], v3
    buffer_load_dword v170, v168, s[8:11], s28 offen offset:2048 sc1
    v_mov_b64_e64 v[128:129], 0
    v_smfmac_f32_16x16x64_bf16 v[132:135], v[112:115], v[192:199], v3
    v_smfmac_f32_16x16x64_bf16 v[140:143], v[88:91], v[200:207], v3
    s_waitcnt lgkmcnt(0)
    s_mov_b32 s44, 0
    v_smfmac_f32_16x16x64_bf16 v[136:139], v[108:111], v[148:155], v3
    ds_read_b128 v[148:151], v166 offset:36864
    ds_read_b128 v[152:155], v166 offset:37888
    v_smfmac_f32_16x16x64_bf16 v[140:143], v[92:95], v[208:215], v3
    buffer_load_dword v170, v168, s[8:11], s28 offen offset:2048 sc1
    v_add_f32_e64 v132, v132, v134
    v_smfmac_f32_16x16x64_bf16 v[140:143], v[96:99], v[216:223], v3
    v_add_f32_e64 v133, v133, v135
    v_smfmac_f32_16x16x64_bf16 v[140:143], v[100:103], v[224:231], v3
    v_cvt_pk_bf16_f32 v76, v132, v133
    v_smfmac_f32_16x16x64_bf16 v[140:143], v[104:107], v[232:239], v3
    v_mov_b64_e64 v[134:135], 0
    v_smfmac_f32_16x16x64_bf16 v[140:143], v[108:111], v[240:247], v3
    s_waitcnt lgkmcnt(0)
    buffer_load_dword v170, v168, s[8:11], s28 offen offset:2048 sc1
    v_mov_b64 v[132:133], 0
    v_smfmac_f32_16x16x64_bf16 v[136:139], v[112:115], v[148:155], v3
    v_smfmac_f32_16x16x64_bf16 v[140:143], v[112:115], v[248:255], v3
L_va_y_any:
    s_cmp_ge_u32 s30, 63
    s_cbranch_scc1 L_va_last_any
    s_cmp_lg_u32 s20, 0
    s_cbranch_scc1 L_va_go_any
    s_mov_b32 s31, 200000
L_va_probe_any:
    buffer_load_dword v170, v168, s[8:11], s28 offen offset:2048 sc1
    s_waitcnt vmcnt(2)
    v_cmp_eq_u32 vcc, -1, v170
    s_sub_u32 s31, s31, 1
    s_cbranch_scc1 L_fail
    s_cbranch_vccnz L_va_probe_any
L_va_go_any:
    s_barrier
    buffer_load_dwordx4 v[88:91], v2, s[8:11], s64 offen offset:0 sc1
    buffer_load_dwordx4 v[92:95], v2, s[8:11], s65 offen offset:0 sc1
    buffer_load_dwordx4 v[96:99], v2, s[8:11], s66 offen offset:0 sc1
    buffer_load_dwordx4 v[100:103], v2, s[8:11], s67 offen offset:0 sc1
    buffer_load_dwordx4 v[104:107], v2, s[8:11], s68 offen offset:0 sc1
    buffer_load_dwordx4 v[108:111], v2, s[8:11], s69 offen offset:0 sc1
    buffer_load_dwordx4 v[112:115], v2, s[8:11], s70 offen offset:0 sc1
    buffer_load_dwordx4 v[116:119], v2, s[8:11], s71 offen offset:0 sc1
    buffer_load_dwordx4 v[120:123], v2, s[8:11], s28 offen offset:0 sc1
    buffer_load_dwordx4 v[124:127], v2, s[8:11], s28 offen offset:1024 sc1
    v_mov_b64 v[144:145], 0
    v_mov_b64 v[146:147], 0
    ds_read_b32 v79, v7 offset:1036
    ds_read_b128 v[80:83], v7 offset:2048
    ds_read_b128 v[84:87], v7 offset:3072
    v_add_f32 v136, v136, v138
    v_add_f32 v137, v137, v139
    v_cvt_pk_bf16_f32 v78, v136, v137
    v_mov_b64 v[138:139], 0
    v_mov_b64 v[136:137], 0
    v_add_f32 v140, v140, v142
    v_add_f32 v141, v141, v143
    v_cvt_pk_bf16_f32 v77, v140, v141
    v_mov_b64 v[142:143], 0
    v_mov_b64 v[140:141], 0
    s_waitcnt vmcnt(9)
    v_smfmac_f32_16x16x64_bf16 v[144:147], v[88:91], v[8:15], v3
    s_waitcnt vmcnt(8)
    v_smfmac_f32_16x16x64_bf16 v[144:147], v[92:95], v[16:23], v3
    s_waitcnt vmcnt(7)
    v_smfmac_f32_16x16x64_bf16 v[144:147], v[96:99], v[24:31], v3
    s_waitcnt vmcnt(6)
    v_smfmac_f32_16x16x64_bf16 v[144:147], v[100:103], v[32:39], v3
    buffer_store_dword v3, v169, s[8:11], s36 offen sc1
    s_waitcnt vmcnt(6)
    v_smfmac_f32_16x16x64_bf16 v[144:147], v[104:107], v[40:47], v3
    s_waitcnt vmcnt(5)
    v_smfmac_f32_16x16x64_bf16 v[144:147], v[108:111], v[48:55], v3
    s_waitcnt vmcnt(4)
    v_smfmac_f32_16x16x64_bf16 v[144:147], v[112:115], v[56:63], v3
    s_waitcnt vmcnt(3)
    v_smfmac_f32_16x16x64_bf16 v[144:147], v[116:119], v[64:71], v3
    s_waitcnt vmcnt(2) lgkmcnt(0)
    v_smfmac_f32_16x16x64_bf16 v[144:147], v[120:123], v[72:79], v3
    s_waitcnt vmcnt(1)
    v_smfmac_f32_16x16x64_bf16 v[144:147], v[124:127], v[80:87], v3
    s_nop 7
    v_add_f32 v144, v144, v146
    v_add_f32 v145, v145, v147
    v_cmp_u_f32 vcc, v144, v145
    v_cvt_pk_bf16_f32 v144, v144, v145
    s_nop 1
    v_mov_b32_dpp v145, v144 quad_perm:[1,0,3,2] row_mask:0xf bank_mask:0xf
    v_perm_b32 v144, v145, v144, v165
    v_min_u32 v144, -2, v144
    s_cbranch_vccnz L_va_redo_any
L_va_pub_any:
    buffer_store_dword v144, v164, s[8:11], s36 offen sc1
    s_cmp_lg_u32 s30, 62
    s_cbranch_scc1 L_va_nx_any
    s_add_u32 s32, s36, 1245184
    buffer_store_dword v144, v164, s[8:11], s32 offen sc1
L_va_nx_any:
    s_add_u32 s24, s24, 8192
    s_add_u32 s25, s25, 8192
    s_add_u32 s36, s36, 8192
    s_add_u32 s28, s28, 11264
    s_add_u32 s34, s34, 114688
    s_add_u32 s39, s39, 11264
    s_add_u32 s30, s30, 1
    s_add_u32 s64, s64, 11264
    s_add_u32 s65, s65, 11264
    s_add_u32 s66, s66, 11264
    s_add_u32 s67, s67, 11264
    s_add_u32 s68, s68, 11264
    s_add_u32 s69, s69, 11264
    s_add_u32 s70, s70, 11264
    s_add_u32 s71, s71, 11264
    s_add_u32 s72, s72, 458752
    s_add_u32 s73, s73, 458752
    s_add_u32 s74, s74, 458752
    s_add_u32 s75, s75, 458752
    s_add_u32 s76, s76, 458752
    s_add_u32 s77, s77, 458752
    s_add_u32 s78, s78, 458752
    s_add_u32 s79, s79, 458752
    s_branch L_va_step_any
L_va_last_any:
    s_nop 7
    v_add_f32 v136, v136, v138
    v_add_f32 v137, v137, v139
    v_cvt_pk_bf16_f32 v78, v136, v137
    v_mov_b64 v[138:139], 0
    v_mov_b64 v[136:137], 0
    v_add_f32 v140, v140, v142
    v_add_f32 v141, v141, v143
    v_cvt_pk_bf16_f32 v77, v140, v141
    v_mov_b64 v[142:143], 0
    v_mov_b64 v[140:141], 0
    s_waitcnt lgkmcnt(0)
    s_barrier
    ds_read_b32 v79, v7 offset:1036
    ds_read_b128 v[80:83], v7 offset:2048
    ds_read_b128 v[84:87], v7 offset:3072
    s_add_u32 s34, s34, 114688
    s_add_u32 s39, s39, 11264
    s_waitcnt vmcnt(0) lgkmcnt(0)
    buffer_store_dwordx4 v[72:75], v2, s[8:11], s34 offen offset:0 sc1
    buffer_store_dwordx4 v[76:79], v2, s[8:11], s34 offen offset:1024 sc1
    buffer_store_dwordx4 v[80:83], v2, s[8:11], s34 offen offset:2048 sc1
    buffer_store_dwordx4 v[84:87], v2, s[8:11], s34 offen offset:3072 sc1
    s_add_u32 s39, s39, 11264
    s_waitcnt vmcnt(0)
    s_mov_b64 exec, 0xff
    buffer_store_dwordx4 v[128:131], v2, s[8:11], s39 offen sc1
    s_mov_b64 exec, -1
    s_branch L_done
L_va_redo_any:
    s_mov_b32 s31, 0
L_va_redo_l_any:
    buffer_load_dwordx4 v[88:91], v2, s[8:11], s64 offen offset:0 sc1
    buffer_load_dwordx4 v[92:95], v2, s[8:11], s65 offen offset:0 sc1
    buffer_load_dwordx4 v[96:99], v2, s[8:11], s66 offen offset:0 sc1
    buffer_load_dwordx4 v[100:103], v2, s[8:11], s67 offen offset:0 sc1
    buffer_load_dwordx4 v[104:107], v2, s[8:11], s68 offen offset:0 sc1
    buffer_load_dwordx4 v[108:111], v2, s[8:11], s69 offen offset:0 sc1
    buffer_load_dwordx4 v[112:115], v2, s[8:11], s70 offen offset:0 sc1
    buffer_load_dwordx4 v[116:119], v2, s[8:11], s71 offen offset:0 sc1
    buffer_load_dwordx4 v[120:123], v2, s[8:11], s28 offen offset:0 sc1
    buffer_load_dwordx4 v[124:127], v2, s[8:11], s28 offen offset:1024 sc1
    s_waitcnt vmcnt(0)
    v_max3_u32 v4, v88, v89, v90
    v_max3_u32 v4, v4, v91, v92
    v_max3_u32 v4, v4, v93, v94
    v_max3_u32 v4, v4, v95, v96
    v_max3_u32 v4, v4, v97, v98
    v_max3_u32 v4, v4, v99, v100
    v_max3_u32 v4, v4, v101, v102
    v_max3_u32 v4, v4, v103, v104
    v_max3_u32 v4, v4, v105, v106
    v_max3_u32 v4, v4, v107, v108
    v_max3_u32 v4, v4, v109, v110
    v_max3_u32 v4, v4, v111, v112
    v_max3_u32 v4, v4, v113, v114
    v_max3_u32 v4, v4, v115, v116
    v_max3_u32 v4, v4, v117, v118
    v_max3_u32 v4, v4, v119, v120
    v_max3_u32 v4, v4, v121, v122
    v_max3_u32 v4, v4, v123, v124
    v_max3_u32 v4, v4, v125, v126
    v_max_u32 v4, v4, v127
    v_cmp_eq_u32 vcc, -1, v4
    s_cbranch_vccz L_va_redo_go_any
    s_add_u32 s31, s31, 1
    s_cmp_lt_u32 s31, 200000
    s_cbranch_scc1 L_va_redo_l_any
    s_branch L_fail
L_va_redo_go_any:
    v_mov_b64 v[144:145], 0
    v_mov_b64 v[146:147], 0
    v_mov_b64 v[156:157], 0
    v_mov_b64 v[158:159], 0
    s_nop 1
    v_smfmac_f32_16x16x64_bf16 v[144:147], v[88:91], v[8:15], v3
    v_smfmac_f32_16x16x64_bf16 v[144:147], v[92:95], v[16:23], v3
    v_smfmac_f32_16x16x64_bf16 v[144:147], v[96:99], v[24:31], v3
    v_smfmac_f32_16x16x64_bf16 v[144:147], v[100:103], v[32:39], v3
    v_smfmac_f32_16x16x64_bf16 v[144:147], v[104:107], v[40:47], v3
    v_smfmac_f32_16x16x64_bf16 v[144:147], v[108:111], v[48:55], v3
    v_smfmac_f32_16x16x64_bf16 v[144:147], v[112:115], v[56:63], v3
    v_smfmac_f32_16x16x64_bf16 v[144:147], v[116:119], v[64:71], v3
    v_smfmac_f32_16x16x64_bf16 v[144:147], v[120:123], v[72:79], v3
    v_smfmac_f32_16x16x64_bf16 v[144:147], v[124:127], v[80:87], v3
    s_nop 7
    v_add_f32 v144, v144, v146
    v_add_f32 v145, v145, v147
    v_cvt_pk_bf16_f32 v144, v144, v145
    s_nop 1
    v_mov_b32_dpp v145, v144 quad_perm:[1,0,3,2] row_mask:0xf bank_mask:0xf
    v_perm_b32 v144, v145, v144, v165
    v_min_u32 v144, -2, v144
    s_branch L_va_pub_any
L_va_nan_any:
    s_mov_b32 s31, 0
    s_waitcnt lgkmcnt(0)
L_va_nan_l_any:
    buffer_load_dwordx4 v[88:91], v2, s[8:11], s24 offen offset:0 sc1
    buffer_load_dwordx4 v[92:95], v2, s[8:11], s24 offen offset:1024 sc1
    buffer_load_dwordx4 v[96:99], v2, s[8:11], s24 offen offset:2048 sc1
    buffer_load_dwordx4 v[100:103], v2, s[8:11], s24 offen offset:3072 sc1
    buffer_load_dwordx4 v[104:107], v2, s[8:11], s25 offen offset:0 sc1
    buffer_load_dwordx4 v[108:111], v2, s[8:11], s25 offen offset:1024 sc1
    buffer_load_dwordx4 v[112:115], v2, s[8:11], s25 offen offset:2048 sc1
    s_waitcnt vmcnt(0)
    v_max3_u32 v4, v88, v89, v90
    v_max3_u32 v4, v4, v91, v92
    v_max3_u32 v4, v4, v93, v94
    v_max3_u32 v4, v4, v95, v96
    v_max3_u32 v4, v4, v97, v98
    v_max3_u32 v4, v4, v99, v100
    v_max3_u32 v4, v4, v101, v102
    v_max3_u32 v4, v4, v103, v104
    v_max3_u32 v4, v4, v105, v106
    v_max3_u32 v4, v4, v107, v108
    v_max3_u32 v4, v4, v109, v110
    v_max3_u32 v4, v4, v111, v112
    v_max3_u32 v4, v4, v113, v114
    v_max_u32 v4, v4, v115
    v_cmp_eq_u32 vcc, -1, v4
    s_cbranch_vccz L_va_nan_go_any
    s_add_u32 s31, s31, 1
    s_cmp_lt_u32 s31, 200000
    s_cbranch_scc1 L_va_nan_l_any
    s_branch L_fail
L_va_nan_go_any:
    v_mov_b64 v[128:129], 0
    v_mov_b64 v[130:131], 0
    v_mov_b64 v[132:133], 0
    v_mov_b64 v[134:135], 0
    v_mov_b64 v[136:137], 0
    v_mov_b64 v[138:139], 0
    v_mov_b64 v[140:141], 0
    v_mov_b64 v[142:143], 0
    s_nop 1
    v_smfmac_f32_16x16x64_bf16 v[128:131], v[88:91], a[0:7], v3
    v_smfmac_f32_16x16x64_bf16 v[128:131], v[92:95], a[8:15], v3
    v_smfmac_f32_16x16x64_bf16 v[128:131], v[96:99], a[16:23], v3
    v_smfmac_f32_16x16x64_bf16 v[128:131], v[100:103], a[24:31], v3
    v_smfmac_f32_16x16x64_bf16 v[128:131], v[104:107], a[32:39], v3
    v_smfmac_f32_16x16x64_bf16 v[128:131], v[108:111], a[40:47], v3
    v_smfmac_f32_16x16x64_bf16 v[128:131], v[112:115], a[48:55], v3
    ds_read_b128 v[148:151], v166 offset:24576
    ds_read_b128 v[152:155], v166 offset:25600
    v_smfmac_f32_16x16x64_bf16 v[132:135], v[88:91], a[56:63], v3
    v_smfmac_f32_16x16x64_bf16 v[132:135], v[92:95], a[64:71], v3
    v_smfmac_f32_16x16x64_bf16 v[132:135], v[96:99], a[72:79], v3
    v_add_f32_e64 v128, v128, v130
    v_smfmac_f32_16x16x64_bf16 v[132:135], v[100:103], a[80:87], v3
    s_waitcnt lgkmcnt(0)
    v_add_f32 v129, v129, v131
    v_smfmac_f32_16x16x64_bf16 v[136:139], v[88:91], v[148:155], v3
    ds_read_b128 v[148:151], v166 offset:26624
    ds_read_b128 v[152:155], v166 offset:27648
    v_cvt_pk_bf16_f32 v72, v128, v129
    v_smfmac_f32_16x16x64_bf16 v[132:135], v[104:107], a[88:95], v3
    v_mov_b64_e64 v[130:131], 0
    v_smfmac_f32_16x16x64_bf16 v[132:135], v[108:111], a[96:103], v3
    v_mov_b64_e64 v[128:129], 0
    v_smfmac_f32_16x16x64_bf16 v[132:135], v[112:115], a[104:111], v3
    v_smfmac_f32_16x16x64_bf16 v[140:143], v[88:91], a[112:119], v3
    v_smfmac_f32_16x16x64_bf16 v[140:143], v[92:95], a[120:127], v3
    s_waitcnt lgkmcnt(0)
    s_mov_b32 s44, 0
    v_smfmac_f32_16x16x64_bf16 v[136:139], v[92:95], v[148:155], v3
    ds_read_b128 v[148:151], v166 offset:28672
    ds_read_b128 v[152:155], v166 offset:29696
    v_add_f32_e64 v132, v132, v134
    v_smfmac_f32_16x16x64_bf16 v[140:143], v[96:99], a[128:135], v3
    v_add_f32_e64 v133, v133, v135
    v_smfmac_f32_16x16x64_bf16 v[140:143], v[100:103], a[136:143], v3
    v_cvt_pk_bf16_f32 v73, v132, v133
    v_smfmac_f32_16x16x64_bf16 v[140:143], v[104:107], a[144:151], v3
    v_mov_b64_e64 v[134:135], 0
    v_smfmac_f32_16x16x64_bf16 v[140:143], v[108:111], a[152:159], v3
    v_mov_b64_e64 v[132:133], 0
    v_smfmac_f32_16x16x64_bf16 v[140:143], v[112:115], a[160:167], v3
    s_waitcnt lgkmcnt(0)
    s_mov_b32 s44, 0
    v_smfmac_f32_16x16x64_bf16 v[136:139], v[96:99], v[148:155], v3
    ds_read_b128 v[148:151], v166 offset:30720
    ds_read_b128 v[152:155], v166 offset:31744
    v_smfmac_f32_16x16x64_bf16 v[128:131], v[88:91], a[168:175], v3
    v_smfmac_f32_16x16x64_bf16 v[128:131], v[92:95], a[176:183], v3
    v_add_f32_e64 v140, v140, v142
    v_smfmac_f32_16x16x64_bf16 v[128:131], v[96:99], a[184:191], v3
    v_add_f32_e64 v141, v141, v143
    v_smfmac_f32_16x16x64_bf16 v[128:131], v[100:103], a[192:199], v3
    v_cvt_pk_bf16_f32 v74, v140, v141
    v_smfmac_f32_16x16x64_bf16 v[128:131], v[104:107], a[200:207], v3
    s_waitcnt lgkmcnt(0)
    v_mov_b64 v[142:143], 0
    v_smfmac_f32_16x16x64_bf16 v[136:139], v[100:103], v[148:155], v3
    ds_read_b128 v[148:151], v166 offset:32768
    ds_read_b128 v[152:155], v166 offset:33792
    v_mov_b64_e64 v[140:141], 0
    v_smfmac_f32_16x16x64_bf16 v[128:131], v[108:111], a[208:215], v3
    v_mov_b32_e64 v170, -1
    v_smfmac_f32_16x16x64_bf16 v[128:131], v[112:115], a[216:223], v3
    v_smfmac_f32_16x16x64_bf16 v[132:135], v[88:91], a[224:231], v3
    v_smfmac_f32_16x16x64_bf16 v[132:135], v[92:95], a[232:239], v3
    v_smfmac_f32_16x16x64_bf16 v[132:135], v[96:99], a[240:247], v3
    s_waitcnt lgkmcnt(0)
    v_add_f32 v128, v128, v130
    v_smfmac_f32_16x16x64_bf16 v[136:139], v[104:107], v[148:155], v3
    ds_read_b128 v[148:151], v166 offset:34816
    ds_read_b128 v[152:155], v166 offset:35840
    v_add_f32_e64 v129, v129, v131
    v_smfmac_f32_16x16x64_bf16 v[132:135], v[100:103], a[248:255], v3
    v_cvt_pk_bf16_f32 v75, v128, v129
    v_smfmac_f32_16x16x64_bf16 v[132:135], v[104:107], v[176:183], v3
    v_mov_b64_e64 v[130:131], 0
    v_smfmac_f32_16x16x64_bf16 v[132:135], v[108:111], v[184:191], v3
    buffer_load_dword v170, v168, s[8:11], s28 offen offset:2048 sc1
    v_mov_b64_e64 v[128:129], 0
    v_smfmac_f32_16x16x64_bf16 v[132:135], v[112:115], v[192:199], v3
    v_smfmac_f32_16x16x64_bf16 v[140:143], v[88:91], v[200:207], v3
    s_waitcnt lgkmcnt(0)
    s_mov_b32 s44, 0
    v_smfmac_f32_16x16x64_bf16 v[136:139], v[108:111], v[148:155], v3
    ds_read_b128 v[148:151], v166 offset:36864
    ds_read_b128 v[152:155], v166 offset:37888
    v_smfmac_f32_16x16x64_bf16 v[140:143], v[92:95], v[208:215], v3
    buffer_load_dword v170, v168, s[8:11], s28 offen offset:2048 sc1
    v_add_f32_e64 v132, v132, v134
    v_smfmac_f32_16x16x64_bf16 v[140:143], v[96:99], v[216:223], v3
    v_add_f32_e64 v133, v133, v135
    v_smfmac_f32_16x16x64_bf16 v[140:143], v[100:103], v[224:231], v3
    v_cvt_pk_bf16_f32 v76, v132, v133
    v_smfmac_f32_16x16x64_bf16 v[140:143], v[104:107], v[232:239], v3
    v_mov_b64_e64 v[134:135], 0
    v_smfmac_f32_16x16x64_bf16 v[140:143], v[108:111], v[240:247], v3
    s_waitcnt lgkmcnt(0)
    buffer_load_dword v170, v168, s[8:11], s28 offen offset:2048 sc1
    v_mov_b64 v[132:133], 0
    v_smfmac_f32_16x16x64_bf16 v[136:139], v[112:115], v[148:155], v3
    v_smfmac_f32_16x16x64_bf16 v[140:143], v[112:115], v[248:255], v3
    s_branch L_va_y_any
L_vb_any:
    buffer_load_dwordx4 a[0:3], v2, s[8:11], s32 offen offset:0
    buffer_load_dwordx4 a[4:7], v2, s[8:11], s32 offen offset:1024
    buffer_load_dwordx4 a[8:11], v2, s[8:11], s32 offen offset:2048
    buffer_load_dwordx4 a[12:15], v2, s[8:11], s32 offen offset:3072
    s_add_u32 s32, s32, 4096
    buffer_load_dwordx4 a[16:19], v2, s[8:11], s32 offen offset:0
    buffer_load_dwordx4 a[20:23], v2, s[8:11], s32 offen offset:1024
    buffer_load_dwordx4 a[24:27], v2, s[8:11], s32 offen offset:2048
    buffer_load_dwordx4 a[28:31], v2, s[8:11], s32 offen offset:3072
    s_add_u32 s32, s32, 4096
    buffer_load_dwordx4 a[32:35], v2, s[8:11], s32 offen offset:0
    buffer_load_dwordx4 a[36:39], v2, s[8:11], s32 offen offset:1024
    buffer_load_dwordx4 a[40:43], v2, s[8:11], s32 offen offset:2048
    buffer_load_dwordx4 a[44:47], v2, s[8:11], s32 offen offset:3072
    s_add_u32 s32, s32, 4096
    buffer_load_dwordx4 a[48:51], v2, s[8:11], s32 offen offset:0
    buffer_load_dwordx4 a[52:55], v2, s[8:11], s32 offen offset:1024
    buffer_load_dwordx4 a[56:59], v2, s[8:11], s32 offen offset:2048
    buffer_load_dwordx4 a[60:63], v2, s[8:11], s32 offen offset:3072
    s_add_u32 s32, s32, 4096
    buffer_load_dwordx4 a[64:67], v2, s[8:11], s32 offen offset:0
    buffer_load_dwordx4 a[68:71], v2, s[8:11], s32 offen offset:1024
    buffer_load_dwordx4 a[72:75], v2, s[8:11], s32 offen offset:2048
    buffer_load_dwordx4 a[76:79], v2, s[8:11], s32 offen offset:3072
    s_add_u32 s32, s32, 4096
    buffer_load_dwordx4 a[80:83], v2, s[8:11], s32 offen offset:0
    buffer_load_dwordx4 a[84:87], v2, s[8:11], s32 offen offset:1024
    buffer_load_dwordx4 a[88:91], v2, s[8:11], s32 offen offset:2048
    buffer_load_dwordx4 a[92:95], v2, s[8:11], s32 offen offset:3072
    s_add_u32 s32, s32, 4096
    buffer_load_dwordx4 a[96:99], v2, s[8:11], s32 offen offset:0
    buffer_load_dwordx4 a[100:103], v2, s[8:11], s32 offen offset:1024
    buffer_load_dwordx4 a[104:107], v2, s[8:11], s32 offen offset:2048
    buffer_load_dwordx4 a[108:111], v2, s[8:11], s32 offen offset:3072
    s_add_u32 s32, s32, 4096
    buffer_load_dwordx4 a[112:115], v2, s[8:11], s32 offen offset:0
    buffer_load_dwordx4 a[116:119], v2, s[8:11], s32 offen offset:1024
    buffer_load_dwordx4 a[120:123], v2, s[8:11], s32 offen offset:2048
    buffer_load_dwordx4 a[124:127], v2, s[8:11], s32 offen offset:3072
    s_add_u32 s32, s32, 4096
    buffer_load_dwordx4 a[128:131], v2, s[8:11], s32 offen offset:0
    buffer_load_dwordx4 a[132:135], v2, s[8:11], s32 offen offset:1024
    buffer_load_dwordx4 a[136:139], v2, s[8:11], s32 offen offset:2048
    buffer_load_dwordx4 a[140:143], v2, s[8:11], s32 offen offset:3072
    s_add_u32 s32, s32, 4096
    buffer_load_dwordx4 a[144:147], v2, s[8:11], s32 offen offset:0
    buffer_load_dwordx4 a[148:151], v2, s[8:11], s32 offen offset:1024
    buffer_load_dwordx4 a[152:155], v2, s[8:11], s32 offen offset:2048
    buffer_load_dwordx4 a[156:159], v2, s[8:11], s32 offen offset:3072
    s_add_u32 s32, s32, 4096
    buffer_load_dwordx4 a[160:163], v2, s[8:11], s32 offen offset:0
    buffer_load_dwordx4 a[164:167], v2, s[8:11], s32 offen offset:1024
    buffer_load_dwordx4 a[168:171], v2, s[8:11], s32 offen offset:2048
    buffer_load_dwordx4 a[172:175], v2, s[8:11], s32 offen offset:3072
    s_add_u32 s32, s32, 4096
    buffer_load_dwordx4 a[176:179], v2, s[8:11], s32 offen offset:0
    buffer_load_dwordx4 a[180:183], v2, s[8:11], s32 offen offset:1024
    buffer_load_dwordx4 a[184:187], v2, s[8:11], s32 offen offset:2048
    buffer_load_dwordx4 a[188:191], v2, s[8:11], s32 offen offset:3072
    s_add_u32 s32, s32, 4096
    buffer_load_dwordx4 a[192:195], v2, s[8:11], s32 offen offset:0
    buffer_load_dwordx4 a[196:199], v2, s[8:11], s32 offen offset:1024
    buffer_load_dwordx4 a[200:203], v2, s[8:11], s32 offen offset:2048
    buffer_load_dwordx4 a[204:207], v2, s[8:11], s32 offen offset:3072
    s_add_u32 s32, s32, 4096
    buffer_load_dwordx4 a[208:211], v2, s[8:11], s32 offen offset:0
    buffer_load_dwordx4 a[212:215], v2, s[8:11], s32 offen offset:1024
    buffer_load_dwordx4 a[216:219], v2, s[8:11], s32 offen offset:2048
    buffer_load_dwordx4 a[220:223], v2, s[8:11], s32 offen offset:3072
    s_add_u32 s32, s32, 4096
    buffer_load_dwordx4 a[224:227], v2, s[8:11], s32 offen offset:0
    buffer_load_dwordx4 a[228:231], v2, s[8:11], s32 offen offset:1024
    buffer_load_dwordx4 a[232:235], v2, s[8:11], s32 offen offset:2048
    buffer_load_dwordx4 a[236:239], v2, s[8:11], s32 offen offset:3072
    s_add_u32 s32, s32, 4096
    buffer_load_dwordx4 a[240:243], v2, s[8:11], s32 offen offset:0
    buffer_load_dwordx4 a[244:247], v2, s[8:11], s32 offen offset:1024
    buffer_load_dwordx4 a[248:251], v2, s[8:11], s32 offen offset:2048
    buffer_load_dwordx4 a[252:255], v2, s[8:11], s32 offen offset:3072
    s_add_u32 s32, s32, 4096
    buffer_load_dwordx4 v[64:67], v2, s[8:11], s32 offen offset:0
    buffer_load_dwordx4 v[68:71], v2, s[8:11], s32 offen offset:1024
    buffer_load_dwordx4 v[72:75], v2, s[8:11], s32 offen offset:2048
    buffer_load_dwordx4 v[76:79], v2, s[8:11], s32 offen offset:3072
    s_add_u32 s32, s32, 4096
    buffer_load_dwordx4 v[80:83], v2, s[8:11], s32 offen offset:0
    buffer_load_dwordx4 v[84:87], v2, s[8:11], s32 offen offset:1024
    buffer_load_dwordx4 v[88:91], v2, s[8:11], s32 offen offset:2048
    buffer_load_dwordx4 v[92:95], v2, s[8:11], s32 offen offset:3072
    s_add_u32 s32, s32, 4096
    buffer_load_dwordx4 v[96:99], v2, s[8:11], s32 offen offset:0
    buffer_load_dwordx4 v[100:103], v2, s[8:11], s32 offen offset:1024
    buffer_load_dwordx4 v[104:107], v2, s[8:11], s32 offen offset:2048
    buffer_load_dwordx4 v[108:111], v2, s[8:11], s32 offen offset:3072
    s_add_u32 s32, s32, 4096
    buffer_load_dwordx4 v[112:115], v2, s[8:11], s32 offen offset:0
    buffer_load_dwordx4 v[116:119], v2, s[8:11], s32 offen offset:1024
    buffer_load_dwordx4 v[120:123], v2, s[8:11], s32 offen offset:2048
    buffer_load_dwordx4 v[124:127], v2, s[8:11], s32 offen offset:3072
    s_add_u32 s32, s32, 4096
    buffer_load_dwordx4 v[128:131], v2, s[8:11], s32 offen offset:0
    buffer_load_dwordx4 v[132:135], v2, s[8:11], s32 offen offset:1024
    buffer_load_dwordx4 v[136:139], v2, s[8:11], s32 offen offset:2048
    buffer_load_dwordx4 v[140:143], v2, s[8:11], s32 offen offset:3072
    s_add_u32 s32, s32, 4096
    buffer_load_dwordx4 v[144:147], v2, s[8:11], s32 offen offset:0
    buffer_load_dwordx4 v[148:151], v2, s[8:11], s32 offen offset:1024
    buffer_load_dwordx4 v[152:155], v2, s[8:11], s32 offen offset:2048
    buffer_load_dwordx4 v[156:159], v2, s[8:11], s32 offen offset:3072
    s_add_u32 s32, s32, 4096
    buffer_load_dwordx4 v[160:163], v2, s[8:11], s32 offen offset:0
    buffer_load_dwordx4 v[164:167], v2, s[8:11], s32 offen offset:1024
    buffer_load_dwordx4 v[168:171], v2, s[8:11], s32 offen offset:2048
    buffer_load_dwordx4 v[172:175], v2, s[8:11], s32 offen offset:3072
    s_add_u32 s32, s32, 4096
    buffer_load_dwordx4 v[176:179], v2, s[8:11], s32 offen offset:0
    buffer_load_dwordx4 v[180:183], v2, s[8:11], s32 offen offset:1024
    buffer_load_dwordx4 v[184:187], v2, s[8:11], s32 offen offset:2048
    buffer_load_dwordx4 v[188:191], v2, s[8:11], s32 offen offset:3072
    s_add_u32 s32, s32, 4096
    buffer_load_dwordx4 v[192:195], v2, s[8:11], s32 offen offset:0
    buffer_load_dwordx4 v[196:199], v2, s[8:11], s32 offen offset:1024
    buffer_load_dwordx4 v[200:203], v2, s[8:11], s32 offen offset:2048
    buffer_load_dwordx4 v[204:207], v2, s[8:11], s32 offen offset:3072
    s_add_u32 s32, s32, 4096
    buffer_load_dwordx4 v[208:211], v2, s[8:11], s32 offen offset:0
    buffer_load_dwordx4 v[212:215], v2, s[8:11], s32 offen offset:1024
    buffer_load_dwordx4 v[216:219], v2, s[8:11], s32 offen offset:2048
    buffer_load_dwordx4 v[220:223], v2, s[8:11], s32 offen offset:3072
    s_add_u32 s32, s32, 4096
    buffer_load_dwordx4 v[224:227], v2, s[8:11], s32 offen offset:0
    buffer_load_dwordx4 v[228:231], v2, s[8:11], s32 offen offset:1024
    buffer_load_dwordx4 v[232:235], v2, s[8:11], s32 offen offset:2048
    buffer_load_dwordx4 v[236:239], v2, s[8:11], s32 offen offset:3072
    s_add_u32 s32, s32, 4096
    buffer_load_dwordx4 v[240:243], v2, s[8:11], s32 offen offset:0
    buffer_load_dwordx4 v[244:247], v2, s[8:11], s32 offen offset:1024
    buffer_load_dwordx4 v[248:251], v2, s[8:11], s32 offen offset:2048
    buffer_load_dwordx4 v[252:255], v2, s[8:11], s32 offen offset:3072
    s_add_u32 s32, s32, 4096
    s_mov_b32 s46, 0
    v_min_u32 v60, 63, v1
    v_mul_u32_u24 v60, 128, v60
    s_lshl_b32 s3, s46, 7
    s_add_u32 s3, s3, 46833664
    s_mov_b32 s47, 200000
L_vb_na0_any:
    buffer_load_dwordx2 v[62:63], v60, s[8:11], s3 offen sc1
    s_waitcnt vmcnt(0)
    v_xor_b32 v62, s96, v62
    v_xor_b32 v63, s97, v63
    v_or_b32 v62, v62, v63
    v_cmp_ne_u32 vcc, 0, v62
    s_cbranch_vccz L_vb_na0_ok_any
    s_sub_u32 s47, s47, 1
    s_cbranch_scc0 L_vb_na0_any
    s_branch L_fail
L_vb_na0_ok_any:
    s_mov_b32 s46, 64
    v_min_u32 v60, 63, v1
    v_mul_u32_u24 v60, 128, v60
    s_lshl_b32 s3, s46, 7
    s_add_u32 s3, s3, 46833664
    s_mov_b32 s47, 200000
L_vb_na1_any:
    buffer_load_dwordx2 v[62:63], v60, s[8:11], s3 offen sc1
    s_waitcnt vmcnt(0)
    v_xor_b32 v62, s96, v62
    v_xor_b32 v63, s97, v63
    v_or_b32 v62, v62, v63
    v_cmp_ne_u32 vcc, 0, v62
    s_cbranch_vccz L_vb_na1_ok_any
    s_sub_u32 s47, s47, 1
    s_cbranch_scc0 L_vb_na1_any
    s_branch L_fail
L_vb_na1_ok_any:
    s_mov_b32 s46, 128
    v_min_u32 v60, 63, v1
    v_mul_u32_u24 v60, 128, v60
    s_lshl_b32 s3, s46, 7
    s_add_u32 s3, s3, 46833664
    s_mov_b32 s47, 200000
L_vb_na2_any:
    buffer_load_dwordx2 v[62:63], v60, s[8:11], s3 offen sc1
    s_waitcnt vmcnt(0)
    v_xor_b32 v62, s96, v62
    v_xor_b32 v63, s97, v63
    v_or_b32 v62, v62, v63
    v_cmp_ne_u32 vcc, 0, v62
    s_cbranch_vccz L_vb_na2_ok_any
    s_sub_u32 s47, s47, 1
    s_cbranch_scc0 L_vb_na2_any
    s_branch L_fail
L_vb_na2_ok_any:
    s_mov_b32 s46, 192
    v_min_u32 v60, 63, v1
    v_mul_u32_u24 v60, 128, v60
    s_lshl_b32 s3, s46, 7
    s_add_u32 s3, s3, 46833664
    s_mov_b32 s47, 200000
L_vb_na3_any:
    buffer_load_dwordx2 v[62:63], v60, s[8:11], s3 offen sc1
    s_waitcnt vmcnt(0)
    v_xor_b32 v62, s96, v62
    v_xor_b32 v63, s97, v63
    v_or_b32 v62, v62, v63
    v_cmp_ne_u32 vcc, 0, v62
    s_cbranch_vccz L_vb_na3_ok_any
    s_sub_u32 s47, s47, 1
    s_cbranch_scc0 L_vb_na3_any
    s_branch L_fail
L_vb_na3_ok_any:
    s_mov_b32 s46, 256
    v_min_u32 v60, 63, v1
    v_mul_u32_u24 v60, 128, v60
    s_lshl_b32 s3, s46, 7
    s_add_u32 s3, s3, 46833664
    s_mov_b32 s47, 200000
L_vb_na4_any:
    buffer_load_dwordx2 v[62:63], v60, s[8:11], s3 offen sc1
    s_waitcnt vmcnt(0)
    v_xor_b32 v62, s96, v62
    v_xor_b32 v63, s97, v63
    v_or_b32 v62, v62, v63
    v_cmp_ne_u32 vcc, 0, v62
    s_cbranch_vccz L_vb_na4_ok_any
    s_sub_u32 s47, s47, 1
    s_cbranch_scc0 L_vb_na4_any
    s_branch L_fail
L_vb_na4_ok_any:
    s_lshl_b32 s32, s21, 1
    s_add_u32 s32, s32, s20
    s_and_b32 s32, s32, 3
    s_add_u32 s32, s32, 4
    s_lshl_b32 s32, s32, 7
    v_min_u32 v4, 28, v1
    v_lshlrev_b32 v4, 2, v4
    v_add_u32 v6, s32, v4
    v_mov_b32 v6, v4
    s_mul_i32 s33, s38, 28672
    v_add_u32 v1, s33, v2
    s_lshl_b32 s34, s21, 13
    s_lshl_b32 s33, s38, 12
    s_add_u32 s34, s34, s33
    s_add_u32 s34, s34, 47023104
    v_mov_b32 v36, 0
    v_mov_b32 v37, 0
    v_mov_b32 v38, 0
    v_mov_b32 v39, 0
    v_mov_b32 v40, 0
    v_mov_b32 v41, 0
    v_mov_b32 v42, 0
    v_mov_b32 v43, 0
    v_mov_b32 v44, 0
    v_mov_b32 v45, 0
    v_mov_b32 v46, 0
    v_mov_b32 v47, 0
    v_mov_b32 v48, 0
    v_mov_b32 v49, 0
    v_mov_b32 v50, 0
    v_mov_b32 v51, 0
    v_mov_b32 v52, 0
    v_mov_b32 v53, 0
    v_mov_b32 v54, 0
    v_mov_b32 v55, 0
    s_lshl_b32 s35, s21, 10
    s_add_u32 s35, s35, 45547520
    v_mov_b32 v0, 0
    s_cmp_eq_u32 s20, 3
    s_cbranch_scc1 L_vb3_step_any
L_vb2_step_any:
    s_sleep 9
    v_mov_b32 v5, -1
    s_mov_b32 s31, 200000
L_vb2_probe_any:
    buffer_load_dword v5, v6, s[8:11], s25 offen offset:3072 sc1
    s_waitcnt vmcnt(2)
    v_cmp_eq_u32 vcc, -1, v5
    s_sub_u32 s31, s31, 1
    s_cbranch_scc1 L_fail
    s_cbranch_vccnz L_vb2_probe_any
    s_add_u32 s32, s30, 1
    v_mov_b32 v4, s32
    s_barrier
    buffer_load_dwordx4 v[8:11], v2, s[8:11], s24 offen offset:0 sc1
    buffer_load_dwordx4 v[12:15], v2, s[8:11], s24 offen offset:1024 sc1
    buffer_load_dwordx4 v[16:19], v2, s[8:11], s24 offen offset:2048 sc1
    buffer_load_dwordx4 v[20:23], v2, s[8:11], s24 offen offset:3072 sc1
    buffer_load_dwordx4 v[24:27], v2, s[8:11], s25 offen offset:0 sc1
    buffer_load_dwordx4 v[28:31], v2, s[8:11], s25 offen offset:1024 sc1
    buffer_load_dwordx4 v[32:35], v2, s[8:11], s25 offen offset:2048 sc1
    s_waitcnt vmcnt(6)
    .p2align 3
    v_smfmac_f32_16x16x64_bf16 v[36:39], v[8:11], a[0:7], v3
    ds_write_b128 v2, v[8:11] offset:0
    v_smfmac_f32_16x16x64_bf16 v[40:43], v[8:11], a[56:63], v3
    s_waitcnt vmcnt(5)
    s_mov_b32 s44, 0
    v_smfmac_f32_16x16x64_bf16 v[36:39], v[12:15], a[8:15], v3
    ds_write_b128 v2, v[12:15] offset:1024
    v_smfmac_f32_16x16x64_bf16 v[40:43], v[12:15], a[64:71], v3
    s_waitcnt vmcnt(4)
    s_mov_b32 s44, 0
    v_smfmac_f32_16x16x64_bf16 v[36:39], v[16:19], a[16:23], v3
    ds_write_b128 v2, v[16:19] offset:2048
    v_smfmac_f32_16x16x64_bf16 v[40:43], v[16:19], a[72:79], v3
    s_waitcnt vmcnt(3)
    s_mov_b32 s44, 0
    v_smfmac_f32_16x16x64_bf16 v[36:39], v[20:23], a[24:31], v3
    ds_write_b128 v2, v[20:23] offset:3072
    v_smfmac_f32_16x16x64_bf16 v[40:43], v[20:23], a[80:87], v3
    s_waitcnt vmcnt(2)
    ds_write_b32 v0, v4 offset:16384
    s_mov_b32 s44, 0
    v_smfmac_f32_16x16x64_bf16 v[36:39], v[24:27], a[32:39], v3
    v_smfmac_f32_16x16x64_bf16 v[40:43], v[24:27], a[88:95], v3
    s_waitcnt vmcnt(1)
    s_mov_b32 s44, 0
    v_smfmac_f32_16x16x64_bf16 v[36:39], v[28:31], a[40:47], v3
    v_smfmac_f32_16x16x64_bf16 v[40:43], v[28:31], a[96:103], v3
    s_waitcnt vmcnt(0)
    s_mov_b32 s44, 0
    v_smfmac_f32_16x16x64_bf16 v[36:39], v[32:35], a[48:55], v3
    ds_read_b128 v[56:59], v1 offset:38912
    ds_read_b128 v[60:63], v1 offset:39936
    v_smfmac_f32_16x16x64_bf16 v[40:43], v[32:35], a[104:111], v3
    v_smfmac_f32_16x16x64_bf16 v[44:47], v[8:11], a[112:119], v3
    v_smfmac_f32_16x16x64_bf16 v[44:47], v[12:15], a[120:127], v3
    v_add_f32_e64 v36, v36, v38
    v_smfmac_f32_16x16x64_bf16 v[44:47], v[16:19], a[128:135], v3
    v_add_f32_e64 v37, v37, v39
    v_smfmac_f32_16x16x64_bf16 v[44:47], v[20:23], a[136:143], v3
    s_waitcnt lgkmcnt(0)
    v_cmp_u_f32 vcc, v36, v37
    v_smfmac_f32_16x16x64_bf16 v[48:51], v[8:11], v[56:63], v3
    ds_read_b128 v[56:59], v1 offset:40960
    ds_read_b128 v[60:63], v1 offset:41984
    v_cvt_pk_bf16_f32 v4, v36, v37
    v_smfmac_f32_16x16x64_bf16 v[44:47], v[24:27], a[144:151], v3
    ds_write_b32 v7, v4 offset:2048
    v_mov_b64_e64 v[38:39], 0
    v_smfmac_f32_16x16x64_bf16 v[44:47], v[28:31], a[152:159], v3
    s_cbranch_vccnz L_vb2_nan_any
    v_mov_b64 v[36:37], 0
    v_smfmac_f32_16x16x64_bf16 v[44:47], v[32:35], a[160:167], v3
    v_add_f32_e64 v40, v40, v42
    v_smfmac_f32_16x16x64_bf16 v[52:55], v[8:11], a[168:175], v3
    v_add_f32_e64 v41, v41, v43
    v_smfmac_f32_16x16x64_bf16 v[52:55], v[12:15], a[176:183], v3
    v_cvt_pk_bf16_f32 v5, v40, v41
    v_smfmac_f32_16x16x64_bf16 v[52:55], v[16:19], a[184:191], v3
    s_waitcnt lgkmcnt(0)
    ds_write_b32 v7, v5 offset:2052
    v_mov_b64 v[42:43], 0
    v_smfmac_f32_16x16x64_bf16 v[48:51], v[12:15], v[56:63], v3
    ds_read_b128 v[56:59], v1 offset:43008
    ds_read_b128 v[60:63], v1 offset:44032
    v_mov_b64_e64 v[40:41], 0
    v_smfmac_f32_16x16x64_bf16 v[52:55], v[20:23], a[192:199], v3
    v_add_f32_e64 v44, v44, v46
    v_smfmac_f32_16x16x64_bf16 v[52:55], v[24:27], a[200:207], v3
    v_add_f32_e64 v45, v45, v47
    v_smfmac_f32_16x16x64_bf16 v[52:55], v[28:31], a[208:215], v3
    v_cvt_pk_bf16_f32 v4, v44, v45
    v_smfmac_f32_16x16x64_bf16 v[52:55], v[32:35], a[216:223], v3
    ds_write_b32 v7, v4 offset:2056
    v_mov_b64_e64 v[46:47], 0
    v_smfmac_f32_16x16x64_bf16 v[36:39], v[8:11], a[224:231], v3
    v_mov_b64_e64 v[44:45], 0
    v_smfmac_f32_16x16x64_bf16 v[36:39], v[12:15], a[232:239], v3
    s_waitcnt lgkmcnt(0)
    s_mov_b32 s44, 0
    v_smfmac_f32_16x16x64_bf16 v[48:51], v[16:19], v[56:63], v3
    ds_read_b128 v[56:59], v1 offset:45056
    ds_read_b128 v[60:63], v1 offset:46080
    v_add_f32_e64 v52, v52, v54
    v_smfmac_f32_16x16x64_bf16 v[36:39], v[16:19], a[240:247], v3
    v_add_f32_e64 v53, v53, v55
    v_smfmac_f32_16x16x64_bf16 v[36:39], v[20:23], a[248:255], v3
    v_cvt_pk_bf16_f32 v5, v52, v53
    v_smfmac_f32_16x16x64_bf16 v[36:39], v[24:27], v[64:71], v3
    ds_write_b32 v7, v5 offset:2060
    v_mov_b64_e64 v[54:55], 0
    v_smfmac_f32_16x16x64_bf16 v[36:39], v[28:31], v[72:79], v3
    v_mov_b64_e64 v[52:53], 0
    v_smfmac_f32_16x16x64_bf16 v[36:39], v[32:35], v[80:87], v3
    v_smfmac_f32_16x16x64_bf16 v[40:43], v[8:11], v[88:95], v3
    s_waitcnt lgkmcnt(0)
    s_mov_b32 s44, 0
    v_smfmac_f32_16x16x64_bf16 v[48:51], v[20:23], v[56:63], v3
    ds_read_b128 v[56:59], v1 offset:47104
    ds_read_b128 v[60:63], v1 offset:48128
    v_smfmac_f32_16x16x64_bf16 v[40:43], v[12:15], v[96:103], v3
    v_add_f32_e64 v36, v36, v38
    v_smfmac_f32_16x16x64_bf16 v[40:43], v[16:19], v[104:111], v3
    v_add_f32_e64 v37, v37, v39
    v_smfmac_f32_16x16x64_bf16 v[40:43], v[20:23], v[112:119], v3
    v_cvt_pk_bf16_f32 v4, v36, v37
    v_smfmac_f32_16x16x64_bf16 v[40:43], v[24:27], v[120:127], v3
    ds_write_b32 v7, v4 offset:3072
    v_mov_b64_e64 v[38:39], 0
    v_smfmac_f32_16x16x64_bf16 v[40:43], v[28:31], v[128:135], v3
    v_mov_b64_e64 v[36:37], 0
    v_smfmac_f32_16x16x64_bf16 v[40:43], v[32:35], v[136:143], v3
    s_waitcnt lgkmcnt(0)
    s_mov_b32 s44, 0
    v_smfmac_f32_16x16x64_bf16 v[48:51], v[24:27], v[56:63], v3
    ds_read_b128 v[56:59], v1 offset:49152
    ds_read_b128 v[60:63], v1 offset:50176
    v_smfmac_f32_16x16x64_bf16 v[44:47], v[8:11], v[144:151], v3
    v_smfmac_f32_16x16x64_bf16 v[44:47], v[12:15], v[152:159], v3
    v_add_f32_e64 v40, v40, v42
    v_smfmac_f32_16x16x64_bf16 v[44:47], v[16:19], v[160:167], v3
    v_add_f32_e64 v41, v41, v43
    v_smfmac_f32_16x16x64_bf16 v[44:47], v[20:23], v[168:175], v3
    v_cvt_pk_bf16_f32 v5, v40, v41
    v_smfmac_f32_16x16x64_bf16 v[44:47], v[24:27], v[176:183], v3
    ds_write_b32 v7, v5 offset:3076
    v_mov_b64_e64 v[42:43], 0
    v_smfmac_f32_16x16x64_bf16 v[44:47], v[28:31], v[184:191], v3
    s_waitcnt lgkmcnt(0)
    v_mov_b64 v[40:41], 0
    v_smfmac_f32_16x16x64_bf16 v[48:51], v[28:31], v[56:63], v3
    ds_read_b128 v[56:59], v1 offset:51200
    ds_read_b128 v[60:63], v1 offset:52224
    v_smfmac_f32_16x16x64_bf16 v[44:47], v[32:35], v[192:199], v3
    v_smfmac_f32_16x16x64_bf16 v[52:55], v[8:11], v[200:207], v3
    v_smfmac_f32_16x16x64_bf16 v[52:55], v[12:15], v[208:215], v3
    v_smfmac_f32_16x16x64_bf16 v[52:55], v[16:19], v[216:223], v3
    v_add_f32_e64 v44, v44, v46
    v_smfmac_f32_16x16x64_bf16 v[52:55], v[20:23], v[224:231], v3
    v_add_f32_e64 v45, v45, v47
    v_smfmac_f32_16x16x64_bf16 v[52:55], v[24:27], v[232:239], v3
    s_waitcnt lgkmcnt(0)
    s_mov_b32 s44, 0
    v_cvt_pk_bf16_f32 v4, v44, v45
    v_smfmac_f32_16x16x64_bf16 v[48:51], v[32:35], v[56:63], v3
    ds_write_b32 v7, v4 offset:3080
    v_mov_b64_e64 v[46:47], 0
    v_smfmac_f32_16x16x64_bf16 v[52:55], v[28:31], v[240:247], v3
    v_mov_b64_e64 v[44:45], 0
    v_smfmac_f32_16x16x64_bf16 v[52:55], v[32:35], v[248:255], v3
L_vb2_y_any:
    s_nop 7
    v_add_f32 v48, v48, v50
    v_add_f32 v49, v49, v51
    v_cvt_pk_bf16_f32 v5, v48, v49
    ds_write_b32 v7, v5 offset:1036
    v_mov_b64 v[50:51], 0
    v_mov_b64 v[48:49], 0
    v_add_f32 v52, v52, v54
    v_add_f32 v53, v53, v55
    v_cvt_pk_bf16_f32 v5, v52, v53
    ds_write_b32 v7, v5 offset:3084
    v_mov_b64 v[54:55], 0
    v_mov_b64 v[52:53], 0
    s_waitcnt lgkmcnt(0)
    s_barrier
    s_add_u32 s24, s24, 8192
    s_add_u32 s25, s25, 8192
    s_add_u32 s30, s30, 1
    s_cmp_le_u32 s30, 63
    s_cbranch_scc1 L_vb2_step_any
    s_branch L_done
L_vb2_nan_any:
    s_mov_b32 s31, 0
    s_waitcnt lgkmcnt(0)
L_vb2_nan_l_any:
    buffer_load_dwordx4 v[8:11], v2, s[8:11], s24 offen offset:0 sc1
    buffer_load_dwordx4 v[12:15], v2, s[8:11], s24 offen offset:1024 sc1
    buffer_load_dwordx4 v[16:19], v2, s[8:11], s24 offen offset:2048 sc1
    buffer_load_dwordx4 v[20:23], v2, s[8:11], s24 offen offset:3072 sc1
    buffer_load_dwordx4 v[24:27], v2, s[8:11], s25 offen offset:0 sc1
    buffer_load_dwordx4 v[28:31], v2, s[8:11], s25 offen offset:1024 sc1
    buffer_load_dwordx4 v[32:35], v2, s[8:11], s25 offen offset:2048 sc1
    s_waitcnt vmcnt(0)
    v_max3_u32 v4, v8, v9, v10
    v_max3_u32 v4, v4, v11, v12
    v_max3_u32 v4, v4, v13, v14
    v_max3_u32 v4, v4, v15, v16
    v_max3_u32 v4, v4, v17, v18
    v_max3_u32 v4, v4, v19, v20
    v_max3_u32 v4, v4, v21, v22
    v_max3_u32 v4, v4, v23, v24
    v_max3_u32 v4, v4, v25, v26
    v_max3_u32 v4, v4, v27, v28
    v_max3_u32 v4, v4, v29, v30
    v_max3_u32 v4, v4, v31, v32
    v_max3_u32 v4, v4, v33, v34
    v_max_u32 v4, v4, v35
    v_cmp_eq_u32 vcc, -1, v4
    s_cbranch_vccz L_vb2_nan_go_any
    s_add_u32 s31, s31, 1
    s_cmp_lt_u32 s31, 200000
    s_cbranch_scc1 L_vb2_nan_l_any
    s_branch L_fail
L_vb2_nan_go_any:
    v_mov_b64 v[36:37], 0
    v_mov_b64 v[38:39], 0
    v_mov_b64 v[40:41], 0
    v_mov_b64 v[42:43], 0
    v_mov_b64 v[44:45], 0
    v_mov_b64 v[46:47], 0
    v_mov_b64 v[48:49], 0
    v_mov_b64 v[50:51], 0
    v_mov_b64 v[52:53], 0
    v_mov_b64 v[54:55], 0
    s_nop 1
    v_smfmac_f32_16x16x64_bf16 v[36:39], v[8:11], a[0:7], v3
    v_smfmac_f32_16x16x64_bf16 v[40:43], v[8:11], a[56:63], v3
    v_smfmac_f32_16x16x64_bf16 v[36:39], v[12:15], a[8:15], v3
    v_smfmac_f32_16x16x64_bf16 v[40:43], v[12:15], a[64:71], v3
    v_smfmac_f32_16x16x64_bf16 v[36:39], v[16:19], a[16:23], v3
    v_smfmac_f32_16x16x64_bf16 v[40:43], v[16:19], a[72:79], v3
    v_smfmac_f32_16x16x64_bf16 v[36:39], v[20:23], a[24:31], v3
    v_smfmac_f32_16x16x64_bf16 v[40:43], v[20:23], a[80:87], v3
    v_smfmac_f32_16x16x64_bf16 v[36:39], v[24:27], a[32:39], v3
    v_smfmac_f32_16x16x64_bf16 v[40:43], v[24:27], a[88:95], v3
    v_smfmac_f32_16x16x64_bf16 v[36:39], v[28:31], a[40:47], v3
    v_smfmac_f32_16x16x64_bf16 v[40:43], v[28:31], a[96:103], v3
    v_smfmac_f32_16x16x64_bf16 v[36:39], v[32:35], a[48:55], v3
    ds_read_b128 v[56:59], v1 offset:38912
    ds_read_b128 v[60:63], v1 offset:39936
    v_smfmac_f32_16x16x64_bf16 v[40:43], v[32:35], a[104:111], v3
    v_smfmac_f32_16x16x64_bf16 v[44:47], v[8:11], a[112:119], v3
    v_smfmac_f32_16x16x64_bf16 v[44:47], v[12:15], a[120:127], v3
    v_add_f32_e64 v36, v36, v38
    v_smfmac_f32_16x16x64_bf16 v[44:47], v[16:19], a[128:135], v3
    v_add_f32_e64 v37, v37, v39
    v_smfmac_f32_16x16x64_bf16 v[44:47], v[20:23], a[136:143], v3
    s_waitcnt lgkmcnt(0)
    s_mov_b32 s44, 0
    v_cvt_pk_bf16_f32 v4, v36, v37
    v_smfmac_f32_16x16x64_bf16 v[48:51], v[8:11], v[56:63], v3
    ds_read_b128 v[56:59], v1 offset:40960
    ds_read_b128 v[60:63], v1 offset:41984
    ds_write_b32 v7, v4 offset:2048
    v_mov_b64_e64 v[38:39], 0
    v_smfmac_f32_16x16x64_bf16 v[44:47], v[24:27], a[144:151], v3
    v_mov_b64_e64 v[36:37], 0
    v_smfmac_f32_16x16x64_bf16 v[44:47], v[28:31], a[152:159], v3
    v_add_f32_e64 v40, v40, v42
    v_smfmac_f32_16x16x64_bf16 v[44:47], v[32:35], a[160:167], v3
    v_add_f32_e64 v41, v41, v43
    v_smfmac_f32_16x16x64_bf16 v[52:55], v[8:11], a[168:175], v3
    v_cvt_pk_bf16_f32 v5, v40, v41
    v_smfmac_f32_16x16x64_bf16 v[52:55], v[12:15], a[176:183], v3
    ds_write_b32 v7, v5 offset:2052
    v_mov_b64_e64 v[42:43], 0
    v_smfmac_f32_16x16x64_bf16 v[52:55], v[16:19], a[184:191], v3
    s_waitcnt lgkmcnt(0)
    v_mov_b64 v[40:41], 0
    v_smfmac_f32_16x16x64_bf16 v[48:51], v[12:15], v[56:63], v3
    ds_read_b128 v[56:59], v1 offset:43008
    ds_read_b128 v[60:63], v1 offset:44032
    v_add_f32_e64 v44, v44, v46
    v_smfmac_f32_16x16x64_bf16 v[52:55], v[20:23], a[192:199], v3
    v_add_f32_e64 v45, v45, v47
    v_smfmac_f32_16x16x64_bf16 v[52:55], v[24:27], a[200:207], v3
    v_cvt_pk_bf16_f32 v4, v44, v45
    v_smfmac_f32_16x16x64_bf16 v[52:55], v[28:31], a[208:215], v3
    ds_write_b32 v7, v4 offset:2056
    v_mov_b64_e64 v[46:47], 0
    v_smfmac_f32_16x16x64_bf16 v[52:55], v[32:35], a[216:223], v3
    v_mov_b64_e64 v[44:45], 0
    v_smfmac_f32_16x16x64_bf16 v[36:39], v[8:11], a[224:231], v3
    v_smfmac_f32_16x16x64_bf16 v[36:39], v[12:15], a[232:239], v3
    s_waitcnt lgkmcnt(0)
    s_mov_b32 s44, 0
    v_smfmac_f32_16x16x64_bf16 v[48:51], v[16:19], v[56:63], v3
    ds_read_b128 v[56:59], v1 offset:45056
    ds_read_b128 v[60:63], v1 offset:46080
    v_add_f32_e64 v52, v52, v54
    v_smfmac_f32_16x16x64_bf16 v[36:39], v[16:19], a[240:247], v3
    v_add_f32_e64 v53, v53, v55
    v_smfmac_f32_16x16x64_bf16 v[36:39], v[20:23], a[248:255], v3
    v_cvt_pk_bf16_f32 v5, v52, v53
    v_smfmac_f32_16x16x64_bf16 v[36:39], v[24:27], v[64:71], v3
    ds_write_b32 v7, v5 offset:2060
    v_mov_b64_e64 v[54:55], 0
    v_smfmac_f32_16x16x64_bf16 v[36:39], v[28:31], v[72:79], v3
    v_mov_b64_e64 v[52:53], 0
    v_smfmac_f32_16x16x64_bf16 v[36:39], v[32:35], v[80:87], v3
    v_smfmac_f32_16x16x64_bf16 v[40:43], v[8:11], v[88:95], v3
    s_waitcnt lgkmcnt(0)
    s_mov_b32 s44, 0
    v_smfmac_f32_16x16x64_bf16 v[48:51], v[20:23], v[56:63], v3
    ds_read_b128 v[56:59], v1 offset:47104
    ds_read_b128 v[60:63], v1 offset:48128
    v_smfmac_f32_16x16x64_bf16 v[40:43], v[12:15], v[96:103], v3
    v_add_f32_e64 v36, v36, v38
    v_smfmac_f32_16x16x64_bf16 v[40:43], v[16:19], v[104:111], v3
    v_add_f32_e64 v37, v37, v39
    v_smfmac_f32_16x16x64_bf16 v[40:43], v[20:23], v[112:119], v3
    v_cvt_pk_bf16_f32 v4, v36, v37
    v_smfmac_f32_16x16x64_bf16 v[40:43], v[24:27], v[120:127], v3
    ds_write_b32 v7, v4 offset:3072
    v_mov_b64_e64 v[38:39], 0
    v_smfmac_f32_16x16x64_bf16 v[40:43], v[28:31], v[128:135], v3
    v_mov_b64_e64 v[36:37], 0
    v_smfmac_f32_16x16x64_bf16 v[40:43], v[32:35], v[136:143], v3
    s_waitcnt lgkmcnt(0)
    s_mov_b32 s44, 0
    v_smfmac_f32_16x16x64_bf16 v[48:51], v[24:27], v[56:63], v3
    ds_read_b128 v[56:59], v1 offset:49152
    ds_read_b128 v[60:63], v1 offset:50176
    v_smfmac_f32_16x16x64_bf16 v[44:47], v[8:11], v[144:151], v3
    v_smfmac_f32_16x16x64_bf16 v[44:47], v[12:15], v[152:159], v3
    v_add_f32_e64 v40, v40, v42
    v_smfmac_f32_16x16x64_bf16 v[44:47], v[16:19], v[160:167], v3
    v_add_f32_e64 v41, v41, v43
    v_smfmac_f32_16x16x64_bf16 v[44:47], v[20:23], v[168:175], v3
    v_cvt_pk_bf16_f32 v5, v40, v41
    v_smfmac_f32_16x16x64_bf16 v[44:47], v[24:27], v[176:183], v3
    ds_write_b32 v7, v5 offset:3076
    v_mov_b64_e64 v[42:43], 0
    v_smfmac_f32_16x16x64_bf16 v[44:47], v[28:31], v[184:191], v3
    s_waitcnt lgkmcnt(0)
    v_mov_b64 v[40:41], 0
    v_smfmac_f32_16x16x64_bf16 v[48:51], v[28:31], v[56:63], v3
    ds_read_b128 v[56:59], v1 offset:51200
    ds_read_b128 v[60:63], v1 offset:52224
    v_smfmac_f32_16x16x64_bf16 v[44:47], v[32:35], v[192:199], v3
    v_smfmac_f32_16x16x64_bf16 v[52:55], v[8:11], v[200:207], v3
    v_smfmac_f32_16x16x64_bf16 v[52:55], v[12:15], v[208:215], v3
    v_smfmac_f32_16x16x64_bf16 v[52:55], v[16:19], v[216:223], v3
    v_add_f32_e64 v44, v44, v46
    v_smfmac_f32_16x16x64_bf16 v[52:55], v[20:23], v[224:231], v3
    v_add_f32_e64 v45, v45, v47
    v_smfmac_f32_16x16x64_bf16 v[52:55], v[24:27], v[232:239], v3
    s_waitcnt lgkmcnt(0)
    s_mov_b32 s44, 0
    v_cvt_pk_bf16_f32 v4, v44, v45
    v_smfmac_f32_16x16x64_bf16 v[48:51], v[32:35], v[56:63], v3
    ds_write_b32 v7, v4 offset:3080
    v_mov_b64_e64 v[46:47], 0
    v_smfmac_f32_16x16x64_bf16 v[52:55], v[28:31], v[240:247], v3
    v_mov_b64_e64 v[44:45], 0
    v_smfmac_f32_16x16x64_bf16 v[52:55], v[32:35], v[248:255], v3
    s_branch L_vb2_y_any
L_vb3_step_any:
    s_sleep 9
    v_mov_b32 v5, -1
    s_mov_b32 s31, 200000
L_vb3_probe_any:
    buffer_load_dword v5, v6, s[8:11], s25 offen offset:3072 sc1
    s_waitcnt vmcnt(2)
    v_cmp_eq_u32 vcc, -1, v5
    s_sub_u32 s31, s31, 1
    s_cbranch_scc1 L_fail
    s_cbranch_vccnz L_vb3_probe_any
    s_add_u32 s32, s30, 1
    v_mov_b32 v4, s32
    s_barrier
    buffer_load_dwordx4 v[24:27], v2, s[8:11], s25 offen offset:0 sc1
    buffer_load_dwordx4 v[28:31], v2, s[8:11], s25 offen offset:1024 sc1
    buffer_load_dwordx4 v[32:35], v2, s[8:11], s25 offen offset:2048 sc1
    buffer_load_dwordx4 v[8:11], v2, s[8:11], s24 offen offset:0 sc1
    buffer_load_dwordx4 v[12:15], v2, s[8:11], s24 offen offset:1024 sc1
    buffer_load_dwordx4 v[16:19], v2, s[8:11], s24 offen offset:2048 sc1
    buffer_load_dwordx4 v[20:23], v2, s[8:11], s24 offen offset:3072 sc1
    s_waitcnt vmcnt(6)
    .p2align 3
    v_smfmac_f32_16x16x64_bf16 v[36:39], v[24:27], a[32:39], v3
    ds_write_b128 v2, v[24:27] offset:4096
    v_smfmac_f32_16x16x64_bf16 v[40:43], v[24:27], a[88:95], v3
    s_waitcnt vmcnt(5)
    s_mov_b32 s44, 0
    v_smfmac_f32_16x16x64_bf16 v[36:39], v[28:31], a[40:47], v3
    ds_write_b128 v2, v[28:31] offset:5120
    v_smfmac_f32_16x16x64_bf16 v[40:43], v[28:31], a[96:103], v3
    s_waitcnt vmcnt(4)
    s_mov_b32 s44, 0
    v_smfmac_f32_16x16x64_bf16 v[36:39], v[32:35], a[48:55], v3
    ds_write_b128 v2, v[32:35] offset:6144
    v_smfmac_f32_16x16x64_bf16 v[40:43], v[32:35], a[104:111], v3
    s_waitcnt vmcnt(3)
    ds_write_b32 v0, v4 offset:16388
    s_mov_b32 s44, 0
    v_smfmac_f32_16x16x64_bf16 v[36:39], v[8:11], a[0:7], v3
    v_smfmac_f32_16x16x64_bf16 v[40:43], v[8:11], a[56:63], v3
    s_waitcnt vmcnt(2)
    s_mov_b32 s44, 0
    v_smfmac_f32_16x16x64_bf16 v[36:39], v[12:15], a[8:15], v3
    v_smfmac_f32_16x16x64_bf16 v[40:43], v[12:15], a[64:71], v3
    s_waitcnt vmcnt(1)
    s_mov_b32 s44, 0
    v_smfmac_f32_16x16x64_bf16 v[36:39], v[16:19], a[16:23], v3
    v_smfmac_f32_16x16x64_bf16 v[40:43], v[16:19], a[72:79], v3
    s_waitcnt vmcnt(0)
    s_mov_b32 s44, 0
    v_smfmac_f32_16x16x64_bf16 v[36:39], v[20:23], a[24:31], v3
    ds_read_b128 v[56:59], v1 offset:38912
    ds_read_b128 v[60:63], v1 offset:39936
    v_smfmac_f32_16x16x64_bf16 v[40:43], v[20:23], a[80:87], v3
    v_smfmac_f32_16x16x64_bf16 v[44:47], v[8:11], a[112:119], v3
    v_smfmac_f32_16x16x64_bf16 v[44:47], v[12:15], a[120:127], v3
    v_add_f32_e64 v36, v36, v38
    v_smfmac_f32_16x16x64_bf16 v[44:47], v[16:19], a[128:135], v3
    v_add_f32_e64 v37, v37, v39
    v_smfmac_f32_16x16x64_bf16 v[44:47], v[20:23], a[136:143], v3
    s_waitcnt lgkmcnt(0)
    v_cmp_u_f32 vcc, v36, v37
    v_smfmac_f32_16x16x64_bf16 v[48:51], v[8:11], v[56:63], v3
    ds_read_b128 v[56:59], v1 offset:40960
    ds_read_b128 v[60:63], v1 offset:41984
    v_cvt_pk_bf16_f32 v4, v36, v37
    v_smfmac_f32_16x16x64_bf16 v[44:47], v[24:27], a[144:151], v3
    ds_write_b32 v7, v4 offset:2048
    v_mov_b64_e64 v[38:39], 0
    v_smfmac_f32_16x16x64_bf16 v[44:47], v[28:31], a[152:159], v3
    s_cbranch_vccnz L_vb3_nan_any
    v_mov_b64 v[36:37], 0
    v_smfmac_f32_16x16x64_bf16 v[44:47], v[32:35], a[160:167], v3
    v_add_f32_e64 v40, v40, v42
    v_smfmac_f32_16x16x64_bf16 v[52:55], v[8:11], a[168:175], v3
    v_add_f32_e64 v41, v41, v43
    v_smfmac_f32_16x16x64_bf16 v[52:55], v[12:15], a[176:183], v3
    v_cvt_pk_bf16_f32 v5, v40, v41
    v_smfmac_f32_16x16x64_bf16 v[52:55], v[16:19], a[184:191], v3
    s_waitcnt lgkmcnt(0)
    ds_write_b32 v7, v5 offset:2052
    v_mov_b64 v[42:43], 0
    v_smfmac_f32_16x16x64_bf16 v[48:51], v[12:15], v[56:63], v3
    ds_read_b128 v[56:59], v1 offset:43008
    ds_read_b128 v[60:63], v1 offset:44032
    v_mov_b64_e64 v[40:41], 0
    v_smfmac_f32_16x16x64_bf16 v[52:55], v[20:23], a[192:199], v3
    v_add_f32_e64 v44, v44, v46
    v_smfmac_f32_16x16x64_bf16 v[52:55], v[24:27], a[200:207], v3
    v_add_f32_e64 v45, v45, v47
    v_smfmac_f32_16x16x64_bf16 v[52:55], v[28:31], a[208:215], v3
    v_cvt_pk_bf16_f32 v4, v44, v45
    v_smfmac_f32_16x16x64_bf16 v[52:55], v[32:35], a[216:223], v3
    ds_write_b32 v7, v4 offset:2056
    v_mov_b64_e64 v[46:47], 0
    v_smfmac_f32_16x16x64_bf16 v[36:39], v[8:11], a[224:231], v3
    v_mov_b64_e64 v[44:45], 0
    v_smfmac_f32_16x16x64_bf16 v[36:39], v[12:15], a[232:239], v3
    s_waitcnt lgkmcnt(0)
    s_mov_b32 s44, 0
    v_smfmac_f32_16x16x64_bf16 v[48:51], v[16:19], v[56:63], v3
    ds_read_b128 v[56:59], v1 offset:45056
    ds_read_b128 v[60:63], v1 offset:46080
    v_add_f32_e64 v52, v52, v54
    v_smfmac_f32_16x16x64_bf16 v[36:39], v[16:19], a[240:247], v3
    v_add_f32_e64 v53, v53, v55
    v_smfmac_f32_16x16x64_bf16 v[36:39], v[20:23], a[248:255], v3
    v_cvt_pk_bf16_f32 v5, v52, v53
    v_smfmac_f32_16x16x64_bf16 v[36:39], v[24:27], v[64:71], v3
    ds_write_b32 v7, v5 offset:2060
    v_mov_b64_e64 v[54:55], 0
    v_smfmac_f32_16x16x64_bf16 v[36:39], v[28:31], v[72:79], v3
    v_mov_b64_e64 v[52:53], 0
    v_smfmac_f32_16x16x64_bf16 v[36:39], v[32:35], v[80:87], v3
    v_smfmac_f32_16x16x64_bf16 v[40:43], v[8:11], v[88:95], v3
    s_waitcnt lgkmcnt(0)
    s_mov_b32 s44, 0
    v_smfmac_f32_16x16x64_bf16 v[48:51], v[20:23], v[56:63], v3
    ds_read_b128 v[56:59], v1 offset:47104
    ds_read_b128 v[60:63], v1 offset:48128
    v_smfmac_f32_16x16x64_bf16 v[40:43], v[12:15], v[96:103], v3
    v_add_f32_e64 v36, v36, v38
    v_smfmac_f32_16x16x64_bf16 v[40:43], v[16:19], v[104:111], v3
    v_add_f32_e64 v37, v37, v39
    v_smfmac_f32_16x16x64_bf16 v[40:43], v[20:23], v[112:119], v3
    v_cvt_pk_bf16_f32 v4, v36, v37
    v_smfmac_f32_16x16x64_bf16 v[40:43], v[24:27], v[120:127], v3
    ds_write_b32 v7, v4 offset:3072
    v_mov_b64_e64 v[38:39], 0
    v_smfmac_f32_16x16x64_bf16 v[40:43], v[28:31], v[128:135], v3
    v_mov_b64_e64 v[36:37], 0
    v_smfmac_f32_16x16x64_bf16 v[40:43], v[32:35], v[136:143], v3
    s_waitcnt lgkmcnt(0)
    s_mov_b32 s44, 0
    v_smfmac_f32_16x16x64_bf16 v[48:51], v[24:27], v[56:63], v3
    ds_read_b128 v[56:59], v1 offset:49152
    ds_read_b128 v[60:63], v1 offset:50176
    v_smfmac_f32_16x16x64_bf16 v[44:47], v[8:11], v[144:151], v3
    v_smfmac_f32_16x16x64_bf16 v[44:47], v[12:15], v[152:159], v3
    v_add_f32_e64 v40, v40, v42
    v_smfmac_f32_16x16x64_bf16 v[44:47], v[16:19], v[160:167], v3
    v_add_f32_e64 v41, v41, v43
    v_smfmac_f32_16x16x64_bf16 v[44:47], v[20:23], v[168:175], v3
    v_cvt_pk_bf16_f32 v5, v40, v41
    v_smfmac_f32_16x16x64_bf16 v[44:47], v[24:27], v[176:183], v3
    ds_write_b32 v7, v5 offset:3076
    v_mov_b64_e64 v[42:43], 0
    v_smfmac_f32_16x16x64_bf16 v[44:47], v[28:31], v[184:191], v3
    s_waitcnt lgkmcnt(0)
    v_mov_b64 v[40:41], 0
    v_smfmac_f32_16x16x64_bf16 v[48:51], v[28:31], v[56:63], v3
    ds_read_b128 v[56:59], v1 offset:51200
    ds_read_b128 v[60:63], v1 offset:52224
    v_smfmac_f32_16x16x64_bf16 v[44:47], v[32:35], v[192:199], v3
    v_smfmac_f32_16x16x64_bf16 v[52:55], v[8:11], v[200:207], v3
    v_smfmac_f32_16x16x64_bf16 v[52:55], v[12:15], v[208:215], v3
    v_smfmac_f32_16x16x64_bf16 v[52:55], v[16:19], v[216:223], v3
    v_add_f32_e64 v44, v44, v46
    v_smfmac_f32_16x16x64_bf16 v[52:55], v[20:23], v[224:231], v3
    v_add_f32_e64 v45, v45, v47
    v_smfmac_f32_16x16x64_bf16 v[52:55], v[24:27], v[232:239], v3
    s_waitcnt lgkmcnt(0)
    s_mov_b32 s44, 0
    v_cvt_pk_bf16_f32 v4, v44, v45
    v_smfmac_f32_16x16x64_bf16 v[48:51], v[32:35], v[56:63], v3
    ds_write_b32 v7, v4 offset:3080
    v_mov_b64_e64 v[46:47], 0
    v_smfmac_f32_16x16x64_bf16 v[52:55], v[28:31], v[240:247], v3
    v_mov_b64_e64 v[44:45], 0
    v_smfmac_f32_16x16x64_bf16 v[52:55], v[32:35], v[248:255], v3
L_vb3_y_any:
    s_nop 7
    v_add_f32 v48, v48, v50
    v_add_f32 v49, v49, v51
    v_cvt_pk_bf16_f32 v5, v48, v49
    ds_write_b32 v7, v5 offset:1036
    v_mov_b64 v[50:51], 0
    v_mov_b64 v[48:49], 0
    v_add_f32 v52, v52, v54
    v_add_f32 v53, v53, v55
    v_cvt_pk_bf16_f32 v5, v52, v53
    ds_write_b32 v7, v5 offset:3084
    v_mov_b64 v[54:55], 0
    v_mov_b64 v[52:53], 0
    s_waitcnt lgkmcnt(0)
    s_barrier
    s_add_u32 s24, s24, 8192
    s_add_u32 s25, s25, 8192
    s_add_u32 s30, s30, 1
    s_cmp_le_u32 s30, 63
    s_cbranch_scc1 L_vb3_step_any
    s_branch L_done
L_vb3_nan_any:
    s_mov_b32 s31, 0
    s_waitcnt lgkmcnt(0)
L_vb3_nan_l_any:
    buffer_load_dwordx4 v[8:11], v2, s[8:11], s24 offen offset:0 sc1
    buffer_load_dwordx4 v[12:15], v2, s[8:11], s24 offen offset:1024 sc1
    buffer_load_dwordx4 v[16:19], v2, s[8:11], s24 offen offset:2048 sc1
    buffer_load_dwordx4 v[20:23], v2, s[8:11], s24 offen offset:3072 sc1
    buffer_load_dwordx4 v[24:27], v2, s[8:11], s25 offen offset:0 sc1
    buffer_load_dwordx4 v[28:31], v2, s[8:11], s25 offen offset:1024 sc1
    buffer_load_dwordx4 v[32:35], v2, s[8:11], s25 offen offset:2048 sc1
    s_waitcnt vmcnt(0)
    v_max3_u32 v4, v8, v9, v10
    v_max3_u32 v4, v4, v11, v12
    v_max3_u32 v4, v4, v13, v14
    v_max3_u32 v4, v4, v15, v16
    v_max3_u32 v4, v4, v17, v18
    v_max3_u32 v4, v4, v19, v20
    v_max3_u32 v4, v4, v21, v22
    v_max3_u32 v4, v4, v23, v24
    v_max3_u32 v4, v4, v25, v26
    v_max3_u32 v4, v4, v27, v28
    v_max3_u32 v4, v4, v29, v30
    v_max3_u32 v4, v4, v31, v32
    v_max3_u32 v4, v4, v33, v34
    v_max_u32 v4, v4, v35
    v_cmp_eq_u32 vcc, -1, v4
    s_cbranch_vccz L_vb3_nan_go_any
    s_add_u32 s31, s31, 1
    s_cmp_lt_u32 s31, 200000
    s_cbranch_scc1 L_vb3_nan_l_any
    s_branch L_fail
L_vb3_nan_go_any:
    v_mov_b64 v[36:37], 0
    v_mov_b64 v[38:39], 0
    v_mov_b64 v[40:41], 0
    v_mov_b64 v[42:43], 0
    v_mov_b64 v[44:45], 0
    v_mov_b64 v[46:47], 0
    v_mov_b64 v[48:49], 0
    v_mov_b64 v[50:51], 0
    v_mov_b64 v[52:53], 0
    v_mov_b64 v[54:55], 0
    s_nop 1
    v_smfmac_f32_16x16x64_bf16 v[36:39], v[24:27], a[32:39], v3
    v_smfmac_f32_16x16x64_bf16 v[40:43], v[24:27], a[88:95], v3
    v_smfmac_f32_16x16x64_bf16 v[36:39], v[28:31], a[40:47], v3
    v_smfmac_f32_16x16x64_bf16 v[40:43], v[28:31], a[96:103], v3
    v_smfmac_f32_16x16x64_bf16 v[36:39], v[32:35], a[48:55], v3
    v_smfmac_f32_16x16x64_bf16 v[40:43], v[32:35], a[104:111], v3
    v_smfmac_f32_16x16x64_bf16 v[36:39], v[8:11], a[0:7], v3
    v_smfmac_f32_16x16x64_bf16 v[40:43], v[8:11], a[56:63], v3
    v_smfmac_f32_16x16x64_bf16 v[36:39], v[12:15], a[8:15], v3
    v_smfmac_f32_16x16x64_bf16 v[40:43], v[12:15], a[64:71], v3
    v_smfmac_f32_16x16x64_bf16 v[36:39], v[16:19], a[16:23], v3
    v_smfmac_f32_16x16x64_bf16 v[40:43], v[16:19], a[72:79], v3
    v_smfmac_f32_16x16x64_bf16 v[36:39], v[20:23], a[24:31], v3
    ds_read_b128 v[56:59], v1 offset:38912
    ds_read_b128 v[60:63], v1 offset:39936
    v_smfmac_f32_16x16x64_bf16 v[40:43], v[20:23], a[80:87], v3
    v_smfmac_f32_16x16x64_bf16 v[44:47], v[8:11], a[112:119], v3
    v_smfmac_f32_16x16x64_bf16 v[44:47], v[12:15], a[120:127], v3
    v_add_f32_e64 v36, v36, v38
    v_smfmac_f32_16x16x64_bf16 v[44:47], v[16:19], a[128:135], v3
    v_add_f32_e64 v37, v37, v39
    v_smfmac_f32_16x16x64_bf16 v[44:47], v[20:23], a[136:143], v3
    s_waitcnt lgkmcnt(0)
    s_mov_b32 s44, 0
    v_cvt_pk_bf16_f32 v4, v36, v37
    v_smfmac_f32_16x16x64_bf16 v[48:51], v[8:11], v[56:63], v3
    ds_read_b128 v[56:59], v1 offset:40960
    ds_read_b128 v[60:63], v1 offset:41984
    ds_write_b32 v7, v4 offset:2048
    v_mov_b64_e64 v[38:39], 0
    v_smfmac_f32_16x16x64_bf16 v[44:47], v[24:27], a[144:151], v3
    v_mov_b64_e64 v[36:37], 0
    v_smfmac_f32_16x16x64_bf16 v[44:47], v[28:31], a[152:159], v3
    v_add_f32_e64 v40, v40, v42
    v_smfmac_f32_16x16x64_bf16 v[44:47], v[32:35], a[160:167], v3
    v_add_f32_e64 v41, v41, v43
    v_smfmac_f32_16x16x64_bf16 v[52:55], v[8:11], a[168:175], v3
    v_cvt_pk_bf16_f32 v5, v40, v41
    v_smfmac_f32_16x16x64_bf16 v[52:55], v[12:15], a[176:183], v3
    ds_write_b32 v7, v5 offset:2052
    v_mov_b64_e64 v[42:43], 0
    v_smfmac_f32_16x16x64_bf16 v[52:55], v[16:19], a[184:191], v3
    s_waitcnt lgkmcnt(0)
    v_mov_b64 v[40:41], 0
    v_smfmac_f32_16x16x64_bf16 v[48:51], v[12:15], v[56:63], v3
    ds_read_b128 v[56:59], v1 offset:43008
    ds_read_b128 v[60:63], v1 offset:44032
    v_add_f32_e64 v44, v44, v46
    v_smfmac_f32_16x16x64_bf16 v[52:55], v[20:23], a[192:199], v3
    v_add_f32_e64 v45, v45, v47
    v_smfmac_f32_16x16x64_bf16 v[52:55], v[24:27], a[200:207], v3
    v_cvt_pk_bf16_f32 v4, v44, v45
    v_smfmac_f32_16x16x64_bf16 v[52:55], v[28:31], a[208:215], v3
    ds_write_b32 v7, v4 offset:2056
    v_mov_b64_e64 v[46:47], 0
    v_smfmac_f32_16x16x64_bf16 v[52:55], v[32:35], a[216:223], v3
    v_mov_b64_e64 v[44:45], 0
    v_smfmac_f32_16x16x64_bf16 v[36:39], v[8:11], a[224:231], v3
    v_smfmac_f32_16x16x64_bf16 v[36:39], v[12:15], a[232:239], v3
    s_waitcnt lgkmcnt(0)
    s_mov_b32 s44, 0
    v_smfmac_f32_16x16x64_bf16 v[48:51], v[16:19], v[56:63], v3
    ds_read_b128 v[56:59], v1 offset:45056
    ds_read_b128 v[60:63], v1 offset:46080
    v_add_f32_e64 v52, v52, v54
    v_smfmac_f32_16x16x64_bf16 v[36:39], v[16:19], a[240:247], v3
    v_add_f32_e64 v53, v53, v55
    v_smfmac_f32_16x16x64_bf16 v[36:39], v[20:23], a[248:255], v3
    v_cvt_pk_bf16_f32 v5, v52, v53
    v_smfmac_f32_16x16x64_bf16 v[36:39], v[24:27], v[64:71], v3
    ds_write_b32 v7, v5 offset:2060
    v_mov_b64_e64 v[54:55], 0
    v_smfmac_f32_16x16x64_bf16 v[36:39], v[28:31], v[72:79], v3
    v_mov_b64_e64 v[52:53], 0
    v_smfmac_f32_16x16x64_bf16 v[36:39], v[32:35], v[80:87], v3
    v_smfmac_f32_16x16x64_bf16 v[40:43], v[8:11], v[88:95], v3
    s_waitcnt lgkmcnt(0)
    s_mov_b32 s44, 0
    v_smfmac_f32_16x16x64_bf16 v[48:51], v[20:23], v[56:63], v3
    ds_read_b128 v[56:59], v1 offset:47104
    ds_read_b128 v[60:63], v1 offset:48128
    v_smfmac_f32_16x16x64_bf16 v[40:43], v[12:15], v[96:103], v3
    v_add_f32_e64 v36, v36, v38
    v_smfmac_f32_16x16x64_bf16 v[40:43], v[16:19], v[104:111], v3
    v_add_f32_e64 v37, v37, v39
    v_smfmac_f32_16x16x64_bf16 v[40:43], v[20:23], v[112:119], v3
    v_cvt_pk_bf16_f32 v4, v36, v37
    v_smfmac_f32_16x16x64_bf16 v[40:43], v[24:27], v[120:127], v3
    ds_write_b32 v7, v4 offset:3072
    v_mov_b64_e64 v[38:39], 0
    v_smfmac_f32_16x16x64_bf16 v[40:43], v[28:31], v[128:135], v3
    v_mov_b64_e64 v[36:37], 0
    v_smfmac_f32_16x16x64_bf16 v[40:43], v[32:35], v[136:143], v3
    s_waitcnt lgkmcnt(0)
    s_mov_b32 s44, 0
    v_smfmac_f32_16x16x64_bf16 v[48:51], v[24:27], v[56:63], v3
    ds_read_b128 v[56:59], v1 offset:49152
    ds_read_b128 v[60:63], v1 offset:50176
    v_smfmac_f32_16x16x64_bf16 v[44:47], v[8:11], v[144:151], v3
    v_smfmac_f32_16x16x64_bf16 v[44:47], v[12:15], v[152:159], v3
    v_add_f32_e64 v40, v40, v42
    v_smfmac_f32_16x16x64_bf16 v[44:47], v[16:19], v[160:167], v3
    v_add_f32_e64 v41, v41, v43
    v_smfmac_f32_16x16x64_bf16 v[44:47], v[20:23], v[168:175], v3
    v_cvt_pk_bf16_f32 v5, v40, v41
    v_smfmac_f32_16x16x64_bf16 v[44:47], v[24:27], v[176:183], v3
    ds_write_b32 v7, v5 offset:3076
    v_mov_b64_e64 v[42:43], 0
    v_smfmac_f32_16x16x64_bf16 v[44:47], v[28:31], v[184:191], v3
    s_waitcnt lgkmcnt(0)
    v_mov_b64 v[40:41], 0
    v_smfmac_f32_16x16x64_bf16 v[48:51], v[28:31], v[56:63], v3
    ds_read_b128 v[56:59], v1 offset:51200
    ds_read_b128 v[60:63], v1 offset:52224
    v_smfmac_f32_16x16x64_bf16 v[44:47], v[32:35], v[192:199], v3
    v_smfmac_f32_16x16x64_bf16 v[52:55], v[8:11], v[200:207], v3
    v_smfmac_f32_16x16x64_bf16 v[52:55], v[12:15], v[208:215], v3
    v_smfmac_f32_16x16x64_bf16 v[52:55], v[16:19], v[216:223], v3
    v_add_f32_e64 v44, v44, v46
    v_smfmac_f32_16x16x64_bf16 v[52:55], v[20:23], v[224:231], v3
    v_add_f32_e64 v45, v45, v47
    v_smfmac_f32_16x16x64_bf16 v[52:55], v[24:27], v[232:239], v3
    s_waitcnt lgkmcnt(0)
    s_mov_b32 s44, 0
    v_cvt_pk_bf16_f32 v4, v44, v45
    v_smfmac_f32_16x16x64_bf16 v[48:51], v[32:35], v[56:63], v3
    ds_write_b32 v7, v4 offset:3080
    v_mov_b64_e64 v[46:47], 0
    v_smfmac_f32_16x16x64_bf16 v[52:55], v[28:31], v[240:247], v3
    v_mov_b64_e64 v[44:45], 0
    v_smfmac_f32_16x16x64_bf16 v[52:55], v[32:35], v[248:255], v3
    s_branch L_vb3_y_any
L_pref_any:
    s_sub_u32 s21, s21, 30
    s_mov_b32 s46, 0
    v_min_u32 v60, 63, v1
    v_mul_u32_u24 v60, 128, v60
    s_lshl_b32 s3, s46, 7
    s_add_u32 s3, s3, 46833664
    s_mov_b32 s47, 200000
L_pf_na0_any:
    buffer_load_dwordx2 v[62:63], v60, s[8:11], s3 offen sc1
    s_waitcnt vmcnt(0)
    v_xor_b32 v62, s96, v62
    v_xor_b32 v63, s97, v63
    v_or_b32 v62, v62, v63
    v_cmp_ne_u32 vcc, 0, v62
    s_cbranch_vccz L_pf_na0_ok_any
    s_sub_u32 s47, s47, 1
    s_cbranch_scc0 L_pf_na0_any
    s_branch L_fail
L_pf_na0_ok_any:
    s_mov_b32 s46, 64
    v_min_u32 v60, 63, v1
    v_mul_u32_u24 v60, 128, v60
    s_lshl_b32 s3, s46, 7
    s_add_u32 s3, s3, 46833664
    s_mov_b32 s47, 200000
L_pf_na1_any:
    buffer_load_dwordx2 v[62:63], v60, s[8:11], s3 offen sc1
    s_waitcnt vmcnt(0)
    v_xor_b32 v62, s96, v62
    v_xor_b32 v63, s97, v63
    v_or_b32 v62, v62, v63
    v_cmp_ne_u32 vcc, 0, v62
    s_cbranch_vccz L_pf_na1_ok_any
    s_sub_u32 s47, s47, 1
    s_cbranch_scc0 L_pf_na1_any
    s_branch L_fail
L_pf_na1_ok_any:
    s_mov_b32 s46, 128
    v_min_u32 v60, 63, v1
    v_mul_u32_u24 v60, 128, v60
    s_lshl_b32 s3, s46, 7
    s_add_u32 s3, s3, 46833664
    s_mov_b32 s47, 200000
L_pf_na2_any:
    buffer_load_dwordx2 v[62:63], v60, s[8:11], s3 offen sc1
    s_waitcnt vmcnt(0)
    v_xor_b32 v62, s96, v62
    v_xor_b32 v63, s97, v63
    v_or_b32 v62, v62, v63
    v_cmp_ne_u32 vcc, 0, v62
    s_cbranch_vccz L_pf_na2_ok_any
    s_sub_u32 s47, s47, 1
    s_cbranch_scc0 L_pf_na2_any
    s_branch L_fail
L_pf_na2_ok_any:
    s_mov_b32 s46, 192
    v_min_u32 v60, 63, v1
    v_mul_u32_u24 v60, 128, v60
    s_lshl_b32 s3, s46, 7
    s_add_u32 s3, s3, 46833664
    s_mov_b32 s47, 200000
L_pf_na3_any:
    buffer_load_dwordx2 v[62:63], v60, s[8:11], s3 offen sc1
    s_waitcnt vmcnt(0)
    v_xor_b32 v62, s96, v62
    v_xor_b32 v63, s97, v63
    v_or_b32 v62, v62, v63
    v_cmp_ne_u32 vcc, 0, v62
    s_cbranch_vccz L_pf_na3_ok_any
    s_sub_u32 s47, s47, 1
    s_cbranch_scc0 L_pf_na3_any
    s_branch L_fail
L_pf_na3_ok_any:
    s_mov_b32 s46, 256
    v_min_u32 v60, 63, v1
    v_mul_u32_u24 v60, 128, v60
    s_lshl_b32 s3, s46, 7
    s_add_u32 s3, s3, 46833664
    s_mov_b32 s47, 200000
L_pf_na4_any:
    buffer_load_dwordx2 v[62:63], v60, s[8:11], s3 offen sc1
    s_waitcnt vmcnt(0)
    v_xor_b32 v62, s96, v62
    v_xor_b32 v63, s97, v63
    v_or_b32 v62, v62, v63
    v_cmp_ne_u32 vcc, 0, v62
    s_cbranch_vccz L_pf_na4_ok_any
    s_sub_u32 s47, s47, 1
    s_cbranch_scc0 L_pf_na4_any
    s_branch L_fail
L_pf_na4_ok_any:
    v_lshlrev_b32 v2, 7, v1
    v_min_u32 v3, 27, v1
    v_lshlrev_b32 v3, 2, v3
    s_lshl_b32 s32, s21, 2
    s_add_u32 s32, s32, s20
    s_cmp_eq_u32 s32, 7
    s_cbranch_scc1 L_gate_any
    s_cmp_ge_u32 s32, 5
    s_cbranch_scc1 L_relay_any
    s_cmp_lg_u32 s32, 0
    s_cbranch_scc1 L_pf_s0_any
    s_mov_b32 s60, 44302336
    s_mov_b32 s80, 8192
    s_mov_b32 s61, 44826624
    s_mov_b32 s81, 11264
    s_mov_b32 s62, 44829696
    s_mov_b32 s82, 11264
    s_mov_b32 s63, 12845056
    s_mov_b32 s83, 32768
    s_mov_b32 s64, 12853248
    s_mov_b32 s84, 32768
    s_mov_b32 s65, 12861440
    s_mov_b32 s85, 32768
    s_mov_b32 s66, 12869632
    s_mov_b32 s86, 32768
L_pf_s0_any:
    s_cmp_lg_u32 s32, 1
    s_cbranch_scc1 L_pf_s1_any
    s_mov_b32 s60, 268435456
    s_mov_b32 s80, 0
    s_mov_b32 s61, 268435456
    s_mov_b32 s81, 0
    s_mov_b32 s62, 268435456
    s_mov_b32 s82, 0
    s_mov_b32 s63, 268435456
    s_mov_b32 s83, 0
    s_mov_b32 s64, 268435456
    s_mov_b32 s84, 0
    s_mov_b32 s65, 268435456
    s_mov_b32 s85, 0
    s_mov_b32 s66, 268435456
    s_mov_b32 s86, 0
L_pf_s1_any:
    s_cmp_lg_u32 s32, 2
    s_cbranch_scc1 L_pf_s2_any
    s_mov_b32 s60, 268435456
    s_mov_b32 s80, 0
    s_mov_b32 s61, 268435456
    s_mov_b32 s81, 0
    s_mov_b32 s62, 268435456
    s_mov_b32 s82, 0
    s_mov_b32 s63, 268435456
    s_mov_b32 s83, 0
    s_mov_b32 s64, 268435456
    s_mov_b32 s84, 0
    s_mov_b32 s65, 268435456
    s_mov_b32 s85, 0
    s_mov_b32 s66, 268435456
    s_mov_b32 s86, 0
L_pf_s2_any:
    s_cmp_lg_u32 s32, 3
    s_cbranch_scc1 L_pf_s3_any
    s_mov_b32 s60, 268435456
    s_mov_b32 s80, 0
    s_mov_b32 s61, 268435456
    s_mov_b32 s81, 0
    s_mov_b32 s62, 268435456
    s_mov_b32 s82, 0
    s_mov_b32 s63, 268435456
    s_mov_b32 s83, 0
    s_mov_b32 s64, 268435456
    s_mov_b32 s84, 0
    s_mov_b32 s65, 268435456
    s_mov_b32 s85, 0
    s_mov_b32 s66, 268435456
    s_mov_b32 s86, 0
L_pf_s3_any:
    s_cmp_lg_u32 s32, 4
    s_cbranch_scc1 L_pf_s4_any
    s_mov_b32 s60, 268435456
    s_mov_b32 s80, 0
    s_mov_b32 s61, 268435456
    s_mov_b32 s81, 0
    s_mov_b32 s62, 268435456
    s_mov_b32 s82, 0
    s_mov_b32 s63, 268435456
    s_mov_b32 s83, 0
    s_mov_b32 s64, 268435456
    s_mov_b32 s84, 0
    s_mov_b32 s65, 268435456
    s_mov_b32 s85, 0
    s_mov_b32 s66, 268435456
    s_mov_b32 s86, 0
L_pf_s4_any:
    s_mov_b32 s30, 0
    s_mov_b32 s24, 44309504
L_pf_step_any:
    s_mov_b32 s31, 200000
L_pf_wait_any:
    buffer_load_dword v4, v3, s[8:11], s24 offen sc1
    s_waitcnt vmcnt(0)
    v_cmp_eq_u32 vcc, -1, v4
    s_cbranch_vccz L_pf_go_any
    s_sleep 1
    s_sub_u32 s31, s31, 1
    s_cbranch_scc0 L_pf_wait_any
    s_branch L_fail
L_pf_go_any:
    buffer_load_dword v8, v2, s[8:11], s60 offen
    s_add_u32 s60, s60, s80
    buffer_load_dword v9, v2, s[8:11], s61 offen
    s_add_u32 s61, s61, s81
    buffer_load_dword v10, v2, s[8:11], s62 offen
    s_add_u32 s62, s62, s82
    buffer_load_dword v11, v2, s[8:11], s63 offen
    s_add_u32 s63, s63, s83
    buffer_load_dword v12, v2, s[8:11], s64 offen
    s_add_u32 s64, s64, s84
    buffer_load_dword v13, v2, s[8:11], s65 offen
    s_add_u32 s65, s65, s85
    buffer_load_dword v14, v2, s[8:11], s66 offen
    s_add_u32 s66, s66, s86
    s_cmp_ge_u32 s30, 2
    s_cselect_b32 s33, 8192, 0
    s_add_u32 s24, s24, s33
    s_add_u32 s30, s30, 1
    s_cmp_lt_u32 s30, 64
    s_cbranch_scc1 L_pf_step_any
    s_branch L_done
L_relay_any:
    v_mov_b64 v[40:41], 0
    v_mov_b64 v[42:43], 0
    v_lshlrev_b32 v2, 4, v1
    s_sub_u32 s30, s32, 5
    s_lshl_b32 s24, s30, 13
    s_add_u32 s35, s24, 45547520
    s_add_u32 s24, s24, 44302336
L_relay_step_any:
    s_mov_b32 s31, 200000
    s_add_u32 s25, s24, 4096
    s_add_u32 s33, s35, 4096
L_relay_hint_any:
    buffer_load_dword v4, v3, s[8:11], s25 offen offset:3072 sc1
    s_waitcnt vmcnt(0)
    v_cmp_eq_u32 vcc, -1, v4
    s_cbranch_vccz L_relay_wait_any
    s_sleep 1
    s_sub_u32 s31, s31, 1
    s_cbranch_scc0 L_relay_hint_any
    s_branch L_fail
L_relay_wait_any:
    buffer_load_dwordx4 v[8:11], v2, s[8:11], s24 offen offset:0 sc1
    buffer_load_dwordx4 v[12:15], v2, s[8:11], s24 offen offset:1024 sc1
    buffer_load_dwordx4 v[16:19], v2, s[8:11], s24 offen offset:2048 sc1
    buffer_load_dwordx4 v[20:23], v2, s[8:11], s24 offen offset:3072 sc1
    buffer_load_dwordx4 v[24:27], v2, s[8:11], s25 offen offset:0 sc1
    buffer_load_dwordx4 v[28:31], v2, s[8:11], s25 offen offset:1024 sc1
    buffer_load_dwordx4 v[32:35], v2, s[8:11], s25 offen offset:2048 sc1
    s_waitcnt vmcnt(0)
    v_max3_u32 v4, v8, v9, v10
    v_max3_u32 v4, v4, v11, v12
    v_max3_u32 v4, v4, v13, v14
    v_max3_u32 v4, v4, v15, v16
    v_max3_u32 v4, v4, v17, v18
    v_max3_u32 v4, v4, v19, v20
    v_max3_u32 v4, v4, v21, v22
    v_max3_u32 v4, v4, v23, v24
    v_max3_u32 v4, v4, v25, v26
    v_max3_u32 v4, v4, v27, v28
    v_max3_u32 v4, v4, v29, v30
    v_max3_u32 v4, v4, v31, v32
    v_max3_u32 v4, v4, v33, v34
    v_max_u32 v4, v4, v35
    v_cmp_eq_u32 vcc, -1, v4
    s_cbranch_vccz L_relay_go_any
    s_sub_u32 s31, s31, 1
    s_cbranch_scc0 L_relay_wait_any
    s_branch L_fail
L_relay_go_any:
    buffer_store_dwordx4 v[8:11], v2, s[8:11], s35 offen offset:0 sc1
    buffer_store_dwordx4 v[12:15], v2, s[8:11], s35 offen offset:1024 sc1
    buffer_store_dwordx4 v[16:19], v2, s[8:11], s35 offen offset:2048 sc1
    buffer_store_dwordx4 v[20:23], v2, s[8:11], s35 offen offset:3072 sc1
    buffer_store_dwordx4 v[24:27], v2, s[8:11], s33 offen offset:0 sc1
    buffer_store_dwordx4 v[28:31], v2, s[8:11], s33 offen offset:1024 sc1
    buffer_store_dwordx4 v[32:35], v2, s[8:11], s33 offen offset:2048 sc1
    s_add_u32 s24, s24, 16384
    s_add_u32 s35, s35, 16384
    s_add_u32 s30, s30, 2
    s_cmp_lt_u32 s30, 64
    s_cbranch_scc1 L_relay_step_any
    s_branch L_done
L_gate_any:
    v_min_u32 v3, 27, v1
    v_lshlrev_b32 v3, 7, v3
    v_add_u32 v2, 7280, v2
    v_mov_b32 v5, 0x40000000
    v_cmp_gt_u32 vcc, 8, v1
    v_mov_b32 v6, 0
    v_cndmask_b32 v2, v5, v2, vcc
    s_mov_b32 s30, 0
    s_mov_b32 s39, 46094336
    s_mov_b32 s24, 44302336
L_gate_step_any:
    s_cmp_ge_u32 s30, 64
    s_cbranch_scc1 L_gate_go_any
    s_mov_b32 s31, 200000
L_gate_wait_any:
    buffer_load_dword v4, v3, s[8:11], s39 offen sc1
    s_waitcnt vmcnt(0)
    v_cmp_eq_u32 vcc, -1, v4
    s_cbranch_vccz L_gate_go_any
    s_sub_u32 s31, s31, 1
    s_cbranch_scc0 L_gate_wait_any
    s_branch L_fail
L_gate_go_any:
    s_cmp_lt_u32 s30, 0
    s_cbranch_scc1 L_gate_next_any
    buffer_store_dword v6, v2, s[8:11], s24 offen sc1
    s_add_u32 s24, s24, 8192
L_gate_next_any:
    s_add_u32 s39, s39, 11264
    s_add_u32 s30, s30, 1
    s_cmp_lt_u32 s30, 64
    s_cbranch_scc1 L_gate_step_any
    s_branch L_done
L_help_any:
    s_lshr_b32 s21, s23, 5
    s_sub_u32 s21, s21, 1
    s_and_b32 s22, s23, 31
    v_lshlrev_b32 v2, 4, v1
    v_mov_b32 v3, 0
    v_mov_b64 v[96:97], 0
    v_mov_b64 v[98:99], 0
    s_and_b32 s24, s22, 7
    s_lshl_b32 s32, s21, 3
    s_add_u32 s32, s32, s24
    s_lshr_b32 s27, s22, 3
    s_mul_i32 s28, s27, 28672
    s_mul_i32 s24, s20, 7168
    s_add_u32 s28, s28, s24
    s_add_u32 s28, s28, 54363136
    s_mov_b32 s34, 0
    s_mov_b32 s35, 0
    s_cmp_ge_u32 s32, 28
    s_cselect_b32 s26, 28, 0
    s_sub_u32 s26, s32, s26
    s_and_b32 s33, s26, 1
    s_lshl_b32 s33, s33, 3
    s_lshl_b32 s24, s20, 1
    s_add_u32 s33, s33, s24
    s_mul_i32 s30, s27, 11264
    s_lshl_b32 s24, s26, 7
    s_add_u32 s30, s30, s24
    s_add_u32 s30, s30, 46094336
    s_lshr_b32 s26, s26, 1
    s_cmp_ge_u32 s32, 28
    s_cbranch_scc1 H_t_any
    v_bfe_u32 v4, v1, 5, 1
    v_lshlrev_b32 v4, 8, v4
    v_bfe_u32 v6, v1, 0, 4
    v_lshl_add_u32 v4, v6, 4, v4
    v_bfe_u32 v6, v1, 4, 1
    v_lshl_add_u32 v5, v6, 14, v4
    v_mul_u32_u24 v6, 114688, v6
    v_add_u32 v4, v4, v6
    s_lshl_b32 s24, s26, 2
    s_lshr_b32 s25, s33, 3
    s_lshl_b32 s25, s25, 1
    s_add_u32 s24, s24, s25
    s_mul_i32 s24, s24, 56
    s_and_b32 s25, s33, 7
    s_mul_i32 s25, s25, 7
    s_add_u32 s24, s24, s25
    s_lshl_b32 s24, s24, 11
    s_add_u32 s24, s24, 6422528
    s_mul_i32 s29, s27, 458752
    s_lshl_b32 s25, s26, 15
    s_add_u32 s29, s29, s25
    s_lshl_b32 s25, s33, 10
    s_add_u32 s29, s29, s25
    s_add_u32 s29, s29, 14942208
    s_and_b32 s25, s33, 8
    s_mul_i32 s25, s25, 7
    s_lshr_b32 s3, s26, 1
    s_add_u32 s25, s25, s3
    s_add_u32 s25, s25, 112
    v_min_u32 v60, 7, v1
    v_mul_u32_u24 v60, 896, v60
    s_lshl_b32 s3, s25, 7
    s_add_u32 s3, s3, 46833664
    s_mov_b32 s47, 200000
H_u_nw_any:
    buffer_load_dwordx2 v[62:63], v60, s[8:11], s3 offen sc1
    s_waitcnt vmcnt(0)
    v_xor_b32 v62, s96, v62
    v_xor_b32 v63, s97, v63
    v_or_b32 v62, v62, v63
    v_cmp_ne_u32 vcc, 0, v62
    s_cbranch_vccz H_u_nw_ok_any
    s_sub_u32 s47, s47, 1
    s_cbranch_scc0 H_u_nw_any
    s_branch L_fail
H_u_nw_ok_any:
    buffer_load_dwordx4 a[0:3], v4, s[8:11], s24 offen offset:0
    buffer_load_dwordx4 a[4:7], v4, s[8:11], s24 offen offset:512
    buffer_load_dwordx4 a[8:11], v4, s[8:11], s24 offen offset:1024
    buffer_load_dwordx4 a[12:15], v4, s[8:11], s24 offen offset:1536
    buffer_load_dwordx4 a[16:19], v4, s[8:11], s24 offen offset:2048
    buffer_load_dwordx4 a[20:23], v4, s[8:11], s24 offen offset:2560
    buffer_load_dwordx4 a[24:27], v4, s[8:11], s24 offen offset:3072
    buffer_load_dwordx4 a[28:31], v4, s[8:11], s24 offen offset:3584
    s_add_u32 s24, s24, 4096
    buffer_load_dwordx4 a[32:35], v4, s[8:11], s24 offen offset:0
    buffer_load_dwordx4 a[36:39], v4, s[8:11], s24 offen offset:512
    buffer_load_dwordx4 a[40:43], v4, s[8:11], s24 offen offset:1024
    buffer_load_dwordx4 a[44:47], v4, s[8:11], s24 offen offset:1536
    buffer_load_dwordx4 a[48:51], v4, s[8:11], s24 offen offset:2048
    buffer_load_dwordx4 a[52:55], v4, s[8:11], s24 offen offset:2560
    buffer_load_dwordx4 a[56:59], v4, s[8:11], s24 offen offset:3072
    buffer_load_dwordx4 a[60:63], v4, s[8:11], s24 offen offset:3584
    s_add_u32 s24, s24, 4096
    buffer_load_dwordx4 a[64:67], v4, s[8:11], s24 offen offset:0
    buffer_load_dwordx4 a[68:71], v4, s[8:11], s24 offen offset:512
    buffer_load_dwordx4 a[72:75], v4, s[8:11], s24 offen offset:1024
    buffer_load_dwordx4 a[76:79], v4, s[8:11], s24 offen offset:1536
    buffer_load_dwordx4 a[80:83], v4, s[8:11], s24 offen offset:2048
    buffer_load_dwordx4 a[84:87], v4, s[8:11], s24 offen offset:2560
    buffer_load_dwordx4 a[88:91], v4, s[8:11], s24 offen offset:3072
    buffer_load_dwordx4 a[92:95], v4, s[8:11], s24 offen offset:3584
    s_add_u32 s24, s24, 4096
    buffer_load_dwordx4 a[96:99], v4, s[8:11], s24 offen offset:0
    buffer_load_dwordx4 a[100:103], v4, s[8:11], s24 offen offset:512
    buffer_load_dwordx4 a[104:107], v4, s[8:11], s24 offen offset:1024
    buffer_load_dwordx4 a[108:111], v4, s[8:11], s24 offen offset:1536
    s_add_u32 s24, s24, 2048
    buffer_load_dwordx4 a[112:115], v4, s[8:11], s24 offen offset:0
    buffer_load_dwordx4 a[116:119], v4, s[8:11], s24 offen offset:512
    buffer_load_dwordx4 a[120:123], v4, s[8:11], s24 offen offset:1024
    buffer_load_dwordx4 a[124:127], v4, s[8:11], s24 offen offset:1536
    buffer_load_dwordx4 a[128:131], v4, s[8:11], s24 offen offset:2048
    buffer_load_dwordx4 a[132:135], v4, s[8:11], s24 offen offset:2560
    buffer_load_dwordx4 a[136:139], v4, s[8:11], s24 offen offset:3072
    buffer_load_dwordx4 a[140:143], v4, s[8:11], s24 offen offset:3584
    s_add_u32 s24, s24, 4096
    buffer_load_dwordx4 a[144:147], v4, s[8:11], s24 offen offset:0
    buffer_load_dwordx4 a[148:151], v4, s[8:11], s24 offen offset:512
    buffer_load_dwordx4 a[152:155], v4, s[8:11], s24 offen offset:1024
    buffer_load_dwordx4 a[156:159], v4, s[8:11], s24 offen offset:1536
    buffer_load_dwordx4 a[160:163], v4, s[8:11], s24 offen offset:2048
    buffer_load_dwordx4 a[164:167], v4, s[8:11], s24 offen offset:2560
    buffer_load_dwordx4 a[168:171], v4, s[8:11], s24 offen offset:3072
    buffer_load_dwordx4 a[172:175], v4, s[8:11], s24 offen offset:3584
    s_add_u32 s24, s24, 4096
    buffer_load_dwordx4 a[176:179], v4, s[8:11], s24 offen offset:0
    buffer_load_dwordx4 a[180:183], v4, s[8:11], s24 offen offset:512
    buffer_load_dwordx4 a[184:187], v4, s[8:11], s24 offen offset:1024
    buffer_load_dwordx4 a[188:191], v4, s[8:11], s24 offen offset:1536
    buffer_load_dwordx4 a[192:195], v4, s[8:11], s24 offen offset:2048
    buffer_load_dwordx4 a[196:199], v4, s[8:11], s24 offen offset:2560
    buffer_load_dwordx4 a[200:203], v4, s[8:11], s24 offen offset:3072
    buffer_load_dwordx4 a[204:207], v4, s[8:11], s24 offen offset:3584
    s_add_u32 s24, s24, 4096
    buffer_load_dwordx4 a[208:211], v4, s[8:11], s24 offen offset:0
    buffer_load_dwordx4 a[212:215], v4, s[8:11], s24 offen offset:512
    buffer_load_dwordx4 a[216:219], v4, s[8:11], s24 offen offset:1024
    buffer_load_dwordx4 a[220:223], v4, s[8:11], s24 offen offset:1536
    s_add_u32 s24, s24, 2048
    s_mov_b32 s46, 0
    v_min_u32 v60, 63, v1
    v_mul_u32_u24 v60, 128, v60
    s_lshl_b32 s3, s46, 7
    s_add_u32 s3, s3, 46833664
    s_mov_b32 s47, 200000
H_u_na0_any:
    buffer_load_dwordx2 v[62:63], v60, s[8:11], s3 offen sc1
    s_waitcnt vmcnt(0)
    v_xor_b32 v62, s96, v62
    v_xor_b32 v63, s97, v63
    v_or_b32 v62, v62, v63
    v_cmp_ne_u32 vcc, 0, v62
    s_cbranch_vccz H_u_na0_ok_any
    s_sub_u32 s47, s47, 1
    s_cbranch_scc0 H_u_na0_any
    s_branch L_fail
H_u_na0_ok_any:
    s_mov_b32 s46, 64
    v_min_u32 v60, 63, v1
    v_mul_u32_u24 v60, 128, v60
    s_lshl_b32 s3, s46, 7
    s_add_u32 s3, s3, 46833664
    s_mov_b32 s47, 200000
H_u_na1_any:
    buffer_load_dwordx2 v[62:63], v60, s[8:11], s3 offen sc1
    s_waitcnt vmcnt(0)
    v_xor_b32 v62, s96, v62
    v_xor_b32 v63, s97, v63
    v_or_b32 v62, v62, v63
    v_cmp_ne_u32 vcc, 0, v62
    s_cbranch_vccz H_u_na1_ok_any
    s_sub_u32 s47, s47, 1
    s_cbranch_scc0 H_u_na1_any
    s_branch L_fail
H_u_na1_ok_any:
    s_mov_b32 s46, 128
    v_min_u32 v60, 63, v1
    v_mul_u32_u24 v60, 128, v60
    s_lshl_b32 s3, s46, 7
    s_add_u32 s3, s3, 46833664
    s_mov_b32 s47, 200000
H_u_na2_any:
    buffer_load_dwordx2 v[62:63], v60, s[8:11], s3 offen sc1
    s_waitcnt vmcnt(0)
    v_xor_b32 v62, s96, v62
    v_xor_b32 v63, s97, v63
    v_or_b32 v62, v62, v63
    v_cmp_ne_u32 vcc, 0, v62
    s_cbranch_vccz H_u_na2_ok_any
    s_sub_u32 s47, s47, 1
    s_cbranch_scc0 H_u_na2_any
    s_branch L_fail
H_u_na2_ok_any:
    s_mov_b32 s46, 192
    v_min_u32 v60, 63, v1
    v_mul_u32_u24 v60, 128, v60
    s_lshl_b32 s3, s46, 7
    s_add_u32 s3, s3, 46833664
    s_mov_b32 s47, 200000
H_u_na3_any:
    buffer_load_dwordx2 v[62:63], v60, s[8:11], s3 offen sc1
    s_waitcnt vmcnt(0)
    v_xor_b32 v62, s96, v62
    v_xor_b32 v63, s97, v63
    v_or_b32 v62, v62, v63
    v_cmp_ne_u32 vcc, 0, v62
    s_cbranch_vccz H_u_na3_ok_any
    s_sub_u32 s47, s47, 1
    s_cbranch_scc0 H_u_na3_any
    s_branch L_fail
H_u_na3_ok_any:
    s_mov_b32 s46, 256
    v_min_u32 v60, 63, v1
    v_mul_u32_u24 v60, 128, v60
    s_lshl_b32 s3, s46, 7
    s_add_u32 s3, s3, 46833664
    s_mov_b32 s47, 200000
H_u_na4_any:
    buffer_load_dwordx2 v[62:63], v60, s[8:11], s3 offen sc1
    s_waitcnt vmcnt(0)
    v_xor_b32 v62, s96, v62
    v_xor_b32 v63, s97, v63
    v_or_b32 v62, v62, v63
    v_cmp_ne_u32 vcc, 0, v62
    s_cbranch_vccz H_u_na4_ok_any
    s_sub_u32 s47, s47, 1
    s_cbranch_scc0 H_u_na4_any
    s_branch L_fail
H_u_na4_ok_any:
    s_mul_i32 s24, s20, 7168
    s_add_u32 s24, s24, s34
    s_add_u32 s25, s28, 4096
    s_mov_b32 m0, s24
    s_add_u32 s24, s24, 4096
    buffer_load_dwordx4 v2, s[8:11], s28 offen offset:0 lds
    buffer_load_dwordx4 v2, s[8:11], s28 offen offset:1024 lds
    buffer_load_dwordx4 v2, s[8:11], s28 offen offset:2048 lds
    buffer_load_dwordx4 v2, s[8:11], s28 offen offset:3072 lds
    s_mov_b32 m0, s24
    s_add_u32 s24, s24, 4096
    buffer_load_dwordx4 v2, s[8:11], s25 offen offset:0 lds
    buffer_load_dwordx4 v2, s[8:11], s25 offen offset:1024 lds
    buffer_load_dwordx4 v2, s[8:11], s25 offen offset:2048 lds
    s_add_u32 s28, s28, 114688
    s_add_u32 s34, s34, 28672
    s_cmp_eq_u32 s34, 86016
    s_cselect_b32 s34, 0, s34
    s_mul_i32 s24, s20, 7168
    s_add_u32 s24, s24, s34
    s_add_u32 s25, s28, 4096
    s_mov_b32 m0, s24
    s_add_u32 s24, s24, 4096
    buffer_load_dwordx4 v2, s[8:11], s28 offen offset:0 lds
    buffer_load_dwordx4 v2, s[8:11], s28 offen offset:1024 lds
    buffer_load_dwordx4 v2, s[8:11], s28 offen offset:2048 lds
    buffer_load_dwordx4 v2, s[8:11], s28 offen offset:3072 lds
    s_mov_b32 m0, s24
    s_add_u32 s24, s24, 4096
    buffer_load_dwordx4 v2, s[8:11], s25 offen offset:0 lds
    buffer_load_dwordx4 v2, s[8:11], s25 offen offset:1024 lds
    buffer_load_dwordx4 v2, s[8:11], s25 offen offset:2048 lds
    s_add_u32 s28, s28, 114688
    s_add_u32 s34, s34, 28672
    s_cmp_eq_u32 s34, 86016
    s_cselect_b32 s34, 0, s34
    s_waitcnt vmcnt(7)
    s_barrier
    s_mul_i32 s24, s20, 7168
    s_add_u32 s24, s24, s34
    s_add_u32 s25, s28, 4096
    s_mov_b32 m0, s24
    s_add_u32 s24, s24, 4096
    buffer_load_dwordx4 v2, s[8:11], s28 offen offset:0 lds
    buffer_load_dwordx4 v2, s[8:11], s28 offen offset:1024 lds
    buffer_load_dwordx4 v2, s[8:11], s28 offen offset:2048 lds
    buffer_load_dwordx4 v2, s[8:11], s28 offen offset:3072 lds
    s_mov_b32 m0, s24
    s_add_u32 s24, s24, 4096
    buffer_load_dwordx4 v2, s[8:11], s25 offen offset:0 lds
    buffer_load_dwordx4 v2, s[8:11], s25 offen offset:1024 lds
    buffer_load_dwordx4 v2, s[8:11], s25 offen offset:2048 lds
    s_add_u32 s28, s28, 114688
    s_add_u32 s34, s34, 28672
    s_cmp_eq_u32 s34, 86016
    s_cselect_b32 s34, 0, s34
    v_add_u32 v8, s35, v2
    s_add_u32 s35, s35, 28672
    s_cmp_eq_u32 s35, 86016
    s_cselect_b32 s35, 0, s35
    ds_read_b128 v[80:83], v8 offset:0
    ds_read_b128 v[84:87], v8 offset:1024
    ds_read_b128 v[88:91], v8 offset:2048
    ds_read_b128 v[92:95], v8 offset:3072
    s_waitcnt lgkmcnt(3)
    v_mfma_f32_32x32x16_bf16 v[16:31], v[80:83], a[0:3], 0
    v_mfma_f32_32x32x16_bf16 v[32:47], v[80:83], a[112:115], 0
    ds_read_b128 v[80:83], v8 offset:4096
    s_waitcnt lgkmcnt(3)
    v_mfma_f32_32x32x16_bf16 v[16:31], v[84:87], a[4:7], v[16:31]
    v_mfma_f32_32x32x16_bf16 v[32:47], v[84:87], a[116:119], v[32:47]
    ds_read_b128 v[84:87], v8 offset:5120
    s_waitcnt lgkmcnt(3)
    v_mfma_f32_32x32x16_bf16 v[16:31], v[88:91], a[8:11], v[16:31]
    v_mfma_f32_32x32x16_bf16 v[32:47], v[88:91], a[120:123], v[32:47]
    ds_read_b128 v[88:91], v8 offset:6144
    s_waitcnt lgkmcnt(3)
    v_mfma_f32_32x32x16_bf16 v[16:31], v[92:95], a[12:15], v[16:31]
    v_mfma_f32_32x32x16_bf16 v[32:47], v[92:95], a[124:127], v[32:47]
    ds_read_b128 v[92:95], v8 offset:7168
    s_waitcnt lgkmcnt(3)
    v_mfma_f32_32x32x16_bf16 v[16:31], v[80:83], a[16:19], v[16:31]
    v_mfma_f32_32x32x16_bf16 v[32:47], v[80:83], a[128:131], v[32:47]
    ds_read_b128 v[80:83], v8 offset:8192
    s_waitcnt lgkmcnt(3)
    v_mfma_f32_32x32x16_bf16 v[16:31], v[84:87], a[20:23], v[16:31]
    v_mfma_f32_32x32x16_bf16 v[32:47], v[84:87], a[132:135], v[32:47]
    ds_read_b128 v[84:87], v8 offset:9216
    s_waitcnt lgkmcnt(3)
    v_mfma_f32_32x32x16_bf16 v[16:31], v[88:91], a[24:27], v[16:31]
    v_mfma_f32_32x32x16_bf16 v[32:47], v[88:91], a[136:139], v[32:47]
    ds_read_b128 v[88:91], v8 offset:10240
    s_waitcnt lgkmcnt(3)
    v_mfma_f32_32x32x16_bf16 v[16:31], v[92:95], a[28:31], v[16:31]
    v_mfma_f32_32x32x16_bf16 v[32:47], v[92:95], a[140:143], v[32:47]
    ds_read_b128 v[92:95], v8 offset:11264
    s_waitcnt lgkmcnt(3)
    v_mfma_f32_32x32x16_bf16 v[16:31], v[80:83], a[32:35], v[16:31]
    v_mfma_f32_32x32x16_bf16 v[32:47], v[80:83], a[144:147], v[32:47]
    ds_read_b128 v[80:83], v8 offset:12288
    s_waitcnt lgkmcnt(3)
    v_mfma_f32_32x32x16_bf16 v[16:31], v[84:87], a[36:39], v[16:31]
    v_mfma_f32_32x32x16_bf16 v[32:47], v[84:87], a[148:151], v[32:47]
    ds_read_b128 v[84:87], v8 offset:13312
    s_waitcnt lgkmcnt(3)
    v_mfma_f32_32x32x16_bf16 v[16:31], v[88:91], a[40:43], v[16:31]
    v_mfma_f32_32x32x16_bf16 v[32:47], v[88:91], a[152:155], v[32:47]
    ds_read_b128 v[88:91], v8 offset:14336
    s_waitcnt lgkmcnt(3)
    v_mfma_f32_32x32x16_bf16 v[16:31], v[92:95], a[44:47], v[16:31]
    v_mfma_f32_32x32x16_bf16 v[32:47], v[92:95], a[156:159], v[32:47]
    ds_read_b128 v[92:95], v8 offset:15360
    s_waitcnt lgkmcnt(3)
    v_mfma_f32_32x32x16_bf16 v[16:31], v[80:83], a[48:51], v[16:31]
    v_mfma_f32_32x32x16_bf16 v[32:47], v[80:83], a[160:163], v[32:47]
    ds_read_b128 v[80:83], v8 offset:16384
    s_waitcnt lgkmcnt(3)
    v_mfma_f32_32x32x16_bf16 v[16:31], v[84:87], a[52:55], v[16:31]
    v_mfma_f32_32x32x16_bf16 v[32:47], v[84:87], a[164:167], v[32:47]
    ds_read_b128 v[84:87], v8 offset:17408
    s_waitcnt lgkmcnt(3)
    v_mfma_f32_32x32x16_bf16 v[16:31], v[88:91], a[56:59], v[16:31]
    v_mfma_f32_32x32x16_bf16 v[32:47], v[88:91], a[168:171], v[32:47]
    ds_read_b128 v[88:91], v8 offset:18432
    s_waitcnt lgkmcnt(3)
    v_mfma_f32_32x32x16_bf16 v[16:31], v[92:95], a[60:63], v[16:31]
    v_mfma_f32_32x32x16_bf16 v[32:47], v[92:95], a[172:175], v[32:47]
    ds_read_b128 v[92:95], v8 offset:19456
    s_waitcnt lgkmcnt(3)
    v_mfma_f32_32x32x16_bf16 v[16:31], v[80:83], a[64:67], v[16:31]
    v_mfma_f32_32x32x16_bf16 v[32:47], v[80:83], a[176:179], v[32:47]
    ds_read_b128 v[80:83], v8 offset:20480
    s_waitcnt lgkmcnt(3)
    v_mfma_f32_32x32x16_bf16 v[16:31], v[84:87], a[68:71], v[16:31]
    v_mfma_f32_32x32x16_bf16 v[32:47], v[84:87], a[180:183], v[32:47]
    ds_read_b128 v[84:87], v8 offset:21504
    s_waitcnt lgkmcnt(3)
    v_mfma_f32_32x32x16_bf16 v[16:31], v[88:91], a[72:75], v[16:31]
    v_mfma_f32_32x32x16_bf16 v[32:47], v[88:91], a[184:187], v[32:47]
    ds_read_b128 v[88:91], v8 offset:22528
    s_waitcnt lgkmcnt(3)
    v_mfma_f32_32x32x16_bf16 v[16:31], v[92:95], a[76:79], v[16:31]
    v_mfma_f32_32x32x16_bf16 v[32:47], v[92:95], a[188:191], v[32:47]
    ds_read_b128 v[92:95], v8 offset:23552
    s_waitcnt lgkmcnt(3)
    v_mfma_f32_32x32x16_bf16 v[16:31], v[80:83], a[80:83], v[16:31]
    v_mfma_f32_32x32x16_bf16 v[32:47], v[80:83], a[192:195], v[32:47]
    ds_read_b128 v[80:83], v8 offset:24576
    s_waitcnt lgkmcnt(3)
    v_mfma_f32_32x32x16_bf16 v[16:31], v[84:87], a[84:87], v[16:31]
    v_mfma_f32_32x32x16_bf16 v[32:47], v[84:87], a[196:199], v[32:47]
    ds_read_b128 v[84:87], v8 offset:25600
    s_waitcnt lgkmcnt(3)
    v_mfma_f32_32x32x16_bf16 v[16:31], v[88:91], a[88:91], v[16:31]
    v_mfma_f32_32x32x16_bf16 v[32:47], v[88:91], a[200:203], v[32:47]
    ds_read_b128 v[88:91], v8 offset:26624
    s_waitcnt lgkmcnt(3)
    v_mfma_f32_32x32x16_bf16 v[16:31], v[92:95], a[92:95], v[16:31]
    v_mfma_f32_32x32x16_bf16 v[32:47], v[92:95], a[204:207], v[32:47]
    ds_read_b128 v[92:95], v8 offset:27648
    s_waitcnt lgkmcnt(3)
    v_mfma_f32_32x32x16_bf16 v[16:31], v[80:83], a[96:99], v[16:31]
    v_mfma_f32_32x32x16_bf16 v[32:47], v[80:83], a[208:211], v[32:47]
    s_waitcnt lgkmcnt(2)
    v_mfma_f32_32x32x16_bf16 v[16:31], v[84:87], a[100:103], v[16:31]
    v_mfma_f32_32x32x16_bf16 v[32:47], v[84:87], a[212:215], v[32:47]
    s_waitcnt lgkmcnt(1)
    v_mfma_f32_32x32x16_bf16 v[16:31], v[88:91], a[104:107], v[16:31]
    v_mfma_f32_32x32x16_bf16 v[32:47], v[88:91], a[216:219], v[32:47]
    s_waitcnt lgkmcnt(0)
    v_mfma_f32_32x32x16_bf16 v[16:31], v[92:95], a[108:111], v[16:31]
    v_mfma_f32_32x32x16_bf16 v[32:47], v[92:95], a[220:223], v[32:47]
    s_nop 7
    s_nop 3
    s_add_u32 s26, s29, 1024
    v_cvt_pk_bf16_f32 v16, v16, v17
    v_cvt_pk_bf16_f32 v17, v18, v19
    v_cvt_pk_bf16_f32 v18, v20, v21
    v_cvt_pk_bf16_f32 v19, v22, v23
    buffer_store_dwordx4 v[16:19], v5, s[8:11], s29 offen offset:0 sc1
    v_cvt_pk_bf16_f32 v24, v24, v25
    v_cvt_pk_bf16_f32 v25, v26, v27
    v_cvt_pk_bf16_f32 v26, v28, v29
    v_cvt_pk_bf16_f32 v27, v30, v31
    buffer_store_dwordx4 v[24:27], v5, s[8:11], s29 offen offset:512 sc1
    v_cvt_pk_bf16_f32 v32, v32, v33
    v_cvt_pk_bf16_f32 v33, v34, v35
    v_cvt_pk_bf16_f32 v34, v36, v37
    v_cvt_pk_bf16_f32 v35, v38, v39
    buffer_store_dwordx4 v[32:35], v5, s[8:11], s26 offen offset:0 sc1
    v_cvt_pk_bf16_f32 v40, v40, v41
    v_cvt_pk_bf16_f32 v41, v42, v43
    v_cvt_pk_bf16_f32 v42, v44, v45
    v_cvt_pk_bf16_f32 v43, v46, v47
    buffer_store_dwordx4 v[40:43], v5, s[8:11], s26 offen offset:512 sc1
    s_add_u32 s29, s29, 1835008
    s_waitcnt vmcnt(0)
    s_barrier
    s_cmp_lg_u32 s20, 0
    s_cbranch_scc1 H_nf_27_any
    s_mov_b64 exec, 0xff
    buffer_store_dwordx4 v[96:99], v2, s[8:11], s30 offen sc1
    s_mov_b64 exec, -1
H_nf_27_any:
    s_add_u32 s30, s30, 45056
    s_mul_i32 s24, s20, 7168
    s_add_u32 s24, s24, s34
    s_add_u32 s25, s28, 4096
    s_mov_b32 m0, s24
    s_add_u32 s24, s24, 4096
    buffer_load_dwordx4 v2, s[8:11], s28 offen offset:0 lds
    buffer_load_dwordx4 v2, s[8:11], s28 offen offset:1024 lds
    buffer_load_dwordx4 v2, s[8:11], s28 offen offset:2048 lds
    buffer_load_dwordx4 v2, s[8:11], s28 offen offset:3072 lds
    s_mov_b32 m0, s24
    s_add_u32 s24, s24, 4096
    buffer_load_dwordx4 v2, s[8:11], s25 offen offset:0 lds
    buffer_load_dwordx4 v2, s[8:11], s25 offen offset:1024 lds
    buffer_load_dwordx4 v2, s[8:11], s25 offen offset:2048 lds
    s_add_u32 s28, s28, 114688
    s_add_u32 s34, s34, 28672
    s_cmp_eq_u32 s34, 86016
    s_cselect_b32 s34, 0, s34
    v_add_u32 v8, s35, v2
    s_add_u32 s35, s35, 28672
    s_cmp_eq_u32 s35, 86016
    s_cselect_b32 s35, 0, s35
    ds_read_b128 v[80:83], v8 offset:0
    ds_read_b128 v[84:87], v8 offset:1024
    ds_read_b128 v[88:91], v8 offset:2048
    ds_read_b128 v[92:95], v8 offset:3072
    s_waitcnt lgkmcnt(3)
    v_mfma_f32_32x32x16_bf16 v[48:63], v[80:83], a[0:3], 0
    v_mfma_f32_32x32x16_bf16 v[64:79], v[80:83], a[112:115], 0
    ds_read_b128 v[80:83], v8 offset:4096
    s_waitcnt lgkmcnt(3)
    v_mfma_f32_32x32x16_bf16 v[48:63], v[84:87], a[4:7], v[48:63]
    v_mfma_f32_32x32x16_bf16 v[64:79], v[84:87], a[116:119], v[64:79]
    ds_read_b128 v[84:87], v8 offset:5120
    s_waitcnt lgkmcnt(3)
    v_mfma_f32_32x32x16_bf16 v[48:63], v[88:91], a[8:11], v[48:63]
    v_mfma_f32_32x32x16_bf16 v[64:79], v[88:91], a[120:123], v[64:79]
    ds_read_b128 v[88:91], v8 offset:6144
    s_waitcnt lgkmcnt(3)
    v_mfma_f32_32x32x16_bf16 v[48:63], v[92:95], a[12:15], v[48:63]
    v_mfma_f32_32x32x16_bf16 v[64:79], v[92:95], a[124:127], v[64:79]
    ds_read_b128 v[92:95], v8 offset:7168
    s_waitcnt lgkmcnt(3)
    v_mfma_f32_32x32x16_bf16 v[48:63], v[80:83], a[16:19], v[48:63]
    v_mfma_f32_32x32x16_bf16 v[64:79], v[80:83], a[128:131], v[64:79]
    ds_read_b128 v[80:83], v8 offset:8192
    s_waitcnt lgkmcnt(3)
    v_mfma_f32_32x32x16_bf16 v[48:63], v[84:87], a[20:23], v[48:63]
    v_mfma_f32_32x32x16_bf16 v[64:79], v[84:87], a[132:135], v[64:79]
    ds_read_b128 v[84:87], v8 offset:9216
    s_waitcnt lgkmcnt(3)
    v_mfma_f32_32x32x16_bf16 v[48:63], v[88:91], a[24:27], v[48:63]
    v_mfma_f32_32x32x16_bf16 v[64:79], v[88:91], a[136:139], v[64:79]
    ds_read_b128 v[88:91], v8 offset:10240
    s_waitcnt lgkmcnt(3)
    v_mfma_f32_32x32x16_bf16 v[48:63], v[92:95], a[28:31], v[48:63]
    v_mfma_f32_32x32x16_bf16 v[64:79], v[92:95], a[140:143], v[64:79]
    ds_read_b128 v[92:95], v8 offset:11264
    s_waitcnt lgkmcnt(3)
    v_mfma_f32_32x32x16_bf16 v[48:63], v[80:83], a[32:35], v[48:63]
    v_mfma_f32_32x32x16_bf16 v[64:79], v[80:83], a[144:147], v[64:79]
    ds_read_b128 v[80:83], v8 offset:12288
    s_waitcnt lgkmcnt(3)
    v_mfma_f32_32x32x16_bf16 v[48:63], v[84:87], a[36:39], v[48:63]
    v_mfma_f32_32x32x16_bf16 v[64:79], v[84:87], a[148:151], v[64:79]
    ds_read_b128 v[84:87], v8 offset:13312
    s_waitcnt lgkmcnt(3)
    v_mfma_f32_32x32x16_bf16 v[48:63], v[88:91], a[40:43], v[48:63]
    v_mfma_f32_32x32x16_bf16 v[64:79], v[88:91], a[152:155], v[64:79]
    ds_read_b128 v[88:91], v8 offset:14336
    s_waitcnt lgkmcnt(3)
    v_mfma_f32_32x32x16_bf16 v[48:63], v[92:95], a[44:47], v[48:63]
    v_mfma_f32_32x32x16_bf16 v[64:79], v[92:95], a[156:159], v[64:79]
    ds_read_b128 v[92:95], v8 offset:15360
    s_waitcnt lgkmcnt(3)
    v_mfma_f32_32x32x16_bf16 v[48:63], v[80:83], a[48:51], v[48:63]
    v_mfma_f32_32x32x16_bf16 v[64:79], v[80:83], a[160:163], v[64:79]
    ds_read_b128 v[80:83], v8 offset:16384
    s_waitcnt lgkmcnt(3)
    v_mfma_f32_32x32x16_bf16 v[48:63], v[84:87], a[52:55], v[48:63]
    v_mfma_f32_32x32x16_bf16 v[64:79], v[84:87], a[164:167], v[64:79]
    ds_read_b128 v[84:87], v8 offset:17408
    s_waitcnt lgkmcnt(3)
    v_mfma_f32_32x32x16_bf16 v[48:63], v[88:91], a[56:59], v[48:63]
    v_mfma_f32_32x32x16_bf16 v[64:79], v[88:91], a[168:171], v[64:79]
    ds_read_b128 v[88:91], v8 offset:18432
    s_waitcnt lgkmcnt(3)
    v_mfma_f32_32x32x16_bf16 v[48:63], v[92:95], a[60:63], v[48:63]
    v_mfma_f32_32x32x16_bf16 v[64:79], v[92:95], a[172:175], v[64:79]
    ds_read_b128 v[92:95], v8 offset:19456
    s_waitcnt lgkmcnt(3)
    v_mfma_f32_32x32x16_bf16 v[48:63], v[80:83], a[64:67], v[48:63]
    v_mfma_f32_32x32x16_bf16 v[64:79], v[80:83], a[176:179], v[64:79]
    ds_read_b128 v[80:83], v8 offset:20480
    s_waitcnt lgkmcnt(3)
    v_mfma_f32_32x32x16_bf16 v[48:63], v[84:87], a[68:71], v[48:63]
    v_mfma_f32_32x32x16_bf16 v[64:79], v[84:87], a[180:183], v[64:79]
    ds_read_b128 v[84:87], v8 offset:21504
    s_waitcnt lgkmcnt(3)
    v_mfma_f32_32x32x16_bf16 v[48:63], v[88:91], a[72:75], v[48:63]
    v_mfma_f32_32x32x16_bf16 v[64:79], v[88:91], a[184:187], v[64:79]
    ds_read_b128 v[88:91], v8 offset:22528
    s_waitcnt lgkmcnt(3)
    v_mfma_f32_32x32x16_bf16 v[48:63], v[92:95], a[76:79], v[48:63]
    v_mfma_f32_32x32x16_bf16 v[64:79], v[92:95], a[188:191], v[64:79]
    ds_read_b128 v[92:95], v8 offset:23552
    s_waitcnt lgkmcnt(3)
    v_mfma_f32_32x32x16_bf16 v[48:63], v[80:83], a[80:83], v[48:63]
    v_mfma_f32_32x32x16_bf16 v[64:79], v[80:83], a[192:195], v[64:79]
    ds_read_b128 v[80:83], v8 offset:24576
    s_waitcnt lgkmcnt(3)
    v_mfma_f32_32x32x16_bf16 v[48:63], v[84:87], a[84:87], v[48:63]
    v_mfma_f32_32x32x16_bf16 v[64:79], v[84:87], a[196:199], v[64:79]
    ds_read_b128 v[84:87], v8 offset:25600
    s_waitcnt lgkmcnt(3)
    v_mfma_f32_32x32x16_bf16 v[48:63], v[88:91], a[88:91], v[48:63]
    v_mfma_f32_32x32x16_bf16 v[64:79], v[88:91], a[200:203], v[64:79]
    ds_read_b128 v[88:91], v8 offset:26624
    s_waitcnt lgkmcnt(3)
    v_mfma_f32_32x32x16_bf16 v[48:63], v[92:95], a[92:95], v[48:63]
    v_mfma_f32_32x32x16_bf16 v[64:79], v[92:95], a[204:207], v[64:79]
    ds_read_b128 v[92:95], v8 offset:27648
    s_waitcnt lgkmcnt(3)
    v_mfma_f32_32x32x16_bf16 v[48:63], v[80:83], a[96:99], v[48:63]
    v_mfma_f32_32x32x16_bf16 v[64:79], v[80:83], a[208:211], v[64:79]
    s_waitcnt lgkmcnt(2)
    v_mfma_f32_32x32x16_bf16 v[48:63], v[84:87], a[100:103], v[48:63]
    v_mfma_f32_32x32x16_bf16 v[64:79], v[84:87], a[212:215], v[64:79]
    s_waitcnt lgkmcnt(1)
    v_mfma_f32_32x32x16_bf16 v[48:63], v[88:91], a[104:107], v[48:63]
    v_mfma_f32_32x32x16_bf16 v[64:79], v[88:91], a[216:219], v[64:79]
    s_waitcnt lgkmcnt(0)
    v_mfma_f32_32x32x16_bf16 v[48:63], v[92:95], a[108:111], v[48:63]
    v_mfma_f32_32x32x16_bf16 v[64:79], v[92:95], a[220:223], v[64:79]
    s_mov_b32 s31, 2
    s_barrier
    s_mul_i32 s24, s20, 7168
    s_add_u32 s24, s24, s34
    s_add_u32 s25, s28, 4096
    s_mov_b32 m0, s24
    s_add_u32 s24, s24, 4096
    buffer_load_dwordx4 v2, s[8:11], s28 offen offset:0 lds
    buffer_load_dwordx4 v2, s[8:11], s28 offen offset:1024 lds
    buffer_load_dwordx4 v2, s[8:11], s28 offen offset:2048 lds
    buffer_load_dwordx4 v2, s[8:11], s28 offen offset:3072 lds
    s_mov_b32 m0, s24
    s_add_u32 s24, s24, 4096
    buffer_load_dwordx4 v2, s[8:11], s25 offen offset:0 lds
    buffer_load_dwordx4 v2, s[8:11], s25 offen offset:1024 lds
    buffer_load_dwordx4 v2, s[8:11], s25 offen offset:2048 lds
    s_add_u32 s28, s28, 114688
    s_add_u32 s34, s34, 28672
    s_cmp_eq_u32 s34, 86016
    s_cselect_b32 s34, 0, s34
    v_add_u32 v8, s35, v2
    s_add_u32 s35, s35, 28672
    s_cmp_eq_u32 s35, 86016
    s_cselect_b32 s35, 0, s35
    ds_read_b128 v[80:83], v8 offset:0
    ds_read_b128 v[84:87], v8 offset:1024
    ds_read_b128 v[88:91], v8 offset:2048
    ds_read_b128 v[92:95], v8 offset:3072
    s_waitcnt lgkmcnt(3)
    v_mfma_f32_32x32x16_bf16 v[16:31], v[80:83], a[0:3], 0
    v_mfma_f32_32x32x16_bf16 v[32:47], v[80:83], a[112:115], 0
    ds_read_b128 v[80:83], v8 offset:4096
    s_waitcnt lgkmcnt(3)
    v_mfma_f32_32x32x16_bf16 v[16:31], v[84:87], a[4:7], v[16:31]
    s_add_u32 s26, s29, 1024
    v_mfma_f32_32x32x16_bf16 v[32:47], v[84:87], a[116:119], v[32:47]
    v_cvt_pk_bf16_f32 v48, v48, v49
    ds_read_b128 v[84:87], v8 offset:5120
    s_waitcnt lgkmcnt(3)
    v_mfma_f32_32x32x16_bf16 v[16:31], v[88:91], a[8:11], v[16:31]
    v_cvt_pk_bf16_f32 v49, v50, v51
    v_mfma_f32_32x32x16_bf16 v[32:47], v[88:91], a[120:123], v[32:47]
    v_cvt_pk_bf16_f32 v50, v52, v53
    ds_read_b128 v[88:91], v8 offset:6144
    s_waitcnt lgkmcnt(3)
    v_mfma_f32_32x32x16_bf16 v[16:31], v[92:95], a[12:15], v[16:31]
    v_cvt_pk_bf16_f32 v51, v54, v55
    v_mfma_f32_32x32x16_bf16 v[32:47], v[92:95], a[124:127], v[32:47]
    buffer_store_dwordx4 v[48:51], v5, s[8:11], s29 offen offset:0 sc1
    ds_read_b128 v[92:95], v8 offset:7168
    s_waitcnt lgkmcnt(3)
    v_mfma_f32_32x32x16_bf16 v[16:31], v[80:83], a[16:19], v[16:31]
    v_cvt_pk_bf16_f32 v56, v56, v57
    v_mfma_f32_32x32x16_bf16 v[32:47], v[80:83], a[128:131], v[32:47]
    v_cvt_pk_bf16_f32 v57, v58, v59
    ds_read_b128 v[80:83], v8 offset:8192
    s_waitcnt lgkmcnt(3)
    v_mfma_f32_32x32x16_bf16 v[16:31], v[84:87], a[20:23], v[16:31]
    v_cvt_pk_bf16_f32 v58, v60, v61
    v_mfma_f32_32x32x16_bf16 v[32:47], v[84:87], a[132:135], v[32:47]
    v_cvt_pk_bf16_f32 v59, v62, v63
    ds_read_b128 v[84:87], v8 offset:9216
    s_waitcnt lgkmcnt(3)
    v_mfma_f32_32x32x16_bf16 v[16:31], v[88:91], a[24:27], v[16:31]
    buffer_store_dwordx4 v[56:59], v5, s[8:11], s29 offen offset:512 sc1
    v_mfma_f32_32x32x16_bf16 v[32:47], v[88:91], a[136:139], v[32:47]
    v_cvt_pk_bf16_f32 v64, v64, v65
    ds_read_b128 v[88:91], v8 offset:10240
    s_waitcnt lgkmcnt(3)
    v_mfma_f32_32x32x16_bf16 v[16:31], v[92:95], a[28:31], v[16:31]
    v_cvt_pk_bf16_f32 v65, v66, v67
    v_mfma_f32_32x32x16_bf16 v[32:47], v[92:95], a[140:143], v[32:47]
    v_cvt_pk_bf16_f32 v66, v68, v69
    ds_read_b128 v[92:95], v8 offset:11264
    s_waitcnt lgkmcnt(3)
    v_mfma_f32_32x32x16_bf16 v[16:31], v[80:83], a[32:35], v[16:31]
    v_cvt_pk_bf16_f32 v67, v70, v71
    v_mfma_f32_32x32x16_bf16 v[32:47], v[80:83], a[144:147], v[32:47]
    buffer_store_dwordx4 v[64:67], v5, s[8:11], s26 offen offset:0 sc1
    ds_read_b128 v[80:83], v8 offset:12288
    s_waitcnt lgkmcnt(3)
    v_mfma_f32_32x32x16_bf16 v[16:31], v[84:87], a[36:39], v[16:31]
    v_cvt_pk_bf16_f32 v72, v72, v73
    v_mfma_f32_32x32x16_bf16 v[32:47], v[84:87], a[148:151], v[32:47]
    v_cvt_pk_bf16_f32 v73, v74, v75
    ds_read_b128 v[84:87], v8 offset:13312
    s_waitcnt lgkmcnt(3)
    v_mfma_f32_32x32x16_bf16 v[16:31], v[88:91], a[40:43], v[16:31]
    v_cvt_pk_bf16_f32 v74, v76, v77
    v_mfma_f32_32x32x16_bf16 v[32:47], v[88:91], a[152:155], v[32:47]
    v_cvt_pk_bf16_f32 v75, v78, v79
    ds_read_b128 v[88:91], v8 offset:14336
    s_waitcnt lgkmcnt(3)
    v_mfma_f32_32x32x16_bf16 v[16:31], v[92:95], a[44:47], v[16:31]
    buffer_store_dwordx4 v[72:75], v5, s[8:11], s26 offen offset:512 sc1
    v_mfma_f32_32x32x16_bf16 v[32:47], v[92:95], a[156:159], v[32:47]
    s_add_u32 s29, s29, 1835008
    ds_read_b128 v[92:95], v8 offset:15360
    s_waitcnt lgkmcnt(3)
    v_mfma_f32_32x32x16_bf16 v[16:31], v[80:83], a[48:51], v[16:31]
    v_mfma_f32_32x32x16_bf16 v[32:47], v[80:83], a[160:163], v[32:47]
    ds_read_b128 v[80:83], v8 offset:16384
    s_waitcnt lgkmcnt(3)
    v_mfma_f32_32x32x16_bf16 v[16:31], v[84:87], a[52:55], v[16:31]
    v_mfma_f32_32x32x16_bf16 v[32:47], v[84:87], a[164:167], v[32:47]
    ds_read_b128 v[84:87], v8 offset:17408
    s_waitcnt lgkmcnt(3)
    v_mfma_f32_32x32x16_bf16 v[16:31], v[88:91], a[56:59], v[16:31]
    v_mfma_f32_32x32x16_bf16 v[32:47], v[88:91], a[168:171], v[32:47]
    ds_read_b128 v[88:91], v8 offset:18432
    s_waitcnt lgkmcnt(3)
    v_mfma_f32_32x32x16_bf16 v[16:31], v[92:95], a[60:63], v[16:31]
    v_mfma_f32_32x32x16_bf16 v[32:47], v[92:95], a[172:175], v[32:47]
    ds_read_b128 v[92:95], v8 offset:19456
    s_waitcnt lgkmcnt(3)
    v_mfma_f32_32x32x16_bf16 v[16:31], v[80:83], a[64:67], v[16:31]
    v_mfma_f32_32x32x16_bf16 v[32:47], v[80:83], a[176:179], v[32:47]
    ds_read_b128 v[80:83], v8 offset:20480
    s_waitcnt lgkmcnt(3)
    v_mfma_f32_32x32x16_bf16 v[16:31], v[84:87], a[68:71], v[16:31]
    v_mfma_f32_32x32x16_bf16 v[32:47], v[84:87], a[180:183], v[32:47]
    ds_read_b128 v[84:87], v8 offset:21504
    s_waitcnt lgkmcnt(3)
    v_mfma_f32_32x32x16_bf16 v[16:31], v[88:91], a[72:75], v[16:31]
    v_mfma_f32_32x32x16_bf16 v[32:47], v[88:91], a[184:187], v[32:47]
    ds_read_b128 v[88:91], v8 offset:22528
    s_waitcnt lgkmcnt(3)
    v_mfma_f32_32x32x16_bf16 v[16:31], v[92:95], a[76:79], v[16:31]
    v_mfma_f32_32x32x16_bf16 v[32:47], v[92:95], a[188:191], v[32:47]
    ds_read_b128 v[92:95], v8 offset:23552
    s_waitcnt lgkmcnt(3)
    v_mfma_f32_32x32x16_bf16 v[16:31], v[80:83], a[80:83], v[16:31]
    v_mfma_f32_32x32x16_bf16 v[32:47], v[80:83], a[192:195], v[32:47]
    ds_read_b128 v[80:83], v8 offset:24576
    s_waitcnt lgkmcnt(3)
    v_mfma_f32_32x32x16_bf16 v[16:31], v[84:87], a[84:87], v[16:31]
    v_mfma_f32_32x32x16_bf16 v[32:47], v[84:87], a[196:199], v[32:47]
    ds_read_b128 v[84:87], v8 offset:25600
    s_waitcnt lgkmcnt(3)
    v_mfma_f32_32x32x16_bf16 v[16:31], v[88:91], a[88:91], v[16:31]
    v_mfma_f32_32x32x16_bf16 v[32:47], v[88:91], a[200:203], v[32:47]
    ds_read_b128 v[88:91], v8 offset:26624
    s_waitcnt lgkmcnt(3)
    v_mfma_f32_32x32x16_bf16 v[16:31], v[92:95], a[92:95], v[16:31]
    v_mfma_f32_32x32x16_bf16 v[32:47], v[92:95], a[204:207], v[32:47]
    ds_read_b128 v[92:95], v8 offset:27648
    s_waitcnt lgkmcnt(3)
    v_mfma_f32_32x32x16_bf16 v[16:31], v[80:83], a[96:99], v[16:31]
    v_mfma_f32_32x32x16_bf16 v[32:47], v[80:83], a[208:211], v[32:47]
    s_waitcnt lgkmcnt(2)
    v_mfma_f32_32x32x16_bf16 v[16:31], v[84:87], a[100:103], v[16:31]
    v_mfma_f32_32x32x16_bf16 v[32:47], v[84:87], a[212:215], v[32:47]
    s_waitcnt lgkmcnt(1)
    v_mfma_f32_32x32x16_bf16 v[16:31], v[88:91], a[104:107], v[16:31]
    v_mfma_f32_32x32x16_bf16 v[32:47], v[88:91], a[216:219], v[32:47]
    s_waitcnt lgkmcnt(0)
    v_mfma_f32_32x32x16_bf16 v[16:31], v[92:95], a[108:111], v[16:31]
    v_mfma_f32_32x32x16_bf16 v[32:47], v[92:95], a[220:223], v[32:47]
    s_waitcnt vmcnt(11)
    s_branch H_u_mid_any
H_u_loop_any:
    s_waitcnt vmcnt(15)
    s_barrier
    s_add_u32 s31, s31, 1
    s_cmp_lt_u32 s31, 5
    s_cbranch_scc1 H_n3_28_any
    s_cmp_lg_u32 s20, 0
    s_cbranch_scc1 H_nf_29_any
    s_mov_b64 exec, 0xff
    buffer_store_dwordx4 v[96:99], v2, s[8:11], s30 offen sc1
    s_mov_b64 exec, -1
H_nf_29_any:
    s_add_u32 s30, s30, 45056
H_n3_28_any:
    s_cmp_eq_u32 s31, 16
    s_cbranch_scc1 H_u_end_any
    s_mul_i32 s24, s20, 7168
    s_add_u32 s24, s24, s34
    s_add_u32 s25, s28, 4096
    s_mov_b32 m0, s24
    s_add_u32 s24, s24, 4096
    buffer_load_dwordx4 v2, s[8:11], s28 offen offset:0 lds
    buffer_load_dwordx4 v2, s[8:11], s28 offen offset:1024 lds
    buffer_load_dwordx4 v2, s[8:11], s28 offen offset:2048 lds
    buffer_load_dwordx4 v2, s[8:11], s28 offen offset:3072 lds
    s_mov_b32 m0, s24
    s_add_u32 s24, s24, 4096
    buffer_load_dwordx4 v2, s[8:11], s25 offen offset:0 lds
    buffer_load_dwordx4 v2, s[8:11], s25 offen offset:1024 lds
    buffer_load_dwordx4 v2, s[8:11], s25 offen offset:2048 lds
    s_add_u32 s28, s28, 114688
    s_add_u32 s34, s34, 28672
    s_cmp_eq_u32 s34, 86016
    s_cselect_b32 s34, 0, s34
    v_add_u32 v8, s35, v2
    s_add_u32 s35, s35, 28672
    s_cmp_eq_u32 s35, 86016
    s_cselect_b32 s35, 0, s35
    ds_read_b128 v[80:83], v8 offset:0
    ds_read_b128 v[84:87], v8 offset:1024
    ds_read_b128 v[88:91], v8 offset:2048
    ds_read_b128 v[92:95], v8 offset:3072
    s_waitcnt lgkmcnt(3)
    v_mfma_f32_32x32x16_bf16 v[16:31], v[80:83], a[0:3], 0
    v_mfma_f32_32x32x16_bf16 v[32:47], v[80:83], a[112:115], 0
    ds_read_b128 v[80:83], v8 offset:4096
    s_waitcnt lgkmcnt(3)
    v_mfma_f32_32x32x16_bf16 v[16:31], v[84:87], a[4:7], v[16:31]
    s_add_u32 s26, s29, 1024
    v_mfma_f32_32x32x16_bf16 v[32:47], v[84:87], a[116:119], v[32:47]
    v_cvt_pk_bf16_f32 v48, v48, v49
    ds_read_b128 v[84:87], v8 offset:5120
    s_waitcnt lgkmcnt(3)
    v_mfma_f32_32x32x16_bf16 v[16:31], v[88:91], a[8:11], v[16:31]
    v_cvt_pk_bf16_f32 v49, v50, v51
    v_mfma_f32_32x32x16_bf16 v[32:47], v[88:91], a[120:123], v[32:47]
    v_cvt_pk_bf16_f32 v50, v52, v53
    ds_read_b128 v[88:91], v8 offset:6144
    s_waitcnt lgkmcnt(3)
    v_mfma_f32_32x32x16_bf16 v[16:31], v[92:95], a[12:15], v[16:31]
    v_cvt_pk_bf16_f32 v51, v54, v55
    v_mfma_f32_32x32x16_bf16 v[32:47], v[92:95], a[124:127], v[32:47]
    buffer_store_dwordx4 v[48:51], v5, s[8:11], s29 offen offset:0 sc1
    ds_read_b128 v[92:95], v8 offset:7168
    s_waitcnt lgkmcnt(3)
    v_mfma_f32_32x32x16_bf16 v[16:31], v[80:83], a[16:19], v[16:31]
    v_cvt_pk_bf16_f32 v56, v56, v57
    v_mfma_f32_32x32x16_bf16 v[32:47], v[80:83], a[128:131], v[32:47]
    v_cvt_pk_bf16_f32 v57, v58, v59
    ds_read_b128 v[80:83], v8 offset:8192
    s_waitcnt lgkmcnt(3)
    v_mfma_f32_32x32x16_bf16 v[16:31], v[84:87], a[20:23], v[16:31]
    v_cvt_pk_bf16_f32 v58, v60, v61
    v_mfma_f32_32x32x16_bf16 v[32:47], v[84:87], a[132:135], v[32:47]
    v_cvt_pk_bf16_f32 v59, v62, v63
    ds_read_b128 v[84:87], v8 offset:9216
    s_waitcnt lgkmcnt(3)
    v_mfma_f32_32x32x16_bf16 v[16:31], v[88:91], a[24:27], v[16:31]
    buffer_store_dwordx4 v[56:59], v5, s[8:11], s29 offen offset:512 sc1
    v_mfma_f32_32x32x16_bf16 v[32:47], v[88:91], a[136:139], v[32:47]
    v_cvt_pk_bf16_f32 v64, v64, v65
    ds_read_b128 v[88:91], v8 offset:10240
    s_waitcnt lgkmcnt(3)
    v_mfma_f32_32x32x16_bf16 v[16:31], v[92:95], a[28:31], v[16:31]
    v_cvt_pk_bf16_f32 v65, v66, v67
    v_mfma_f32_32x32x16_bf16 v[32:47], v[92:95], a[140:143], v[32:47]
    v_cvt_pk_bf16_f32 v66, v68, v69
    ds_read_b128 v[92:95], v8 offset:11264
    s_waitcnt lgkmcnt(3)
    v_mfma_f32_32x32x16_bf16 v[16:31], v[80:83], a[32:35], v[16:31]
    v_cvt_pk_bf16_f32 v67, v70, v71
    v_mfma_f32_32x32x16_bf16 v[32:47], v[80:83], a[144:147], v[32:47]
    buffer_store_dwordx4 v[64:67], v5, s[8:11], s26 offen offset:0 sc1
    ds_read_b128 v[80:83], v8 offset:12288
    s_waitcnt lgkmcnt(3)
    v_mfma_f32_32x32x16_bf16 v[16:31], v[84:87], a[36:39], v[16:31]
    v_cvt_pk_bf16_f32 v72, v72, v73
    v_mfma_f32_32x32x16_bf16 v[32:47], v[84:87], a[148:151], v[32:47]
    v_cvt_pk_bf16_f32 v73, v74, v75
    ds_read_b128 v[84:87], v8 offset:13312
    s_waitcnt lgkmcnt(3)
    v_mfma_f32_32x32x16_bf16 v[16:31], v[88:91], a[40:43], v[16:31]
    v_cvt_pk_bf16_f32 v74, v76, v77
    v_mfma_f32_32x32x16_bf16 v[32:47], v[88:91], a[152:155], v[32:47]
    v_cvt_pk_bf16_f32 v75, v78, v79
    ds_read_b128 v[88:91], v8 offset:14336
    s_waitcnt lgkmcnt(3)
    v_mfma_f32_32x32x16_bf16 v[16:31], v[92:95], a[44:47], v[16:31]
    buffer_store_dwordx4 v[72:75], v5, s[8:11], s26 offen offset:512 sc1
    v_mfma_f32_32x32x16_bf16 v[32:47], v[92:95], a[156:159], v[32:47]
    s_add_u32 s29, s29, 1835008
    ds_read_b128 v[92:95], v8 offset:15360
    s_waitcnt lgkmcnt(3)
    v_mfma_f32_32x32x16_bf16 v[16:31], v[80:83], a[48:51], v[16:31]
    v_mfma_f32_32x32x16_bf16 v[32:47], v[80:83], a[160:163], v[32:47]
    ds_read_b128 v[80:83], v8 offset:16384
    s_waitcnt lgkmcnt(3)
    v_mfma_f32_32x32x16_bf16 v[16:31], v[84:87], a[52:55], v[16:31]
    v_mfma_f32_32x32x16_bf16 v[32:47], v[84:87], a[164:167], v[32:47]
    ds_read_b128 v[84:87], v8 offset:17408
    s_waitcnt lgkmcnt(3)
    v_mfma_f32_32x32x16_bf16 v[16:31], v[88:91], a[56:59], v[16:31]
    v_mfma_f32_32x32x16_bf16 v[32:47], v[88:91], a[168:171], v[32:47]
    ds_read_b128 v[88:91], v8 offset:18432
    s_waitcnt lgkmcnt(3)
    v_mfma_f32_32x32x16_bf16 v[16:31], v[92:95], a[60:63], v[16:31]
    v_mfma_f32_32x32x16_bf16 v[32:47], v[92:95], a[172:175], v[32:47]
    ds_read_b128 v[92:95], v8 offset:19456
    s_waitcnt lgkmcnt(3)
    v_mfma_f32_32x32x16_bf16 v[16:31], v[80:83], a[64:67], v[16:31]
    v_mfma_f32_32x32x16_bf16 v[32:47], v[80:83], a[176:179], v[32:47]
    ds_read_b128 v[80:83], v8 offset:20480
    s_waitcnt lgkmcnt(3)
    v_mfma_f32_32x32x16_bf16 v[16:31], v[84:87], a[68:71], v[16:31]
    v_mfma_f32_32x32x16_bf16 v[32:47], v[84:87], a[180:183], v[32:47]
    ds_read_b128 v[84:87], v8 offset:21504
    s_waitcnt lgkmcnt(3)
    v_mfma_f32_32x32x16_bf16 v[16:31], v[88:91], a[72:75], v[16:31]
    v_mfma_f32_32x32x16_bf16 v[32:47], v[88:91], a[184:187], v[32:47]
    ds_read_b128 v[88:91], v8 offset:22528
    s_waitcnt lgkmcnt(3)
    v_mfma_f32_32x32x16_bf16 v[16:31], v[92:95], a[76:79], v[16:31]
    v_mfma_f32_32x32x16_bf16 v[32:47], v[92:95], a[188:191], v[32:47]
    ds_read_b128 v[92:95], v8 offset:23552
    s_waitcnt lgkmcnt(3)
    v_mfma_f32_32x32x16_bf16 v[16:31], v[80:83], a[80:83], v[16:31]
    v_mfma_f32_32x32x16_bf16 v[32:47], v[80:83], a[192:195], v[32:47]
    ds_read_b128 v[80:83], v8 offset:24576
    s_waitcnt lgkmcnt(3)
    v_mfma_f32_32x32x16_bf16 v[16:31], v[84:87], a[84:87], v[16:31]
    v_mfma_f32_32x32x16_bf16 v[32:47], v[84:87], a[196:199], v[32:47]
    ds_read_b128 v[84:87], v8 offset:25600
    s_waitcnt lgkmcnt(3)
    v_mfma_f32_32x32x16_bf16 v[16:31], v[88:91], a[88:91], v[16:31]
    v_mfma_f32_32x32x16_bf16 v[32:47], v[88:91], a[200:203], v[32:47]
    ds_read_b128 v[88:91], v8 offset:26624
    s_waitcnt lgkmcnt(3)
    v_mfma_f32_32x32x16_bf16 v[16:31], v[92:95], a[92:95], v[16:31]
    v_mfma_f32_32x32x16_bf16 v[32:47], v[92:95], a[204:207], v[32:47]
    ds_read_b128 v[92:95], v8 offset:27648
    s_waitcnt lgkmcnt(3)
    v_mfma_f32_32x32x16_bf16 v[16:31], v[80:83], a[96:99], v[16:31]
    v_mfma_f32_32x32x16_bf16 v[32:47], v[80:83], a[208:211], v[32:47]
    s_waitcnt lgkmcnt(2)
    v_mfma_f32_32x32x16_bf16 v[16:31], v[84:87], a[100:103], v[16:31]
    v_mfma_f32_32x32x16_bf16 v[32:47], v[84:87], a[212:215], v[32:47]
    s_waitcnt lgkmcnt(1)
    v_mfma_f32_32x32x16_bf16 v[16:31], v[88:91], a[104:107], v[16:31]
    v_mfma_f32_32x32x16_bf16 v[32:47], v[88:91], a[216:219], v[32:47]
    s_waitcnt lgkmcnt(0)
    v_mfma_f32_32x32x16_bf16 v[16:31], v[92:95], a[108:111], v[16:31]
    v_mfma_f32_32x32x16_bf16 v[32:47], v[92:95], a[220:223], v[32:47]
    s_waitcnt vmcnt(15)
H_u_mid_any:
    s_barrier
    s_add_u32 s31, s31, 1
    s_cmp_lt_u32 s31, 5
    s_cbranch_scc1 H_n3_30_any
    s_cmp_lg_u32 s20, 0
    s_cbranch_scc1 H_nf_31_any
    s_mov_b64 exec, 0xff
    buffer_store_dwordx4 v[96:99], v2, s[8:11], s30 offen sc1
    s_mov_b64 exec, -1
H_nf_31_any:
    s_add_u32 s30, s30, 45056
H_n3_30_any:
    s_cmp_lg_u32 s31, 11
    s_cbranch_scc1 H_nw_32_any
    s_cmp_ge_u32 s22, 28
    s_cbranch_scc1 H_nw_32_any
    s_load_dwordx2 s[56:57], s[0:1], 64
    s_load_dwordx2 s[58:59], s[0:1], 80
    v_lshlrev_b32 v9, 7, v0
    s_mul_i32 s24, s22, 57344
    v_add_u32 v9, s24, v9
    s_waitcnt lgkmcnt(0)
    v_add_u32 v10, 24576, v9
    global_load_dword v11, v9, s[56:57]
    global_load_dword v11, v10, s[56:57]
    global_load_dword v11, v9, s[58:59]
    global_load_dword v11, v10, s[58:59]
H_nw_32_any:
    s_mul_i32 s24, s20, 7168
    s_add_u32 s24, s24, s34
    s_add_u32 s25, s28, 4096
    s_mov_b32 m0, s24
    s_add_u32 s24, s24, 4096
    buffer_load_dwordx4 v2, s[8:11], s28 offen offset:0 lds
    buffer_load_dwordx4 v2, s[8:11], s28 offen offset:1024 lds
    buffer_load_dwordx4 v2, s[8:11], s28 offen offset:2048 lds
    buffer_load_dwordx4 v2, s[8:11], s28 offen offset:3072 lds
    s_mov_b32 m0, s24
    s_add_u32 s24, s24, 4096
    buffer_load_dwordx4 v2, s[8:11], s25 offen offset:0 lds
    buffer_load_dwordx4 v2, s[8:11], s25 offen offset:1024 lds
    buffer_load_dwordx4 v2, s[8:11], s25 offen offset:2048 lds
    s_add_u32 s28, s28, 114688
    s_add_u32 s34, s34, 28672
    s_cmp_eq_u32 s34, 86016
    s_cselect_b32 s34, 0, s34
    v_add_u32 v8, s35, v2
    s_add_u32 s35, s35, 28672
    s_cmp_eq_u32 s35, 86016
    s_cselect_b32 s35, 0, s35
    ds_read_b128 v[80:83], v8 offset:0
    ds_read_b128 v[84:87], v8 offset:1024
    ds_read_b128 v[88:91], v8 offset:2048
    ds_read_b128 v[92:95], v8 offset:3072
    s_waitcnt lgkmcnt(3)
    v_mfma_f32_32x32x16_bf16 v[48:63], v[80:83], a[0:3], 0
    v_mfma_f32_32x32x16_bf16 v[64:79], v[80:83], a[112:115], 0
    ds_read_b128 v[80:83], v8 offset:4096
    s_waitcnt lgkmcnt(3)
    v_mfma_f32_32x32x16_bf16 v[48:63], v[84:87], a[4:7], v[48:63]
    s_add_u32 s26, s29, 1024
    v_mfma_f32_32x32x16_bf16 v[64:79], v[84:87], a[116:119], v[64:79]
    v_cvt_pk_bf16_f32 v16, v16, v17
    ds_read_b128 v[84:87], v8 offset:5120
    s_waitcnt lgkmcnt(3)
    v_mfma_f32_32x32x16_bf16 v[48:63], v[88:91], a[8:11], v[48:63]
    v_cvt_pk_bf16_f32 v17, v18, v19
    v_mfma_f32_32x32x16_bf16 v[64:79], v[88:91], a[120:123], v[64:79]
    v_cvt_pk_bf16_f32 v18, v20, v21
    ds_read_b128 v[88:91], v8 offset:6144
    s_waitcnt lgkmcnt(3)
    v_mfma_f32_32x32x16_bf16 v[48:63], v[92:95], a[12:15], v[48:63]
    v_cvt_pk_bf16_f32 v19, v22, v23
    v_mfma_f32_32x32x16_bf16 v[64:79], v[92:95], a[124:127], v[64:79]
    buffer_store_dwordx4 v[16:19], v5, s[8:11], s29 offen offset:0 sc1
    ds_read_b128 v[92:95], v8 offset:7168
    s_waitcnt lgkmcnt(3)
    v_mfma_f32_32x32x16_bf16 v[48:63], v[80:83], a[16:19], v[48:63]
    v_cvt_pk_bf16_f32 v24, v24, v25
    v_mfma_f32_32x32x16_bf16 v[64:79], v[80:83], a[128:131], v[64:79]
    v_cvt_pk_bf16_f32 v25, v26, v27
    ds_read_b128 v[80:83], v8 offset:8192
    s_waitcnt lgkmcnt(3)
    v_mfma_f32_32x32x16_bf16 v[48:63], v[84:87], a[20:23], v[48:63]
    v_cvt_pk_bf16_f32 v26, v28, v29
    v_mfma_f32_32x32x16_bf16 v[64:79], v[84:87], a[132:135], v[64:79]
    v_cvt_pk_bf16_f32 v27, v30, v31
    ds_read_b128 v[84:87], v8 offset:9216
    s_waitcnt lgkmcnt(3)
    v_mfma_f32_32x32x16_bf16 v[48:63], v[88:91], a[24:27], v[48:63]
    buffer_store_dwordx4 v[24:27], v5, s[8:11], s29 offen offset:512 sc1
    v_mfma_f32_32x32x16_bf16 v[64:79], v[88:91], a[136:139], v[64:79]
    v_cvt_pk_bf16_f32 v32, v32, v33
    ds_read_b128 v[88:91], v8 offset:10240
    s_waitcnt lgkmcnt(3)
    v_mfma_f32_32x32x16_bf16 v[48:63], v[92:95], a[28:31], v[48:63]
    v_cvt_pk_bf16_f32 v33, v34, v35
    v_mfma_f32_32x32x16_bf16 v[64:79], v[92:95], a[140:143], v[64:79]
    v_cvt_pk_bf16_f32 v34, v36, v37
    ds_read_b128 v[92:95], v8 offset:11264
    s_waitcnt lgkmcnt(3)
    v_mfma_f32_32x32x16_bf16 v[48:63], v[80:83], a[32:35], v[48:63]
    v_cvt_pk_bf16_f32 v35, v38, v39
    v_mfma_f32_32x32x16_bf16 v[64:79], v[80:83], a[144:147], v[64:79]
    buffer_store_dwordx4 v[32:35], v5, s[8:11], s26 offen offset:0 sc1
    ds_read_b128 v[80:83], v8 offset:12288
    s_waitcnt lgkmcnt(3)
    v_mfma_f32_32x32x16_bf16 v[48:63], v[84:87], a[36:39], v[48:63]
    v_cvt_pk_bf16_f32 v40, v40, v41
    v_mfma_f32_32x32x16_bf16 v[64:79], v[84:87], a[148:151], v[64:79]
    v_cvt_pk_bf16_f32 v41, v42, v43
    ds_read_b128 v[84:87], v8 offset:13312
    s_waitcnt lgkmcnt(3)
    v_mfma_f32_32x32x16_bf16 v[48:63], v[88:91], a[40:43], v[48:63]
    v_cvt_pk_bf16_f32 v42, v44, v45
    v_mfma_f32_32x32x16_bf16 v[64:79], v[88:91], a[152:155], v[64:79]
    v_cvt_pk_bf16_f32 v43, v46, v47
    ds_read_b128 v[88:91], v8 offset:14336
    s_waitcnt lgkmcnt(3)
    v_mfma_f32_32x32x16_bf16 v[48:63], v[92:95], a[44:47], v[48:63]
    buffer_store_dwordx4 v[40:43], v5, s[8:11], s26 offen offset:512 sc1
    v_mfma_f32_32x32x16_bf16 v[64:79], v[92:95], a[156:159], v[64:79]
    s_add_u32 s29, s29, 1835008
    ds_read_b128 v[92:95], v8 offset:15360
    s_waitcnt lgkmcnt(3)
    v_mfma_f32_32x32x16_bf16 v[48:63], v[80:83], a[48:51], v[48:63]
    v_mfma_f32_32x32x16_bf16 v[64:79], v[80:83], a[160:163], v[64:79]
    ds_read_b128 v[80:83], v8 offset:16384
    s_waitcnt lgkmcnt(3)
    v_mfma_f32_32x32x16_bf16 v[48:63], v[84:87], a[52:55], v[48:63]
    v_mfma_f32_32x32x16_bf16 v[64:79], v[84:87], a[164:167], v[64:79]
    ds_read_b128 v[84:87], v8 offset:17408
    s_waitcnt lgkmcnt(3)
    v_mfma_f32_32x32x16_bf16 v[48:63], v[88:91], a[56:59], v[48:63]
    v_mfma_f32_32x32x16_bf16 v[64:79], v[88:91], a[168:171], v[64:79]
    ds_read_b128 v[88:91], v8 offset:18432
    s_waitcnt lgkmcnt(3)
    v_mfma_f32_32x32x16_bf16 v[48:63], v[92:95], a[60:63], v[48:63]
    v_mfma_f32_32x32x16_bf16 v[64:79], v[92:95], a[172:175], v[64:79]
    ds_read_b128 v[92:95], v8 offset:19456
    s_waitcnt lgkmcnt(3)
    v_mfma_f32_32x32x16_bf16 v[48:63], v[80:83], a[64:67], v[48:63]
    v_mfma_f32_32x32x16_bf16 v[64:79], v[80:83], a[176:179], v[64:79]
    ds_read_b128 v[80:83], v8 offset:20480
    s_waitcnt lgkmcnt(3)
    v_mfma_f32_32x32x16_bf16 v[48:63], v[84:87], a[68:71], v[48:63]
    v_mfma_f32_32x32x16_bf16 v[64:79], v[84:87], a[180:183], v[64:79]
    ds_read_b128 v[84:87], v8 offset:21504
    s_waitcnt lgkmcnt(3)
    v_mfma_f32_32x32x16_bf16 v[48:63], v[88:91], a[72:75], v[48:63]
    v_mfma_f32_32x32x16_bf16 v[64:79], v[88:91], a[184:187], v[64:79]
    ds_read_b128 v[88:91], v8 offset:22528
    s_waitcnt lgkmcnt(3)
    v_mfma_f32_32x32x16_bf16 v[48:63], v[92:95], a[76:79], v[48:63]
    v_mfma_f32_32x32x16_bf16 v[64:79], v[92:95], a[188:191], v[64:79]
    ds_read_b128 v[92:95], v8 offset:23552
    s_waitcnt lgkmcnt(3)
    v_mfma_f32_32x32x16_bf16 v[48:63], v[80:83], a[80:83], v[48:63]
    v_mfma_f32_32x32x16_bf16 v[64:79], v[80:83], a[192:195], v[64:79]
    ds_read_b128 v[80:83], v8 offset:24576
    s_waitcnt lgkmcnt(3)
    v_mfma_f32_32x32x16_bf16 v[48:63], v[84:87], a[84:87], v[48:63]
    v_mfma_f32_32x32x16_bf16 v[64:79], v[84:87], a[196:199], v[64:79]
    ds_read_b128 v[84:87], v8 offset:25600
    s_waitcnt lgkmcnt(3)
    v_mfma_f32_32x32x16_bf16 v[48:63], v[88:91], a[88:91], v[48:63]
    v_mfma_f32_32x32x16_bf16 v[64:79], v[88:91], a[200:203], v[64:79]
    ds_read_b128 v[88:91], v8 offset:26624
    s_waitcnt lgkmcnt(3)
    v_mfma_f32_32x32x16_bf16 v[48:63], v[92:95], a[92:95], v[48:63]
    v_mfma_f32_32x32x16_bf16 v[64:79], v[92:95], a[204:207], v[64:79]
    ds_read_b128 v[92:95], v8 offset:27648
    s_waitcnt lgkmcnt(3)
    v_mfma_f32_32x32x16_bf16 v[48:63], v[80:83], a[96:99], v[48:63]
    v_mfma_f32_32x32x16_bf16 v[64:79], v[80:83], a[208:211], v[64:79]
    s_waitcnt lgkmcnt(2)
    v_mfma_f32_32x32x16_bf16 v[48:63], v[84:87], a[100:103], v[48:63]
    v_mfma_f32_32x32x16_bf16 v[64:79], v[84:87], a[212:215], v[64:79]
    s_waitcnt lgkmcnt(1)
    v_mfma_f32_32x32x16_bf16 v[48:63], v[88:91], a[104:107], v[48:63]
    v_mfma_f32_32x32x16_bf16 v[64:79], v[88:91], a[216:219], v[64:79]
    s_waitcnt lgkmcnt(0)
    v_mfma_f32_32x32x16_bf16 v[48:63], v[92:95], a[108:111], v[48:63]
    v_mfma_f32_32x32x16_bf16 v[64:79], v[92:95], a[220:223], v[64:79]
    s_branch H_u_loop_any
H_u_end_any:
    s_add_u32 s26, s29, 1024
    v_cvt_pk_bf16_f32 v48, v48, v49
    v_cvt_pk_bf16_f32 v49, v50, v51
    v_cvt_pk_bf16_f32 v50, v52, v53
    v_cvt_pk_bf16_f32 v51, v54, v55
    buffer_store_dwordx4 v[48:51], v5, s[8:11], s29 offen offset:0 sc1
    v_cvt_pk_bf16_f32 v56, v56, v57
    v_cvt_pk_bf16_f32 v57, v58, v59
    v_cvt_pk_bf16_f32 v58, v60, v61
    v_cvt_pk_bf16_f32 v59, v62, v63
    buffer_store_dwordx4 v[56:59], v5, s[8:11], s29 offen offset:512 sc1
    v_cvt_pk_bf16_f32 v64, v64, v65
    v_cvt_pk_bf16_f32 v65, v66, v67
    v_cvt_pk_bf16_f32 v66, v68, v69
    v_cvt_pk_bf16_f32 v67, v70, v71
    buffer_store_dwordx4 v[64:67], v5, s[8:11], s26 offen offset:0 sc1
    v_cvt_pk_bf16_f32 v72, v72, v73
    v_cvt_pk_bf16_f32 v73, v74, v75
    v_cvt_pk_bf16_f32 v74, v76, v77
    v_cvt_pk_bf16_f32 v75, v78, v79
    buffer_store_dwordx4 v[72:75], v5, s[8:11], s26 offen offset:512 sc1
    s_add_u32 s29, s29, 1835008
    s_waitcnt vmcnt(0)
    s_barrier
    s_cmp_lg_u32 s20, 0
    s_cbranch_scc1 H_nf_33_any
    s_mov_b64 exec, 0xff
    buffer_store_dwordx4 v[96:99], v2, s[8:11], s30 offen sc1
    s_mov_b64 exec, -1
H_nf_33_any:
    s_add_u32 s30, s30, 45056
    s_cmp_lg_u32 s20, 0
    s_cbranch_scc1 H_nf_34_any
    s_mov_b64 exec, 0xff
    buffer_store_dwordx4 v[96:99], v2, s[8:11], s30 offen sc1
    s_mov_b64 exec, -1
H_nf_34_any:
    s_add_u32 s30, s30, 45056
    s_cmp_lg_u32 s20, 0
    s_cbranch_scc1 H_nf_35_any
    s_mov_b64 exec, 0xff
    buffer_store_dwordx4 v[96:99], v2, s[8:11], s30 offen sc1
    s_mov_b64 exec, -1
H_nf_35_any:
    s_add_u32 s30, s30, 45056
    s_branch H_trail_any
H_t_any:
    v_bfe_u32 v4, v1, 5, 1
    v_lshlrev_b32 v4, 8, v4
    v_bfe_u32 v6, v1, 3, 1
    v_lshl_add_u32 v4, v6, 7, v4
    v_bfe_u32 v6, v1, 1, 1
    v_lshl_add_u32 v4, v6, 6, v4
    v_bfe_u32 v6, v1, 2, 1
    v_lshl_add_u32 v4, v6, 5, v4
    v_bfe_u32 v6, v1, 0, 1
    v_lshl_add_u32 v4, v6, 4, v4
    v_bfe_u32 v6, v1, 4, 1
    v_mul_u32_u24 v6, 14336, v6
    v_add_u32 v4, v4, v6
    v_mov_b32 v5, v2
    s_mul_i32 s24, s33, 196
    s_mul_i32 s25, s26, 14
    s_add_u32 s24, s24, s25
    s_lshl_b32 s24, s24, 11
    s_mul_i32 s29, s27, 458752
    s_lshl_b32 s25, s26, 11
    s_add_u32 s29, s29, s25
    s_mul_i32 s25, s33, 28672
    s_add_u32 s29, s29, s25
    s_add_u32 s29, s29, 56198144
    s_add_u32 s30, s30, 3584
    s_and_b32 s25, s33, 8
    s_mul_i32 s25, s25, 7
    s_lshr_b32 s3, s26, 1
    s_add_u32 s25, s25, s3
    v_min_u32 v60, 7, v1
    v_mul_u32_u24 v60, 896, v60
    s_lshl_b32 s3, s25, 7
    s_add_u32 s3, s3, 46833664
    s_mov_b32 s47, 200000
H_t_nw_any:
    buffer_load_dwordx2 v[62:63], v60, s[8:11], s3 offen sc1
    s_waitcnt vmcnt(0)
    v_xor_b32 v62, s96, v62
    v_xor_b32 v63, s97, v63
    v_or_b32 v62, v62, v63
    v_cmp_ne_u32 vcc, 0, v62
    s_cbranch_vccz H_t_nw_ok_any
    s_sub_u32 s47, s47, 1
    s_cbranch_scc0 H_t_nw_any
    s_branch L_fail
H_t_nw_ok_any:
    buffer_load_dwordx4 a[0:3], v4, s[8:11], s24 offen offset:0
    buffer_load_dwordx4 a[4:7], v4, s[8:11], s24 offen offset:512
    buffer_load_dwordx4 a[8:11], v4, s[8:11], s24 offen offset:1024
    buffer_load_dwordx4 a[12:15], v4, s[8:11], s24 offen offset:1536
    buffer_load_dwordx4 a[16:19], v4, s[8:11], s24 offen offset:2048
    buffer_load_dwordx4 a[20:23], v4, s[8:11], s24 offen offset:2560
    buffer_load_dwordx4 a[24:27], v4, s[8:11], s24 offen offset:3072
    buffer_load_dwordx4 a[28:31], v4, s[8:11], s24 offen offset:3584
    s_add_u32 s24, s24, 4096
    buffer_load_dwordx4 a[32:35], v4, s[8:11], s24 offen offset:0
    buffer_load_dwordx4 a[36:39], v4, s[8:11], s24 offen offset:512
    buffer_load_dwordx4 a[40:43], v4, s[8:11], s24 offen offset:1024
    buffer_load_dwordx4 a[44:47], v4, s[8:11], s24 offen offset:1536
    buffer_load_dwordx4 a[48:51], v4, s[8:11], s24 offen offset:2048
    buffer_load_dwordx4 a[52:55], v4, s[8:11], s24 offen offset:2560
    buffer_load_dwordx4 a[56:59], v4, s[8:11], s24 offen offset:3072
    buffer_load_dwordx4 a[60:63], v4, s[8:11], s24 offen offset:3584
    s_add_u32 s24, s24, 4096
    buffer_load_dwordx4 a[64:67], v4, s[8:11], s24 offen offset:0
    buffer_load_dwordx4 a[68:71], v4, s[8:11], s24 offen offset:512
    buffer_load_dwordx4 a[72:75], v4, s[8:11], s24 offen offset:1024
    buffer_load_dwordx4 a[76:79], v4, s[8:11], s24 offen offset:1536
    buffer_load_dwordx4 a[80:83], v4, s[8:11], s24 offen offset:2048
    buffer_load_dwordx4 a[84:87], v4, s[8:11], s24 offen offset:2560
    buffer_load_dwordx4 a[88:91], v4, s[8:11], s24 offen offset:3072
    buffer_load_dwordx4 a[92:95], v4, s[8:11], s24 offen offset:3584
    s_add_u32 s24, s24, 4096
    buffer_load_dwordx4 a[96:99], v4, s[8:11], s24 offen offset:0
    buffer_load_dwordx4 a[100:103], v4, s[8:11], s24 offen offset:512
    buffer_load_dwordx4 a[104:107], v4, s[8:11], s24 offen offset:1024
    buffer_load_dwordx4 a[108:111], v4, s[8:11], s24 offen offset:1536
    s_add_u32 s24, s24, 389120
    buffer_load_dwordx4 a[112:115], v4, s[8:11], s24 offen offset:0
    buffer_load_dwordx4 a[116:119], v4, s[8:11], s24 offen offset:512
    buffer_load_dwordx4 a[120:123], v4, s[8:11], s24 offen offset:1024
    buffer_load_dwordx4 a[124:127], v4, s[8:11], s24 offen offset:1536
    buffer_load_dwordx4 a[128:131], v4, s[8:11], s24 offen offset:2048
    buffer_load_dwordx4 a[132:135], v4, s[8:11], s24 offen offset:2560
    buffer_load_dwordx4 a[136:139], v4, s[8:11], s24 offen offset:3072
    buffer_load_dwordx4 a[140:143], v4, s[8:11], s24 offen offset:3584
    s_add_u32 s24, s24, 4096
    buffer_load_dwordx4 a[144:147], v4, s[8:11], s24 offen offset:0
    buffer_load_dwordx4 a[148:151], v4, s[8:11], s24 offen offset:512
    buffer_load_dwordx4 a[152:155], v4, s[8:11], s24 offen offset:1024
    buffer_load_dwordx4 a[156:159], v4, s[8:11], s24 offen offset:1536
    buffer_load_dwordx4 a[160:163], v4, s[8:11], s24 offen offset:2048
    buffer_load_dwordx4 a[164:167], v4, s[8:11], s24 offen offset:2560
    buffer_load_dwordx4 a[168:171], v4, s[8:11], s24 offen offset:3072
    buffer_load_dwordx4 a[172:175], v4, s[8:11], s24 offen offset:3584
    s_add_u32 s24, s24, 4096
    buffer_load_dwordx4 a[176:179], v4, s[8:11], s24 offen offset:0
    buffer_load_dwordx4 a[180:183], v4, s[8:11], s24 offen offset:512
    buffer_load_dwordx4 a[184:187], v4, s[8:11], s24 offen offset:1024
    buffer_load_dwordx4 a[188:191], v4, s[8:11], s24 offen offset:1536
    buffer_load_dwordx4 a[192:195], v4, s[8:11], s24 offen offset:2048
    buffer_load_dwordx4 a[196:199], v4, s[8:11], s24 offen offset:2560
    buffer_load_dwordx4 a[200:203], v4, s[8:11], s24 offen offset:3072
    buffer_load_dwordx4 a[204:207], v4, s[8:11], s24 offen offset:3584
    s_add_u32 s24, s24, 4096
    buffer_load_dwordx4 a[208:211], v4, s[8:11], s24 offen offset:0
    buffer_load_dwordx4 a[212:215], v4, s[8:11], s24 offen offset:512
    buffer_load_dwordx4 a[216:219], v4, s[8:11], s24 offen offset:1024
    buffer_load_dwordx4 a[220:223], v4, s[8:11], s24 offen offset:1536
    s_add_u32 s24, s24, 389120
    s_mov_b32 s46, 0
    v_min_u32 v60, 63, v1
    v_mul_u32_u24 v60, 128, v60
    s_lshl_b32 s3, s46, 7
    s_add_u32 s3, s3, 46833664
    s_mov_b32 s47, 200000
H_t_na0_any:
    buffer_load_dwordx2 v[62:63], v60, s[8:11], s3 offen sc1
    s_waitcnt vmcnt(0)
    v_xor_b32 v62, s96, v62
    v_xor_b32 v63, s97, v63
    v_or_b32 v62, v62, v63
    v_cmp_ne_u32 vcc, 0, v62
    s_cbranch_vccz H_t_na0_ok_any
    s_sub_u32 s47, s47, 1
    s_cbranch_scc0 H_t_na0_any
    s_branch L_fail
H_t_na0_ok_any:
    s_mov_b32 s46, 64
    v_min_u32 v60, 63, v1
    v_mul_u32_u24 v60, 128, v60
    s_lshl_b32 s3, s46, 7
    s_add_u32 s3, s3, 46833664
    s_mov_b32 s47, 200000
H_t_na1_any:
    buffer_load_dwordx2 v[62:63], v60, s[8:11], s3 offen sc1
    s_waitcnt vmcnt(0)
    v_xor_b32 v62, s96, v62
    v_xor_b32 v63, s97, v63
    v_or_b32 v62, v62, v63
    v_cmp_ne_u32 vcc, 0, v62
    s_cbranch_vccz H_t_na1_ok_any
    s_sub_u32 s47, s47, 1
    s_cbranch_scc0 H_t_na1_any
    s_branch L_fail
H_t_na1_ok_any:
    s_mov_b32 s46, 128
    v_min_u32 v60, 63, v1
    v_mul_u32_u24 v60, 128, v60
    s_lshl_b32 s3, s46, 7
    s_add_u32 s3, s3, 46833664
    s_mov_b32 s47, 200000
H_t_na2_any:
    buffer_load_dwordx2 v[62:63], v60, s[8:11], s3 offen sc1
    s_waitcnt vmcnt(0)
    v_xor_b32 v62, s96, v62
    v_xor_b32 v63, s97, v63
    v_or_b32 v62, v62, v63
    v_cmp_ne_u32 vcc, 0, v62
    s_cbranch_vccz H_t_na2_ok_any
    s_sub_u32 s47, s47, 1
    s_cbranch_scc0 H_t_na2_any
    s_branch L_fail
H_t_na2_ok_any:
    s_mov_b32 s46, 192
    v_min_u32 v60, 63, v1
    v_mul_u32_u24 v60, 128, v60
    s_lshl_b32 s3, s46, 7
    s_add_u32 s3, s3, 46833664
    s_mov_b32 s47, 200000
H_t_na3_any:
    buffer_load_dwordx2 v[62:63], v60, s[8:11], s3 offen sc1
    s_waitcnt vmcnt(0)
    v_xor_b32 v62, s96, v62
    v_xor_b32 v63, s97, v63
    v_or_b32 v62, v62, v63
    v_cmp_ne_u32 vcc, 0, v62
    s_cbranch_vccz H_t_na3_ok_any
    s_sub_u32 s47, s47, 1
    s_cbranch_scc0 H_t_na3_any
    s_branch L_fail
H_t_na3_ok_any:
    s_mov_b32 s46, 256
    v_min_u32 v60, 63, v1
    v_mul_u32_u24 v60, 128, v60
    s_lshl_b32 s3, s46, 7
    s_add_u32 s3, s3, 46833664
    s_mov_b32 s47, 200000
H_t_na4_any:
    buffer_load_dwordx2 v[62:63], v60, s[8:11], s3 offen sc1
    s_waitcnt vmcnt(0)
    v_xor_b32 v62, s96, v62
    v_xor_b32 v63, s97, v63
    v_or_b32 v62, v62, v63
    v_cmp_ne_u32 vcc, 0, v62
    s_cbranch_vccz H_t_na4_ok_any
    s_sub_u32 s47, s47, 1
    s_cbranch_scc0 H_t_na4_any
    s_branch L_fail
H_t_na4_ok_any:
    s_mul_i32 s24, s20, 7168
    s_add_u32 s24, s24, s34
    s_add_u32 s25, s28, 4096
    s_mov_b32 m0, s24
    s_add_u32 s24, s24, 4096
    buffer_load_dwordx4 v2, s[8:11], s28 offen offset:0 lds
    buffer_load_dwordx4 v2, s[8:11], s28 offen offset:1024 lds
    buffer_load_dwordx4 v2, s[8:11], s28 offen offset:2048 lds
    buffer_load_dwordx4 v2, s[8:11], s28 offen offset:3072 lds
    s_mov_b32 m0, s24
    s_add_u32 s24, s24, 4096
    buffer_load_dwordx4 v2, s[8:11], s25 offen offset:0 lds
    buffer_load_dwordx4 v2, s[8:11], s25 offen offset:1024 lds
    buffer_load_dwordx4 v2, s[8:11], s25 offen offset:2048 lds
    s_add_u32 s28, s28, 114688
    s_add_u32 s34, s34, 28672
    s_cmp_eq_u32 s34, 86016
    s_cselect_b32 s34, 0, s34
    s_mul_i32 s24, s20, 7168
    s_add_u32 s24, s24, s34
    s_add_u32 s25, s28, 4096
    s_mov_b32 m0, s24
    s_add_u32 s24, s24, 4096
    buffer_load_dwordx4 v2, s[8:11], s28 offen offset:0 lds
    buffer_load_dwordx4 v2, s[8:11], s28 offen offset:1024 lds
    buffer_load_dwordx4 v2, s[8:11], s28 offen offset:2048 lds
    buffer_load_dwordx4 v2, s[8:11], s28 offen offset:3072 lds
    s_mov_b32 m0, s24
    s_add_u32 s24, s24, 4096
    buffer_load_dwordx4 v2, s[8:11], s25 offen offset:0 lds
    buffer_load_dwordx4 v2, s[8:11], s25 offen offset:1024 lds
    buffer_load_dwordx4 v2, s[8:11], s25 offen offset:2048 lds
    s_add_u32 s28, s28, 114688
    s_add_u32 s34, s34, 28672
    s_cmp_eq_u32 s34, 86016
    s_cselect_b32 s34, 0, s34
    s_waitcnt vmcnt(7)
    s_barrier
    s_mul_i32 s24, s20, 7168
    s_add_u32 s24, s24, s34
    s_add_u32 s25, s28, 4096
    s_mov_b32 m0, s24
    s_add_u32 s24, s24, 4096
    buffer_load_dwordx4 v2, s[8:11], s28 offen offset:0 lds
    buffer_load_dwordx4 v2, s[8:11], s28 offen offset:1024 lds
    buffer_load_dwordx4 v2, s[8:11], s28 offen offset:2048 lds
    buffer_load_dwordx4 v2, s[8:11], s28 offen offset:3072 lds
    s_mov_b32 m0, s24
    s_add_u32 s24, s24, 4096
    buffer_load_dwordx4 v2, s[8:11], s25 offen offset:0 lds
    buffer_load_dwordx4 v2, s[8:11], s25 offen offset:1024 lds
    buffer_load_dwordx4 v2, s[8:11], s25 offen offset:2048 lds
    s_add_u32 s28, s28, 114688
    s_add_u32 s34, s34, 28672
    s_cmp_eq_u32 s34, 86016
    s_cselect_b32 s34, 0, s34
    v_add_u32 v8, s35, v2
    s_add_u32 s35, s35, 28672
    s_cmp_eq_u32 s35, 86016
    s_cselect_b32 s35, 0, s35
    ds_read_b128 v[80:83], v8 offset:0
    ds_read_b128 v[84:87], v8 offset:1024
    ds_read_b128 v[88:91], v8 offset:2048
    ds_read_b128 v[92:95], v8 offset:3072
    s_waitcnt lgkmcnt(3)
    v_mfma_f32_32x32x16_bf16 v[16:31], a[0:3], v[80:83], 0
    v_mfma_f32_32x32x16_bf16 v[32:47], a[112:115], v[80:83], 0
    ds_read_b128 v[80:83], v8 offset:4096
    s_waitcnt lgkmcnt(3)
    v_mfma_f32_32x32x16_bf16 v[16:31], a[4:7], v[84:87], v[16:31]
    v_mfma_f32_32x32x16_bf16 v[32:47], a[116:119], v[84:87], v[32:47]
    ds_read_b128 v[84:87], v8 offset:5120
    s_waitcnt lgkmcnt(3)
    v_mfma_f32_32x32x16_bf16 v[16:31], a[8:11], v[88:91], v[16:31]
    v_mfma_f32_32x32x16_bf16 v[32:47], a[120:123], v[88:91], v[32:47]
    ds_read_b128 v[88:91], v8 offset:6144
    s_waitcnt lgkmcnt(3)
    v_mfma_f32_32x32x16_bf16 v[16:31], a[12:15], v[92:95], v[16:31]
    v_mfma_f32_32x32x16_bf16 v[32:47], a[124:127], v[92:95], v[32:47]
    ds_read_b128 v[92:95], v8 offset:7168
    s_waitcnt lgkmcnt(3)
    v_mfma_f32_32x32x16_bf16 v[16:31], a[16:19], v[80:83], v[16:31]
    v_mfma_f32_32x32x16_bf16 v[32:47], a[128:131], v[80:83], v[32:47]
    ds_read_b128 v[80:83], v8 offset:8192
    s_waitcnt lgkmcnt(3)
    v_mfma_f32_32x32x16_bf16 v[16:31], a[20:23], v[84:87], v[16:31]
    v_mfma_f32_32x32x16_bf16 v[32:47], a[132:135], v[84:87], v[32:47]
    ds_read_b128 v[84:87], v8 offset:9216
    s_waitcnt lgkmcnt(3)
    v_mfma_f32_32x32x16_bf16 v[16:31], a[24:27], v[88:91], v[16:31]
    v_mfma_f32_32x32x16_bf16 v[32:47], a[136:139], v[88:91], v[32:47]
    ds_read_b128 v[88:91], v8 offset:10240
    s_waitcnt lgkmcnt(3)
    v_mfma_f32_32x32x16_bf16 v[16:31], a[28:31], v[92:95], v[16:31]
    v_mfma_f32_32x32x16_bf16 v[32:47], a[140:143], v[92:95], v[32:47]
    ds_read_b128 v[92:95], v8 offset:11264
    s_waitcnt lgkmcnt(3)
    v_mfma_f32_32x32x16_bf16 v[16:31], a[32:35], v[80:83], v[16:31]
    v_mfma_f32_32x32x16_bf16 v[32:47], a[144:147], v[80:83], v[32:47]
    ds_read_b128 v[80:83], v8 offset:12288
    s_waitcnt lgkmcnt(3)
    v_mfma_f32_32x32x16_bf16 v[16:31], a[36:39], v[84:87], v[16:31]
    v_mfma_f32_32x32x16_bf16 v[32:47], a[148:151], v[84:87], v[32:47]
    ds_read_b128 v[84:87], v8 offset:13312
    s_waitcnt lgkmcnt(3)
    v_mfma_f32_32x32x16_bf16 v[16:31], a[40:43], v[88:91], v[16:31]
    v_mfma_f32_32x32x16_bf16 v[32:47], a[152:155], v[88:91], v[32:47]
    ds_read_b128 v[88:91], v8 offset:14336
    s_waitcnt lgkmcnt(3)
    v_mfma_f32_32x32x16_bf16 v[16:31], a[44:47], v[92:95], v[16:31]
    v_mfma_f32_32x32x16_bf16 v[32:47], a[156:159], v[92:95], v[32:47]
    ds_read_b128 v[92:95], v8 offset:15360
    s_waitcnt lgkmcnt(3)
    v_mfma_f32_32x32x16_bf16 v[16:31], a[48:51], v[80:83], v[16:31]
    v_mfma_f32_32x32x16_bf16 v[32:47], a[160:163], v[80:83], v[32:47]
    ds_read_b128 v[80:83], v8 offset:16384
    s_waitcnt lgkmcnt(3)
    v_mfma_f32_32x32x16_bf16 v[16:31], a[52:55], v[84:87], v[16:31]
    v_mfma_f32_32x32x16_bf16 v[32:47], a[164:167], v[84:87], v[32:47]
    ds_read_b128 v[84:87], v8 offset:17408
    s_waitcnt lgkmcnt(3)
    v_mfma_f32_32x32x16_bf16 v[16:31], a[56:59], v[88:91], v[16:31]
    v_mfma_f32_32x32x16_bf16 v[32:47], a[168:171], v[88:91], v[32:47]
    ds_read_b128 v[88:91], v8 offset:18432
    s_waitcnt lgkmcnt(3)
    v_mfma_f32_32x32x16_bf16 v[16:31], a[60:63], v[92:95], v[16:31]
    v_mfma_f32_32x32x16_bf16 v[32:47], a[172:175], v[92:95], v[32:47]
    ds_read_b128 v[92:95], v8 offset:19456
    s_waitcnt lgkmcnt(3)
    v_mfma_f32_32x32x16_bf16 v[16:31], a[64:67], v[80:83], v[16:31]
    v_mfma_f32_32x32x16_bf16 v[32:47], a[176:179], v[80:83], v[32:47]
    ds_read_b128 v[80:83], v8 offset:20480
    s_waitcnt lgkmcnt(3)
    v_mfma_f32_32x32x16_bf16 v[16:31], a[68:71], v[84:87], v[16:31]
    v_mfma_f32_32x32x16_bf16 v[32:47], a[180:183], v[84:87], v[32:47]
    ds_read_b128 v[84:87], v8 offset:21504
    s_waitcnt lgkmcnt(3)
    v_mfma_f32_32x32x16_bf16 v[16:31], a[72:75], v[88:91], v[16:31]
    v_mfma_f32_32x32x16_bf16 v[32:47], a[184:187], v[88:91], v[32:47]
    ds_read_b128 v[88:91], v8 offset:22528
    s_waitcnt lgkmcnt(3)
    v_mfma_f32_32x32x16_bf16 v[16:31], a[76:79], v[92:95], v[16:31]
    v_mfma_f32_32x32x16_bf16 v[32:47], a[188:191], v[92:95], v[32:47]
    ds_read_b128 v[92:95], v8 offset:23552
    s_waitcnt lgkmcnt(3)
    v_mfma_f32_32x32x16_bf16 v[16:31], a[80:83], v[80:83], v[16:31]
    v_mfma_f32_32x32x16_bf16 v[32:47], a[192:195], v[80:83], v[32:47]
    ds_read_b128 v[80:83], v8 offset:24576
    s_waitcnt lgkmcnt(3)
    v_mfma_f32_32x32x16_bf16 v[16:31], a[84:87], v[84:87], v[16:31]
    v_mfma_f32_32x32x16_bf16 v[32:47], a[196:199], v[84:87], v[32:47]
    ds_read_b128 v[84:87], v8 offset:25600
    s_waitcnt lgkmcnt(3)
    v_mfma_f32_32x32x16_bf16 v[16:31], a[88:91], v[88:91], v[16:31]
    v_mfma_f32_32x32x16_bf16 v[32:47], a[200:203], v[88:91], v[32:47]
    ds_read_b128 v[88:91], v8 offset:26624
    s_waitcnt lgkmcnt(3)
    v_mfma_f32_32x32x16_bf16 v[16:31], a[92:95], v[92:95], v[16:31]
    v_mfma_f32_32x32x16_bf16 v[32:47], a[204:207], v[92:95], v[32:47]
    ds_read_b128 v[92:95], v8 offset:27648
    s_waitcnt lgkmcnt(3)
    v_mfma_f32_32x32x16_bf16 v[16:31], a[96:99], v[80:83], v[16:31]
    v_mfma_f32_32x32x16_bf16 v[32:47], a[208:211], v[80:83], v[32:47]
    s_waitcnt lgkmcnt(2)
    v_mfma_f32_32x32x16_bf16 v[16:31], a[100:103], v[84:87], v[16:31]
    v_mfma_f32_32x32x16_bf16 v[32:47], a[212:215], v[84:87], v[32:47]
    s_waitcnt lgkmcnt(1)
    v_mfma_f32_32x32x16_bf16 v[16:31], a[104:107], v[88:91], v[16:31]
    v_mfma_f32_32x32x16_bf16 v[32:47], a[216:219], v[88:91], v[32:47]
    s_waitcnt lgkmcnt(0)
    v_mfma_f32_32x32x16_bf16 v[16:31], a[108:111], v[92:95], v[16:31]
    v_mfma_f32_32x32x16_bf16 v[32:47], a[220:223], v[92:95], v[32:47]
    s_nop 7
    s_nop 3
    s_add_u32 s26, s29, 28672
    v_cvt_pk_bf16_f32 v16, v16, v17
    v_cvt_pk_bf16_f32 v17, v18, v19
    v_cvt_pk_bf16_f32 v18, v20, v21
    v_cvt_pk_bf16_f32 v19, v22, v23
    buffer_store_dwordx4 v[16:19], v5, s[8:11], s29 offen offset:0 sc1
    v_cvt_pk_bf16_f32 v24, v24, v25
    v_cvt_pk_bf16_f32 v25, v26, v27
    v_cvt_pk_bf16_f32 v26, v28, v29
    v_cvt_pk_bf16_f32 v27, v30, v31
    buffer_store_dwordx4 v[24:27], v5, s[8:11], s29 offen offset:1024 sc1
    v_cvt_pk_bf16_f32 v32, v32, v33
    v_cvt_pk_bf16_f32 v33, v34, v35
    v_cvt_pk_bf16_f32 v34, v36, v37
    v_cvt_pk_bf16_f32 v35, v38, v39
    buffer_store_dwordx4 v[32:35], v5, s[8:11], s26 offen offset:0 sc1
    v_cvt_pk_bf16_f32 v40, v40, v41
    v_cvt_pk_bf16_f32 v41, v42, v43
    v_cvt_pk_bf16_f32 v42, v44, v45
    v_cvt_pk_bf16_f32 v43, v46, v47
    buffer_store_dwordx4 v[40:43], v5, s[8:11], s26 offen offset:1024 sc1
    s_add_u32 s29, s29, 1835008
    s_waitcnt vmcnt(0)
    s_barrier
    s_cmp_lg_u32 s20, 0
    s_cbranch_scc1 H_nf_36_any
    s_mov_b64 exec, 0xff
    buffer_store_dwordx4 v[96:99], v2, s[8:11], s30 offen sc1
    s_mov_b64 exec, -1
H_nf_36_any:
    s_add_u32 s30, s30, 45056
    s_mul_i32 s24, s20, 7168
    s_add_u32 s24, s24, s34
    s_add_u32 s25, s28, 4096
    s_mov_b32 m0, s24
    s_add_u32 s24, s24, 4096
    buffer_load_dwordx4 v2, s[8:11], s28 offen offset:0 lds
    buffer_load_dwordx4 v2, s[8:11], s28 offen offset:1024 lds
    buffer_load_dwordx4 v2, s[8:11], s28 offen offset:2048 lds
    buffer_load_dwordx4 v2, s[8:11], s28 offen offset:3072 lds
    s_mov_b32 m0, s24
    s_add_u32 s24, s24, 4096
    buffer_load_dwordx4 v2, s[8:11], s25 offen offset:0 lds
    buffer_load_dwordx4 v2, s[8:11], s25 offen offset:1024 lds
    buffer_load_dwordx4 v2, s[8:11], s25 offen offset:2048 lds
    s_add_u32 s28, s28, 114688
    s_add_u32 s34, s34, 28672
    s_cmp_eq_u32 s34, 86016
    s_cselect_b32 s34, 0, s34
    v_add_u32 v8, s35, v2
    s_add_u32 s35, s35, 28672
    s_cmp_eq_u32 s35, 86016
    s_cselect_b32 s35, 0, s35
    ds_read_b128 v[80:83], v8 offset:0
    ds_read_b128 v[84:87], v8 offset:1024
    ds_read_b128 v[88:91], v8 offset:2048
    ds_read_b128 v[92:95], v8 offset:3072
    s_waitcnt lgkmcnt(3)
    v_mfma_f32_32x32x16_bf16 v[48:63], a[0:3], v[80:83], 0
    v_mfma_f32_32x32x16_bf16 v[64:79], a[112:115], v[80:83], 0
    ds_read_b128 v[80:83], v8 offset:4096
    s_waitcnt lgkmcnt(3)
    v_mfma_f32_32x32x16_bf16 v[48:63], a[4:7], v[84:87], v[48:63]
    v_mfma_f32_32x32x16_bf16 v[64:79], a[116:119], v[84:87], v[64:79]
    ds_read_b128 v[84:87], v8 offset:5120
    s_waitcnt lgkmcnt(3)
    v_mfma_f32_32x32x16_bf16 v[48:63], a[8:11], v[88:91], v[48:63]
    v_mfma_f32_32x32x16_bf16 v[64:79], a[120:123], v[88:91], v[64:79]
    ds_read_b128 v[88:91], v8 offset:6144
    s_waitcnt lgkmcnt(3)
    v_mfma_f32_32x32x16_bf16 v[48:63], a[12:15], v[92:95], v[48:63]
    v_mfma_f32_32x32x16_bf16 v[64:79], a[124:127], v[92:95], v[64:79]
    ds_read_b128 v[92:95], v8 offset:7168
    s_waitcnt lgkmcnt(3)
    v_mfma_f32_32x32x16_bf16 v[48:63], a[16:19], v[80:83], v[48:63]
    v_mfma_f32_32x32x16_bf16 v[64:79], a[128:131], v[80:83], v[64:79]
    ds_read_b128 v[80:83], v8 offset:8192
    s_waitcnt lgkmcnt(3)
    v_mfma_f32_32x32x16_bf16 v[48:63], a[20:23], v[84:87], v[48:63]
    v_mfma_f32_32x32x16_bf16 v[64:79], a[132:135], v[84:87], v[64:79]
    ds_read_b128 v[84:87], v8 offset:9216
    s_waitcnt lgkmcnt(3)
    v_mfma_f32_32x32x16_bf16 v[48:63], a[24:27], v[88:91], v[48:63]
    v_mfma_f32_32x32x16_bf16 v[64:79], a[136:139], v[88:91], v[64:79]
    ds_read_b128 v[88:91], v8 offset:10240
    s_waitcnt lgkmcnt(3)
    v_mfma_f32_32x32x16_bf16 v[48:63], a[28:31], v[92:95], v[48:63]
    v_mfma_f32_32x32x16_bf16 v[64:79], a[140:143], v[92:95], v[64:79]
    ds_read_b128 v[92:95], v8 offset:11264
    s_waitcnt lgkmcnt(3)
    v_mfma_f32_32x32x16_bf16 v[48:63], a[32:35], v[80:83], v[48:63]
    v_mfma_f32_32x32x16_bf16 v[64:79], a[144:147], v[80:83], v[64:79]
    ds_read_b128 v[80:83], v8 offset:12288
    s_waitcnt lgkmcnt(3)
    v_mfma_f32_32x32x16_bf16 v[48:63], a[36:39], v[84:87], v[48:63]
    v_mfma_f32_32x32x16_bf16 v[64:79], a[148:151], v[84:87], v[64:79]
    ds_read_b128 v[84:87], v8 offset:13312
    s_waitcnt lgkmcnt(3)
    v_mfma_f32_32x32x16_bf16 v[48:63], a[40:43], v[88:91], v[48:63]
    v_mfma_f32_32x32x16_bf16 v[64:79], a[152:155], v[88:91], v[64:79]
    ds_read_b128 v[88:91], v8 offset:14336
    s_waitcnt lgkmcnt(3)
    v_mfma_f32_32x32x16_bf16 v[48:63], a[44:47], v[92:95], v[48:63]
    v_mfma_f32_32x32x16_bf16 v[64:79], a[156:159], v[92:95], v[64:79]
    ds_read_b128 v[92:95], v8 offset:15360
    s_waitcnt lgkmcnt(3)
    v_mfma_f32_32x32x16_bf16 v[48:63], a[48:51], v[80:83], v[48:63]
    v_mfma_f32_32x32x16_bf16 v[64:79], a[160:163], v[80:83], v[64:79]
    ds_read_b128 v[80:83], v8 offset:16384
    s_waitcnt lgkmcnt(3)
    v_mfma_f32_32x32x16_bf16 v[48:63], a[52:55], v[84:87], v[48:63]
    v_mfma_f32_32x32x16_bf16 v[64:79], a[164:167], v[84:87], v[64:79]
    ds_read_b128 v[84:87], v8 offset:17408
    s_waitcnt lgkmcnt(3)
    v_mfma_f32_32x32x16_bf16 v[48:63], a[56:59], v[88:91], v[48:63]
    v_mfma_f32_32x32x16_bf16 v[64:79], a[168:171], v[88:91], v[64:79]
    ds_read_b128 v[88:91], v8 offset:18432
    s_waitcnt lgkmcnt(3)
    v_mfma_f32_32x32x16_bf16 v[48:63], a[60:63], v[92:95], v[48:63]
    v_mfma_f32_32x32x16_bf16 v[64:79], a[172:175], v[92:95], v[64:79]
    ds_read_b128 v[92:95], v8 offset:19456
    s_waitcnt lgkmcnt(3)
    v_mfma_f32_32x32x16_bf16 v[48:63], a[64:67], v[80:83], v[48:63]
    v_mfma_f32_32x32x16_bf16 v[64:79], a[176:179], v[80:83], v[64:79]
    ds_read_b128 v[80:83], v8 offset:20480
    s_waitcnt lgkmcnt(3)
    v_mfma_f32_32x32x16_bf16 v[48:63], a[68:71], v[84:87], v[48:63]
    v_mfma_f32_32x32x16_bf16 v[64:79], a[180:183], v[84:87], v[64:79]
    ds_read_b128 v[84:87], v8 offset:21504
    s_waitcnt lgkmcnt(3)
    v_mfma_f32_32x32x16_bf16 v[48:63], a[72:75], v[88:91], v[48:63]
    v_mfma_f32_32x32x16_bf16 v[64:79], a[184:187], v[88:91], v[64:79]
    ds_read_b128 v[88:91], v8 offset:22528
    s_waitcnt lgkmcnt(3)
    v_mfma_f32_32x32x16_bf16 v[48:63], a[76:79], v[92:95], v[48:63]
    v_mfma_f32_32x32x16_bf16 v[64:79], a[188:191], v[92:95], v[64:79]
    ds_read_b128 v[92:95], v8 offset:23552
    s_waitcnt lgkmcnt(3)
    v_mfma_f32_32x32x16_bf16 v[48:63], a[80:83], v[80:83], v[48:63]
    v_mfma_f32_32x32x16_bf16 v[64:79], a[192:195], v[80:83], v[64:79]
    ds_read_b128 v[80:83], v8 offset:24576
    s_waitcnt lgkmcnt(3)
    v_mfma_f32_32x32x16_bf16 v[48:63], a[84:87], v[84:87], v[48:63]
    v_mfma_f32_32x32x16_bf16 v[64:79], a[196:199], v[84:87], v[64:79]
    ds_read_b128 v[84:87], v8 offset:25600
    s_waitcnt lgkmcnt(3)
    v_mfma_f32_32x32x16_bf16 v[48:63], a[88:91], v[88:91], v[48:63]
    v_mfma_f32_32x32x16_bf16 v[64:79], a[200:203], v[88:91], v[64:79]
    ds_read_b128 v[88:91], v8 offset:26624
    s_waitcnt lgkmcnt(3)
    v_mfma_f32_32x32x16_bf16 v[48:63], a[92:95], v[92:95], v[48:63]
    v_mfma_f32_32x32x16_bf16 v[64:79], a[204:207], v[92:95], v[64:79]
    ds_read_b128 v[92:95], v8 offset:27648
    s_waitcnt lgkmcnt(3)
    v_mfma_f32_32x32x16_bf16 v[48:63], a[96:99], v[80:83], v[48:63]
    v_mfma_f32_32x32x16_bf16 v[64:79], a[208:211], v[80:83], v[64:79]
    s_waitcnt lgkmcnt(2)
    v_mfma_f32_32x32x16_bf16 v[48:63], a[100:103], v[84:87], v[48:63]
    v_mfma_f32_32x32x16_bf16 v[64:79], a[212:215], v[84:87], v[64:79]
    s_waitcnt lgkmcnt(1)
    v_mfma_f32_32x32x16_bf16 v[48:63], a[104:107], v[88:91], v[48:63]
    v_mfma_f32_32x32x16_bf16 v[64:79], a[216:219], v[88:91], v[64:79]
    s_waitcnt lgkmcnt(0)
    v_mfma_f32_32x32x16_bf16 v[48:63], a[108:111], v[92:95], v[48:63]
    v_mfma_f32_32x32x16_bf16 v[64:79], a[220:223], v[92:95], v[64:79]
    s_mov_b32 s31, 2
    s_barrier
    s_mul_i32 s24, s20, 7168
    s_add_u32 s24, s24, s34
    s_add_u32 s25, s28, 4096
    s_mov_b32 m0, s24
    s_add_u32 s24, s24, 4096
    buffer_load_dwordx4 v2, s[8:11], s28 offen offset:0 lds
    buffer_load_dwordx4 v2, s[8:11], s28 offen offset:1024 lds
    buffer_load_dwordx4 v2, s[8:11], s28 offen offset:2048 lds
    buffer_load_dwordx4 v2, s[8:11], s28 offen offset:3072 lds
    s_mov_b32 m0, s24
    s_add_u32 s24, s24, 4096
    buffer_load_dwordx4 v2, s[8:11], s25 offen offset:0 lds
    buffer_load_dwordx4 v2, s[8:11], s25 offen offset:1024 lds
    buffer_load_dwordx4 v2, s[8:11], s25 offen offset:2048 lds
    s_add_u32 s28, s28, 114688
    s_add_u32 s34, s34, 28672
    s_cmp_eq_u32 s34, 86016
    s_cselect_b32 s34, 0, s34
    v_add_u32 v8, s35, v2
    s_add_u32 s35, s35, 28672
    s_cmp_eq_u32 s35, 86016
    s_cselect_b32 s35, 0, s35
    ds_read_b128 v[80:83], v8 offset:0
    ds_read_b128 v[84:87], v8 offset:1024
    ds_read_b128 v[88:91], v8 offset:2048
    ds_read_b128 v[92:95], v8 offset:3072
    s_waitcnt lgkmcnt(3)
    v_mfma_f32_32x32x16_bf16 v[16:31], a[0:3], v[80:83], 0
    v_mfma_f32_32x32x16_bf16 v[32:47], a[112:115], v[80:83], 0
    ds_read_b128 v[80:83], v8 offset:4096
    s_waitcnt lgkmcnt(3)
    v_mfma_f32_32x32x16_bf16 v[16:31], a[4:7], v[84:87], v[16:31]
    s_add_u32 s26, s29, 28672
    v_mfma_f32_32x32x16_bf16 v[32:47], a[116:119], v[84:87], v[32:47]
    v_cvt_pk_bf16_f32 v48, v48, v49
    ds_read_b128 v[84:87], v8 offset:5120
    s_waitcnt lgkmcnt(3)
    v_mfma_f32_32x32x16_bf16 v[16:31], a[8:11], v[88:91], v[16:31]
    v_cvt_pk_bf16_f32 v49, v50, v51
    v_mfma_f32_32x32x16_bf16 v[32:47], a[120:123], v[88:91], v[32:47]
    v_cvt_pk_bf16_f32 v50, v52, v53
    ds_read_b128 v[88:91], v8 offset:6144
    s_waitcnt lgkmcnt(3)
    v_mfma_f32_32x32x16_bf16 v[16:31], a[12:15], v[92:95], v[16:31]
    v_cvt_pk_bf16_f32 v51, v54, v55
    v_mfma_f32_32x32x16_bf16 v[32:47], a[124:127], v[92:95], v[32:47]
    buffer_store_dwordx4 v[48:51], v5, s[8:11], s29 offen offset:0 sc1
    ds_read_b128 v[92:95], v8 offset:7168
    s_waitcnt lgkmcnt(3)
    v_mfma_f32_32x32x16_bf16 v[16:31], a[16:19], v[80:83], v[16:31]
    v_cvt_pk_bf16_f32 v56, v56, v57
    v_mfma_f32_32x32x16_bf16 v[32:47], a[128:131], v[80:83], v[32:47]
    v_cvt_pk_bf16_f32 v57, v58, v59
    ds_read_b128 v[80:83], v8 offset:8192
    s_waitcnt lgkmcnt(3)
    v_mfma_f32_32x32x16_bf16 v[16:31], a[20:23], v[84:87], v[16:31]
    v_cvt_pk_bf16_f32 v58, v60, v61
    v_mfma_f32_32x32x16_bf16 v[32:47], a[132:135], v[84:87], v[32:47]
    v_cvt_pk_bf16_f32 v59, v62, v63
    ds_read_b128 v[84:87], v8 offset:9216
    s_waitcnt lgkmcnt(3)
    v_mfma_f32_32x32x16_bf16 v[16:31], a[24:27], v[88:91], v[16:31]
    buffer_store_dwordx4 v[56:59], v5, s[8:11], s29 offen offset:1024 sc1
    v_mfma_f32_32x32x16_bf16 v[32:47], a[136:139], v[88:91], v[32:47]
    v_cvt_pk_bf16_f32 v64, v64, v65
    ds_read_b128 v[88:91], v8 offset:10240
    s_waitcnt lgkmcnt(3)
    v_mfma_f32_32x32x16_bf16 v[16:31], a[28:31], v[92:95], v[16:31]
    v_cvt_pk_bf16_f32 v65, v66, v67
    v_mfma_f32_32x32x16_bf16 v[32:47], a[140:143], v[92:95], v[32:47]
    v_cvt_pk_bf16_f32 v66, v68, v69
    ds_read_b128 v[92:95], v8 offset:11264
    s_waitcnt lgkmcnt(3)
    v_mfma_f32_32x32x16_bf16 v[16:31], a[32:35], v[80:83], v[16:31]
    v_cvt_pk_bf16_f32 v67, v70, v71
    v_mfma_f32_32x32x16_bf16 v[32:47], a[144:147], v[80:83], v[32:47]
    buffer_store_dwordx4 v[64:67], v5, s[8:11], s26 offen offset:0 sc1
    ds_read_b128 v[80:83], v8 offset:12288
    s_waitcnt lgkmcnt(3)
    v_mfma_f32_32x32x16_bf16 v[16:31], a[36:39], v[84:87], v[16:31]
    v_cvt_pk_bf16_f32 v72, v72, v73
    v_mfma_f32_32x32x16_bf16 v[32:47], a[148:151], v[84:87], v[32:47]
    v_cvt_pk_bf16_f32 v73, v74, v75
    ds_read_b128 v[84:87], v8 offset:13312
    s_waitcnt lgkmcnt(3)
    v_mfma_f32_32x32x16_bf16 v[16:31], a[40:43], v[88:91], v[16:31]
    v_cvt_pk_bf16_f32 v74, v76, v77
    v_mfma_f32_32x32x16_bf16 v[32:47], a[152:155], v[88:91], v[32:47]
    v_cvt_pk_bf16_f32 v75, v78, v79
    ds_read_b128 v[88:91], v8 offset:14336
    s_waitcnt lgkmcnt(3)
    v_mfma_f32_32x32x16_bf16 v[16:31], a[44:47], v[92:95], v[16:31]
    buffer_store_dwordx4 v[72:75], v5, s[8:11], s26 offen offset:1024 sc1
    v_mfma_f32_32x32x16_bf16 v[32:47], a[156:159], v[92:95], v[32:47]
    s_add_u32 s29, s29, 1835008
    ds_read_b128 v[92:95], v8 offset:15360
    s_waitcnt lgkmcnt(3)
    v_mfma_f32_32x32x16_bf16 v[16:31], a[48:51], v[80:83], v[16:31]
    v_mfma_f32_32x32x16_bf16 v[32:47], a[160:163], v[80:83], v[32:47]
    ds_read_b128 v[80:83], v8 offset:16384
    s_waitcnt lgkmcnt(3)
    v_mfma_f32_32x32x16_bf16 v[16:31], a[52:55], v[84:87], v[16:31]
    v_mfma_f32_32x32x16_bf16 v[32:47], a[164:167], v[84:87], v[32:47]
    ds_read_b128 v[84:87], v8 offset:17408
    s_waitcnt lgkmcnt(3)
    v_mfma_f32_32x32x16_bf16 v[16:31], a[56:59], v[88:91], v[16:31]
    v_mfma_f32_32x32x16_bf16 v[32:47], a[168:171], v[88:91], v[32:47]
    ds_read_b128 v[88:91], v8 offset:18432
    s_waitcnt lgkmcnt(3)
    v_mfma_f32_32x32x16_bf16 v[16:31], a[60:63], v[92:95], v[16:31]
    v_mfma_f32_32x32x16_bf16 v[32:47], a[172:175], v[92:95], v[32:47]
    ds_read_b128 v[92:95], v8 offset:19456
    s_waitcnt lgkmcnt(3)
    v_mfma_f32_32x32x16_bf16 v[16:31], a[64:67], v[80:83], v[16:31]
    v_mfma_f32_32x32x16_bf16 v[32:47], a[176:179], v[80:83], v[32:47]
    ds_read_b128 v[80:83], v8 offset:20480
    s_waitcnt lgkmcnt(3)
    v_mfma_f32_32x32x16_bf16 v[16:31], a[68:71], v[84:87], v[16:31]
    v_mfma_f32_32x32x16_bf16 v[32:47], a[180:183], v[84:87], v[32:47]
    ds_read_b128 v[84:87], v8 offset:21504
    s_waitcnt lgkmcnt(3)
    v_mfma_f32_32x32x16_bf16 v[16:31], a[72:75], v[88:91], v[16:31]
    v_mfma_f32_32x32x16_bf16 v[32:47], a[184:187], v[88:91], v[32:47]
    ds_read_b128 v[88:91], v8 offset:22528
    s_waitcnt lgkmcnt(3)
    v_mfma_f32_32x32x16_bf16 v[16:31], a[76:79], v[92:95], v[16:31]
    v_mfma_f32_32x32x16_bf16 v[32:47], a[188:191], v[92:95], v[32:47]
    ds_read_b128 v[92:95], v8 offset:23552
    s_waitcnt lgkmcnt(3)
    v_mfma_f32_32x32x16_bf16 v[16:31], a[80:83], v[80:83], v[16:31]
    v_mfma_f32_32x32x16_bf16 v[32:47], a[192:195], v[80:83], v[32:47]
    ds_read_b128 v[80:83], v8 offset:24576
    s_waitcnt lgkmcnt(3)
    v_mfma_f32_32x32x16_bf16 v[16:31], a[84:87], v[84:87], v[16:31]
    v_mfma_f32_32x32x16_bf16 v[32:47], a[196:199], v[84:87], v[32:47]
    ds_read_b128 v[84:87], v8 offset:25600
    s_waitcnt lgkmcnt(3)
    v_mfma_f32_32x32x16_bf16 v[16:31], a[88:91], v[88:91], v[16:31]
    v_mfma_f32_32x32x16_bf16 v[32:47], a[200:203], v[88:91], v[32:47]
    ds_read_b128 v[88:91], v8 offset:26624
    s_waitcnt lgkmcnt(3)
    v_mfma_f32_32x32x16_bf16 v[16:31], a[92:95], v[92:95], v[16:31]
    v_mfma_f32_32x32x16_bf16 v[32:47], a[204:207], v[92:95], v[32:47]
    ds_read_b128 v[92:95], v8 offset:27648
    s_waitcnt lgkmcnt(3)
    v_mfma_f32_32x32x16_bf16 v[16:31], a[96:99], v[80:83], v[16:31]
    v_mfma_f32_32x32x16_bf16 v[32:47], a[208:211], v[80:83], v[32:47]
    s_waitcnt lgkmcnt(2)
    v_mfma_f32_32x32x16_bf16 v[16:31], a[100:103], v[84:87], v[16:31]
    v_mfma_f32_32x32x16_bf16 v[32:47], a[212:215], v[84:87], v[32:47]
    s_waitcnt lgkmcnt(1)
    v_mfma_f32_32x32x16_bf16 v[16:31], a[104:107], v[88:91], v[16:31]
    v_mfma_f32_32x32x16_bf16 v[32:47], a[216:219], v[88:91], v[32:47]
    s_waitcnt lgkmcnt(0)
    v_mfma_f32_32x32x16_bf16 v[16:31], a[108:111], v[92:95], v[16:31]
    v_mfma_f32_32x32x16_bf16 v[32:47], a[220:223], v[92:95], v[32:47]
    s_waitcnt vmcnt(11)
    s_branch H_t_mid_any
H_t_loop_any:
    s_waitcnt vmcnt(15)
    s_barrier
    s_add_u32 s31, s31, 1
    s_cmp_lt_u32 s31, 5
    s_cbranch_scc1 H_n3_37_any
    s_cmp_lg_u32 s20, 0
    s_cbranch_scc1 H_nf_38_any
    s_mov_b64 exec, 0xff
    buffer_store_dwordx4 v[96:99], v2, s[8:11], s30 offen sc1
    s_mov_b64 exec, -1
H_nf_38_any:
    s_add_u32 s30, s30, 45056
H_n3_37_any:
    s_cmp_eq_u32 s31, 16
    s_cbranch_scc1 H_t_end_any
    s_mul_i32 s24, s20, 7168
    s_add_u32 s24, s24, s34
    s_add_u32 s25, s28, 4096
    s_mov_b32 m0, s24
    s_add_u32 s24, s24, 4096
    buffer_load_dwordx4 v2, s[8:11], s28 offen offset:0 lds
    buffer_load_dwordx4 v2, s[8:11], s28 offen offset:1024 lds
    buffer_load_dwordx4 v2, s[8:11], s28 offen offset:2048 lds
    buffer_load_dwordx4 v2, s[8:11], s28 offen offset:3072 lds
    s_mov_b32 m0, s24
    s_add_u32 s24, s24, 4096
    buffer_load_dwordx4 v2, s[8:11], s25 offen offset:0 lds
    buffer_load_dwordx4 v2, s[8:11], s25 offen offset:1024 lds
    buffer_load_dwordx4 v2, s[8:11], s25 offen offset:2048 lds
    s_add_u32 s28, s28, 114688
    s_add_u32 s34, s34, 28672
    s_cmp_eq_u32 s34, 86016
    s_cselect_b32 s34, 0, s34
    v_add_u32 v8, s35, v2
    s_add_u32 s35, s35, 28672
    s_cmp_eq_u32 s35, 86016
    s_cselect_b32 s35, 0, s35
    ds_read_b128 v[80:83], v8 offset:0
    ds_read_b128 v[84:87], v8 offset:1024
    ds_read_b128 v[88:91], v8 offset:2048
    ds_read_b128 v[92:95], v8 offset:3072
    s_waitcnt lgkmcnt(3)
    v_mfma_f32_32x32x16_bf16 v[16:31], a[0:3], v[80:83], 0
    v_mfma_f32_32x32x16_bf16 v[32:47], a[112:115], v[80:83], 0
    ds_read_b128 v[80:83], v8 offset:4096
    s_waitcnt lgkmcnt(3)
    v_mfma_f32_32x32x16_bf16 v[16:31], a[4:7], v[84:87], v[16:31]
    s_add_u32 s26, s29, 28672
    v_mfma_f32_32x32x16_bf16 v[32:47], a[116:119], v[84:87], v[32:47]
    v_cvt_pk_bf16_f32 v48, v48, v49
    ds_read_b128 v[84:87], v8 offset:5120
    s_waitcnt lgkmcnt(3)
    v_mfma_f32_32x32x16_bf16 v[16:31], a[8:11], v[88:91], v[16:31]
    v_cvt_pk_bf16_f32 v49, v50, v51
    v_mfma_f32_32x32x16_bf16 v[32:47], a[120:123], v[88:91], v[32:47]
    v_cvt_pk_bf16_f32 v50, v52, v53
    ds_read_b128 v[88:91], v8 offset:6144
    s_waitcnt lgkmcnt(3)
    v_mfma_f32_32x32x16_bf16 v[16:31], a[12:15], v[92:95], v[16:31]
    v_cvt_pk_bf16_f32 v51, v54, v55
    v_mfma_f32_32x32x16_bf16 v[32:47], a[124:127], v[92:95], v[32:47]
    buffer_store_dwordx4 v[48:51], v5, s[8:11], s29 offen offset:0 sc1
    ds_read_b128 v[92:95], v8 offset:7168
    s_waitcnt lgkmcnt(3)
    v_mfma_f32_32x32x16_bf16 v[16:31], a[16:19], v[80:83], v[16:31]
    v_cvt_pk_bf16_f32 v56, v56, v57
    v_mfma_f32_32x32x16_bf16 v[32:47], a[128:131], v[80:83], v[32:47]
    v_cvt_pk_bf16_f32 v57, v58, v59
    ds_read_b128 v[80:83], v8 offset:8192
    s_waitcnt lgkmcnt(3)
    v_mfma_f32_32x32x16_bf16 v[16:31], a[20:23], v[84:87], v[16:31]
    v_cvt_pk_bf16_f32 v58, v60, v61
    v_mfma_f32_32x32x16_bf16 v[32:47], a[132:135], v[84:87], v[32:47]
    v_cvt_pk_bf16_f32 v59, v62, v63
    ds_read_b128 v[84:87], v8 offset:9216
    s_waitcnt lgkmcnt(3)
    v_mfma_f32_32x32x16_bf16 v[16:31], a[24:27], v[88:91], v[16:31]
    buffer_store_dwordx4 v[56:59], v5, s[8:11], s29 offen offset:1024 sc1
    v_mfma_f32_32x32x16_bf16 v[32:47], a[136:139], v[88:91], v[32:47]
    v_cvt_pk_bf16_f32 v64, v64, v65
    ds_read_b128 v[88:91], v8 offset:10240
    s_waitcnt lgkmcnt(3)
    v_mfma_f32_32x32x16_bf16 v[16:31], a[28:31], v[92:95], v[16:31]
    v_cvt_pk_bf16_f32 v65, v66, v67
    v_mfma_f32_32x32x16_bf16 v[32:47], a[140:143], v[92:95], v[32:47]
    v_cvt_pk_bf16_f32 v66, v68, v69
    ds_read_b128 v[92:95], v8 offset:11264
    s_waitcnt lgkmcnt(3)
    v_mfma_f32_32x32x16_bf16 v[16:31], a[32:35], v[80:83], v[16:31]
    v_cvt_pk_bf16_f32 v67, v70, v71
    v_mfma_f32_32x32x16_bf16 v[32:47], a[144:147], v[80:83], v[32:47]
    buffer_store_dwordx4 v[64:67], v5, s[8:11], s26 offen offset:0 sc1
    ds_read_b128 v[80:83], v8 offset:12288
    s_waitcnt lgkmcnt(3)
    v_mfma_f32_32x32x16_bf16 v[16:31], a[36:39], v[84:87], v[16:31]
    v_cvt_pk_bf16_f32 v72, v72, v73
    v_mfma_f32_32x32x16_bf16 v[32:47], a[148:151], v[84:87], v[32:47]
    v_cvt_pk_bf16_f32 v73, v74, v75
    ds_read_b128 v[84:87], v8 offset:13312
    s_waitcnt lgkmcnt(3)
    v_mfma_f32_32x32x16_bf16 v[16:31], a[40:43], v[88:91], v[16:31]
    v_cvt_pk_bf16_f32 v74, v76, v77
    v_mfma_f32_32x32x16_bf16 v[32:47], a[152:155], v[88:91], v[32:47]
    v_cvt_pk_bf16_f32 v75, v78, v79
    ds_read_b128 v[88:91], v8 offset:14336
    s_waitcnt lgkmcnt(3)
    v_mfma_f32_32x32x16_bf16 v[16:31], a[44:47], v[92:95], v[16:31]
    buffer_store_dwordx4 v[72:75], v5, s[8:11], s26 offen offset:1024 sc1
    v_mfma_f32_32x32x16_bf16 v[32:47], a[156:159], v[92:95], v[32:47]
    s_add_u32 s29, s29, 1835008
    ds_read_b128 v[92:95], v8 offset:15360
    s_waitcnt lgkmcnt(3)
    v_mfma_f32_32x32x16_bf16 v[16:31], a[48:51], v[80:83], v[16:31]
    v_mfma_f32_32x32x16_bf16 v[32:47], a[160:163], v[80:83], v[32:47]
    ds_read_b128 v[80:83], v8 offset:16384
    s_waitcnt lgkmcnt(3)
    v_mfma_f32_32x32x16_bf16 v[16:31], a[52:55], v[84:87], v[16:31]
    v_mfma_f32_32x32x16_bf16 v[32:47], a[164:167], v[84:87], v[32:47]
    ds_read_b128 v[84:87], v8 offset:17408
    s_waitcnt lgkmcnt(3)
    v_mfma_f32_32x32x16_bf16 v[16:31], a[56:59], v[88:91], v[16:31]
    v_mfma_f32_32x32x16_bf16 v[32:47], a[168:171], v[88:91], v[32:47]
    ds_read_b128 v[88:91], v8 offset:18432
    s_waitcnt lgkmcnt(3)
    v_mfma_f32_32x32x16_bf16 v[16:31], a[60:63], v[92:95], v[16:31]
    v_mfma_f32_32x32x16_bf16 v[32:47], a[172:175], v[92:95], v[32:47]
    ds_read_b128 v[92:95], v8 offset:19456
    s_waitcnt lgkmcnt(3)
    v_mfma_f32_32x32x16_bf16 v[16:31], a[64:67], v[80:83], v[16:31]
    v_mfma_f32_32x32x16_bf16 v[32:47], a[176:179], v[80:83], v[32:47]
    ds_read_b128 v[80:83], v8 offset:20480
    s_waitcnt lgkmcnt(3)
    v_mfma_f32_32x32x16_bf16 v[16:31], a[68:71], v[84:87], v[16:31]
    v_mfma_f32_32x32x16_bf16 v[32:47], a[180:183], v[84:87], v[32:47]
    ds_read_b128 v[84:87], v8 offset:21504
    s_waitcnt lgkmcnt(3)
    v_mfma_f32_32x32x16_bf16 v[16:31], a[72:75], v[88:91], v[16:31]
    v_mfma_f32_32x32x16_bf16 v[32:47], a[184:187], v[88:91], v[32:47]
    ds_read_b128 v[88:91], v8 offset:22528
    s_waitcnt lgkmcnt(3)
    v_mfma_f32_32x32x16_bf16 v[16:31], a[76:79], v[92:95], v[16:31]
    v_mfma_f32_32x32x16_bf16 v[32:47], a[188:191], v[92:95], v[32:47]
    ds_read_b128 v[92:95], v8 offset:23552
    s_waitcnt lgkmcnt(3)
    v_mfma_f32_32x32x16_bf16 v[16:31], a[80:83], v[80:83], v[16:31]
    v_mfma_f32_32x32x16_bf16 v[32:47], a[192:195], v[80:83], v[32:47]
    ds_read_b128 v[80:83], v8 offset:24576
    s_waitcnt lgkmcnt(3)
    v_mfma_f32_32x32x16_bf16 v[16:31], a[84:87], v[84:87], v[16:31]
    v_mfma_f32_32x32x16_bf16 v[32:47], a[196:199], v[84:87], v[32:47]
    ds_read_b128 v[84:87], v8 offset:25600
    s_waitcnt lgkmcnt(3)
    v_mfma_f32_32x32x16_bf16 v[16:31], a[88:91], v[88:91], v[16:31]
    v_mfma_f32_32x32x16_bf16 v[32:47], a[200:203], v[88:91], v[32:47]
    ds_read_b128 v[88:91], v8 offset:26624
    s_waitcnt lgkmcnt(3)
    v_mfma_f32_32x32x16_bf16 v[16:31], a[92:95], v[92:95], v[16:31]
    v_mfma_f32_32x32x16_bf16 v[32:47], a[204:207], v[92:95], v[32:47]
    ds_read_b128 v[92:95], v8 offset:27648
    s_waitcnt lgkmcnt(3)
    v_mfma_f32_32x32x16_bf16 v[16:31], a[96:99], v[80:83], v[16:31]
    v_mfma_f32_32x32x16_bf16 v[32:47], a[208:211], v[80:83], v[32:47]
    s_waitcnt lgkmcnt(2)
    v_mfma_f32_32x32x16_bf16 v[16:31], a[100:103], v[84:87], v[16:31]
    v_mfma_f32_32x32x16_bf16 v[32:47], a[212:215], v[84:87], v[32:47]
    s_waitcnt lgkmcnt(1)
    v_mfma_f32_32x32x16_bf16 v[16:31], a[104:107], v[88:91], v[16:31]
    v_mfma_f32_32x32x16_bf16 v[32:47], a[216:219], v[88:91], v[32:47]
    s_waitcnt lgkmcnt(0)
    v_mfma_f32_32x32x16_bf16 v[16:31], a[108:111], v[92:95], v[16:31]
    v_mfma_f32_32x32x16_bf16 v[32:47], a[220:223], v[92:95], v[32:47]
    s_waitcnt vmcnt(15)
H_t_mid_any:
    s_barrier
    s_add_u32 s31, s31, 1
    s_cmp_lt_u32 s31, 5
    s_cbranch_scc1 H_n3_39_any
    s_cmp_lg_u32 s20, 0
    s_cbranch_scc1 H_nf_40_any
    s_mov_b64 exec, 0xff
    buffer_store_dwordx4 v[96:99], v2, s[8:11], s30 offen sc1
    s_mov_b64 exec, -1
H_nf_40_any:
    s_add_u32 s30, s30, 45056
H_n3_39_any:
    s_cmp_lg_u32 s31, 11
    s_cbranch_scc1 H_nw_41_any
    s_cmp_ge_u32 s22, 28
    s_cbranch_scc1 H_nw_41_any
    s_load_dwordx2 s[56:57], s[0:1], 64
    s_load_dwordx2 s[58:59], s[0:1], 80
    v_lshlrev_b32 v9, 7, v0
    s_mul_i32 s24, s22, 57344
    v_add_u32 v9, s24, v9
    s_waitcnt lgkmcnt(0)
    v_add_u32 v10, 24576, v9
    global_load_dword v11, v9, s[56:57]
    global_load_dword v11, v10, s[56:57]
    global_load_dword v11, v9, s[58:59]
    global_load_dword v11, v10, s[58:59]
H_nw_41_any:
    s_mul_i32 s24, s20, 7168
    s_add_u32 s24, s24, s34
    s_add_u32 s25, s28, 4096
    s_mov_b32 m0, s24
    s_add_u32 s24, s24, 4096
    buffer_load_dwordx4 v2, s[8:11], s28 offen offset:0 lds
    buffer_load_dwordx4 v2, s[8:11], s28 offen offset:1024 lds
    buffer_load_dwordx4 v2, s[8:11], s28 offen offset:2048 lds
    buffer_load_dwordx4 v2, s[8:11], s28 offen offset:3072 lds
    s_mov_b32 m0, s24
    s_add_u32 s24, s24, 4096
    buffer_load_dwordx4 v2, s[8:11], s25 offen offset:0 lds
    buffer_load_dwordx4 v2, s[8:11], s25 offen offset:1024 lds
    buffer_load_dwordx4 v2, s[8:11], s25 offen offset:2048 lds
    s_add_u32 s28, s28, 114688
    s_add_u32 s34, s34, 28672
    s_cmp_eq_u32 s34, 86016
    s_cselect_b32 s34, 0, s34
    v_add_u32 v8, s35, v2
    s_add_u32 s35, s35, 28672
    s_cmp_eq_u32 s35, 86016
    s_cselect_b32 s35, 0, s35
    ds_read_b128 v[80:83], v8 offset:0
    ds_read_b128 v[84:87], v8 offset:1024
    ds_read_b128 v[88:91], v8 offset:2048
    ds_read_b128 v[92:95], v8 offset:3072
    s_waitcnt lgkmcnt(3)
    v_mfma_f32_32x32x16_bf16 v[48:63], a[0:3], v[80:83], 0
    v_mfma_f32_32x32x16_bf16 v[64:79], a[112:115], v[80:83], 0
    ds_read_b128 v[80:83], v8 offset:4096
    s_waitcnt lgkmcnt(3)
    v_mfma_f32_32x32x16_bf16 v[48:63], a[4:7], v[84:87], v[48:63]
    s_add_u32 s26, s29, 28672
    v_mfma_f32_32x32x16_bf16 v[64:79], a[116:119], v[84:87], v[64:79]
    v_cvt_pk_bf16_f32 v16, v16, v17
    ds_read_b128 v[84:87], v8 offset:5120
    s_waitcnt lgkmcnt(3)
    v_mfma_f32_32x32x16_bf16 v[48:63], a[8:11], v[88:91], v[48:63]
    v_cvt_pk_bf16_f32 v17, v18, v19
    v_mfma_f32_32x32x16_bf16 v[64:79], a[120:123], v[88:91], v[64:79]
    v_cvt_pk_bf16_f32 v18, v20, v21
    ds_read_b128 v[88:91], v8 offset:6144
    s_waitcnt lgkmcnt(3)
    v_mfma_f32_32x32x16_bf16 v[48:63], a[12:15], v[92:95], v[48:63]
    v_cvt_pk_bf16_f32 v19, v22, v23
    v_mfma_f32_32x32x16_bf16 v[64:79], a[124:127], v[92:95], v[64:79]
    buffer_store_dwordx4 v[16:19], v5, s[8:11], s29 offen offset:0 sc1
    ds_read_b128 v[92:95], v8 offset:7168
    s_waitcnt lgkmcnt(3)
    v_mfma_f32_32x32x16_bf16 v[48:63], a[16:19], v[80:83], v[48:63]
    v_cvt_pk_bf16_f32 v24, v24, v25
    v_mfma_f32_32x32x16_bf16 v[64:79], a[128:131], v[80:83], v[64:79]
    v_cvt_pk_bf16_f32 v25, v26, v27
    ds_read_b128 v[80:83], v8 offset:8192
    s_waitcnt lgkmcnt(3)
    v_mfma_f32_32x32x16_bf16 v[48:63], a[20:23], v[84:87], v[48:63]
    v_cvt_pk_bf16_f32 v26, v28, v29
    v_mfma_f32_32x32x16_bf16 v[64:79], a[132:135], v[84:87], v[64:79]
    v_cvt_pk_bf16_f32 v27, v30, v31
    ds_read_b128 v[84:87], v8 offset:9216
    s_waitcnt lgkmcnt(3)
    v_mfma_f32_32x32x16_bf16 v[48:63], a[24:27], v[88:91], v[48:63]
    buffer_store_dwordx4 v[24:27], v5, s[8:11], s29 offen offset:1024 sc1
    v_mfma_f32_32x32x16_bf16 v[64:79], a[136:139], v[88:91], v[64:79]
    v_cvt_pk_bf16_f32 v32, v32, v33
    ds_read_b128 v[88:91], v8 offset:10240
    s_waitcnt lgkmcnt(3)
    v_mfma_f32_32x32x16_bf16 v[48:63], a[28:31], v[92:95], v[48:63]
    v_cvt_pk_bf16_f32 v33, v34, v35
    v_mfma_f32_32x32x16_bf16 v[64:79], a[140:143], v[92:95], v[64:79]
    v_cvt_pk_bf16_f32 v34, v36, v37
    ds_read_b128 v[92:95], v8 offset:11264
    s_waitcnt lgkmcnt(3)
    v_mfma_f32_32x32x16_bf16 v[48:63], a[32:35], v[80:83], v[48:63]
    v_cvt_pk_bf16_f32 v35, v38, v39
    v_mfma_f32_32x32x16_bf16 v[64:79], a[144:147], v[80:83], v[64:79]
    buffer_store_dwordx4 v[32:35], v5, s[8:11], s26 offen offset:0 sc1
    ds_read_b128 v[80:83], v8 offset:12288
    s_waitcnt lgkmcnt(3)
    v_mfma_f32_32x32x16_bf16 v[48:63], a[36:39], v[84:87], v[48:63]
    v_cvt_pk_bf16_f32 v40, v40, v41
    v_mfma_f32_32x32x16_bf16 v[64:79], a[148:151], v[84:87], v[64:79]
    v_cvt_pk_bf16_f32 v41, v42, v43
    ds_read_b128 v[84:87], v8 offset:13312
    s_waitcnt lgkmcnt(3)
    v_mfma_f32_32x32x16_bf16 v[48:63], a[40:43], v[88:91], v[48:63]
    v_cvt_pk_bf16_f32 v42, v44, v45
    v_mfma_f32_32x32x16_bf16 v[64:79], a[152:155], v[88:91], v[64:79]
    v_cvt_pk_bf16_f32 v43, v46, v47
    ds_read_b128 v[88:91], v8 offset:14336
    s_waitcnt lgkmcnt(3)
    v_mfma_f32_32x32x16_bf16 v[48:63], a[44:47], v[92:95], v[48:63]
    buffer_store_dwordx4 v[40:43], v5, s[8:11], s26 offen offset:1024 sc1
    v_mfma_f32_32x32x16_bf16 v[64:79], a[156:159], v[92:95], v[64:79]
    s_add_u32 s29, s29, 1835008
    ds_read_b128 v[92:95], v8 offset:15360
    s_waitcnt lgkmcnt(3)
    v_mfma_f32_32x32x16_bf16 v[48:63], a[48:51], v[80:83], v[48:63]
    v_mfma_f32_32x32x16_bf16 v[64:79], a[160:163], v[80:83], v[64:79]
    ds_read_b128 v[80:83], v8 offset:16384
    s_waitcnt lgkmcnt(3)
    v_mfma_f32_32x32x16_bf16 v[48:63], a[52:55], v[84:87], v[48:63]
    v_mfma_f32_32x32x16_bf16 v[64:79], a[164:167], v[84:87], v[64:79]
    ds_read_b128 v[84:87], v8 offset:17408
    s_waitcnt lgkmcnt(3)
    v_mfma_f32_32x32x16_bf16 v[48:63], a[56:59], v[88:91], v[48:63]
    v_mfma_f32_32x32x16_bf16 v[64:79], a[168:171], v[88:91], v[64:79]
    ds_read_b128 v[88:91], v8 offset:18432
    s_waitcnt lgkmcnt(3)
    v_mfma_f32_32x32x16_bf16 v[48:63], a[60:63], v[92:95], v[48:63]
    v_mfma_f32_32x32x16_bf16 v[64:79], a[172:175], v[92:95], v[64:79]
    ds_read_b128 v[92:95], v8 offset:19456
    s_waitcnt lgkmcnt(3)
    v_mfma_f32_32x32x16_bf16 v[48:63], a[64:67], v[80:83], v[48:63]
    v_mfma_f32_32x32x16_bf16 v[64:79], a[176:179], v[80:83], v[64:79]
    ds_read_b128 v[80:83], v8 offset:20480
    s_waitcnt lgkmcnt(3)
    v_mfma_f32_32x32x16_bf16 v[48:63], a[68:71], v[84:87], v[48:63]
    v_mfma_f32_32x32x16_bf16 v[64:79], a[180:183], v[84:87], v[64:79]
    ds_read_b128 v[84:87], v8 offset:21504
    s_waitcnt lgkmcnt(3)
    v_mfma_f32_32x32x16_bf16 v[48:63], a[72:75], v[88:91], v[48:63]
    v_mfma_f32_32x32x16_bf16 v[64:79], a[184:187], v[88:91], v[64:79]
    ds_read_b128 v[88:91], v8 offset:22528
    s_waitcnt lgkmcnt(3)
    v_mfma_f32_32x32x16_bf16 v[48:63], a[76:79], v[92:95], v[48:63]
    v_mfma_f32_32x32x16_bf16 v[64:79], a[188:191], v[92:95], v[64:79]
    ds_read_b128 v[92:95], v8 offset:23552
    s_waitcnt lgkmcnt(3)
    v_mfma_f32_32x32x16_bf16 v[48:63], a[80:83], v[80:83], v[48:63]
    v_mfma_f32_32x32x16_bf16 v[64:79], a[192:195], v[80:83], v[64:79]
    ds_read_b128 v[80:83], v8 offset:24576
    s_waitcnt lgkmcnt(3)
    v_mfma_f32_32x32x16_bf16 v[48:63], a[84:87], v[84:87], v[48:63]
    v_mfma_f32_32x32x16_bf16 v[64:79], a[196:199], v[84:87], v[64:79]
    ds_read_b128 v[84:87], v8 offset:25600
    s_waitcnt lgkmcnt(3)
    v_mfma_f32_32x32x16_bf16 v[48:63], a[88:91], v[88:91], v[48:63]
    v_mfma_f32_32x32x16_bf16 v[64:79], a[200:203], v[88:91], v[64:79]
    ds_read_b128 v[88:91], v8 offset:26624
    s_waitcnt lgkmcnt(3)
    v_mfma_f32_32x32x16_bf16 v[48:63], a[92:95], v[92:95], v[48:63]
    v_mfma_f32_32x32x16_bf16 v[64:79], a[204:207], v[92:95], v[64:79]
    ds_read_b128 v[92:95], v8 offset:27648
    s_waitcnt lgkmcnt(3)
    v_mfma_f32_32x32x16_bf16 v[48:63], a[96:99], v[80:83], v[48:63]
    v_mfma_f32_32x32x16_bf16 v[64:79], a[208:211], v[80:83], v[64:79]
    s_waitcnt lgkmcnt(2)
    v_mfma_f32_32x32x16_bf16 v[48:63], a[100:103], v[84:87], v[48:63]
    v_mfma_f32_32x32x16_bf16 v[64:79], a[212:215], v[84:87], v[64:79]
    s_waitcnt lgkmcnt(1)
    v_mfma_f32_32x32x16_bf16 v[48:63], a[104:107], v[88:91], v[48:63]
    v_mfma_f32_32x32x16_bf16 v[64:79], a[216:219], v[88:91], v[64:79]
    s_waitcnt lgkmcnt(0)
    v_mfma_f32_32x32x16_bf16 v[48:63], a[108:111], v[92:95], v[48:63]
    v_mfma_f32_32x32x16_bf16 v[64:79], a[220:223], v[92:95], v[64:79]
    s_branch H_t_loop_any
H_t_end_any:
    s_add_u32 s26, s29, 28672
    v_cvt_pk_bf16_f32 v48, v48, v49
    v_cvt_pk_bf16_f32 v49, v50, v51
    v_cvt_pk_bf16_f32 v50, v52, v53
    v_cvt_pk_bf16_f32 v51, v54, v55
    buffer_store_dwordx4 v[48:51], v5, s[8:11], s29 offen offset:0 sc1
    v_cvt_pk_bf16_f32 v56, v56, v57
    v_cvt_pk_bf16_f32 v57, v58, v59
    v_cvt_pk_bf16_f32 v58, v60, v61
    v_cvt_pk_bf16_f32 v59, v62, v63
    buffer_store_dwordx4 v[56:59], v5, s[8:11], s29 offen offset:1024 sc1
    v_cvt_pk_bf16_f32 v64, v64, v65
    v_cvt_pk_bf16_f32 v65, v66, v67
    v_cvt_pk_bf16_f32 v66, v68, v69
    v_cvt_pk_bf16_f32 v67, v70, v71
    buffer_store_dwordx4 v[64:67], v5, s[8:11], s26 offen offset:0 sc1
    v_cvt_pk_bf16_f32 v72, v72, v73
    v_cvt_pk_bf16_f32 v73, v74, v75
    v_cvt_pk_bf16_f32 v74, v76, v77
    v_cvt_pk_bf16_f32 v75, v78, v79
    buffer_store_dwordx4 v[72:75], v5, s[8:11], s26 offen offset:1024 sc1
    s_add_u32 s29, s29, 1835008
    s_waitcnt vmcnt(0)
    s_barrier
    s_cmp_lg_u32 s20, 0
    s_cbranch_scc1 H_nf_42_any
    s_mov_b64 exec, 0xff
    buffer_store_dwordx4 v[96:99], v2, s[8:11], s30 offen sc1
    s_mov_b64 exec, -1
H_nf_42_any:
    s_add_u32 s30, s30, 45056
    s_cmp_lg_u32 s20, 0
    s_cbranch_scc1 H_nf_43_any
    s_mov_b64 exec, 0xff
    buffer_store_dwordx4 v[96:99], v2, s[8:11], s30 offen sc1
    s_mov_b64 exec, -1
H_nf_43_any:
    s_add_u32 s30, s30, 45056
    s_cmp_lg_u32 s20, 0
    s_cbranch_scc1 H_nf_44_any
    s_mov_b64 exec, 0xff
    buffer_store_dwordx4 v[96:99], v2, s[8:11], s30 offen sc1
    s_mov_b64 exec, -1
H_nf_44_any:
    s_add_u32 s30, s30, 45056
    s_branch H_trail_any
H_trail_any:
    s_load_dwordx2 s[56:57], s[0:1], 0
    s_load_dwordx4 s[60:63], s[0:1], 64
    s_load_dwordx2 s[64:65], s[0:1], 80
    s_load_dwordx2 s[66:67], s[0:1], 104
    s_waitcnt lgkmcnt(0)
    s_mov_b32 s36, s56
    s_mov_b32 s37, s57
    s_mov_b32 s38, 1835008
    s_mov_b32 s39, 0x20000
    s_mov_b32 s40, s60
    s_mov_b32 s41, s61
    s_mov_b32 s42, 1605632
    s_mov_b32 s43, 0x20000
    s_mov_b32 s44, s62
    s_mov_b32 s45, s63
    s_mov_b32 s46, 3584
    s_mov_b32 s47, 0x20000
    s_mov_b32 s48, s64
    s_mov_b32 s49, s65
    s_mov_b32 s50, 1605632
    s_mov_b32 s51, 0x20000
    s_mov_b32 s52, s66
    s_mov_b32 s53, s67
    s_mov_b32 s54, 1835008
    s_mov_b32 s55, 0x20000
    s_cmp_ge_u32 s22, 30
    s_cbranch_scc1 H_y_any
    v_lshrrev_b32 v8, 4, v1
    v_and_b32 v9, 15, v1
    s_cmp_ge_u32 s22, 28
    s_cbranch_scc1 H_nomlp_any
    v_lshrrev_b32 v6, 3, v0
    v_mul_u32_u24 v6, 3584, v6
    v_and_b32 v7, 7, v0
    v_lshl_add_u32 v6, v7, 4, v6
    s_lshl_b32 s29, s22, 7
    s_lshl_b32 s30, s20, 10
    s_mov_b32 m0, s30
    s_add_u32 s30, s30, 4096
    buffer_load_dwordx4 v6, s[40:43], s29 offen lds
    s_add_u32 s29, s29, 114688
    s_mov_b32 m0, s30
    s_add_u32 s30, s30, 4096
    buffer_load_dwordx4 v6, s[40:43], s29 offen lds
    s_add_u32 s29, s29, 114688
    s_mov_b32 m0, s30
    s_add_u32 s30, s30, 4096
    buffer_load_dwordx4 v6, s[40:43], s29 offen lds
    s_add_u32 s29, s29, 114688
    s_mov_b32 m0, s30
    s_add_u32 s30, s30, 4096
    buffer_load_dwordx4 v6, s[40:43], s29 offen lds
    s_add_u32 s29, s29, 114688
    s_mov_b32 m0, s30
    s_add_u32 s30, s30, 4096
    buffer_load_dwordx4 v6, s[40:43], s29 offen lds
    s_add_u32 s29, s29, 114688
    s_mov_b32 m0, s30
    s_add_u32 s30, s30, 4096
    buffer_load_dwordx4 v6, s[40:43], s29 offen lds
    s_add_u32 s29, s29, 114688
    s_mov_b32 m0, s30
    s_add_u32 s30, s30, 4096
    buffer_load_dwordx4 v6, s[40:43], s29 offen lds
    s_add_u32 s29, s29, 114688
    s_mov_b32 m0, s30
    s_add_u32 s30, s30, 4096
    buffer_load_dwordx4 v6, s[40:43], s29 offen lds
    s_add_u32 s29, s29, 114688
    s_mov_b32 m0, s30
    s_add_u32 s30, s30, 4096
    buffer_load_dwordx4 v6, s[40:43], s29 offen lds
    s_add_u32 s29, s29, 114688
    s_mov_b32 m0, s30
    s_add_u32 s30, s30, 4096
    buffer_load_dwordx4 v6, s[40:43], s29 offen lds
    s_add_u32 s29, s29, 114688
    s_mov_b32 m0, s30
    s_add_u32 s30, s30, 4096
    buffer_load_dwordx4 v6, s[40:43], s29 offen lds
    s_add_u32 s29, s29, 114688
    s_mov_b32 m0, s30
    s_add_u32 s30, s30, 4096
    buffer_load_dwordx4 v6, s[40:43], s29 offen lds
    s_add_u32 s29, s29, 114688
    s_mov_b32 m0, s30
    s_add_u32 s30, s30, 4096
    buffer_load_dwordx4 v6, s[40:43], s29 offen lds
    s_add_u32 s29, s29, 114688
    s_mov_b32 m0, s30
    s_add_u32 s30, s30, 4096
    buffer_load_dwordx4 v6, s[40:43], s29 offen lds
    s_add_u32 s29, s29, 114688
    v_lshrrev_b32 v6, 1, v0
    v_mul_u32_u24 v6, 896, v6
    v_and_b32 v7, 1, v0
    v_lshl_add_u32 v6, v7, 4, v6
    s_lshl_b32 s29, s22, 5
    s_mov_b32 m0, s30
    s_add_u32 s30, s30, 4096
    buffer_load_dwordx4 v6, s[48:51], s29 offen lds
    s_add_u32 s29, s29, 114688
    s_mov_b32 m0, s30
    s_add_u32 s30, s30, 4096
    buffer_load_dwordx4 v6, s[48:51], s29 offen lds
    s_add_u32 s29, s29, 114688
    s_mov_b32 m0, s30
    s_add_u32 s30, s30, 4096
    buffer_load_dwordx4 v6, s[48:51], s29 offen lds
    s_add_u32 s29, s29, 114688
    s_mov_b32 m0, s30
    s_add_u32 s30, s30, 4096
    buffer_load_dwordx4 v6, s[48:51], s29 offen lds
    s_add_u32 s29, s29, 114688
    s_mov_b32 m0, s30
    s_add_u32 s30, s30, 4096
    buffer_load_dwordx4 v6, s[48:51], s29 offen lds
    s_add_u32 s29, s29, 114688
    s_mov_b32 m0, s30
    s_add_u32 s30, s30, 4096
    buffer_load_dwordx4 v6, s[48:51], s29 offen lds
    s_add_u32 s29, s29, 114688
    s_mov_b32 m0, s30
    s_add_u32 s30, s30, 4096
    buffer_load_dwordx4 v6, s[48:51], s29 offen lds
    s_add_u32 s29, s29, 114688
    s_mov_b32 m0, s30
    s_add_u32 s30, s30, 4096
    buffer_load_dwordx4 v6, s[48:51], s29 offen lds
    s_add_u32 s29, s29, 114688
    s_mov_b32 m0, s30
    s_add_u32 s30, s30, 4096
    buffer_load_dwordx4 v6, s[48:51], s29 offen lds
    s_add_u32 s29, s29, 114688
    s_mov_b32 m0, s30
    s_add_u32 s30, s30, 4096
    buffer_load_dwordx4 v6, s[48:51], s29 offen lds
    s_add_u32 s29, s29, 114688
    s_mov_b32 m0, s30
    s_add_u32 s30, s30, 4096
    buffer_load_dwordx4 v6, s[48:51], s29 offen lds
    s_add_u32 s29, s29, 114688
    s_mov_b32 m0, s30
    s_add_u32 s30, s30, 4096
    buffer_load_dwordx4 v6, s[48:51], s29 offen lds
    s_add_u32 s29, s29, 114688
    s_mov_b32 m0, s30
    s_add_u32 s30, s30, 4096
    buffer_load_dwordx4 v6, s[48:51], s29 offen lds
    s_add_u32 s29, s29, 114688
    s_mov_b32 m0, s30
    s_add_u32 s30, s30, 4096
    buffer_load_dwordx4 v6, s[48:51], s29 offen lds
    s_add_u32 s29, s29, 114688
    s_and_b32 s31, s20, 1
    s_lshl_b32 s29, s31, 6
    s_lshl_b32 s30, s22, 7
    s_add_u32 s29, s29, s30
    v_lshlrev_b32 v7, 3, v8
    buffer_load_dwordx2 v[22:23], v7, s[44:47], s29 offen
    buffer_load_dwordx2 v[24:25], v7, s[44:47], s29 offen offset:32
    v_lshlrev_b32 v7, 4, v8
    s_lshl_b32 s29, s22, 6
    s_add_u32 s29, s29, 85567232
    buffer_load_dwordx4 v[18:21], v7, s[8:11], s29 offen
    v_bfe_u32 v6, v1, 4, 2
    v_lshlrev_b32 v6, 10, v6
    v_bfe_u32 v7, v1, 2, 2
    v_lshl_add_u32 v6, v7, 7, v6
    v_bfe_u32 v7, v1, 0, 2
    v_lshl_add_u32 v6, v7, 3, v6
    s_lshl_b32 s31, s31, 6
    v_add_u32 v6, s31, v6
    s_waitcnt vmcnt(0)
    s_barrier
    ds_read_b64_tr_b16 a[0:1], v6 offset:0
    ds_read_b64_tr_b16 a[2:3], v6 offset:512
    ds_read_b64_tr_b16 a[4:5], v6 offset:4096
    ds_read_b64_tr_b16 a[6:7], v6 offset:4608
    ds_read_b64_tr_b16 a[8:9], v6 offset:8192
    ds_read_b64_tr_b16 a[10:11], v6 offset:8704
    ds_read_b64_tr_b16 a[12:13], v6 offset:12288
    ds_read_b64_tr_b16 a[14:15], v6 offset:12800
    ds_read_b64_tr_b16 a[16:17], v6 offset:16384
    ds_read_b64_tr_b16 a[18:19], v6 offset:16896
    ds_read_b64_tr_b16 a[20:21], v6 offset:20480
    ds_read_b64_tr_b16 a[22:23], v6 offset:20992
    ds_read_b64_tr_b16 a[24:25], v6 offset:24576
    ds_read_b64_tr_b16 a[26:27], v6 offset:25088
    ds_read_b64_tr_b16 a[28:29], v6 offset:28672
    ds_read_b64_tr_b16 a[30:31], v6 offset:29184
    ds_read_b64_tr_b16 a[32:33], v6 offset:32768
    ds_read_b64_tr_b16 a[34:35], v6 offset:33280
    ds_read_b64_tr_b16 a[36:37], v6 offset:36864
    ds_read_b64_tr_b16 a[38:39], v6 offset:37376
    ds_read_b64_tr_b16 a[40:41], v6 offset:40960
    ds_read_b64_tr_b16 a[42:43], v6 offset:41472
    ds_read_b64_tr_b16 a[44:45], v6 offset:45056
    ds_read_b64_tr_b16 a[46:47], v6 offset:45568
    ds_read_b64_tr_b16 a[48:49], v6 offset:49152
    ds_read_b64_tr_b16 a[50:51], v6 offset:49664
    ds_read_b64_tr_b16 a[52:53], v6 offset:53248
    ds_read_b64_tr_b16 a[54:55], v6 offset:53760
    ds_read_b64_tr_b16 a[56:57], v6 offset:32
    ds_read_b64_tr_b16 a[58:59], v6 offset:544
    ds_read_b64_tr_b16 a[60:61], v6 offset:4128
    ds_read_b64_tr_b16 a[62:63], v6 offset:4640
    ds_read_b64_tr_b16 a[64:65], v6 offset:8224
    ds_read_b64_tr_b16 a[66:67], v6 offset:8736
    ds_read_b64_tr_b16 a[68:69], v6 offset:12320
    ds_read_b64_tr_b16 a[70:71], v6 offset:12832
    ds_read_b64_tr_b16 a[72:73], v6 offset:16416
    ds_read_b64_tr_b16 a[74:75], v6 offset:16928
    ds_read_b64_tr_b16 a[76:77], v6 offset:20512
    ds_read_b64_tr_b16 a[78:79], v6 offset:21024
    ds_read_b64_tr_b16 a[80:81], v6 offset:24608
    ds_read_b64_tr_b16 a[82:83], v6 offset:25120
    ds_read_b64_tr_b16 a[84:85], v6 offset:28704
    ds_read_b64_tr_b16 a[86:87], v6 offset:29216
    ds_read_b64_tr_b16 a[88:89], v6 offset:32800
    ds_read_b64_tr_b16 a[90:91], v6 offset:33312
    ds_read_b64_tr_b16 a[92:93], v6 offset:36896
    ds_read_b64_tr_b16 a[94:95], v6 offset:37408
    ds_read_b64_tr_b16 a[96:97], v6 offset:40992
    ds_read_b64_tr_b16 a[98:99], v6 offset:41504
    ds_read_b64_tr_b16 a[100:101], v6 offset:45088
    ds_read_b64_tr_b16 a[102:103], v6 offset:45600
    ds_read_b64_tr_b16 a[104:105], v6 offset:49184
    ds_read_b64_tr_b16 a[106:107], v6 offset:49696
    ds_read_b64_tr_b16 a[108:109], v6 offset:53280
    ds_read_b64_tr_b16 a[110:111], v6 offset:53792
    v_bfe_u32 v6, v1, 4, 2
    v_lshlrev_b32 v6, 7, v6
    v_bfe_u32 v7, v1, 2, 2
    v_lshl_add_u32 v6, v7, 5, v6
    v_bfe_u32 v7, v1, 0, 2
    v_lshl_add_u32 v6, v7, 3, v6
    v_add_u32 v6, 0xe000, v6
    s_mul_i32 s31, s20, 14336
    v_add_u32 v6, s31, v6
    ds_read_b64_tr_b16 a[112:113], v6 offset:0
    ds_read_b64_tr_b16 a[114:115], v6 offset:512
    ds_read_b64_tr_b16 a[116:117], v6 offset:1024
    ds_read_b64_tr_b16 a[118:119], v6 offset:1536
    ds_read_b64_tr_b16 a[120:121], v6 offset:2048
    ds_read_b64_tr_b16 a[122:123], v6 offset:2560
    ds_read_b64_tr_b16 a[124:125], v6 offset:3072
    ds_read_b64_tr_b16 a[126:127], v6 offset:3584
    ds_read_b64_tr_b16 a[128:129], v6 offset:4096
    ds_read_b64_tr_b16 a[130:131], v6 offset:4608
    ds_read_b64_tr_b16 a[132:133], v6 offset:5120
    ds_read_b64_tr_b16 a[134:135], v6 offset:5632
    ds_read_b64_tr_b16 a[136:137], v6 offset:6144
    ds_read_b64_tr_b16 a[138:139], v6 offset:6656
    ds_read_b64_tr_b16 a[140:141], v6 offset:7168
    ds_read_b64_tr_b16 a[142:143], v6 offset:7680
    ds_read_b64_tr_b16 a[144:145], v6 offset:8192
    ds_read_b64_tr_b16 a[146:147], v6 offset:8704
    ds_read_b64_tr_b16 a[148:149], v6 offset:9216
    ds_read_b64_tr_b16 a[150:151], v6 offset:9728
    ds_read_b64_tr_b16 a[152:153], v6 offset:10240
    ds_read_b64_tr_b16 a[154:155], v6 offset:10752
    ds_read_b64_tr_b16 a[156:157], v6 offset:11264
    ds_read_b64_tr_b16 a[158:159], v6 offset:11776
    ds_read_b64_tr_b16 a[160:161], v6 offset:12288
    ds_read_b64_tr_b16 a[162:163], v6 offset:12800
    ds_read_b64_tr_b16 a[164:165], v6 offset:13312
    ds_read_b64_tr_b16 a[166:167], v6 offset:13824
    v_lshlrev_b32 v10, 16, v22
    v_and_b32 v11, 0xffff0000, v22
    v_lshlrev_b32 v12, 16, v23
    v_and_b32 v13, 0xffff0000, v23
    v_lshlrev_b32 v14, 16, v24
    v_and_b32 v15, 0xffff0000, v24
    v_lshlrev_b32 v16, 16, v25
    v_and_b32 v17, 0xffff0000, v25
    s_waitcnt lgkmcnt(0)
    s_barrier
    v_lshlrev_b32 v6, 4, v0
    s_mov_b32 s29, 85563648
    buffer_load_dwordx4 v[24:27], v6, s[8:11], s29 offen
    v_mov_b32 v28, 0
    v_cmp_lt_u32 vcc, 111, v0
    s_nop 1
    v_cndmask_b32 v28, v28, 1.0, vcc
    s_waitcnt vmcnt(0)
    v_add_f32 v24, v24, v28
    v_add_f32 v25, v25, v28
    v_add_f32 v26, v26, v28
    v_add_f32 v27, v27, v28
    ds_write_b128 v6, v[24:27] offset:40960
    s_waitcnt lgkmcnt(0)
    s_barrier
H_nomlp_any:
    v_min_u32 v22, 55, v1
    v_lshlrev_b32 v22, 7, v22
    s_mov_b32 s28, 46770176
    s_mov_b32 s33, 400000
H_all0_any:
    buffer_load_dword v23, v22, s[8:11], s28 offen offset:0 sc1
    s_waitcnt vmcnt(0)
    v_cmp_eq_u32 vcc, -1, v23
    s_cbranch_vccz H_all0_ok_any
    s_sub_u32 s33, s33, 1
    s_cbranch_scc0 H_all0_any
    s_branch L_fail
H_all0_ok_any:
    s_mov_b32 s28, 46781440
    s_mov_b32 s33, 400000
H_all1_any:
    buffer_load_dword v23, v22, s[8:11], s28 offen offset:0 sc1
    s_waitcnt vmcnt(0)
    v_cmp_eq_u32 vcc, -1, v23
    s_cbranch_vccz H_all1_ok_any
    s_sub_u32 s33, s33, 1
    s_cbranch_scc0 H_all1_any
    s_branch L_fail
H_all1_ok_any:
    s_mov_b32 s28, 46792704
    s_mov_b32 s33, 400000
H_all2_any:
    buffer_load_dword v23, v22, s[8:11], s28 offen offset:0 sc1
    s_waitcnt vmcnt(0)
    v_cmp_eq_u32 vcc, -1, v23
    s_cbranch_vccz H_all2_ok_any
    s_sub_u32 s33, s33, 1
    s_cbranch_scc0 H_all2_any
    s_branch L_fail
H_all2_ok_any:
    s_mov_b32 s28, 46803968
    s_mov_b32 s33, 400000
H_all3_any:
    buffer_load_dword v23, v22, s[8:11], s28 offen offset:0 sc1
    s_waitcnt vmcnt(0)
    v_cmp_eq_u32 vcc, -1, v23
    s_cbranch_vccz H_all3_ok_any
    s_sub_u32 s33, s33, 1
    s_cbranch_scc0 H_all3_any
    s_branch L_fail
H_all3_ok_any:
    s_cmp_eq_u32 s21, 1
    s_cselect_b32 s27, 0, s21
    s_cmp_eq_u32 s21, 0
    s_cselect_b32 s27, 7, s27
    s_cmp_ge_u32 s22, 16
    s_cbranch_scc1 H_seg_any
    s_cmp_ge_u32 s20, 2
    s_cbranch_scc1 H_seg_any
    v_bfe_u32 v200, v1, 5, 1
    v_lshlrev_b32 v200, 10, v200
    v_bfe_u32 v6, v1, 4, 1
    v_lshl_add_u32 v200, v6, 9, v200
    v_bfe_u32 v6, v1, 0, 4
    v_lshl_add_u32 v200, v6, 4, v200
    s_mul_i32 s29, s27, 458752
    s_mul_i32 s30, s22, 28672
    s_add_u32 s29, s29, s30
    s_lshl_b32 s30, s20, 8
    s_add_u32 s29, s29, s30
    s_add_u32 s29, s29, 56198144
    buffer_load_dwordx4 a[168:171], v200, s[8:11], s29 offen offset:0 sc1
    buffer_load_dwordx4 a[172:175], v200, s[8:11], s29 offen offset:2048 sc1
    s_add_u32 s29, s29, 4096
    buffer_load_dwordx4 a[176:179], v200, s[8:11], s29 offen offset:0 sc1
    buffer_load_dwordx4 a[180:183], v200, s[8:11], s29 offen offset:2048 sc1
    s_add_u32 s29, s29, 4096
    buffer_load_dwordx4 a[184:187], v200, s[8:11], s29 offen offset:0 sc1
    buffer_load_dwordx4 a[188:191], v200, s[8:11], s29 offen offset:2048 sc1
    s_add_u32 s29, s29, 4096
    buffer_load_dwordx4 a[192:195], v200, s[8:11], s29 offen offset:0 sc1
    buffer_load_dwordx4 a[196:199], v200, s[8:11], s29 offen offset:2048 sc1
    s_add_u32 s29, s29, 4096
    buffer_load_dwordx4 a[200:203], v200, s[8:11], s29 offen offset:0 sc1
    buffer_load_dwordx4 a[204:207], v200, s[8:11], s29 offen offset:2048 sc1
    s_add_u32 s29, s29, 4096
    buffer_load_dwordx4 a[208:211], v200, s[8:11], s29 offen offset:0 sc1
    buffer_load_dwordx4 a[212:215], v200, s[8:11], s29 offen offset:2048 sc1
    s_add_u32 s29, s29, 4096
    buffer_load_dwordx4 a[216:219], v200, s[8:11], s29 offen offset:0 sc1
    buffer_load_dwordx4 a[220:223], v200, s[8:11], s29 offen offset:2048 sc1
    s_add_u32 s29, s29, 4096
    v_bfe_u32 v200, v1, 3, 1
    v_lshlrev_b32 v200, 12, v200
    v_bfe_u32 v6, v1, 4, 1
    v_lshl_add_u32 v200, v6, 8, v200
    v_bfe_u32 v6, v1, 0, 3
    v_lshl_add_u32 v200, v6, 4, v200
    v_bfe_u32 v6, v1, 5, 1
    v_mul_u32_u24 v7, 5120, v6
    v_add_u32 v201, v200, v7
    v_lshl_add_u32 v200, v6, 9, v200
    s_lshl_b32 s29, s27, 15
    s_add_u32 s29, s29, 12845056
    buffer_load_dwordx4 v[32:35], v200, s[8:11], s29 offen offset:0
    buffer_load_dwordx4 v[36:39], v200, s[8:11], s29 offen offset:128
    buffer_load_dwordx4 v[40:43], v200, s[8:11], s29 offen offset:1024
    buffer_load_dwordx4 v[44:47], v200, s[8:11], s29 offen offset:1152
    buffer_load_dwordx4 v[48:51], v200, s[8:11], s29 offen offset:2048
    buffer_load_dwordx4 v[52:55], v200, s[8:11], s29 offen offset:2176
    buffer_load_dwordx4 v[56:59], v201, s[8:11], s29 offen offset:3072
    buffer_load_dwordx4 v[60:63], v201, s[8:11], s29 offen offset:3200
    s_lshl_b32 s29, s27, 15
    s_add_u32 s29, s29, 12853248
    buffer_load_dwordx4 v[64:67], v200, s[8:11], s29 offen offset:512
    buffer_load_dwordx4 v[68:71], v200, s[8:11], s29 offen offset:640
    buffer_load_dwordx4 v[72:75], v200, s[8:11], s29 offen offset:1536
    buffer_load_dwordx4 v[76:79], v200, s[8:11], s29 offen offset:1664
    buffer_load_dwordx4 v[80:83], v200, s[8:11], s29 offen offset:2560
    buffer_load_dwordx4 v[84:87], v200, s[8:11], s29 offen offset:2688
    s_lshl_b32 s29, s27, 15
    s_add_u32 s29, s29, 12861440
    buffer_load_dwordx4 v[88:91], v200, s[8:11], s29 offen offset:0
    buffer_load_dwordx4 v[92:95], v200, s[8:11], s29 offen offset:128
    buffer_load_dwordx4 v[96:99], v200, s[8:11], s29 offen offset:1024
    buffer_load_dwordx4 v[100:103], v200, s[8:11], s29 offen offset:1152
    buffer_load_dwordx4 v[104:107], v200, s[8:11], s29 offen offset:2048
    buffer_load_dwordx4 v[108:111], v200, s[8:11], s29 offen offset:2176
    buffer_load_dwordx4 v[112:115], v201, s[8:11], s29 offen offset:3072
    buffer_load_dwordx4 v[116:119], v201, s[8:11], s29 offen offset:3200
    s_lshl_b32 s29, s27, 15
    s_add_u32 s29, s29, 12869632
    buffer_load_dwordx4 v[120:123], v200, s[8:11], s29 offen offset:512
    buffer_load_dwordx4 v[124:127], v200, s[8:11], s29 offen offset:640
    buffer_load_dwordx4 v[128:131], v200, s[8:11], s29 offen offset:1536
    buffer_load_dwordx4 v[132:135], v200, s[8:11], s29 offen offset:1664
    buffer_load_dwordx4 v[136:139], v200, s[8:11], s29 offen offset:2560
    buffer_load_dwordx4 v[140:143], v200, s[8:11], s29 offen offset:2688
    s_waitcnt vmcnt(26)
    v_mfma_f32_16x16x32_bf16 v[24:27], v[32:35], a[168:171], 0
    v_mfma_f32_16x16x32_bf16 v[28:31], v[36:39], a[168:171], 0
    s_waitcnt vmcnt(24)
    v_mfma_f32_16x16x32_bf16 v[24:27], v[40:43], a[172:175], v[24:27]
    v_mfma_f32_16x16x32_bf16 v[28:31], v[44:47], a[172:175], v[28:31]
    s_waitcnt vmcnt(22)
    v_mfma_f32_16x16x32_bf16 v[24:27], v[48:51], a[176:179], v[24:27]
    v_mfma_f32_16x16x32_bf16 v[28:31], v[52:55], a[176:179], v[28:31]
    s_waitcnt vmcnt(20)
    v_mfma_f32_16x16x32_bf16 v[24:27], v[56:59], a[180:183], v[24:27]
    v_mfma_f32_16x16x32_bf16 v[28:31], v[60:63], a[180:183], v[28:31]
    s_waitcnt vmcnt(18)
    v_mfma_f32_16x16x32_bf16 v[24:27], v[64:67], a[184:187], v[24:27]
    v_mfma_f32_16x16x32_bf16 v[28:31], v[68:71], a[184:187], v[28:31]
    s_waitcnt vmcnt(16)
    v_mfma_f32_16x16x32_bf16 v[24:27], v[72:75], a[188:191], v[24:27]
    v_mfma_f32_16x16x32_bf16 v[28:31], v[76:79], a[188:191], v[28:31]
    s_waitcnt vmcnt(14)
    v_mfma_f32_16x16x32_bf16 v[24:27], v[80:83], a[192:195], v[24:27]
    v_mfma_f32_16x16x32_bf16 v[28:31], v[84:87], a[192:195], v[28:31]
    s_waitcnt vmcnt(12)
    v_mfma_f32_16x16x32_bf16 v[24:27], v[88:91], a[196:199], v[24:27]
    v_mfma_f32_16x16x32_bf16 v[28:31], v[92:95], a[196:199], v[28:31]
    s_waitcnt vmcnt(10)
    v_mfma_f32_16x16x32_bf16 v[24:27], v[96:99], a[200:203], v[24:27]
    v_mfma_f32_16x16x32_bf16 v[28:31], v[100:103], a[200:203], v[28:31]
    s_waitcnt vmcnt(8)
    v_mfma_f32_16x16x32_bf16 v[24:27], v[104:107], a[204:207], v[24:27]
    v_mfma_f32_16x16x32_bf16 v[28:31], v[108:111], a[204:207], v[28:31]
    s_waitcnt vmcnt(6)
    v_mfma_f32_16x16x32_bf16 v[24:27], v[112:115], a[208:211], v[24:27]
    v_mfma_f32_16x16x32_bf16 v[28:31], v[116:119], a[208:211], v[28:31]
    s_waitcnt vmcnt(4)
    v_mfma_f32_16x16x32_bf16 v[24:27], v[120:123], a[212:215], v[24:27]
    v_mfma_f32_16x16x32_bf16 v[28:31], v[124:127], a[212:215], v[28:31]
    s_waitcnt vmcnt(2)
    v_mfma_f32_16x16x32_bf16 v[24:27], v[128:131], a[216:219], v[24:27]
    v_mfma_f32_16x16x32_bf16 v[28:31], v[132:135], a[216:219], v[28:31]
    s_waitcnt vmcnt(0)
    v_mfma_f32_16x16x32_bf16 v[24:27], v[136:139], a[220:223], v[24:27]
    v_mfma_f32_16x16x32_bf16 v[28:31], v[140:143], a[220:223], v[28:31]
    v_bfe_u32 v200, v1, 5, 1
    v_lshlrev_b32 v200, 4, v200
    v_bfe_u32 v6, v1, 4, 1
    v_lshl_add_u32 v200, v6, 2, v200
    s_lshl_b32 s29, s20, 4
    v_add_u32 v6, s29, v9
    v_sub_u32 v200, v6, v200
    v_mov_b32 v7, 0xf149f2ca
    s_nop 3
    v_cmp_gt_i32 vcc, 0, v200
    s_nop 1
    v_cndmask_b32 v24, v24, v7, vcc
    v_cmp_gt_i32 vcc, 1, v200
    s_nop 1
    v_cndmask_b32 v25, v25, v7, vcc
    v_cmp_gt_i32 vcc, 2, v200
    s_nop 1
    v_cndmask_b32 v26, v26, v7, vcc
    v_cmp_gt_i32 vcc, 3, v200
    s_nop 1
    v_cndmask_b32 v27, v27, v7, vcc
    v_cmp_gt_i32 vcc, 8, v200
    s_nop 1
    v_cndmask_b32 v28, v28, v7, vcc
    v_cmp_gt_i32 vcc, 9, v200
    s_nop 1
    v_cndmask_b32 v29, v29, v7, vcc
    v_cmp_gt_i32 vcc, 10, v200
    s_nop 1
    v_cndmask_b32 v30, v30, v7, vcc
    v_cmp_gt_i32 vcc, 11, v200
    s_nop 1
    v_cndmask_b32 v31, v31, v7, vcc
    v_accvgpr_write_b32 a224, v24
    v_accvgpr_write_b32 a225, v25
    v_accvgpr_write_b32 a226, v26
    v_accvgpr_write_b32 a227, v27
    v_accvgpr_write_b32 a228, v28
    v_accvgpr_write_b32 a229, v29
    v_accvgpr_write_b32 a230, v30
    v_accvgpr_write_b32 a231, v31
H_seg_any:
    s_mul_i32 s28, s27, 11264
    s_add_u32 s28, s28, 46094336
    s_add_u32 s24, s28, 10752
    s_cmp_lg_u32 s20, 3
    s_cbranch_scc1 H_nt_any
    s_mul_i32 s29, s27, 114688
    s_add_u32 s29, s29, 90031104
    s_mov_b32 s30, 0
    s_mul_i32 s31, s27, 40960
    s_add_u32 s31, s31, 85574656
    s_cmp_ge_u32 s22, 14
    s_cselect_b32 s29, s31, s29
    s_cselect_b32 s30, 14, s30
    s_mul_i32 s31, s27, 28672
    s_add_u32 s31, s31, 88196096
    s_cmp_ge_u32 s22, 19
    s_cselect_b32 s29, s31, s29
    s_cselect_b32 s30, 19, s30
    s_sub_u32 s30, s22, s30
    s_lshl_b32 s30, s30, 13
    s_add_u32 s29, s29, s30
    s_cmp_ge_u32 s22, 23
    s_cbranch_scc1 H_nt_any
    v_lshlrev_b32 v6, 7, v1
    buffer_load_dword v7, v6, s[8:11], s29 offen
H_nt_any:
    s_cmp_ge_u32 s22, 16
    s_cbranch_scc1 H_x2_any
    s_cmp_ge_u32 s20, 2
    s_cbranch_scc1 H_x1_end_any
    v_accvgpr_read_b32 v24, a224
    v_accvgpr_read_b32 v25, a225
    v_accvgpr_read_b32 v26, a226
    v_accvgpr_read_b32 v27, a227
    v_accvgpr_read_b32 v28, a228
    v_accvgpr_read_b32 v29, a229
    v_accvgpr_read_b32 v30, a230
    v_accvgpr_read_b32 v31, a231
    v_bfe_u32 v200, v1, 5, 1
    v_lshlrev_b32 v200, 8, v200
    v_bfe_u32 v6, v1, 2, 2
    v_lshl_add_u32 v200, v6, 6, v200
    v_bfe_u32 v6, v1, 4, 1
    v_lshl_add_u32 v200, v6, 5, v200
    v_bfe_u32 v6, v1, 0, 1
    v_lshl_add_u32 v200, v6, 4, v200
    s_lshl_b32 s29, s27, 13
    s_add_u32 s29, s29, 45547520
    s_add_u32 s30, s29, 4096
    s_mov_b32 s33, 400000
    s_cmp_eq_u32 s27, 0
    s_cbranch_scc1 H_x1_m_any
    s_sub_u32 s31, s29, 8192
    s_mov_b32 s33, 400000
H_x1_wm_any:
    buffer_load_dword v23, v3, s[8:11], s31 offen offset:0 sc1
    s_waitcnt vmcnt(0)
    v_cmp_eq_u32 vcc, -1, v23
    s_cbranch_vccz H_x1_wm_ok_any
    s_sleep 4
    s_sub_u32 s33, s33, 1
    s_cbranch_scc0 H_x1_wm_any
    s_branch L_fail
H_x1_wm_ok_any:
    s_mov_b32 s33, 400000
H_x1_m_any:
    buffer_load_dwordx4 v[144:147], v200, s[8:11], s29 offen offset:0 sc1
    buffer_load_dwordx4 v[148:151], v200, s[8:11], s29 offen offset:512 sc1
    buffer_load_dwordx4 v[152:155], v200, s[8:11], s29 offen offset:1024 sc1
    buffer_load_dwordx4 v[156:159], v200, s[8:11], s29 offen offset:1536 sc1
    buffer_load_dwordx4 v[160:163], v200, s[8:11], s29 offen offset:2048 sc1
    buffer_load_dwordx4 v[164:167], v200, s[8:11], s29 offen offset:2560 sc1
    buffer_load_dwordx4 v[168:171], v200, s[8:11], s29 offen offset:3072 sc1
    buffer_load_dwordx4 v[172:175], v200, s[8:11], s29 offen offset:3584 sc1
    buffer_load_dwordx4 v[176:179], v200, s[8:11], s30 offen offset:0 sc1
    buffer_load_dwordx4 v[180:183], v200, s[8:11], s30 offen offset:512 sc1
    buffer_load_dwordx4 v[184:187], v200, s[8:11], s30 offen offset:1024 sc1
    buffer_load_dwordx4 v[188:191], v200, s[8:11], s30 offen offset:1536 sc1
    buffer_load_dwordx4 v[192:195], v200, s[8:11], s30 offen offset:2048 sc1
    buffer_load_dwordx4 v[196:199], v200, s[8:11], s30 offen offset:2560 sc1
    s_waitcnt vmcnt(0)
    v_max3_u32 v6, v144, v145, v146
    v_max3_u32 v6, v6, v147, v148
    v_max3_u32 v6, v6, v149, v150
    v_max3_u32 v6, v6, v151, v152
    v_max3_u32 v6, v6, v153, v154
    v_max3_u32 v6, v6, v155, v156
    v_max3_u32 v6, v6, v157, v158
    v_max3_u32 v6, v6, v159, v160
    v_max3_u32 v6, v6, v161, v162
    v_max3_u32 v6, v6, v163, v164
    v_max3_u32 v6, v6, v165, v166
    v_max3_u32 v6, v6, v167, v168
    v_max3_u32 v6, v6, v169, v170
    v_max3_u32 v6, v6, v171, v172
    v_max3_u32 v6, v6, v173, v174
    v_max3_u32 v6, v6, v175, v176
    v_max3_u32 v6, v6, v177, v178
    v_max3_u32 v6, v6, v179, v180
    v_max3_u32 v6, v6, v181, v182
    v_max3_u32 v6, v6, v183, v184
    v_max3_u32 v6, v6, v185, v186
    v_max3_u32 v6, v6, v187, v188
    v_max3_u32 v6, v6, v189, v190
    v_max3_u32 v6, v6, v191, v192
    v_max3_u32 v6, v6, v193, v194
    v_max3_u32 v6, v6, v195, v196
    v_max3_u32 v6, v6, v197, v198
    v_max_u32 v6, v6, v199
    v_cmp_eq_u32 vcc, -1, v6
    s_cbranch_vccz H_x1_go_any
    s_sub_u32 s33, s33, 1
    s_cbranch_scc0 H_x1_m_any
    s_branch L_fail
H_x1_go_any:
    v_mfma_f32_16x16x32_bf16 v[88:91], v[144:147], a[168:171], 0
    v_mfma_f32_16x16x32_bf16 v[88:91], v[148:151], a[172:175], v[88:91]
    v_mfma_f32_16x16x32_bf16 v[88:91], v[152:155], a[176:179], v[88:91]
    v_mfma_f32_16x16x32_bf16 v[88:91], v[156:159], a[180:183], v[88:91]
    v_mfma_f32_16x16x32_bf16 v[88:91], v[160:163], a[184:187], v[88:91]
    v_mfma_f32_16x16x32_bf16 v[88:91], v[164:167], a[188:191], v[88:91]
    v_mfma_f32_16x16x32_bf16 v[88:91], v[168:171], a[192:195], v[88:91]
    v_mfma_f32_16x16x32_bf16 v[88:91], v[172:175], a[196:199], v[88:91]
    v_mfma_f32_16x16x32_bf16 v[88:91], v[176:179], a[200:203], v[88:91]
    v_mfma_f32_16x16x32_bf16 v[88:91], v[180:183], a[204:207], v[88:91]
    v_mfma_f32_16x16x32_bf16 v[88:91], v[184:187], a[208:211], v[88:91]
    v_mfma_f32_16x16x32_bf16 v[88:91], v[188:191], a[212:215], v[88:91]
    v_mfma_f32_16x16x32_bf16 v[88:91], v[192:195], a[216:219], v[88:91]
    v_mfma_f32_16x16x32_bf16 v[88:91], v[196:199], a[220:223], v[88:91]
    v_max3_f32 v92, v24, v25, v26
    v_max3_f32 v92, v92, v27, v28
    v_max3_f32 v92, v92, v29, v30
    v_max_f32 v92, v92, v31
    s_nop 3
    v_max3_f32 v92, v92, v88, v89
    v_mov_b32 v93, v92
    s_nop 1
    v_permlane16_swap_b32 v92, v93
    v_max_f32 v92, v92, v93
    v_mov_b32 v93, v92
    s_nop 1
    v_permlane32_swap_b32 v92, v93
    v_max_f32 v92, v92, v93
    v_sub_f32 v24, v24, v92
    v_sub_f32 v25, v25, v92
    v_sub_f32 v26, v26, v92
    v_sub_f32 v27, v27, v92
    v_sub_f32 v28, v28, v92
    v_sub_f32 v29, v29, v92
    v_sub_f32 v30, v30, v92
    v_sub_f32 v31, v31, v92
    v_sub_f32 v88, v88, v92
    v_sub_f32 v89, v89, v92
    v_exp_f32 v24, v24
    v_exp_f32 v25, v25
    v_exp_f32 v26, v26
    v_exp_f32 v27, v27
    v_exp_f32 v28, v28
    v_exp_f32 v29, v29
    v_exp_f32 v30, v30
    v_exp_f32 v31, v31
    v_exp_f32 v88, v88
    v_exp_f32 v89, v89
    v_add_f32 v92, v24, v25
    v_add_f32 v92, v92, v26
    v_add_f32 v92, v92, v27
    v_add_f32 v92, v92, v28
    v_add_f32 v92, v92, v29
    v_add_f32 v92, v92, v30
    v_add_f32 v92, v92, v31
    v_add_f32 v92, v92, v88
    v_add_f32 v92, v92, v89
    v_mov_b32 v93, v92
    s_nop 1
    v_permlane16_swap_b32 v92, v93
    v_add_f32 v92, v92, v93
    v_mov_b32 v93, v92
    s_nop 1
    v_permlane32_swap_b32 v92, v93
    v_add_f32 v92, v92, v93
    v_rcp_f32 v92, v92
    s_nop 0
    v_mul_f32 v24, v24, v92
    v_mul_f32 v25, v25, v92
    v_mul_f32 v26, v26, v92
    v_mul_f32 v27, v27, v92
    v_mul_f32 v28, v28, v92
    v_mul_f32 v29, v29, v92
    v_mul_f32 v30, v30, v92
    v_mul_f32 v31, v31, v92
    v_mul_f32 v88, v88, v92
    v_mul_f32 v89, v89, v92
    v_cvt_pk_bf16_f32 v24, v24, v25
    v_cvt_pk_bf16_f32 v25, v26, v27
    v_cvt_pk_bf16_f32 v26, v28, v29
    v_cvt_pk_bf16_f32 v27, v30, v31
    v_cvt_pk_bf16_f32 v88, v88, v89
    s_mul_i32 s29, s27, 40960
    s_mul_i32 s30, s20, 20480
    s_add_u32 s29, s29, s30
    s_add_u32 s29, s29, 85574656
    s_lshl_b32 s30, s22, 10
    s_add_u32 s30, s30, s29
    buffer_store_dwordx4 v[24:27], v2, s[8:11], s30 offen offset:0 sc1
    s_lshr_b32 s30, s22, 2
    s_lshl_b32 s30, s30, 10
    s_add_u32 s29, s29, s30
    s_and_b32 s30, s22, 3
    s_lshl_b32 s30, s30, 2
    s_add_u32 s29, s29, s30
    s_add_u32 s29, s29, 16384
    buffer_store_dword v88, v2, s[8:11], s29 offen offset:0 sc1
    s_waitcnt vmcnt(0)
H_x1_end_any:
    s_lshl_b32 s29, s22, 2
    s_add_u32 s29, s29, s24
    s_barrier
    s_cmp_lg_u32 s20, 0
    s_cbranch_scc1 H_f_45_any
    s_mov_b64 exec, 1
    buffer_store_dword v3, v3, s[8:11], s29 offen offset:0 sc1
    s_mov_b64 exec, -1
H_f_45_any:
    s_cmp_eq_u32 s27, 0
    s_cselect_b32 s25, 1, 7
    s_add_u32 s25, s25, s27
    s_cmp_ge_u32 s25, 64
    s_cbranch_scc1 H_fa_any
    s_cmp_ge_u32 s20, 2
    s_cbranch_scc1 H_fa_any
    v_bfe_u32 v200, v1, 5, 1
    v_lshlrev_b32 v200, 10, v200
    v_bfe_u32 v6, v1, 4, 1
    v_lshl_add_u32 v200, v6, 9, v200
    v_bfe_u32 v6, v1, 0, 4
    v_lshl_add_u32 v200, v6, 4, v200
    s_mul_i32 s29, s25, 458752
    s_mul_i32 s30, s22, 28672
    s_add_u32 s29, s29, s30
    s_lshl_b32 s30, s20, 8
    s_add_u32 s29, s29, s30
    s_add_u32 s29, s29, 56198144
    buffer_load_dwordx4 a[168:171], v200, s[8:11], s29 offen offset:0 sc1
    buffer_load_dwordx4 a[172:175], v200, s[8:11], s29 offen offset:2048 sc1
    s_add_u32 s29, s29, 4096
    buffer_load_dwordx4 a[176:179], v200, s[8:11], s29 offen offset:0 sc1
    buffer_load_dwordx4 a[180:183], v200, s[8:11], s29 offen offset:2048 sc1
    s_add_u32 s29, s29, 4096
    buffer_load_dwordx4 a[184:187], v200, s[8:11], s29 offen offset:0 sc1
    buffer_load_dwordx4 a[188:191], v200, s[8:11], s29 offen offset:2048 sc1
    s_add_u32 s29, s29, 4096
    buffer_load_dwordx4 a[192:195], v200, s[8:11], s29 offen offset:0 sc1
    buffer_load_dwordx4 a[196:199], v200, s[8:11], s29 offen offset:2048 sc1
    s_add_u32 s29, s29, 4096
    buffer_load_dwordx4 a[200:203], v200, s[8:11], s29 offen offset:0 sc1
    buffer_load_dwordx4 a[204:207], v200, s[8:11], s29 offen offset:2048 sc1
    s_add_u32 s29, s29, 4096
    buffer_load_dwordx4 a[208:211], v200, s[8:11], s29 offen offset:0 sc1
    buffer_load_dwordx4 a[212:215], v200, s[8:11], s29 offen offset:2048 sc1
    s_add_u32 s29, s29, 4096
    buffer_load_dwordx4 a[216:219], v200, s[8:11], s29 offen offset:0 sc1
    buffer_load_dwordx4 a[220:223], v200, s[8:11], s29 offen offset:2048 sc1
    s_add_u32 s29, s29, 4096
    v_bfe_u32 v200, v1, 3, 1
    v_lshlrev_b32 v200, 12, v200
    v_bfe_u32 v6, v1, 4, 1
    v_lshl_add_u32 v200, v6, 8, v200
    v_bfe_u32 v6, v1, 0, 3
    v_lshl_add_u32 v200, v6, 4, v200
    v_bfe_u32 v6, v1, 5, 1
    v_mul_u32_u24 v7, 5120, v6
    v_add_u32 v201, v200, v7
    v_lshl_add_u32 v200, v6, 9, v200
    s_lshl_b32 s29, s25, 15
    s_add_u32 s29, s29, 12845056
    buffer_load_dwordx4 v[32:35], v200, s[8:11], s29 offen offset:0
    buffer_load_dwordx4 v[36:39], v200, s[8:11], s29 offen offset:128
    buffer_load_dwordx4 v[40:43], v200, s[8:11], s29 offen offset:1024
    buffer_load_dwordx4 v[44:47], v200, s[8:11], s29 offen offset:1152
    buffer_load_dwordx4 v[48:51], v200, s[8:11], s29 offen offset:2048
    buffer_load_dwordx4 v[52:55], v200, s[8:11], s29 offen offset:2176
    buffer_load_dwordx4 v[56:59], v201, s[8:11], s29 offen offset:3072
    buffer_load_dwordx4 v[60:63], v201, s[8:11], s29 offen offset:3200
    s_lshl_b32 s29, s25, 15
    s_add_u32 s29, s29, 12853248
    buffer_load_dwordx4 v[64:67], v200, s[8:11], s29 offen offset:512
    buffer_load_dwordx4 v[68:71], v200, s[8:11], s29 offen offset:640
    buffer_load_dwordx4 v[72:75], v200, s[8:11], s29 offen offset:1536
    buffer_load_dwordx4 v[76:79], v200, s[8:11], s29 offen offset:1664
    buffer_load_dwordx4 v[80:83], v200, s[8:11], s29 offen offset:2560
    buffer_load_dwordx4 v[84:87], v200, s[8:11], s29 offen offset:2688
    s_lshl_b32 s29, s25, 15
    s_add_u32 s29, s29, 12861440
    buffer_load_dwordx4 v[88:91], v200, s[8:11], s29 offen offset:0
    buffer_load_dwordx4 v[92:95], v200, s[8:11], s29 offen offset:128
    buffer_load_dwordx4 v[96:99], v200, s[8:11], s29 offen offset:1024
    buffer_load_dwordx4 v[100:103], v200, s[8:11], s29 offen offset:1152
    buffer_load_dwordx4 v[104:107], v200, s[8:11], s29 offen offset:2048
    buffer_load_dwordx4 v[108:111], v200, s[8:11], s29 offen offset:2176
    buffer_load_dwordx4 v[112:115], v201, s[8:11], s29 offen offset:3072
    buffer_load_dwordx4 v[116:119], v201, s[8:11], s29 offen offset:3200
    s_lshl_b32 s29, s25, 15
    s_add_u32 s29, s29, 12869632
    buffer_load_dwordx4 v[120:123], v200, s[8:11], s29 offen offset:512
    buffer_load_dwordx4 v[124:127], v200, s[8:11], s29 offen offset:640
    buffer_load_dwordx4 v[128:131], v200, s[8:11], s29 offen offset:1536
    buffer_load_dwordx4 v[132:135], v200, s[8:11], s29 offen offset:1664
    buffer_load_dwordx4 v[136:139], v200, s[8:11], s29 offen offset:2560
    buffer_load_dwordx4 v[140:143], v200, s[8:11], s29 offen offset:2688
    s_waitcnt vmcnt(26)
    v_mfma_f32_16x16x32_bf16 v[24:27], v[32:35], a[168:171], 0
    v_mfma_f32_16x16x32_bf16 v[28:31], v[36:39], a[168:171], 0
    s_waitcnt vmcnt(24)
    v_mfma_f32_16x16x32_bf16 v[24:27], v[40:43], a[172:175], v[24:27]
    v_mfma_f32_16x16x32_bf16 v[28:31], v[44:47], a[172:175], v[28:31]
    s_waitcnt vmcnt(22)
    v_mfma_f32_16x16x32_bf16 v[24:27], v[48:51], a[176:179], v[24:27]
    v_mfma_f32_16x16x32_bf16 v[28:31], v[52:55], a[176:179], v[28:31]
    s_waitcnt vmcnt(20)
    v_mfma_f32_16x16x32_bf16 v[24:27], v[56:59], a[180:183], v[24:27]
    v_mfma_f32_16x16x32_bf16 v[28:31], v[60:63], a[180:183], v[28:31]
    s_waitcnt vmcnt(18)
    v_mfma_f32_16x16x32_bf16 v[24:27], v[64:67], a[184:187], v[24:27]
    v_mfma_f32_16x16x32_bf16 v[28:31], v[68:71], a[184:187], v[28:31]
    s_waitcnt vmcnt(16)
    v_mfma_f32_16x16x32_bf16 v[24:27], v[72:75], a[188:191], v[24:27]
    v_mfma_f32_16x16x32_bf16 v[28:31], v[76:79], a[188:191], v[28:31]
    s_waitcnt vmcnt(14)
    v_mfma_f32_16x16x32_bf16 v[24:27], v[80:83], a[192:195], v[24:27]
    v_mfma_f32_16x16x32_bf16 v[28:31], v[84:87], a[192:195], v[28:31]
    s_waitcnt vmcnt(12)
    v_mfma_f32_16x16x32_bf16 v[24:27], v[88:91], a[196:199], v[24:27]
    v_mfma_f32_16x16x32_bf16 v[28:31], v[92:95], a[196:199], v[28:31]
    s_waitcnt vmcnt(10)
    v_mfma_f32_16x16x32_bf16 v[24:27], v[96:99], a[200:203], v[24:27]
    v_mfma_f32_16x16x32_bf16 v[28:31], v[100:103], a[200:203], v[28:31]
    s_waitcnt vmcnt(8)
    v_mfma_f32_16x16x32_bf16 v[24:27], v[104:107], a[204:207], v[24:27]
    v_mfma_f32_16x16x32_bf16 v[28:31], v[108:111], a[204:207], v[28:31]
    s_waitcnt vmcnt(6)
    v_mfma_f32_16x16x32_bf16 v[24:27], v[112:115], a[208:211], v[24:27]
    v_mfma_f32_16x16x32_bf16 v[28:31], v[116:119], a[208:211], v[28:31]
    s_waitcnt vmcnt(4)
    v_mfma_f32_16x16x32_bf16 v[24:27], v[120:123], a[212:215], v[24:27]
    v_mfma_f32_16x16x32_bf16 v[28:31], v[124:127], a[212:215], v[28:31]
    s_waitcnt vmcnt(2)
    v_mfma_f32_16x16x32_bf16 v[24:27], v[128:131], a[216:219], v[24:27]
    v_mfma_f32_16x16x32_bf16 v[28:31], v[132:135], a[216:219], v[28:31]
    s_waitcnt vmcnt(0)
    v_mfma_f32_16x16x32_bf16 v[24:27], v[136:139], a[220:223], v[24:27]
    v_mfma_f32_16x16x32_bf16 v[28:31], v[140:143], a[220:223], v[28:31]
    v_bfe_u32 v200, v1, 5, 1
    v_lshlrev_b32 v200, 4, v200
    v_bfe_u32 v6, v1, 4, 1
    v_lshl_add_u32 v200, v6, 2, v200
    s_lshl_b32 s29, s20, 4
    v_add_u32 v6, s29, v9
    v_sub_u32 v200, v6, v200
    v_mov_b32 v7, 0xf149f2ca
    s_nop 3
    v_cmp_gt_i32 vcc, 0, v200
    s_nop 1
    v_cndmask_b32 v24, v24, v7, vcc
    v_cmp_gt_i32 vcc, 1, v200
    s_nop 1
    v_cndmask_b32 v25, v25, v7, vcc
    v_cmp_gt_i32 vcc, 2, v200
    s_nop 1
    v_cndmask_b32 v26, v26, v7, vcc
    v_cmp_gt_i32 vcc, 3, v200
    s_nop 1
    v_cndmask_b32 v27, v27, v7, vcc
    v_cmp_gt_i32 vcc, 8, v200
    s_nop 1
    v_cndmask_b32 v28, v28, v7, vcc
    v_cmp_gt_i32 vcc, 9, v200
    s_nop 1
    v_cndmask_b32 v29, v29, v7, vcc
    v_cmp_gt_i32 vcc, 10, v200
    s_nop 1
    v_cndmask_b32 v30, v30, v7, vcc
    v_cmp_gt_i32 vcc, 11, v200
    s_nop 1
    v_cndmask_b32 v31, v31, v7, vcc
    v_accvgpr_write_b32 a224, v24
    v_accvgpr_write_b32 a225, v25
    v_accvgpr_write_b32 a226, v26
    v_accvgpr_write_b32 a227, v27
    v_accvgpr_write_b32 a228, v28
    v_accvgpr_write_b32 a229, v29
    v_accvgpr_write_b32 a230, v30
    v_accvgpr_write_b32 a231, v31
    s_branch H_fa_any
H_x2_any:
    s_sub_u32 s34, s22, 16
    s_lshr_b32 s32, s20, 1
    s_and_b32 s31, s20, 1
    v_and_b32 v22, 1, v1
    v_lshlrev_b32 v22, 7, v22
    s_lshl_b32 s29, s34, 8
    v_add_u32 v22, s29, v22
    s_mul_i32 s29, s27, 458752
    s_lshl_b32 s30, s34, 15
    s_add_u32 s29, s29, s30
    s_lshl_b32 s30, s31, 13
    s_add_u32 s29, s29, s30
    s_add_u32 s29, s29, 14942208
    buffer_load_dwordx4 v[32:35], v2, s[8:11], s29 offen offset:0 sc1
    buffer_load_dwordx4 v[36:39], v2, s[8:11], s29 offen offset:1024 sc1
    buffer_load_dwordx4 v[40:43], v2, s[8:11], s29 offen offset:2048 sc1
    buffer_load_dwordx4 v[44:47], v2, s[8:11], s29 offen offset:3072 sc1
    s_add_u32 s29, s29, 4096
    buffer_load_dwordx4 v[48:51], v2, s[8:11], s29 offen offset:0 sc1
    buffer_load_dwordx4 v[52:55], v2, s[8:11], s29 offen offset:1024 sc1
    buffer_load_dwordx4 v[56:59], v2, s[8:11], s29 offen offset:2048 sc1
    buffer_load_dwordx4 v[60:63], v2, s[8:11], s29 offen offset:3072 sc1
    s_add_u32 s29, s29, 12288
    buffer_load_dwordx4 v[72:75], v2, s[8:11], s29 offen offset:0 sc1
    buffer_load_dwordx4 v[76:79], v2, s[8:11], s29 offen offset:1024 sc1
    buffer_load_dwordx4 v[80:83], v2, s[8:11], s29 offen offset:2048 sc1
    buffer_load_dwordx4 v[84:87], v2, s[8:11], s29 offen offset:3072 sc1
    s_add_u32 s29, s29, 4096
    buffer_load_dwordx4 v[88:91], v2, s[8:11], s29 offen offset:0 sc1
    buffer_load_dwordx4 v[92:95], v2, s[8:11], s29 offen offset:1024 sc1
    buffer_load_dwordx4 v[96:99], v2, s[8:11], s29 offen offset:2048 sc1
    buffer_load_dwordx4 v[100:103], v2, s[8:11], s29 offen offset:3072 sc1
    s_add_u32 s29, s29, 12288
    v_mul_u32_u24 v200, 896, v9
    v_lshl_add_u32 v200, v8, 3, v200
    s_lshl_b32 s30, s27, 1
    s_add_u32 s30, s30, s32
    s_mul_i32 s30, s30, 14336
    s_lshl_b32 s35, s34, 1
    s_add_u32 s35, s35, s31
    s_lshl_b32 s29, s35, 5
    s_add_u32 s30, s30, s29
    buffer_load_dwordx2 v[24:25], v200, s[36:39], s30 offen
    v_lshlrev_b32 v6, 4, v8
    s_lshl_b32 s29, s35, 6
    s_add_u32 s29, s29, 85561856
    buffer_load_dwordx4 v[28:31], v6, s[8:11], s29 offen
    s_cmp_eq_u32 s27, 63
    s_cselect_b32 s35, 6, 5
    v_and_b32 v22, 3, v1
    v_lshlrev_b32 v22, s35, v22
    s_lshl_b32 s35, s34, 8
    s_add_u32 s35, s35, 7168
    v_add_u32 v22, s35, v22
    s_mov_b32 s33, 400000
H_x2_wy_any:
    buffer_load_dword v23, v22, s[8:11], s28 offen offset:0 sc1
    s_waitcnt vmcnt(0)
    v_cmp_eq_u32 vcc, -1, v23
    s_cbranch_vccz H_x2_wy_ok_any
    s_sub_u32 s33, s33, 1
    s_cbranch_scc0 H_x2_wy_any
    s_branch L_fail
H_x2_wy_ok_any:
    s_mul_i32 s29, s27, 114688
    s_lshl_b32 s35, s34, 13
    s_add_u32 s29, s29, s35
    s_lshl_b32 s35, s31, 11
    s_add_u32 s29, s29, s35
    s_add_u32 s29, s29, 47023104
    s_add_u32 s35, s29, 4096
    buffer_load_dwordx4 v[64:67], v2, s[8:11], s29 offen offset:0 sc1
    buffer_load_dwordx4 v[68:71], v2, s[8:11], s29 offen offset:1024 sc1
    buffer_load_dwordx4 v[104:107], v2, s[8:11], s35 offen offset:0 sc1
    buffer_load_dwordx4 v[108:111], v2, s[8:11], s35 offen offset:1024 sc1
    v_lshlrev_b32 v22, 2, v9
    s_mul_i32 s29, s27, 40960
    s_mul_i32 s35, s32, 20480
    s_add_u32 s29, s29, s35
    s_add_u32 s29, s29, 85574656
    s_lshl_b32 s35, s31, 11
    s_add_u32 s35, s35, s29
    s_add_u32 s35, s35, 16384
    s_lshl_b32 s25, s31, 13
    s_add_u32 s29, s29, s25
    s_add_u32 s25, s29, 4096
    s_xor_b32 s26, s20, 1
    s_lshl_b32 s26, s26, 10
    v_add_u32 v201, s26, v2
    s_lshl_b32 s26, s20, 10
    s_mov_b32 s33, 400000
H_x2_wp_any:
    buffer_load_dword v23, v22, s[8:11], s24 offen offset:0 sc1
    s_waitcnt vmcnt(0)
    v_cmp_eq_u32 vcc, -1, v23
    s_cbranch_vccz H_x2_wp_ok_any
    s_sub_u32 s33, s33, 1
    s_cbranch_scc0 H_x2_wp_any
    s_branch L_fail
H_x2_wp_ok_any:
    buffer_load_dwordx4 v[112:115], v2, s[8:11], s29 offen offset:0 sc1
    buffer_load_dwordx4 v[116:119], v2, s[8:11], s29 offen offset:1024 sc1
    buffer_load_dwordx4 v[120:123], v2, s[8:11], s29 offen offset:2048 sc1
    buffer_load_dwordx4 v[124:127], v2, s[8:11], s29 offen offset:3072 sc1
    buffer_load_dwordx4 v[128:131], v2, s[8:11], s25 offen offset:0 sc1
    buffer_load_dwordx4 v[132:135], v2, s[8:11], s25 offen offset:1024 sc1
    buffer_load_dwordx4 v[136:139], v2, s[8:11], s25 offen offset:2048 sc1
    buffer_load_dwordx4 v[140:143], v2, s[8:11], s25 offen offset:3072 sc1
    buffer_load_dwordx4 v[144:147], v2, s[8:11], s35 offen offset:0 sc1
    buffer_load_dwordx4 v[148:151], v2, s[8:11], s35 offen offset:1024 sc1
    v_lshlrev_b32 v204, 16, v24
    v_and_b32 v205, 0xffff0000, v24
    v_lshlrev_b32 v206, 16, v25
    v_and_b32 v207, 0xffff0000, v25
    s_waitcnt vmcnt(9)
    v_mfma_f32_16x16x32_bf16 v[192:195], v[32:35], v[112:115], 0
    v_mfma_f32_16x16x32_bf16 v[196:199], v[72:75], v[112:115], 0
    s_waitcnt vmcnt(8)
    v_mfma_f32_16x16x32_bf16 v[192:195], v[36:39], v[116:119], v[192:195]
    v_mfma_f32_16x16x32_bf16 v[196:199], v[76:79], v[116:119], v[196:199]
    s_waitcnt vmcnt(7)
    v_mfma_f32_16x16x32_bf16 v[192:195], v[40:43], v[120:123], v[192:195]
    v_mfma_f32_16x16x32_bf16 v[196:199], v[80:83], v[120:123], v[196:199]
    s_waitcnt vmcnt(6)
    v_mfma_f32_16x16x32_bf16 v[192:195], v[44:47], v[124:127], v[192:195]
    v_mfma_f32_16x16x32_bf16 v[196:199], v[84:87], v[124:127], v[196:199]
    s_waitcnt vmcnt(5)
    v_mfma_f32_16x16x32_bf16 v[192:195], v[48:51], v[128:131], v[192:195]
    v_mfma_f32_16x16x32_bf16 v[196:199], v[88:91], v[128:131], v[196:199]
    s_waitcnt vmcnt(4)
    v_mfma_f32_16x16x32_bf16 v[192:195], v[52:55], v[132:135], v[192:195]
    v_mfma_f32_16x16x32_bf16 v[196:199], v[92:95], v[132:135], v[196:199]
    s_waitcnt vmcnt(3)
    v_mfma_f32_16x16x32_bf16 v[192:195], v[56:59], v[136:139], v[192:195]
    v_mfma_f32_16x16x32_bf16 v[196:199], v[96:99], v[136:139], v[196:199]
    s_waitcnt vmcnt(2)
    v_mfma_f32_16x16x32_bf16 v[192:195], v[60:63], v[140:143], v[192:195]
    v_mfma_f32_16x16x32_bf16 v[196:199], v[100:103], v[140:143], v[196:199]
    s_waitcnt vmcnt(1)
    v_mfma_f32_16x16x32_bf16 v[192:195], v[64:67], v[144:147], v[192:195]
    v_mfma_f32_16x16x32_bf16 v[196:199], v[104:107], v[144:147], v[196:199]
    s_waitcnt vmcnt(0)
    v_mfma_f32_16x16x32_bf16 v[192:195], v[68:71], v[148:151], v[192:195]
    v_mfma_f32_16x16x32_bf16 v[196:199], v[108:111], v[148:151], v[196:199]
    s_cmp_eq_u32 s31, 0
    s_cbranch_scc1 H_x2_k0_any
    s_nop 5
    ds_write_b128 v201, v[192:195] offset:45056
    v_mov_b32 v192, v196
    v_mov_b32 v193, v197
    v_mov_b32 v194, v198
    v_mov_b32 v195, v199
    s_branch H_x2_x_any
H_x2_k0_any:
    s_nop 5
    ds_write_b128 v201, v[196:199] offset:45056
H_x2_x_any:
    v_add_u32 v201, s26, v2
    s_waitcnt lgkmcnt(0)
    s_barrier
    ds_read_b128 v[196:199], v201 offset:45056
    s_add_u32 s30, s30, 88196096
    s_waitcnt lgkmcnt(0)
    v_add_f32 v192, v192, v196
    v_add_f32 v193, v193, v197
    v_add_f32 v194, v194, v198
    v_add_f32 v195, v195, v199
    v_fmac_f32 v204, v192, v28
    v_fmac_f32 v205, v193, v29
    v_fmac_f32 v206, v194, v30
    v_fmac_f32 v207, v195, v31
    v_cvt_pk_bf16_f32 v204, v204, v205
    v_cvt_pk_bf16_f32 v205, v206, v207
    buffer_store_dwordx2 v[204:205], v200, s[8:11], s30 offen offset:0 sc1
    s_lshl_b32 s29, s34, 2
    s_add_u32 s29, s29, s24
    s_waitcnt vmcnt(0)
    s_barrier
    s_cmp_lg_u32 s20, 0
    s_cbranch_scc1 H_f_46_any
    s_mov_b64 exec, 1
    buffer_store_dword v3, v3, s[8:11], s29 offen offset:128 sc1
    s_mov_b64 exec, -1
H_f_46_any:
    s_cmp_ge_u32 s22, 28
    s_cbranch_scc1 H_next_any
H_fa_any:
    v_lshrrev_b32 v24, 3, v0
    v_and_b32 v25, 7, v0
    v_lshlrev_b32 v28, 6, v25
    ds_read_b128 v[128:131], v28 offset:40960
    ds_read_b128 v[192:195], v28 offset:42752
    ds_read_b128 v[132:135], v28 offset:40976
    ds_read_b128 v[196:199], v28 offset:42768
    ds_read_b128 v[136:139], v28 offset:40992
    ds_read_b128 v[200:203], v28 offset:42784
    ds_read_b128 v[140:143], v28 offset:41008
    ds_read_b128 v[204:207], v28 offset:42800
    ds_read_b128 v[144:147], v28 offset:41472
    ds_read_b128 v[208:211], v28 offset:43264
    ds_read_b128 v[148:151], v28 offset:41488
    ds_read_b128 v[212:215], v28 offset:43280
    ds_read_b128 v[152:155], v28 offset:41504
    ds_read_b128 v[216:219], v28 offset:43296
    ds_read_b128 v[156:159], v28 offset:41520
    ds_read_b128 v[220:223], v28 offset:43312
    ds_read_b128 v[160:163], v28 offset:41984
    ds_read_b128 v[224:227], v28 offset:43776
    ds_read_b128 v[164:167], v28 offset:42000
    ds_read_b128 v[228:231], v28 offset:43792
    ds_read_b128 v[168:171], v28 offset:42016
    ds_read_b128 v[232:235], v28 offset:43808
    ds_read_b128 v[172:175], v28 offset:42032
    ds_read_b128 v[236:239], v28 offset:43824
    ds_read_b128 v[176:179], v28 offset:42496
    ds_read_b128 v[240:243], v28 offset:44288
    ds_read_b128 v[180:183], v28 offset:42512
    ds_read_b128 v[244:247], v28 offset:44304
    ds_read_b128 v[184:187], v28 offset:42528
    ds_read_b128 v[248:251], v28 offset:44320
    ds_read_b128 v[188:191], v28 offset:42544
    ds_read_b128 v[252:255], v28 offset:44336
    v_mul_u32_u24 v26, 896, v24
    v_lshl_add_u32 v26, v25, 5, v26
    v_add_u32 v27, 768, v26
    v_mov_b32 v6, 0x40000000
    v_cmp_gt_u32 vcc, 4, v25
    v_mov_b32 v30, 0
    v_mov_b32 v31, 1.0
    v_cndmask_b32 v27, v6, v27, vcc
    v_cndmask_b32 v29, v30, v31, vcc
    v_min_u32 v22, 13, v1
    v_lshlrev_b32 v22, 2, v22
    s_mov_b32 s33, 400000
H_fa_wx_any:
    buffer_load_dword v23, v22, s[8:11], s24 offen offset:128 sc1
    s_waitcnt vmcnt(0)
    v_cmp_eq_u32 vcc, -1, v23
    s_cbranch_vccz H_fa_wx_ok_any
    s_sub_u32 s33, s33, 1
    s_cbranch_scc0 H_fa_wx_any
    s_branch L_fail
H_fa_wx_ok_any:
    s_mul_i32 s29, s27, 28672
    s_add_u32 s29, s29, 88196096
    buffer_load_dwordx4 v[32:35], v26, s[8:11], s29 offen offset:0 sc1
    buffer_load_dwordx4 v[36:39], v26, s[8:11], s29 offen offset:16 sc1
    buffer_load_dwordx4 v[40:43], v26, s[8:11], s29 offen offset:256 sc1
    buffer_load_dwordx4 v[44:47], v26, s[8:11], s29 offen offset:272 sc1
    buffer_load_dwordx4 v[48:51], v26, s[8:11], s29 offen offset:512 sc1
    buffer_load_dwordx4 v[52:55], v26, s[8:11], s29 offen offset:528 sc1
    buffer_load_dwordx4 v[56:59], v27, s[8:11], s29 offen offset:0 sc1
    buffer_load_dwordx4 v[60:63], v27, s[8:11], s29 offen offset:16 sc1
    s_waitcnt vmcnt(7)
    v_lshlrev_b32 v64, 16, v32
    v_and_b32 v65, 0xffff0000, v32
    v_lshlrev_b32 v66, 16, v33
    v_and_b32 v67, 0xffff0000, v33
    v_pk_add_f32 v[30:31], v[64:65], v[66:67]
    v_lshlrev_b32 v68, 16, v34
    v_and_b32 v69, 0xffff0000, v34
    v_pk_add_f32 v[30:31], v[30:31], v[68:69]
    v_lshlrev_b32 v70, 16, v35
    v_and_b32 v71, 0xffff0000, v35
    v_pk_add_f32 v[30:31], v[30:31], v[70:71]
    s_waitcnt vmcnt(6)
    v_lshlrev_b32 v72, 16, v36
    v_and_b32 v73, 0xffff0000, v36
    v_pk_add_f32 v[30:31], v[30:31], v[72:73]
    v_lshlrev_b32 v74, 16, v37
    v_and_b32 v75, 0xffff0000, v37
    v_pk_add_f32 v[30:31], v[30:31], v[74:75]
    v_lshlrev_b32 v76, 16, v38
    v_and_b32 v77, 0xffff0000, v38
    v_pk_add_f32 v[30:31], v[30:31], v[76:77]
    v_lshlrev_b32 v78, 16, v39
    v_and_b32 v79, 0xffff0000, v39
    v_pk_add_f32 v[30:31], v[30:31], v[78:79]
    s_waitcnt vmcnt(5)
    v_lshlrev_b32 v80, 16, v40
    v_and_b32 v81, 0xffff0000, v40
    v_pk_add_f32 v[30:31], v[30:31], v[80:81]
    v_lshlrev_b32 v82, 16, v41
    v_and_b32 v83, 0xffff0000, v41
    v_pk_add_f32 v[30:31], v[30:31], v[82:83]
    v_lshlrev_b32 v84, 16, v42
    v_and_b32 v85, 0xffff0000, v42
    v_pk_add_f32 v[30:31], v[30:31], v[84:85]
    v_lshlrev_b32 v86, 16, v43
    v_and_b32 v87, 0xffff0000, v43
    v_pk_add_f32 v[30:31], v[30:31], v[86:87]
    s_waitcnt vmcnt(4)
    v_lshlrev_b32 v88, 16, v44
    v_and_b32 v89, 0xffff0000, v44
    v_pk_add_f32 v[30:31], v[30:31], v[88:89]
    v_lshlrev_b32 v90, 16, v45
    v_and_b32 v91, 0xffff0000, v45
    v_pk_add_f32 v[30:31], v[30:31], v[90:91]
    v_lshlrev_b32 v92, 16, v46
    v_and_b32 v93, 0xffff0000, v46
    v_pk_add_f32 v[30:31], v[30:31], v[92:93]
    v_lshlrev_b32 v94, 16, v47
    v_and_b32 v95, 0xffff0000, v47
    v_pk_add_f32 v[30:31], v[30:31], v[94:95]
    s_waitcnt vmcnt(3)
    v_lshlrev_b32 v96, 16, v48
    v_and_b32 v97, 0xffff0000, v48
    v_pk_add_f32 v[30:31], v[30:31], v[96:97]
    v_lshlrev_b32 v98, 16, v49
    v_and_b32 v99, 0xffff0000, v49
    v_pk_add_f32 v[30:31], v[30:31], v[98:99]
    v_lshlrev_b32 v100, 16, v50
    v_and_b32 v101, 0xffff0000, v50
    v_pk_add_f32 v[30:31], v[30:31], v[100:101]
    v_lshlrev_b32 v102, 16, v51
    v_and_b32 v103, 0xffff0000, v51
    v_pk_add_f32 v[30:31], v[30:31], v[102:103]
    s_waitcnt vmcnt(2)
    v_lshlrev_b32 v104, 16, v52
    v_and_b32 v105, 0xffff0000, v52
    v_pk_add_f32 v[30:31], v[30:31], v[104:105]
    v_lshlrev_b32 v106, 16, v53
    v_and_b32 v107, 0xffff0000, v53
    v_pk_add_f32 v[30:31], v[30:31], v[106:107]
    v_lshlrev_b32 v108, 16, v54
    v_and_b32 v109, 0xffff0000, v54
    v_pk_add_f32 v[30:31], v[30:31], v[108:109]
    v_lshlrev_b32 v110, 16, v55
    v_and_b32 v111, 0xffff0000, v55
    v_pk_add_f32 v[30:31], v[30:31], v[110:111]
    s_waitcnt vmcnt(1)
    v_lshlrev_b32 v112, 16, v56
    v_and_b32 v113, 0xffff0000, v56
    v_pk_add_f32 v[30:31], v[30:31], v[112:113]
    v_lshlrev_b32 v114, 16, v57
    v_and_b32 v115, 0xffff0000, v57
    v_pk_add_f32 v[30:31], v[30:31], v[114:115]
    v_lshlrev_b32 v116, 16, v58
    v_and_b32 v117, 0xffff0000, v58
    v_pk_add_f32 v[30:31], v[30:31], v[116:117]
    v_lshlrev_b32 v118, 16, v59
    v_and_b32 v119, 0xffff0000, v59
    v_pk_add_f32 v[30:31], v[30:31], v[118:119]
    s_waitcnt vmcnt(0)
    v_lshlrev_b32 v120, 16, v60
    v_and_b32 v121, 0xffff0000, v60
    v_pk_add_f32 v[30:31], v[30:31], v[120:121]
    v_lshlrev_b32 v122, 16, v61
    v_and_b32 v123, 0xffff0000, v61
    v_pk_add_f32 v[30:31], v[30:31], v[122:123]
    v_lshlrev_b32 v124, 16, v62
    v_and_b32 v125, 0xffff0000, v62
    v_pk_add_f32 v[30:31], v[30:31], v[124:125]
    v_lshlrev_b32 v126, 16, v63
    v_and_b32 v127, 0xffff0000, v63
    v_pk_add_f32 v[30:31], v[30:31], v[126:127]
    v_add_f32 v30, v30, v31
    s_nop 1
    v_add_f32_dpp v30, v30, v30 quad_perm:[1,0,3,2] row_mask:0xf bank_mask:0xf
    s_nop 1
    v_add_f32_dpp v30, v30, v30 quad_perm:[2,3,0,1] row_mask:0xf bank_mask:0xf
    s_nop 1
    v_add_f32_dpp v30, v30, v30 row_half_mirror row_mask:0xf bank_mask:0xf
    v_mul_f32 v30, 0xbb124925, v30
    v_mov_b64 v[32:33], 0
    v_mov_b64 v[34:35], 0
    v_pk_add_f32 v[64:65], v[64:65], v[30:31] op_sel_hi:[1,0]
    v_pk_add_f32 v[66:67], v[66:67], v[30:31] op_sel_hi:[1,0]
    v_pk_add_f32 v[68:69], v[68:69], v[30:31] op_sel_hi:[1,0]
    v_pk_add_f32 v[70:71], v[70:71], v[30:31] op_sel_hi:[1,0]
    v_pk_add_f32 v[72:73], v[72:73], v[30:31] op_sel_hi:[1,0]
    v_pk_add_f32 v[74:75], v[74:75], v[30:31] op_sel_hi:[1,0]
    v_pk_add_f32 v[76:77], v[76:77], v[30:31] op_sel_hi:[1,0]
    v_pk_add_f32 v[78:79], v[78:79], v[30:31] op_sel_hi:[1,0]
    v_pk_add_f32 v[80:81], v[80:81], v[30:31] op_sel_hi:[1,0]
    v_pk_add_f32 v[82:83], v[82:83], v[30:31] op_sel_hi:[1,0]
    v_pk_add_f32 v[84:85], v[84:85], v[30:31] op_sel_hi:[1,0]
    v_pk_add_f32 v[86:87], v[86:87], v[30:31] op_sel_hi:[1,0]
    v_pk_add_f32 v[88:89], v[88:89], v[30:31] op_sel_hi:[1,0]
    v_pk_add_f32 v[90:91], v[90:91], v[30:31] op_sel_hi:[1,0]
    v_pk_add_f32 v[92:93], v[92:93], v[30:31] op_sel_hi:[1,0]
    v_pk_add_f32 v[94:95], v[94:95], v[30:31] op_sel_hi:[1,0]
    v_pk_add_f32 v[96:97], v[96:97], v[30:31] op_sel_hi:[1,0]
    v_pk_add_f32 v[98:99], v[98:99], v[30:31] op_sel_hi:[1,0]
    v_pk_add_f32 v[100:101], v[100:101], v[30:31] op_sel_hi:[1,0]
    v_pk_add_f32 v[102:103], v[102:103], v[30:31] op_sel_hi:[1,0]
    v_pk_add_f32 v[104:105], v[104:105], v[30:31] op_sel_hi:[1,0]
    v_pk_add_f32 v[106:107], v[106:107], v[30:31] op_sel_hi:[1,0]
    v_pk_add_f32 v[108:109], v[108:109], v[30:31] op_sel_hi:[1,0]
    v_pk_add_f32 v[110:111], v[110:111], v[30:31] op_sel_hi:[1,0]
    v_pk_add_f32 v[112:113], v[112:113], v[30:31] op_sel_hi:[1,0]
    v_pk_add_f32 v[114:115], v[114:115], v[30:31] op_sel_hi:[1,0]
    v_pk_add_f32 v[116:117], v[116:117], v[30:31] op_sel_hi:[1,0]
    v_pk_add_f32 v[118:119], v[118:119], v[30:31] op_sel_hi:[1,0]
    v_pk_add_f32 v[120:121], v[120:121], v[30:31] op_sel_hi:[1,0]
    v_pk_add_f32 v[122:123], v[122:123], v[30:31] op_sel_hi:[1,0]
    v_pk_add_f32 v[124:125], v[124:125], v[30:31] op_sel_hi:[1,0]
    v_pk_add_f32 v[126:127], v[126:127], v[30:31] op_sel_hi:[1,0]
    v_pk_fma_f32 v[32:33], v[64:65], v[64:65], v[32:33]
    v_pk_fma_f32 v[32:33], v[66:67], v[66:67], v[32:33]
    v_pk_fma_f32 v[32:33], v[68:69], v[68:69], v[32:33]
    v_pk_fma_f32 v[32:33], v[70:71], v[70:71], v[32:33]
    v_pk_fma_f32 v[32:33], v[72:73], v[72:73], v[32:33]
    v_pk_fma_f32 v[32:33], v[74:75], v[74:75], v[32:33]
    v_pk_fma_f32 v[32:33], v[76:77], v[76:77], v[32:33]
    v_pk_fma_f32 v[32:33], v[78:79], v[78:79], v[32:33]
    v_pk_fma_f32 v[32:33], v[80:81], v[80:81], v[32:33]
    v_pk_fma_f32 v[32:33], v[82:83], v[82:83], v[32:33]
    v_pk_fma_f32 v[32:33], v[84:85], v[84:85], v[32:33]
    v_pk_fma_f32 v[32:33], v[86:87], v[86:87], v[32:33]
    v_pk_fma_f32 v[32:33], v[88:89], v[88:89], v[32:33]
    v_pk_fma_f32 v[32:33], v[90:91], v[90:91], v[32:33]
    v_pk_fma_f32 v[32:33], v[92:93], v[92:93], v[32:33]
    v_pk_fma_f32 v[32:33], v[94:95], v[94:95], v[32:33]
    v_pk_fma_f32 v[32:33], v[96:97], v[96:97], v[32:33]
    v_pk_fma_f32 v[32:33], v[98:99], v[98:99], v[32:33]
    v_pk_fma_f32 v[32:33], v[100:101], v[100:101], v[32:33]
    v_pk_fma_f32 v[32:33], v[102:103], v[102:103], v[32:33]
    v_pk_fma_f32 v[32:33], v[104:105], v[104:105], v[32:33]
    v_pk_fma_f32 v[32:33], v[106:107], v[106:107], v[32:33]
    v_pk_fma_f32 v[32:33], v[108:109], v[108:109], v[32:33]
    v_pk_fma_f32 v[32:33], v[110:111], v[110:111], v[32:33]
    v_pk_fma_f32 v[34:35], v[112:113], v[112:113], v[34:35]
    v_pk_fma_f32 v[34:35], v[114:115], v[114:115], v[34:35]
    v_pk_fma_f32 v[34:35], v[116:117], v[116:117], v[34:35]
    v_pk_fma_f32 v[34:35], v[118:119], v[118:119], v[34:35]
    v_pk_fma_f32 v[34:35], v[120:121], v[120:121], v[34:35]
    v_pk_fma_f32 v[34:35], v[122:123], v[122:123], v[34:35]
    v_pk_fma_f32 v[34:35], v[124:125], v[124:125], v[34:35]
    v_pk_fma_f32 v[34:35], v[126:127], v[126:127], v[34:35]
    v_add_f32 v30, v32, v33
    v_add_f32 v31, v34, v35
    v_fmac_f32 v30, v31, v29
    s_nop 1
    v_add_f32_dpp v30, v30, v30 quad_perm:[1,0,3,2] row_mask:0xf bank_mask:0xf
    s_nop 1
    v_add_f32_dpp v30, v30, v30 quad_perm:[2,3,0,1] row_mask:0xf bank_mask:0xf
    s_nop 1
    v_add_f32_dpp v30, v30, v30 row_half_mirror row_mask:0xf bank_mask:0xf
    v_mov_b32 v31, 0x3727c5ac
    v_fmac_f32 v31, 0x3b124925, v30
    v_rsq_f32 v30, v31
    s_waitcnt lgkmcnt(0)
    v_bfe_u32 v28, v24, 0, 4
    v_lshlrev_b32 v28, 4, v28
    v_bfe_u32 v6, v24, 4, 1
    v_mul_u32_u24 v6, 14336, v6
    v_add_u32 v28, v28, v6
    v_lshl_add_u32 v28, v25, 9, v28
    v_pk_mul_f32 v[64:65], v[64:65], v[30:31] op_sel_hi:[1,0]
    v_pk_fma_f32 v[64:65], v[64:65], v[192:193], v[128:129]
    v_pk_mul_f32 v[66:67], v[66:67], v[30:31] op_sel_hi:[1,0]
    v_pk_fma_f32 v[66:67], v[66:67], v[194:195], v[130:131]
    v_pk_mul_f32 v[68:69], v[68:69], v[30:31] op_sel_hi:[1,0]
    v_pk_fma_f32 v[68:69], v[68:69], v[196:197], v[132:133]
    v_pk_mul_f32 v[70:71], v[70:71], v[30:31] op_sel_hi:[1,0]
    v_pk_fma_f32 v[70:71], v[70:71], v[198:199], v[134:135]
    v_pk_mul_f32 v[72:73], v[72:73], v[30:31] op_sel_hi:[1,0]
    v_pk_fma_f32 v[72:73], v[72:73], v[200:201], v[136:137]
    v_pk_mul_f32 v[74:75], v[74:75], v[30:31] op_sel_hi:[1,0]
    v_pk_fma_f32 v[74:75], v[74:75], v[202:203], v[138:139]
    v_pk_mul_f32 v[76:77], v[76:77], v[30:31] op_sel_hi:[1,0]
    v_pk_fma_f32 v[76:77], v[76:77], v[204:205], v[140:141]
    v_pk_mul_f32 v[78:79], v[78:79], v[30:31] op_sel_hi:[1,0]
    v_pk_fma_f32 v[78:79], v[78:79], v[206:207], v[142:143]
    v_cvt_pk_bf16_f32 v32, v64, v65
    v_cvt_pk_bf16_f32 v33, v66, v67
    v_cvt_pk_bf16_f32 v34, v68, v69
    v_cvt_pk_bf16_f32 v35, v70, v71
    v_cvt_pk_bf16_f32 v36, v72, v73
    v_cvt_pk_bf16_f32 v37, v74, v75
    v_cvt_pk_bf16_f32 v38, v76, v77
    v_cvt_pk_bf16_f32 v39, v78, v79
    ds_write_b128 v28, v[32:35] offset:0
    ds_write_b128 v28, v[36:39] offset:256
    v_pk_mul_f32 v[80:81], v[80:81], v[30:31] op_sel_hi:[1,0]
    v_pk_fma_f32 v[80:81], v[80:81], v[208:209], v[144:145]
    v_pk_mul_f32 v[82:83], v[82:83], v[30:31] op_sel_hi:[1,0]
    v_pk_fma_f32 v[82:83], v[82:83], v[210:211], v[146:147]
    v_pk_mul_f32 v[84:85], v[84:85], v[30:31] op_sel_hi:[1,0]
    v_pk_fma_f32 v[84:85], v[84:85], v[212:213], v[148:149]
    v_pk_mul_f32 v[86:87], v[86:87], v[30:31] op_sel_hi:[1,0]
    v_pk_fma_f32 v[86:87], v[86:87], v[214:215], v[150:151]
    v_pk_mul_f32 v[88:89], v[88:89], v[30:31] op_sel_hi:[1,0]
    v_pk_fma_f32 v[88:89], v[88:89], v[216:217], v[152:153]
    v_pk_mul_f32 v[90:91], v[90:91], v[30:31] op_sel_hi:[1,0]
    v_pk_fma_f32 v[90:91], v[90:91], v[218:219], v[154:155]
    v_pk_mul_f32 v[92:93], v[92:93], v[30:31] op_sel_hi:[1,0]
    v_pk_fma_f32 v[92:93], v[92:93], v[220:221], v[156:157]
    v_pk_mul_f32 v[94:95], v[94:95], v[30:31] op_sel_hi:[1,0]
    v_pk_fma_f32 v[94:95], v[94:95], v[222:223], v[158:159]
    v_cvt_pk_bf16_f32 v40, v80, v81
    v_cvt_pk_bf16_f32 v41, v82, v83
    v_cvt_pk_bf16_f32 v42, v84, v85
    v_cvt_pk_bf16_f32 v43, v86, v87
    v_cvt_pk_bf16_f32 v44, v88, v89
    v_cvt_pk_bf16_f32 v45, v90, v91
    v_cvt_pk_bf16_f32 v46, v92, v93
    v_cvt_pk_bf16_f32 v47, v94, v95
    ds_write_b128 v28, v[40:43] offset:4096
    ds_write_b128 v28, v[44:47] offset:4352
    v_pk_mul_f32 v[96:97], v[96:97], v[30:31] op_sel_hi:[1,0]
    v_pk_fma_f32 v[96:97], v[96:97], v[224:225], v[160:161]
    v_pk_mul_f32 v[98:99], v[98:99], v[30:31] op_sel_hi:[1,0]
    v_pk_fma_f32 v[98:99], v[98:99], v[226:227], v[162:163]
    v_pk_mul_f32 v[100:101], v[100:101], v[30:31] op_sel_hi:[1,0]
    v_pk_fma_f32 v[100:101], v[100:101], v[228:229], v[164:165]
    v_pk_mul_f32 v[102:103], v[102:103], v[30:31] op_sel_hi:[1,0]
    v_pk_fma_f32 v[102:103], v[102:103], v[230:231], v[166:167]
    v_pk_mul_f32 v[104:105], v[104:105], v[30:31] op_sel_hi:[1,0]
    v_pk_fma_f32 v[104:105], v[104:105], v[232:233], v[168:169]
    v_pk_mul_f32 v[106:107], v[106:107], v[30:31] op_sel_hi:[1,0]
    v_pk_fma_f32 v[106:107], v[106:107], v[234:235], v[170:171]
    v_pk_mul_f32 v[108:109], v[108:109], v[30:31] op_sel_hi:[1,0]
    v_pk_fma_f32 v[108:109], v[108:109], v[236:237], v[172:173]
    v_pk_mul_f32 v[110:111], v[110:111], v[30:31] op_sel_hi:[1,0]
    v_pk_fma_f32 v[110:111], v[110:111], v[238:239], v[174:175]
    v_cvt_pk_bf16_f32 v48, v96, v97
    v_cvt_pk_bf16_f32 v49, v98, v99
    v_cvt_pk_bf16_f32 v50, v100, v101
    v_cvt_pk_bf16_f32 v51, v102, v103
    v_cvt_pk_bf16_f32 v52, v104, v105
    v_cvt_pk_bf16_f32 v53, v106, v107
    v_cvt_pk_bf16_f32 v54, v108, v109
    v_cvt_pk_bf16_f32 v55, v110, v111
    ds_write_b128 v28, v[48:51] offset:8192
    ds_write_b128 v28, v[52:55] offset:8448
    v_pk_mul_f32 v[112:113], v[112:113], v[30:31] op_sel_hi:[1,0]
    v_pk_fma_f32 v[112:113], v[112:113], v[240:241], v[176:177]
    v_pk_mul_f32 v[114:115], v[114:115], v[30:31] op_sel_hi:[1,0]
    v_pk_fma_f32 v[114:115], v[114:115], v[242:243], v[178:179]
    v_pk_mul_f32 v[116:117], v[116:117], v[30:31] op_sel_hi:[1,0]
    v_pk_fma_f32 v[116:117], v[116:117], v[244:245], v[180:181]
    v_pk_mul_f32 v[118:119], v[118:119], v[30:31] op_sel_hi:[1,0]
    v_pk_fma_f32 v[118:119], v[118:119], v[246:247], v[182:183]
    v_pk_mul_f32 v[120:121], v[120:121], v[30:31] op_sel_hi:[1,0]
    v_pk_fma_f32 v[120:121], v[120:121], v[248:249], v[184:185]
    v_pk_mul_f32 v[122:123], v[122:123], v[30:31] op_sel_hi:[1,0]
    v_pk_fma_f32 v[122:123], v[122:123], v[250:251], v[186:187]
    v_pk_mul_f32 v[124:125], v[124:125], v[30:31] op_sel_hi:[1,0]
    v_pk_fma_f32 v[124:125], v[124:125], v[252:253], v[188:189]
    v_pk_mul_f32 v[126:127], v[126:127], v[30:31] op_sel_hi:[1,0]
    v_pk_fma_f32 v[126:127], v[126:127], v[254:255], v[190:191]
    v_cvt_pk_bf16_f32 v56, v112, v113
    v_cvt_pk_bf16_f32 v57, v114, v115
    v_cvt_pk_bf16_f32 v58, v116, v117
    v_cvt_pk_bf16_f32 v59, v118, v119
    v_cvt_pk_bf16_f32 v60, v120, v121
    v_cvt_pk_bf16_f32 v61, v122, v123
    v_cvt_pk_bf16_f32 v62, v124, v125
    v_cvt_pk_bf16_f32 v63, v126, v127
    v_cmp_gt_u32 vcc, 4, v25
    s_and_saveexec_b64 s[68:69], vcc
    ds_write_b128 v28, v[56:59] offset:12288
    ds_write_b128 v28, v[60:63] offset:12544
    s_mov_b64 exec, s[68:69]
    s_lshr_b32 s32, s20, 1
    s_mul_i32 s29, s32, 14336
    v_add_u32 v28, s29, v2
    s_waitcnt lgkmcnt(0)
    s_barrier
    ds_read_b128 v[64:67], v28 offset:0
    ds_read_b128 v[68:71], v28 offset:1024
    ds_read_b128 v[72:75], v28 offset:2048
    ds_read_b128 v[76:79], v28 offset:3072
    ds_read_b128 v[80:83], v28 offset:4096
    ds_read_b128 v[84:87], v28 offset:5120
    ds_read_b128 v[88:91], v28 offset:6144
    ds_read_b128 v[92:95], v28 offset:7168
    ds_read_b128 v[96:99], v28 offset:8192
    ds_read_b128 v[100:103], v28 offset:9216
    ds_read_b128 v[104:107], v28 offset:10240
    ds_read_b128 v[108:111], v28 offset:11264
    ds_read_b128 v[112:115], v28 offset:12288
    ds_read_b128 v[116:119], v28 offset:13312
    s_waitcnt lgkmcnt(13)
    v_mfma_f32_16x16x32_bf16 v[32:35], a[0:3], v[64:67], 0
    v_mfma_f32_16x16x32_bf16 v[36:39], a[56:59], v[64:67], 0
    s_waitcnt lgkmcnt(12)
    v_mfma_f32_16x16x32_bf16 v[32:35], a[4:7], v[68:71], v[32:35]
    v_mfma_f32_16x16x32_bf16 v[36:39], a[60:63], v[68:71], v[36:39]
    s_waitcnt lgkmcnt(11)
    v_mfma_f32_16x16x32_bf16 v[32:35], a[8:11], v[72:75], v[32:35]
    v_mfma_f32_16x16x32_bf16 v[36:39], a[64:67], v[72:75], v[36:39]
    s_waitcnt lgkmcnt(10)
    v_mfma_f32_16x16x32_bf16 v[32:35], a[12:15], v[76:79], v[32:35]
    v_mfma_f32_16x16x32_bf16 v[36:39], a[68:71], v[76:79], v[36:39]
    s_waitcnt lgkmcnt(9)
    v_mfma_f32_16x16x32_bf16 v[32:35], a[16:19], v[80:83], v[32:35]
    v_mfma_f32_16x16x32_bf16 v[36:39], a[72:75], v[80:83], v[36:39]
    s_waitcnt lgkmcnt(8)
    v_mfma_f32_16x16x32_bf16 v[32:35], a[20:23], v[84:87], v[32:35]
    v_mfma_f32_16x16x32_bf16 v[36:39], a[76:79], v[84:87], v[36:39]
    s_waitcnt lgkmcnt(7)
    v_mfma_f32_16x16x32_bf16 v[32:35], a[24:27], v[88:91], v[32:35]
    v_mfma_f32_16x16x32_bf16 v[36:39], a[80:83], v[88:91], v[36:39]
    s_waitcnt lgkmcnt(6)
    v_mfma_f32_16x16x32_bf16 v[32:35], a[28:31], v[92:95], v[32:35]
    v_mfma_f32_16x16x32_bf16 v[36:39], a[84:87], v[92:95], v[36:39]
    s_waitcnt lgkmcnt(5)
    v_mfma_f32_16x16x32_bf16 v[32:35], a[32:35], v[96:99], v[32:35]
    v_mfma_f32_16x16x32_bf16 v[36:39], a[88:91], v[96:99], v[36:39]
    s_waitcnt lgkmcnt(4)
    v_mfma_f32_16x16x32_bf16 v[32:35], a[36:39], v[100:103], v[32:35]
    v_mfma_f32_16x16x32_bf16 v[36:39], a[92:95], v[100:103], v[36:39]
    s_waitcnt lgkmcnt(3)
    v_mfma_f32_16x16x32_bf16 v[32:35], a[40:43], v[104:107], v[32:35]
    v_mfma_f32_16x16x32_bf16 v[36:39], a[96:99], v[104:107], v[36:39]
    s_waitcnt lgkmcnt(2)
    v_mfma_f32_16x16x32_bf16 v[32:35], a[44:47], v[108:111], v[32:35]
    v_mfma_f32_16x16x32_bf16 v[36:39], a[100:103], v[108:111], v[36:39]
    s_waitcnt lgkmcnt(1)
    v_mfma_f32_16x16x32_bf16 v[32:35], a[48:51], v[112:115], v[32:35]
    v_mfma_f32_16x16x32_bf16 v[36:39], a[104:107], v[112:115], v[36:39]
    s_waitcnt lgkmcnt(0)
    v_mfma_f32_16x16x32_bf16 v[32:35], a[52:55], v[116:119], v[32:35]
    v_mfma_f32_16x16x32_bf16 v[36:39], a[108:111], v[116:119], v[36:39]
    s_nop 7
    v_add_f32 v32, v32, v10
    v_add_f32 v33, v33, v11
    v_add_f32 v34, v34, v12
    v_add_f32 v35, v35, v13
    v_add_f32 v36, v36, v14
    v_add_f32 v37, v37, v15
    v_add_f32 v38, v38, v16
    v_add_f32 v39, v39, v17
    v_min_f32 v40, 0x42200000, v32
    v_mul_f32 v40, 0x3fb8aa3b, v40
    v_min_f32 v41, 0x42200000, v33
    v_mul_f32 v41, 0x3fb8aa3b, v41
    v_min_f32 v42, 0x42200000, v34
    v_mul_f32 v42, 0x3fb8aa3b, v42
    v_min_f32 v43, 0x42200000, v35
    v_mul_f32 v43, 0x3fb8aa3b, v43
    v_min_f32 v44, 0x42200000, v36
    v_mul_f32 v44, 0x3fb8aa3b, v44
    v_min_f32 v45, 0x42200000, v37
    v_mul_f32 v45, 0x3fb8aa3b, v45
    v_min_f32 v46, 0x42200000, v38
    v_mul_f32 v46, 0x3fb8aa3b, v46
    v_min_f32 v47, 0x42200000, v39
    v_mul_f32 v47, 0x3fb8aa3b, v47
    v_exp_f32 v40, v40
    v_exp_f32 v41, v41
    v_exp_f32 v42, v42
    v_exp_f32 v43, v43
    v_exp_f32 v44, v44
    v_exp_f32 v45, v45
    v_exp_f32 v46, v46
    v_exp_f32 v47, v47
    v_add_f32 v48, 2.0, v40
    v_mul_f32 v40, v40, v48
    v_add_f32 v48, 2.0, v40
    v_add_f32 v49, 2.0, v41
    v_mul_f32 v41, v41, v49
    v_add_f32 v49, 2.0, v41
    v_add_f32 v50, 2.0, v42
    v_mul_f32 v42, v42, v50
    v_add_f32 v50, 2.0, v42
    v_add_f32 v51, 2.0, v43
    v_mul_f32 v43, v43, v51
    v_add_f32 v51, 2.0, v43
    v_add_f32 v52, 2.0, v44
    v_mul_f32 v44, v44, v52
    v_add_f32 v52, 2.0, v44
    v_add_f32 v53, 2.0, v45
    v_mul_f32 v45, v45, v53
    v_add_f32 v53, 2.0, v45
    v_add_f32 v54, 2.0, v46
    v_mul_f32 v46, v46, v54
    v_add_f32 v54, 2.0, v46
    v_add_f32 v55, 2.0, v47
    v_mul_f32 v47, v47, v55
    v_add_f32 v55, 2.0, v47
    v_rcp_f32 v48, v48
    v_rcp_f32 v49, v49
    v_rcp_f32 v50, v50
    v_rcp_f32 v51, v51
    v_rcp_f32 v52, v52
    v_rcp_f32 v53, v53
    v_rcp_f32 v54, v54
    v_rcp_f32 v55, v55
    v_mul_f32 v32, v32, v40
    v_mul_f32 v33, v33, v41
    v_mul_f32 v34, v34, v42
    v_mul_f32 v35, v35, v43
    v_mul_f32 v36, v36, v44
    v_mul_f32 v37, v37, v45
    v_mul_f32 v38, v38, v46
    v_mul_f32 v39, v39, v47
    v_mul_f32 v32, v32, v48
    v_mul_f32 v33, v33, v49
    v_mul_f32 v34, v34, v50
    v_mul_f32 v35, v35, v51
    v_mul_f32 v36, v36, v52
    v_mul_f32 v37, v37, v53
    v_mul_f32 v38, v38, v54
    v_mul_f32 v39, v39, v55
    v_cvt_pk_bf16_f32 v32, v32, v33
    v_cvt_pk_bf16_f32 v33, v34, v35
    v_cvt_pk_bf16_f32 v34, v36, v37
    v_cvt_pk_bf16_f32 v35, v38, v39
    s_and_b32 s29, s20, 1
    s_lshl_b32 s30, s22, 1
    s_add_u32 s29, s29, s30
    s_lshl_b32 s29, s29, 1
    s_add_u32 s29, s29, s32
    s_lshl_b32 s29, s29, 10
    s_mul_i32 s31, s27, 114688
    s_add_u32 s31, s31, 90031104
    s_add_u32 s29, s29, s31
    buffer_store_dwordx4 v[32:35], v2, s[8:11], s29 offen offset:0 sc1
    s_waitcnt vmcnt(0)
    s_lshl_b32 s29, s22, 2
    s_add_u32 s29, s29, s24
    s_barrier
    s_cmp_lg_u32 s20, 0
    s_cbranch_scc1 H_f_47_any
    s_mov_b64 exec, 1
    buffer_store_dword v3, v3, s[8:11], s29 offen offset:256 sc1
    s_mov_b64 exec, -1
H_f_47_any:
    v_mul_u32_u24 v26, 896, v9
    v_lshl_add_u32 v26, v8, 3, v26
    s_lshl_b32 s30, s27, 1
    s_and_b32 s29, s20, 1
    s_add_u32 s30, s30, s29
    s_mul_i32 s30, s30, 14336
    s_lshl_b32 s29, s22, 5
    s_add_u32 s30, s30, s29
    s_add_u32 s29, s30, 88196096
    buffer_load_dwordx2 v[40:41], v26, s[8:11], s29 offen sc1
    v_min_u32 v22, 27, v1
    v_lshlrev_b32 v22, 2, v22
    s_mov_b32 s33, 400000
H_fb_wa_any:
    buffer_load_dword v23, v22, s[8:11], s24 offen offset:256 sc1
    s_waitcnt vmcnt(0)
    v_cmp_eq_u32 vcc, -1, v23
    s_cbranch_vccz H_fb_wa_ok_any
    s_sub_u32 s33, s33, 1
    s_cbranch_scc0 H_fb_wa_any
    s_branch L_fail
H_fb_wa_ok_any:
    s_mul_i32 s29, s20, 28672
    s_add_u32 s31, s31, s29
    buffer_load_dwordx4 v[64:67], v2, s[8:11], s31 offen offset:0 sc1
    buffer_load_dwordx4 v[68:71], v2, s[8:11], s31 offen offset:1024 sc1
    buffer_load_dwordx4 v[72:75], v2, s[8:11], s31 offen offset:2048 sc1
    buffer_load_dwordx4 v[76:79], v2, s[8:11], s31 offen offset:3072 sc1
    s_add_u32 s31, s31, 4096
    buffer_load_dwordx4 v[80:83], v2, s[8:11], s31 offen offset:0 sc1
    buffer_load_dwordx4 v[84:87], v2, s[8:11], s31 offen offset:1024 sc1
    buffer_load_dwordx4 v[88:91], v2, s[8:11], s31 offen offset:2048 sc1
    buffer_load_dwordx4 v[92:95], v2, s[8:11], s31 offen offset:3072 sc1
    s_add_u32 s31, s31, 4096
    buffer_load_dwordx4 v[96:99], v2, s[8:11], s31 offen offset:0 sc1
    buffer_load_dwordx4 v[100:103], v2, s[8:11], s31 offen offset:1024 sc1
    buffer_load_dwordx4 v[104:107], v2, s[8:11], s31 offen offset:2048 sc1
    buffer_load_dwordx4 v[108:111], v2, s[8:11], s31 offen offset:3072 sc1
    s_add_u32 s31, s31, 4096
    buffer_load_dwordx4 v[112:115], v2, s[8:11], s31 offen offset:0 sc1
    buffer_load_dwordx4 v[116:119], v2, s[8:11], s31 offen offset:1024 sc1
    buffer_load_dwordx4 v[120:123], v2, s[8:11], s31 offen offset:2048 sc1
    buffer_load_dwordx4 v[124:127], v2, s[8:11], s31 offen offset:3072 sc1
    s_add_u32 s31, s31, 4096
    buffer_load_dwordx4 v[128:131], v2, s[8:11], s31 offen offset:0 sc1
    buffer_load_dwordx4 v[132:135], v2, s[8:11], s31 offen offset:1024 sc1
    buffer_load_dwordx4 v[136:139], v2, s[8:11], s31 offen offset:2048 sc1
    buffer_load_dwordx4 v[140:143], v2, s[8:11], s31 offen offset:3072 sc1
    s_add_u32 s31, s31, 4096
    buffer_load_dwordx4 v[144:147], v2, s[8:11], s31 offen offset:0 sc1
    buffer_load_dwordx4 v[148:151], v2, s[8:11], s31 offen offset:1024 sc1
    buffer_load_dwordx4 v[152:155], v2, s[8:11], s31 offen offset:2048 sc1
    buffer_load_dwordx4 v[156:159], v2, s[8:11], s31 offen offset:3072 sc1
    s_add_u32 s31, s31, 4096
    buffer_load_dwordx4 v[160:163], v2, s[8:11], s31 offen offset:0 sc1
    buffer_load_dwordx4 v[164:167], v2, s[8:11], s31 offen offset:1024 sc1
    buffer_load_dwordx4 v[168:171], v2, s[8:11], s31 offen offset:2048 sc1
    buffer_load_dwordx4 v[172:175], v2, s[8:11], s31 offen offset:3072 sc1
    s_add_u32 s31, s31, 4096
    s_waitcnt vmcnt(27)
    v_mfma_f32_16x16x32_bf16 v[32:35], a[112:115], v[64:67], 0
    s_waitcnt vmcnt(26)
    v_mfma_f32_16x16x32_bf16 v[36:39], a[112:115], v[68:71], 0
    s_waitcnt vmcnt(25)
    v_mfma_f32_16x16x32_bf16 v[32:35], a[116:119], v[72:75], v[32:35]
    s_waitcnt vmcnt(24)
    v_mfma_f32_16x16x32_bf16 v[36:39], a[116:119], v[76:79], v[36:39]
    s_waitcnt vmcnt(23)
    v_mfma_f32_16x16x32_bf16 v[32:35], a[120:123], v[80:83], v[32:35]
    s_waitcnt vmcnt(22)
    v_mfma_f32_16x16x32_bf16 v[36:39], a[120:123], v[84:87], v[36:39]
    s_waitcnt vmcnt(21)
    v_mfma_f32_16x16x32_bf16 v[32:35], a[124:127], v[88:91], v[32:35]
    s_waitcnt vmcnt(20)
    v_mfma_f32_16x16x32_bf16 v[36:39], a[124:127], v[92:95], v[36:39]
    s_waitcnt vmcnt(19)
    v_mfma_f32_16x16x32_bf16 v[32:35], a[128:131], v[96:99], v[32:35]
    s_waitcnt vmcnt(18)
    v_mfma_f32_16x16x32_bf16 v[36:39], a[128:131], v[100:103], v[36:39]
    s_waitcnt vmcnt(17)
    v_mfma_f32_16x16x32_bf16 v[32:35], a[132:135], v[104:107], v[32:35]
    s_waitcnt vmcnt(16)
    v_mfma_f32_16x16x32_bf16 v[36:39], a[132:135], v[108:111], v[36:39]
    s_waitcnt vmcnt(15)
    v_mfma_f32_16x16x32_bf16 v[32:35], a[136:139], v[112:115], v[32:35]
    s_waitcnt vmcnt(14)
    v_mfma_f32_16x16x32_bf16 v[36:39], a[136:139], v[116:119], v[36:39]
    s_waitcnt vmcnt(13)
    v_mfma_f32_16x16x32_bf16 v[32:35], a[140:143], v[120:123], v[32:35]
    s_waitcnt vmcnt(12)
    v_mfma_f32_16x16x32_bf16 v[36:39], a[140:143], v[124:127], v[36:39]
    s_waitcnt vmcnt(11)
    v_mfma_f32_16x16x32_bf16 v[32:35], a[144:147], v[128:131], v[32:35]
    s_waitcnt vmcnt(10)
    v_mfma_f32_16x16x32_bf16 v[36:39], a[144:147], v[132:135], v[36:39]
    s_waitcnt vmcnt(9)
    v_mfma_f32_16x16x32_bf16 v[32:35], a[148:151], v[136:139], v[32:35]
    s_waitcnt vmcnt(8)
    v_mfma_f32_16x16x32_bf16 v[36:39], a[148:151], v[140:143], v[36:39]
    s_waitcnt vmcnt(7)
    v_mfma_f32_16x16x32_bf16 v[32:35], a[152:155], v[144:147], v[32:35]
    s_waitcnt vmcnt(6)
    v_mfma_f32_16x16x32_bf16 v[36:39], a[152:155], v[148:151], v[36:39]
    s_waitcnt vmcnt(5)
    v_mfma_f32_16x16x32_bf16 v[32:35], a[156:159], v[152:155], v[32:35]
    s_waitcnt vmcnt(4)
    v_mfma_f32_16x16x32_bf16 v[36:39], a[156:159], v[156:159], v[36:39]
    s_waitcnt vmcnt(3)
    v_mfma_f32_16x16x32_bf16 v[32:35], a[160:163], v[160:163], v[32:35]
    s_waitcnt vmcnt(2)
    v_mfma_f32_16x16x32_bf16 v[36:39], a[160:163], v[164:167], v[36:39]
    s_waitcnt vmcnt(1)
    v_mfma_f32_16x16x32_bf16 v[32:35], a[164:167], v[168:171], v[32:35]
    s_waitcnt vmcnt(0)
    v_mfma_f32_16x16x32_bf16 v[36:39], a[164:167], v[172:175], v[36:39]
    s_lshl_b32 s29, s20, 11
    v_add_u32 v27, s29, v2
    s_nop 5
    ds_write_b128 v27, v[32:35] offset:32768
    ds_write_b128 v27, v[36:39] offset:33792
    s_waitcnt lgkmcnt(0)
    s_barrier
    s_cmp_ge_u32 s20, 2
    s_cbranch_scc1 H_next_any
    s_lshl_b32 s29, s20, 10
    v_add_u32 v27, s29, v2
    ds_read_b128 v[48:51], v27 offset:32768
    ds_read_b128 v[52:55], v27 offset:34816
    ds_read_b128 v[56:59], v27 offset:36864
    ds_read_b128 v[60:63], v27 offset:38912
    v_lshlrev_b32 v44, 16, v40
    v_and_b32 v45, 0xffff0000, v40
    v_lshlrev_b32 v46, 16, v41
    v_and_b32 v47, 0xffff0000, v41
    s_waitcnt lgkmcnt(0)
    v_add_f32 v48, v48, v52
    v_add_f32 v56, v56, v60
    v_add_f32 v48, v48, v56
    v_fmac_f32 v44, v48, v18
    v_add_f32 v49, v49, v53
    v_add_f32 v57, v57, v61
    v_add_f32 v49, v49, v57
    v_fmac_f32 v45, v49, v19
    v_add_f32 v50, v50, v54
    v_add_f32 v58, v58, v62
    v_add_f32 v50, v50, v58
    v_fmac_f32 v46, v50, v20
    v_add_f32 v51, v51, v55
    v_add_f32 v59, v59, v63
    v_add_f32 v51, v51, v59
    v_fmac_f32 v47, v51, v21
    v_cvt_pk_bf16_f32 v44, v44, v45
    v_cvt_pk_bf16_f32 v45, v46, v47
    buffer_store_dwordx2 v[44:45], v26, s[52:55], s30 offen
H_next_any:
    s_cmp_eq_u32 s27, 0
    s_cselect_b32 s25, 1, 7
    s_add_u32 s27, s27, s25
    s_cmp_lt_u32 s27, 64
    s_cbranch_scc1 H_seg_any
    s_branch L_done
H_y_any:
    s_lshl_b32 s27, s21, 1
    s_add_u32 s27, s27, s22
    s_sub_u32 s27, s27, 30
    s_lshl_b32 s29, s27, 2
    s_add_u32 s29, s29, s20
    s_mul_i32 s29, s29, 114688
    s_add_u32 s29, s29, 6422528
    buffer_load_dwordx4 a[0:3], v2, s[8:11], s29 offen offset:0
    buffer_load_dwordx4 a[4:7], v2, s[8:11], s29 offen offset:1024
    buffer_load_dwordx4 a[8:11], v2, s[8:11], s29 offen offset:2048
    buffer_load_dwordx4 a[12:15], v2, s[8:11], s29 offen offset:3072
    s_add_u32 s29, s29, 4096
    buffer_load_dwordx4 a[16:19], v2, s[8:11], s29 offen offset:0
    buffer_load_dwordx4 a[20:23], v2, s[8:11], s29 offen offset:1024
    buffer_load_dwordx4 a[24:27], v2, s[8:11], s29 offen offset:2048
    buffer_load_dwordx4 a[28:31], v2, s[8:11], s29 offen offset:3072
    s_add_u32 s29, s29, 4096
    buffer_load_dwordx4 a[32:35], v2, s[8:11], s29 offen offset:0
    buffer_load_dwordx4 a[36:39], v2, s[8:11], s29 offen offset:1024
    buffer_load_dwordx4 a[40:43], v2, s[8:11], s29 offen offset:2048
    buffer_load_dwordx4 a[44:47], v2, s[8:11], s29 offen offset:3072
    s_add_u32 s29, s29, 4096
    buffer_load_dwordx4 a[48:51], v2, s[8:11], s29 offen offset:0
    buffer_load_dwordx4 a[52:55], v2, s[8:11], s29 offen offset:1024
    buffer_load_dwordx4 a[56:59], v2, s[8:11], s29 offen offset:2048
    buffer_load_dwordx4 a[60:63], v2, s[8:11], s29 offen offset:3072
    s_add_u32 s29, s29, 4096
    buffer_load_dwordx4 a[64:67], v2, s[8:11], s29 offen offset:0
    buffer_load_dwordx4 a[68:71], v2, s[8:11], s29 offen offset:1024
    buffer_load_dwordx4 a[72:75], v2, s[8:11], s29 offen offset:2048
    buffer_load_dwordx4 a[76:79], v2, s[8:11], s29 offen offset:3072
    s_add_u32 s29, s29, 4096
    buffer_load_dwordx4 a[80:83], v2, s[8:11], s29 offen offset:0
    buffer_load_dwordx4 a[84:87], v2, s[8:11], s29 offen offset:1024
    buffer_load_dwordx4 a[88:91], v2, s[8:11], s29 offen offset:2048
    buffer_load_dwordx4 a[92:95], v2, s[8:11], s29 offen offset:3072
    s_add_u32 s29, s29, 4096
    buffer_load_dwordx4 a[96:99], v2, s[8:11], s29 offen offset:0
    buffer_load_dwordx4 a[100:103], v2, s[8:11], s29 offen offset:1024
    buffer_load_dwordx4 a[104:107], v2, s[8:11], s29 offen offset:2048
    buffer_load_dwordx4 a[108:111], v2, s[8:11], s29 offen offset:3072
    s_add_u32 s29, s29, 4096
    buffer_load_dwordx4 a[112:115], v2, s[8:11], s29 offen offset:0
    buffer_load_dwordx4 a[116:119], v2, s[8:11], s29 offen offset:1024
    buffer_load_dwordx4 a[120:123], v2, s[8:11], s29 offen offset:2048
    buffer_load_dwordx4 a[124:127], v2, s[8:11], s29 offen offset:3072
    s_add_u32 s29, s29, 4096
    buffer_load_dwordx4 a[128:131], v2, s[8:11], s29 offen offset:0
    buffer_load_dwordx4 a[132:135], v2, s[8:11], s29 offen offset:1024
    buffer_load_dwordx4 a[136:139], v2, s[8:11], s29 offen offset:2048
    buffer_load_dwordx4 a[140:143], v2, s[8:11], s29 offen offset:3072
    s_add_u32 s29, s29, 4096
    buffer_load_dwordx4 a[144:147], v2, s[8:11], s29 offen offset:0
    buffer_load_dwordx4 a[148:151], v2, s[8:11], s29 offen offset:1024
    buffer_load_dwordx4 a[152:155], v2, s[8:11], s29 offen offset:2048
    buffer_load_dwordx4 a[156:159], v2, s[8:11], s29 offen offset:3072
    s_add_u32 s29, s29, 4096
    buffer_load_dwordx4 a[160:163], v2, s[8:11], s29 offen offset:0
    buffer_load_dwordx4 a[164:167], v2, s[8:11], s29 offen offset:1024
    buffer_load_dwordx4 a[168:171], v2, s[8:11], s29 offen offset:2048
    buffer_load_dwordx4 a[172:175], v2, s[8:11], s29 offen offset:3072
    s_add_u32 s29, s29, 4096
    buffer_load_dwordx4 a[176:179], v2, s[8:11], s29 offen offset:0
    buffer_load_dwordx4 a[180:183], v2, s[8:11], s29 offen offset:1024
    buffer_load_dwordx4 a[184:187], v2, s[8:11], s29 offen offset:2048
    buffer_load_dwordx4 a[188:191], v2, s[8:11], s29 offen offset:3072
    s_add_u32 s29, s29, 4096
    buffer_load_dwordx4 a[192:195], v2, s[8:11], s29 offen offset:0
    buffer_load_dwordx4 a[196:199], v2, s[8:11], s29 offen offset:1024
    buffer_load_dwordx4 a[200:203], v2, s[8:11], s29 offen offset:2048
    buffer_load_dwordx4 a[204:207], v2, s[8:11], s29 offen offset:3072
    s_add_u32 s29, s29, 4096
    buffer_load_dwordx4 a[208:211], v2, s[8:11], s29 offen offset:0
    buffer_load_dwordx4 a[212:215], v2, s[8:11], s29 offen offset:1024
    buffer_load_dwordx4 a[216:219], v2, s[8:11], s29 offen offset:2048
    buffer_load_dwordx4 a[220:223], v2, s[8:11], s29 offen offset:3072
    s_add_u32 s29, s29, 4096
    buffer_load_dwordx4 a[224:227], v2, s[8:11], s29 offen offset:0
    buffer_load_dwordx4 a[228:231], v2, s[8:11], s29 offen offset:1024
    buffer_load_dwordx4 a[232:235], v2, s[8:11], s29 offen offset:2048
    buffer_load_dwordx4 a[236:239], v2, s[8:11], s29 offen offset:3072
    s_add_u32 s29, s29, 4096
    buffer_load_dwordx4 a[240:243], v2, s[8:11], s29 offen offset:0
    buffer_load_dwordx4 a[244:247], v2, s[8:11], s29 offen offset:1024
    buffer_load_dwordx4 a[248:251], v2, s[8:11], s29 offen offset:2048
    buffer_load_dwordx4 a[252:255], v2, s[8:11], s29 offen offset:3072
    s_add_u32 s29, s29, 4096
    buffer_load_dwordx4 v[64:67], v2, s[8:11], s29 offen offset:0
    buffer_load_dwordx4 v[68:71], v2, s[8:11], s29 offen offset:1024
    buffer_load_dwordx4 v[72:75], v2, s[8:11], s29 offen offset:2048
    buffer_load_dwordx4 v[76:79], v2, s[8:11], s29 offen offset:3072
    s_add_u32 s29, s29, 4096
    buffer_load_dwordx4 v[80:83], v2, s[8:11], s29 offen offset:0
    buffer_load_dwordx4 v[84:87], v2, s[8:11], s29 offen offset:1024
    buffer_load_dwordx4 v[88:91], v2, s[8:11], s29 offen offset:2048
    buffer_load_dwordx4 v[92:95], v2, s[8:11], s29 offen offset:3072
    s_add_u32 s29, s29, 4096
    buffer_load_dwordx4 v[96:99], v2, s[8:11], s29 offen offset:0
    buffer_load_dwordx4 v[100:103], v2, s[8:11], s29 offen offset:1024
    buffer_load_dwordx4 v[104:107], v2, s[8:11], s29 offen offset:2048
    buffer_load_dwordx4 v[108:111], v2, s[8:11], s29 offen offset:3072
    s_add_u32 s29, s29, 4096
    buffer_load_dwordx4 v[112:115], v2, s[8:11], s29 offen offset:0
    buffer_load_dwordx4 v[116:119], v2, s[8:11], s29 offen offset:1024
    buffer_load_dwordx4 v[120:123], v2, s[8:11], s29 offen offset:2048
    buffer_load_dwordx4 v[124:127], v2, s[8:11], s29 offen offset:3072
    s_add_u32 s29, s29, 4096
    buffer_load_dwordx4 v[128:131], v2, s[8:11], s29 offen offset:0
    buffer_load_dwordx4 v[132:135], v2, s[8:11], s29 offen offset:1024
    buffer_load_dwordx4 v[136:139], v2, s[8:11], s29 offen offset:2048
    buffer_load_dwordx4 v[140:143], v2, s[8:11], s29 offen offset:3072
    s_add_u32 s29, s29, 4096
    buffer_load_dwordx4 v[144:147], v2, s[8:11], s29 offen offset:0
    buffer_load_dwordx4 v[148:151], v2, s[8:11], s29 offen offset:1024
    buffer_load_dwordx4 v[152:155], v2, s[8:11], s29 offen offset:2048
    buffer_load_dwordx4 v[156:159], v2, s[8:11], s29 offen offset:3072
    s_add_u32 s29, s29, 4096
    buffer_load_dwordx4 v[160:163], v2, s[8:11], s29 offen offset:0
    buffer_load_dwordx4 v[164:167], v2, s[8:11], s29 offen offset:1024
    buffer_load_dwordx4 v[168:171], v2, s[8:11], s29 offen offset:2048
    buffer_load_dwordx4 v[172:175], v2, s[8:11], s29 offen offset:3072
    s_add_u32 s29, s29, 4096
    buffer_load_dwordx4 v[176:179], v2, s[8:11], s29 offen offset:0
    buffer_load_dwordx4 v[180:183], v2, s[8:11], s29 offen offset:1024
    buffer_load_dwordx4 v[184:187], v2, s[8:11], s29 offen offset:2048
    buffer_load_dwordx4 v[188:191], v2, s[8:11], s29 offen offset:3072
    s_add_u32 s29, s29, 4096
    buffer_load_dwordx4 v[192:195], v2, s[8:11], s29 offen offset:0
    buffer_load_dwordx4 v[196:199], v2, s[8:11], s29 offen offset:1024
    buffer_load_dwordx4 v[200:203], v2, s[8:11], s29 offen offset:2048
    buffer_load_dwordx4 v[204:207], v2, s[8:11], s29 offen offset:3072
    s_add_u32 s29, s29, 4096
    buffer_load_dwordx4 v[208:211], v2, s[8:11], s29 offen offset:0
    buffer_load_dwordx4 v[212:215], v2, s[8:11], s29 offen offset:1024
    buffer_load_dwordx4 v[216:219], v2, s[8:11], s29 offen offset:2048
    buffer_load_dwordx4 v[220:223], v2, s[8:11], s29 offen offset:3072
    s_add_u32 s29, s29, 4096
    buffer_load_dwordx4 v[224:227], v2, s[8:11], s29 offen offset:0
    buffer_load_dwordx4 v[228:231], v2, s[8:11], s29 offen offset:1024
    buffer_load_dwordx4 v[232:235], v2, s[8:11], s29 offen offset:2048
    buffer_load_dwordx4 v[236:239], v2, s[8:11], s29 offen offset:3072
    s_add_u32 s29, s29, 4096
    buffer_load_dwordx4 v[240:243], v2, s[8:11], s29 offen offset:0
    buffer_load_dwordx4 v[244:247], v2, s[8:11], s29 offen offset:1024
    buffer_load_dwordx4 v[248:251], v2, s[8:11], s29 offen offset:2048
    buffer_load_dwordx4 v[252:255], v2, s[8:11], s29 offen offset:3072
    s_add_u32 s29, s29, 4096
    v_mov_b32 v5, 0x4444
    v_mov_b32 v6, 0xeeee
    v_and_b32 v7, 2, v1
    v_cmp_ne_u32 vcc, 0, v7
    s_nop 1
    v_cndmask_b32 v4, v5, v6, vcc
    s_lshl_b32 s34, s27, 13
    s_and_b32 s29, s20, 1
    s_lshl_b32 s29, s29, 12
    s_add_u32 s34, s34, s29
    s_lshr_b32 s29, s20, 1
    s_lshl_b32 s29, s29, 11
    s_add_u32 s34, s34, s29
    s_add_u32 s34, s34, 47023104
    s_lshl_b32 s28, s27, 8
    s_add_u32 s28, s28, 46090240
    s_mov_b32 s35, 45547520
    s_mov_b32 s36, 45551616
    s_mov_b32 s27, 0
    v_mov_b64 v[36:37], 0
    v_mov_b64 v[38:39], 0
    v_mov_b64 v[40:41], 0
    v_mov_b64 v[42:43], 0
    v_mov_b64 v[44:45], 0
    v_mov_b64 v[46:47], 0
    v_mov_b64 v[56:57], 0
    v_mov_b64 v[58:59], 0
    s_lshl_b32 s29, s20, 5
    s_add_u32 s28, s28, s29
H_y_seg_any:
    s_mov_b32 s33, 400000
H_y_m_any:
    buffer_load_dwordx4 v[8:11], v2, s[8:11], s35 offen offset:0 sc1
    buffer_load_dwordx4 v[12:15], v2, s[8:11], s35 offen offset:1024 sc1
    buffer_load_dwordx4 v[16:19], v2, s[8:11], s35 offen offset:2048 sc1
    buffer_load_dwordx4 v[20:23], v2, s[8:11], s35 offen offset:3072 sc1
    buffer_load_dwordx4 v[24:27], v2, s[8:11], s36 offen offset:0 sc1
    buffer_load_dwordx4 v[28:31], v2, s[8:11], s36 offen offset:1024 sc1
    buffer_load_dwordx4 v[32:35], v2, s[8:11], s36 offen offset:2048 sc1
    s_waitcnt vmcnt(0)
    s_cmp_lg_u32 s33, 400000
    s_cbranch_scc1 H_y_nf_any
    s_mov_b64 exec, 3
    buffer_store_dwordx4 v[56:59], v2, s[8:11], s28 offen sc1
    s_mov_b64 exec, -1
H_y_nf_any:
    v_max3_u32 v5, v8, v9, v10
    v_max3_u32 v5, v5, v11, v12
    v_max3_u32 v5, v5, v13, v14
    v_max3_u32 v5, v5, v15, v16
    v_max3_u32 v5, v5, v17, v18
    v_max3_u32 v5, v5, v19, v20
    v_max3_u32 v5, v5, v21, v22
    v_max3_u32 v5, v5, v23, v24
    v_max3_u32 v5, v5, v25, v26
    v_max3_u32 v5, v5, v27, v28
    v_max3_u32 v5, v5, v29, v30
    v_max3_u32 v5, v5, v31, v32
    v_max3_u32 v5, v5, v33, v34
    v_max_u32 v5, v5, v35
    v_cmp_eq_u32 vcc, -1, v5
    s_cbranch_vccz H_y_go_any
    s_sleep 2
    s_sub_u32 s33, s33, 1
    s_cbranch_scc0 H_y_m_any
    s_branch L_fail
H_y_go_any:
    v_smfmac_f32_16x16x64_bf16 v[36:39], v[8:11], a[0:7], v4
    v_smfmac_f32_16x16x64_bf16 v[36:39], v[12:15], a[8:15], v4
    v_smfmac_f32_16x16x64_bf16 v[36:39], v[16:19], a[16:23], v4
    v_smfmac_f32_16x16x64_bf16 v[36:39], v[20:23], a[24:31], v4
    v_smfmac_f32_16x16x64_bf16 v[36:39], v[24:27], a[32:39], v4
    v_smfmac_f32_16x16x64_bf16 v[36:39], v[28:31], a[40:47], v4
    v_smfmac_f32_16x16x64_bf16 v[36:39], v[32:35], a[48:55], v4
    v_smfmac_f32_16x16x64_bf16 v[40:43], v[8:11], a[56:63], v4
    v_smfmac_f32_16x16x64_bf16 v[40:43], v[12:15], a[64:71], v4
    v_smfmac_f32_16x16x64_bf16 v[40:43], v[16:19], a[72:79], v4
    v_add_f32_e64 v36, v36, v38
    v_smfmac_f32_16x16x64_bf16 v[40:43], v[20:23], a[80:87], v4
    v_add_f32_e64 v37, v37, v39
    v_smfmac_f32_16x16x64_bf16 v[40:43], v[24:27], a[88:95], v4
    v_cvt_pk_bf16_f32 v48, v36, v37
    v_smfmac_f32_16x16x64_bf16 v[40:43], v[28:31], a[96:103], v4
    v_mov_b64_e64 v[36:37], 0
    v_smfmac_f32_16x16x64_bf16 v[40:43], v[32:35], a[104:111], v4
    v_mov_b64_e64 v[38:39], 0
    v_smfmac_f32_16x16x64_bf16 v[44:47], v[8:11], a[112:119], v4
    v_smfmac_f32_16x16x64_bf16 v[44:47], v[12:15], a[120:127], v4
    v_smfmac_f32_16x16x64_bf16 v[44:47], v[16:19], a[128:135], v4
    v_add_f32_e64 v40, v40, v42
    v_smfmac_f32_16x16x64_bf16 v[44:47], v[20:23], a[136:143], v4
    v_add_f32_e64 v41, v41, v43
    v_smfmac_f32_16x16x64_bf16 v[44:47], v[24:27], a[144:151], v4
    v_cvt_pk_bf16_f32 v49, v40, v41
    v_smfmac_f32_16x16x64_bf16 v[44:47], v[28:31], a[152:159], v4
    v_mov_b64_e64 v[40:41], 0
    v_smfmac_f32_16x16x64_bf16 v[44:47], v[32:35], a[160:167], v4
    v_mov_b64_e64 v[42:43], 0
    v_smfmac_f32_16x16x64_bf16 v[36:39], v[8:11], a[168:175], v4
    v_smfmac_f32_16x16x64_bf16 v[36:39], v[12:15], a[176:183], v4
    v_smfmac_f32_16x16x64_bf16 v[36:39], v[16:19], a[184:191], v4
    v_add_f32_e64 v44, v44, v46
    v_smfmac_f32_16x16x64_bf16 v[36:39], v[20:23], a[192:199], v4
    v_add_f32_e64 v45, v45, v47
    v_smfmac_f32_16x16x64_bf16 v[36:39], v[24:27], a[200:207], v4
    v_cvt_pk_bf16_f32 v50, v44, v45
    v_smfmac_f32_16x16x64_bf16 v[36:39], v[28:31], a[208:215], v4
    v_mov_b64_e64 v[44:45], 0
    v_smfmac_f32_16x16x64_bf16 v[36:39], v[32:35], a[216:223], v4
    v_mov_b64_e64 v[46:47], 0
    v_smfmac_f32_16x16x64_bf16 v[40:43], v[8:11], a[224:231], v4
    v_smfmac_f32_16x16x64_bf16 v[40:43], v[12:15], a[232:239], v4
    v_smfmac_f32_16x16x64_bf16 v[40:43], v[16:19], a[240:247], v4
    v_add_f32_e64 v36, v36, v38
    v_smfmac_f32_16x16x64_bf16 v[40:43], v[20:23], a[248:255], v4
    v_add_f32_e64 v37, v37, v39
    v_smfmac_f32_16x16x64_bf16 v[40:43], v[24:27], v[64:71], v4
    v_cvt_pk_bf16_f32 v51, v36, v37
    v_smfmac_f32_16x16x64_bf16 v[40:43], v[28:31], v[72:79], v4
    v_mov_b64_e64 v[36:37], 0
    v_smfmac_f32_16x16x64_bf16 v[40:43], v[32:35], v[80:87], v4
    v_mov_b64_e64 v[38:39], 0
    v_smfmac_f32_16x16x64_bf16 v[44:47], v[8:11], v[88:95], v4
    v_smfmac_f32_16x16x64_bf16 v[44:47], v[12:15], v[96:103], v4
    v_smfmac_f32_16x16x64_bf16 v[44:47], v[16:19], v[104:111], v4
    v_add_f32_e64 v40, v40, v42
    v_smfmac_f32_16x16x64_bf16 v[44:47], v[20:23], v[112:119], v4
    v_add_f32_e64 v41, v41, v43
    v_smfmac_f32_16x16x64_bf16 v[44:47], v[24:27], v[120:127], v4
    v_cvt_pk_bf16_f32 v52, v40, v41
    v_smfmac_f32_16x16x64_bf16 v[44:47], v[28:31], v[128:135], v4
    v_mov_b64_e64 v[40:41], 0
    v_smfmac_f32_16x16x64_bf16 v[44:47], v[32:35], v[136:143], v4
    v_mov_b64_e64 v[42:43], 0
    v_smfmac_f32_16x16x64_bf16 v[36:39], v[8:11], v[144:151], v4
    v_smfmac_f32_16x16x64_bf16 v[36:39], v[12:15], v[152:159], v4
    v_smfmac_f32_16x16x64_bf16 v[36:39], v[16:19], v[160:167], v4
    v_add_f32_e64 v44, v44, v46
    v_smfmac_f32_16x16x64_bf16 v[36:39], v[20:23], v[168:175], v4
    v_add_f32_e64 v45, v45, v47
    v_smfmac_f32_16x16x64_bf16 v[36:39], v[24:27], v[176:183], v4
    v_cvt_pk_bf16_f32 v53, v44, v45
    v_smfmac_f32_16x16x64_bf16 v[36:39], v[28:31], v[184:191], v4
    v_mov_b64_e64 v[44:45], 0
    v_smfmac_f32_16x16x64_bf16 v[36:39], v[32:35], v[192:199], v4
    v_mov_b64_e64 v[46:47], 0
    v_smfmac_f32_16x16x64_bf16 v[40:43], v[8:11], v[200:207], v4
    v_smfmac_f32_16x16x64_bf16 v[40:43], v[12:15], v[208:215], v4
    v_smfmac_f32_16x16x64_bf16 v[40:43], v[16:19], v[216:223], v4
    v_add_f32_e64 v36, v36, v38
    v_smfmac_f32_16x16x64_bf16 v[40:43], v[20:23], v[224:231], v4
    v_add_f32_e64 v37, v37, v39
    v_smfmac_f32_16x16x64_bf16 v[40:43], v[24:27], v[232:239], v4
    v_cvt_pk_bf16_f32 v54, v36, v37
    v_smfmac_f32_16x16x64_bf16 v[40:43], v[28:31], v[240:247], v4
    v_mov_b64_e64 v[36:37], 0
    v_smfmac_f32_16x16x64_bf16 v[40:43], v[32:35], v[248:255], v4
    v_mov_b64_e64 v[38:39], 0
    s_nop 7
    v_add_f32 v40, v40, v42
    v_add_f32 v41, v41, v43
    v_cvt_pk_bf16_f32 v55, v40, v41
    v_mov_b64 v[40:41], 0
    v_mov_b64 v[42:43], 0
    buffer_store_dwordx4 v[48:51], v2, s[8:11], s34 offen offset:0 sc1
    buffer_store_dwordx4 v[52:55], v2, s[8:11], s34 offen offset:1024 sc1
    s_add_u32 s35, s35, 8192
    s_add_u32 s36, s36, 8192
    s_add_u32 s34, s34, 114688
    s_add_u32 s28, s28, 11264
    s_add_u32 s27, s27, 1
    s_cmp_lt_u32 s27, 63
    s_cbranch_scc1 H_y_seg_any
    s_waitcnt vmcnt(0)
    s_mov_b64 exec, 3
    buffer_store_dwordx4 v[56:59], v2, s[8:11], s28 offen sc1
    s_mov_b64 exec, -1
    s_branch L_done
L_fail:
    v_mov_b32 v3, 0xdead
    v_mov_b32 v4, 124
    buffer_store_dword v3, v4, s[12:15], 0 offen
L_done:
L_exit:
    s_endpgm
.section .rodata,"a"
.p2align 6
.amdhsa_kernel adaLN_cond__memory_aug_recurrent_mem_tr__dense_activation_mish__prompt_kernel
  .amdhsa_next_free_vgpr 512
  .amdhsa_next_free_sgpr 102
  .amdhsa_accum_offset 256
  .amdhsa_group_segment_fixed_size 0
  .amdhsa_kernarg_size 128
  .amdhsa_user_sgpr_count 2
  .amdhsa_user_sgpr_kernarg_segment_ptr 1
  .amdhsa_system_sgpr_workgroup_id_x 1
  .amdhsa_float_denorm_mode_32 3
.end_amdhsa_kernel
```
